```python
import torch

def _softmax(x, axis=-1):
    return torch.softmax(x, dim=axis)
def _gelu(x):
    return torch.nn.functional.gelu(x, approximate="tanh")
def _silu(x):
    return torch.nn.functional.silu(x)
def _sigmoid(x):
    return torch.sigmoid(x)
def _layernorm(x, axis=-1, eps=1e-5):
    m = x.mean(dim=axis, keepdim=True)
    v = x.var(dim=axis, keepdim=True, unbiased=False)
    return (x - m) / torch.sqrt(v + eps)
def _scatter_add(tgt, idx, src, axis=0):
    return tgt.clone().index_add_(axis, idx, src)
def _segment_sum(src, seg, n):
    out = torch.zeros((n,) + src.shape[1:], dtype=src.dtype)
    return out.index_add_(0, seg, src)
def _pad(x, pw):
    flat = tuple(v for pair in reversed(pw) for v in pair)
    return torch.nn.functional.pad(x, flat)

kernel_name = 'sequential_preLN__compressed_kv_cla__geglu_ffn__prompt'

def setup_inputs():

    _w = (lambda a: (lambda t: t.to(torch.bfloat16) if t.is_floating_point() else t)(torch.as_tensor(a)))
    def _A_setup():
        B, H, Sq, Sk, D, M = 1, 32, 2048, 2048, 128, 512
        Dc = 4 * D
        return {
            "x": _w((lambda *s: torch.randn(*s, dtype=torch.bfloat16) * 0.05)(B, Sq, M)),
            "c_kv": _w((lambda *s: torch.randn(*s, dtype=torch.bfloat16) * 0.4)(B, Sk, Dc)),
            "w_q": _w((lambda *s: torch.randn(*s, dtype=torch.bfloat16) * 1.6)(M, H, D) * (M ** -0.5)),
            "w_uk": _w((lambda *s: torch.randn(*s, dtype=torch.bfloat16) * 1.6)(Dc, H, D) * (Dc ** -0.5)),
            "w_uv": _w((lambda *s: torch.randn(*s, dtype=torch.bfloat16) * 0.4)(Dc, H, D) * (Dc ** -0.5)),
            "w_o": _w((lambda *s: torch.randn(*s, dtype=torch.bfloat16) * 0.4)(H, D, M) * ((H * D) ** -0.5)),
        }
    _A_in = _A_setup()

    def _B_setup():
        B, S, D, F = 1, 2048, 512, 1792
        return {
            "x": _w((lambda *s: torch.randn(*s, dtype=torch.bfloat16) * 0.05)(B, S, D)),
            "w_gate": _w((lambda *s: torch.randn(*s, dtype=torch.bfloat16) * 0.05)(D, F)),
            "w_up": _w((lambda *s: torch.randn(*s, dtype=torch.bfloat16) * 0.05)(D, F)),
            "w_down": _w((lambda *s: torch.randn(*s, dtype=torch.bfloat16) * 0.05)(F, D)),
        }
    _B_in = _B_setup()

    return {
        "A_x": _A_in["x"],
        "A_c_kv": _A_in["c_kv"],
        "A_w_q": _A_in["w_q"],
        "A_w_uk": _A_in["w_uk"],
        "A_w_uv": _A_in["w_uv"],
        "A_w_o": _A_in["w_o"],
        "B_x": _B_in["x"],
        "B_w_gate": _B_in["w_gate"],
        "B_w_up": _B_in["w_up"],
        "B_w_down": _B_in["w_down"],
    }

def reference(A_x, A_c_kv, A_w_q, A_w_uk, A_w_uv, A_w_o, B_x, B_w_gate, B_w_up, B_w_down):
    def _A_ref(x, c_kv, w_q, w_uk, w_uv, w_o):
        B, Sq, M = x.shape[0], x.shape[1], x.shape[2]
        Sk = c_kv.shape[1]
        H, D = w_q.shape[1], w_q.shape[2]
        q = torch.einsum("bqm,mhd->bhqd", x, w_q)
        k = torch.einsum("bkc,chd->bhkd", c_kv, w_uk)
        v = torch.einsum("bkc,chd->bhkd", c_kv, w_uv)
        scores = torch.einsum("bhqd,bhkd->bhqk", q, k) * (D ** -0.5)
        off = Sk - Sq
        qi = torch.arange(Sq)[:, None]
        kj = torch.arange(Sk)[None, :]
        cmask = kj <= (qi + off)
        scores = torch.where(cmask[None, None], scores, -1e9)
        p = _softmax(scores, axis=-1)
        ctx = torch.einsum("bhqk,bhkd->bhqd", p, v)
        return torch.einsum("bhqd,hdm->bqm", ctx, w_o)

    def _B_ref(x, w_gate, w_up, w_down):
        return (_gelu(x @ w_gate) * (x @ w_up)) @ w_down

    x = A_x
    h = x + _A_ref(_layernorm(x, axis=-1), A_c_kv, A_w_q, A_w_uk, A_w_uv, A_w_o)
    h2 = h + _B_ref(_layernorm(h, axis=-1), B_w_gate, B_w_up, B_w_down)
    return h2
```

```asm
; @launch grid=(256,1,1) block=(256,1,1) lds=163840
.amdgcn_target "amdgcn-amd-amdhsa--gfx950"
.text
.globl sequential_preLN__compressed_kv_cla__geglu_ffn__prompt_kernel
.p2align 8
.type sequential_preLN__compressed_kv_cla__geglu_ffn__prompt_kernel,@function
sequential_preLN__compressed_kv_cla__geglu_ffn__prompt_kernel:
    s_cmp_ge_u32 s2, 256
    s_cbranch_scc1 L_end_sequential_preLN__compressed_kv_cla__geglu_ffn__prompt_kernel
    s_load_dwordx4 s[40:43], s[0:1], 0
    s_load_dwordx4 s[60:63], s[0:1], 16
    s_load_dwordx4 s[4:7], s[0:1], 88
    s_load_dwordx4 s[64:67], s[0:1], 32
    s_load_dwordx4 s[44:47], s[0:1], 56
    s_load_dwordx2 s[52:53], s[0:1], 72
    v_lshrrev_b32 v70, 6, v0
    v_and_b32 v71, 63, v0
    v_mov_b32 v69, v0
    v_readfirstlane_b32 s71, v70
    s_getpc_b64 s[8:9]
L_pcc_sequential_preLN__compressed_kv_cla__geglu_ffn__prompt_kernel:
    s_lshr_b32 s3, s2, 3
    s_mul_i32 s3, s3, 24
    v_min_u32 v68, 5, v71
    v_mad_u32_u24 v68, v70, 6, v68
    v_add_u32 v68, s3, v68
    v_lshlrev_b32 v68, 7, v68
    v_min_u32 v68, L_codeend_sequential_preLN__compressed_kv_cla__geglu_ffn__prompt_kernel-L_pcc_sequential_preLN__compressed_kv_cla__geglu_ffn__prompt_kernel-4, v68
    global_load_dword v159, v68, s[8:9]
    v_lshlrev_b32 v224, 4, v71
    v_lshrrev_b32 v72, 3, v71
    v_lshrrev_b32 v73, 4, v71
    v_and_b32 v74, 7, v71
    v_and_b32 v80, 15, v71
    v_and_b32 v82, 1, v71
    v_lshlrev_b32 v75, 10, v72
    v_lshl_add_u32 v75, v74, 4, v75
    v_lshl_add_u32 v75, v70, 8, v75
    v_add_u32 v76, 0, v73
    v_lshrrev_b32 v77, 1, v80
    v_xor_b32 v76, v76, v77
    v_lshl_add_u32 v76, v76, 1, v82
    v_lshlrev_b32 v76, 4, v76
    v_lshl_add_u32 v76, v73, 13, v76
    v_add_u32 v226, 0, v76
    v_add_u32 v227, 31744, v76
    v_add_u32 v76, 4, v73
    v_lshrrev_b32 v77, 1, v80
    v_xor_b32 v76, v76, v77
    v_lshl_add_u32 v76, v76, 1, v82
    v_lshlrev_b32 v76, 4, v76
    v_lshl_add_u32 v76, v73, 13, v76
    v_add_u32 v238, 63488, v76
    v_add_u32 v239, 95232, v76
    v_add_u32 v76, 0, v73
    v_xor_b32 v76, v76, v74
    v_lshlrev_b32 v76, 4, v76
    v_lshl_add_u32 v76, v72, 10, v76
    v_add_u32 v230, 0, v76
    v_add_u32 v223, 14336, v76
    v_add_u32 v76, 4, v73
    v_xor_b32 v76, v76, v74
    v_lshlrev_b32 v76, 4, v76
    v_lshl_add_u32 v76, v72, 10, v76
    v_add_u32 v231, 7168, v76
    v_add_u32 v252, 21504, v76
    s_and_b32 s68, s2, 7
    s_lshr_b32 s69, s2, 3
    s_and_b32 s70, s69, 3
    s_lshl_b32 s68, s68, 2
    s_add_u32 s75, s68, s70
    s_lshr_b32 s74, s69, 2
    s_mov_b32 s80, s75
    s_mov_b32 s81, s74
    s_and_b32 s82, s2, 7
    s_lshl_b32 s72, s2, 13
    s_lshl_b32 s70, s81, 2
    s_add_u32 s70, s70, s71
    s_waitcnt lgkmcnt(0)
    s_mov_b32 s32, s40
    s_and_b32 s33, s41, 0xffff
    s_mov_b32 s34, 0x200000
    s_mov_b32 s35, 0x20000
    s_mov_b32 s8, s6
    s_and_b32 s9, s7, 0xffff
    s_mov_b32 s10, 0x6000000
    s_mov_b32 s11, 0x20000
    s_cmp_lg_u32 s2, 0
    s_cbranch_scc1 L_notag0_sequential_preLN__compressed_kv_cla__geglu_ffn__prompt_kernel
    s_cmp_lg_u32 s71, 0
    s_cbranch_scc1 L_notag0_sequential_preLN__compressed_kv_cla__geglu_ffn__prompt_kernel
    s_mov_b32 s3, 0x4e00000
    v_mov_b32 v157, 0
    buffer_load_dword v158, v157, s[8:11], s3 offen sc1
L_notag0_sequential_preLN__compressed_kv_cla__geglu_ffn__prompt_kernel:
    buffer_load_dwordx4 v[128:131], v75, s[32:35], s72 offen nt
    buffer_load_dwordx4 v[132:135], v75, s[32:35], s72 offen offset:128 nt
    s_mov_b32 s20, s62
    s_and_b32 s21, s63, 0xffff
    s_mov_b32 s22, 0x400000
    s_mov_b32 s23, 0x20000
    s_mov_b32 s16, s42
    s_and_b32 s17, s43, 0xffff
    s_mov_b32 s18, 0x200000
    s_mov_b32 s19, 0x20000
    s_mov_b32 s28, s60
    s_and_b32 s29, s61, 0xffff
    s_mov_b32 s30, 0x400000
    s_mov_b32 s31, 0x20000
    s_mov_b32 s24, s64
    s_and_b32 s25, s65, 0xffff
    s_mov_b32 s26, 0x400000
    s_mov_b32 s27, 0x20000
    s_mov_b32 s42, s66
    s_mov_b32 s43, s67
    s_lshl_b32 s60, s70, 16
    s_lshl_b32 s66, s71, 13
    s_lshl_b32 s67, s71, 12
    s_lshl_b32 s3, s80, 8
    s_lshl_b32 s61, s82, 19
    s_add_u32 s3, s3, s61
    s_lshl_b32 s61, s71, 17
    s_add_u32 s83, s61, s3
    s_lshl_b32 s62, s71, 18
    s_add_u32 s62, s62, s3
    s_lshl_b32 s82, s82, 7
    s_add_u32 s63, s83, 0
    s_add_u32 m0, s67, 98304
    s_and_b32 s63, s63, 0x3fffff
    buffer_load_dwordx4 v226, s[20:23], s63 offen offset:0 nt lds
    buffer_load_dwordx4 v227, s[20:23], s63 offen offset:1024 nt lds
    buffer_load_dwordx4 v238, s[20:23], s63 offen offset:2048 nt lds
    buffer_load_dwordx4 v239, s[20:23], s63 offen offset:3072 nt lds
    s_add_u32 s64, s82, 0
    s_and_b32 s64, s64, 1023
    s_add_u32 m0, s66, 0
    s_add_u32 s64, s64, s60
    buffer_load_dwordx4 v230, s[16:19], s64 offen offset:0 lds
    buffer_load_dwordx4 v231, s[16:19], s64 offen offset:1024 lds
    buffer_load_dwordx4 v223, s[16:19], s64 offen offset:2048 lds
    buffer_load_dwordx4 v252, s[16:19], s64 offen offset:3072 lds
    s_add_u32 m0, s66, 4096
    s_add_u32 s64, s64, 32768
    buffer_load_dwordx4 v230, s[16:19], s64 offen offset:0 lds
    buffer_load_dwordx4 v231, s[16:19], s64 offen offset:1024 lds
    buffer_load_dwordx4 v223, s[16:19], s64 offen offset:2048 lds
    buffer_load_dwordx4 v252, s[16:19], s64 offen offset:3072 lds
    s_mov_b32 s36, s4
    s_and_b32 s37, s5, 0xffff
    s_mov_b32 s38, 0x100
    s_mov_b32 s39, 0x20000
    v_bfe_u32 v77, v71, 1, 2
    v_lshlrev_b32 v77, 13, v77
    v_lshl_add_u32 v174, v82, 7, v77
    s_lshl_b32 s3, s75, 8
    s_add_u32 s61, s61, s3
    s_lshl_b32 s84, s74, 17
    s_lshl_b32 s3, s71, 15
    s_add_u32 s84, s84, s3
    s_lshl_b32 s3, s75, 8
    s_add_u32 s84, s84, s3
    s_lshl_b32 s3, s82, 12
    s_add_u32 s72, s84, s3
    v_bfe_u32 v77, v71, 3, 2
    v_lshl_add_u32 v174, v77, 20, v174
    v_add_u32 v179, s72, v174
    v_and_b32 v179, 0x3fffff, v179
    s_bfe_u32 s3, s2, 0x20003
    s_lshl_b32 s3, s3, 14
    s_add_u32 s59, s3, s60
    v_lshlrev_b32 v173, 10, v80
    s_mul_i32 s3, s75, 1081344
    s_add_u32 s12, s6, s3
    s_addc_u32 s13, s7, 0
    s_and_b32 s13, s13, 0xffff
    s_mul_i32 s4, s74, 67584
    s_sub_u32 s14, 0x108000, s4
    s_mov_b32 s15, 0x20000
    s_mul_i32 s70, s70, 33792
    s_mul_i32 s3, s80, 1081344
    s_add_u32 s65, s3, s70
    v_cmp_eq_u32 vcc, 0, v69
    v_mov_b32 v76, 0x7f000000
    s_nop 0
    v_cndmask_b32 v255, v76, 0, vcc
    s_cmp_lg_u32 s2, 0
    s_cbranch_scc1 L_notag_sequential_preLN__compressed_kv_cla__geglu_ffn__prompt_kernel
    s_cmp_lg_u32 s71, 0
    s_cbranch_scc1 L_notag_sequential_preLN__compressed_kv_cla__geglu_ffn__prompt_kernel
    s_mov_b32 s3, 0x4e00000
    s_mov_b32 s4, 0x9e3779b1
    s_waitcnt vmcnt(14)
    v_mul_lo_u32 v78, v158, s4
    v_add_u32 v78, 0x7f4a7c15, v78
    v_mov_b32 v79, 1
    buffer_store_dword v78, v255, s[8:11], s3 offen sc1
    buffer_store_dwordx2 v[78:79], v255, s[36:39], 0 offen sc1
L_notag_sequential_preLN__compressed_kv_cla__geglu_ffn__prompt_kernel:
    v_and_b32 v76, 1, v73
    v_add_u32 v76, 0, v76
    v_lshrrev_b32 v77, 1, v74
    v_xor_b32 v76, v76, v77
    v_lshl_add_u32 v76, v76, 1, v82
    v_lshlrev_b32 v76, 4, v76
    v_lshl_add_u32 v76, v72, 13, v76
    v_add_u32 v248, 0, v76
    v_add_u32 v250, 129024, v76
    v_and_b32 v76, 1, v73
    v_add_u32 v76, 2, v76
    v_lshrrev_b32 v77, 1, v74
    v_xor_b32 v76, v76, v77
    v_lshl_add_u32 v76, v76, 1, v82
    v_lshlrev_b32 v76, 4, v76
    v_lshl_add_u32 v76, v72, 13, v76
    v_add_u32 v249, 64512, v76
    v_add_u32 v251, 193536, v76
    v_lshrrev_b32 v77, 1, v80
    v_lshlrev_b32 v76, 7, v80
    v_add_u32 v76, s66, v76
    v_add_u32 v79, 0, v73
    v_xor_b32 v79, v79, v77
    v_lshl_add_u32 v232, v79, 4, v76
    v_add_u32 v228, 0x10000, v232
    v_add_u32 v79, 4, v73
    v_xor_b32 v79, v79, v77
    v_lshl_add_u32 v233, v79, 4, v76
    v_add_u32 v229, 0x10000, v233
    v_lshrrev_b32 v81, 2, v80
    v_and_b32 v83, 3, v71
    v_lshlrev_b32 v83, 3, v83
    v_and_b32 v84, 1, v73
    v_lshl_add_u32 v85, v73, 3, v81
    v_lshl_add_u32 v86, v85, 8, v83
    v_add_u32 v86, 98304, v86
    v_lshl_add_u32 v87, v84, 2, v81
    v_xor_b32 v79, 0, v87
    v_lshl_add_u32 v240, v79, 5, v86
    v_xor_b32 v79, 1, v87
    v_lshl_add_u32 v241, v79, 5, v86
    v_xor_b32 v79, 2, v87
    v_lshl_add_u32 v242, v79, 5, v86
    v_xor_b32 v79, 3, v87
    v_lshl_add_u32 v243, v79, 5, v86
    v_xor_b32 v79, 4, v87
    v_lshl_add_u32 v244, v79, 5, v86
    v_xor_b32 v79, 5, v87
    v_lshl_add_u32 v245, v79, 5, v86
    v_xor_b32 v79, 6, v87
    v_lshl_add_u32 v246, v79, 5, v86
    v_xor_b32 v79, 7, v87
    v_lshl_add_u32 v247, v79, 5, v86
    v_lshl_add_u32 v86, v85, 7, v83
    v_add_u32 v86, 65536, v86
    v_lshrrev_b32 v87, 1, v81
    v_lshl_add_u32 v87, v84, 1, v87
    v_xor_b32 v79, 0, v87
    v_lshl_add_u32 v234, v79, 5, v86
    v_xor_b32 v79, 1, v87
    v_lshl_add_u32 v235, v79, 5, v86
    v_xor_b32 v79, 2, v87
    v_lshl_add_u32 v236, v79, 5, v86
    v_xor_b32 v79, 3, v87
    v_lshl_add_u32 v237, v79, 5, v86
    v_and_b32 v79, 0x33, v71
    v_bfe_u32 v85, v71, 2, 1
    v_lshl_add_u32 v79, v85, 3, v79
    v_bfe_u32 v85, v71, 3, 1
    v_lshl_add_u32 v79, v85, 2, v79
    v_lshlrev_b32 v225, 4, v79
    s_and_b32 s3, s2, 1
    s_lshl_b32 s3, s3, 7
    v_lshrrev_b32 v79, 5, v71
    v_and_b32 v85, 3, v72
    v_lshlrev_b32 v85, 8, v85
    v_lshl_add_u32 v85, v79, 11, v85
    v_lshl_add_u32 v85, v74, 4, v85
    v_add_u32 v216, s3, v85
    v_lshlrev_b32 v156, 3, v72
    v_add_u32 v156, 147456, v156
    v_lshl_add_u32 v155, v70, 6, v156
    v_lshl_add_u32 v172, v74, 3, v72
    v_lshlrev_b32 v172, 2, v172
    s_lshl_b32 s3, s74, 7
    s_sub_u32 s4, 1920, s3
    v_mov_b32 v76, s3
    v_mov_b32 v77, s4
    v_cmp_gt_u32 vcc, 32, v71
    v_lshlrev_b32 v85, 2, v80
    s_nop 0
    v_cndmask_b32 v76, v77, v76, vcc
    v_add_u32 v217, v76, v85
    v_lshlrev_b32 v220, 2, v74
    v_mov_b32 v221, 0
    v_and_b32 v222, 31, v71
    v_lshlrev_b32 v79, 3, v79
    v_sub_u32 v222, v222, v79
    s_lshl_b32 s3, s74, 2
    s_add_u32 s4, s3, s71
    s_sub_u32 s3, 60, s3
    s_add_u32 s3, s3, s71
    s_mul_i32 s68, s4, 33792
    s_add_u32 s68, s68, 0x2200000
    s_mul_i32 s69, s3, 33792
    s_add_u32 s69, s69, 0x2200000
    s_lshl_b32 s54, s71, 13
    s_mov_b32 s55, s54
    s_waitcnt vmcnt(12)
    s_add_u32 s63, s83, 524288
    s_add_u32 m0, s67, 114688
    s_and_b32 s63, s63, 0x3fffff
    buffer_load_dwordx4 v226, s[20:23], s63 offen offset:0 nt lds
    buffer_load_dwordx4 v227, s[20:23], s63 offen offset:1024 nt lds
    buffer_load_dwordx4 v238, s[20:23], s63 offen offset:2048 nt lds
    buffer_load_dwordx4 v239, s[20:23], s63 offen offset:3072 nt lds
    v_lshrrev_b32 v77, 3, v71
    v_min_u32 v77, 2, v77
    v_add_u32 v77, 1, v77
    v_and_b32 v78, 0xfffff, v174
    v_lshl_add_u32 v77, v77, 20, v78
    v_add_u32 v77, s72, v77
    v_and_b32 v77, 0x3fffff, v77
    buffer_load_dword v175, v77, s[20:23], 0 offen
    v_lshlrev_b32 v136, 16, v128
    v_and_b32 v137, 0xffff0000, v128
    v_lshlrev_b32 v138, 16, v129
    v_and_b32 v139, 0xffff0000, v129
    v_lshlrev_b32 v140, 16, v130
    v_and_b32 v141, 0xffff0000, v130
    v_lshlrev_b32 v142, 16, v131
    v_and_b32 v143, 0xffff0000, v131
    v_lshlrev_b32 v144, 16, v132
    v_and_b32 v145, 0xffff0000, v132
    v_lshlrev_b32 v146, 16, v133
    v_and_b32 v147, 0xffff0000, v133
    v_lshlrev_b32 v148, 16, v134
    v_and_b32 v149, 0xffff0000, v134
    v_lshlrev_b32 v150, 16, v135
    v_and_b32 v151, 0xffff0000, v135
    v_add_f32 v152, v136, v137
    v_add_f32 v154, v138, v139
    v_add_f32 v152, v152, v140
    v_add_f32 v154, v154, v141
    v_add_f32 v152, v152, v142
    v_add_f32 v154, v154, v143
    v_add_f32 v152, v152, v144
    v_add_f32 v154, v154, v145
    v_add_f32 v152, v152, v146
    v_add_f32 v154, v154, v147
    v_add_f32 v152, v152, v148
    v_add_f32 v154, v154, v149
    v_add_f32 v152, v152, v150
    v_add_f32 v154, v154, v151
    v_add_f32 v152, v152, v154
    s_nop 1
    v_add_f32_dpp v152, v152, v152 quad_perm:[1,0,3,2] row_mask:0xf bank_mask:0xf
    s_nop 1
    v_add_f32_dpp v152, v152, v152 quad_perm:[2,3,0,1] row_mask:0xf bank_mask:0xf
    s_nop 1
    v_add_f32_dpp v152, v152, v152 row_half_mirror row_mask:0xf bank_mask:0xf
    v_mul_f32 v157, 0xbc000000, v152
    v_add_f32 v136, v136, v157
    v_add_f32 v137, v137, v157
    v_add_f32 v138, v138, v157
    v_add_f32 v139, v139, v157
    v_add_f32 v140, v140, v157
    v_add_f32 v141, v141, v157
    v_add_f32 v142, v142, v157
    v_add_f32 v143, v143, v157
    v_add_f32 v144, v144, v157
    v_add_f32 v145, v145, v157
    v_add_f32 v146, v146, v157
    v_add_f32 v147, v147, v157
    v_add_f32 v148, v148, v157
    v_add_f32 v149, v149, v157
    v_add_f32 v150, v150, v157
    v_add_f32 v151, v151, v157
    v_mul_f32 v153, v136, v136
    v_mul_f32 v154, v137, v137
    v_fmac_f32 v153, v138, v138
    v_fmac_f32 v154, v139, v139
    v_fmac_f32 v153, v140, v140
    v_fmac_f32 v154, v141, v141
    v_fmac_f32 v153, v142, v142
    v_fmac_f32 v154, v143, v143
    v_fmac_f32 v153, v144, v144
    v_fmac_f32 v154, v145, v145
    v_fmac_f32 v153, v146, v146
    v_fmac_f32 v154, v147, v147
    v_fmac_f32 v153, v148, v148
    v_fmac_f32 v154, v149, v149
    v_fmac_f32 v153, v150, v150
    v_fmac_f32 v154, v151, v151
    v_add_f32 v153, v153, v154
    s_nop 1
    v_add_f32_dpp v153, v153, v153 quad_perm:[1,0,3,2] row_mask:0xf bank_mask:0xf
    s_nop 1
    v_add_f32_dpp v153, v153, v153 quad_perm:[2,3,0,1] row_mask:0xf bank_mask:0xf
    s_nop 1
    v_add_f32_dpp v153, v153, v153 row_half_mirror row_mask:0xf bank_mask:0xf
    ds_write_b64 v155, v[152:153]
    s_add_u32 s64, s82, 128
    s_and_b32 s64, s64, 1023
    s_add_u32 m0, s66, 32768
    s_add_u32 s64, s64, s60
    buffer_load_dwordx4 v230, s[16:19], s64 offen offset:0 lds
    buffer_load_dwordx4 v231, s[16:19], s64 offen offset:1024 lds
    buffer_load_dwordx4 v223, s[16:19], s64 offen offset:2048 lds
    buffer_load_dwordx4 v252, s[16:19], s64 offen offset:3072 lds
    s_waitcnt vmcnt(13)
    ds_read_b128 a[0:3], v232 offset:0
    ds_read_b128 a[16:19], v233 offset:0
    ds_read_b128 a[4:7], v232 offset:2048
    ds_read_b128 a[20:23], v233 offset:2048
    s_waitcnt vmcnt(9) lgkmcnt(4)
    s_barrier
    ds_read_b64_tr_b16 v[192:193], v240 offset:0
    ds_read_b64_tr_b16 v[194:195], v240 offset:1024
    ds_read_b64_tr_b16 v[196:197], v240 offset:8192
    ds_read_b64_tr_b16 v[198:199], v240 offset:9216
    ds_read_b128 a[8:11], v232 offset:4096
    ds_read_b128 a[24:27], v233 offset:4096
    ds_read_b128 a[12:15], v232 offset:6144
    ds_read_b128 a[28:31], v233 offset:6144
    ds_read_b64_tr_b16 v[200:201], v241 offset:0
    ds_read_b64_tr_b16 v[202:203], v241 offset:1024
    ds_read_b64_tr_b16 v[204:205], v241 offset:8192
    ds_read_b64_tr_b16 v[206:207], v241 offset:9216
    ds_read_b64 v[160:161], v156 offset:0
    ds_read_b64 v[162:163], v156 offset:64
    ds_read_b64 v[164:165], v156 offset:128
    ds_read_b64 v[166:167], v156 offset:192
    s_waitcnt lgkmcnt(12)
    v_mfma_f32_16x16x32_bf16 v[0:3], v[192:195], a[0:3], 0
    ds_read_b64_tr_b16 v[208:209], v242 offset:0
    v_mfma_f32_16x16x32_bf16 v[0:3], v[196:199], a[16:19], v[0:3]
    v_mfma_f32_16x16x32_bf16 v[4:7], v[192:195], a[4:7], 0
    s_lshr_b32 s4, s2, 2
    s_mul_i32 s4, s4, 33792
    ds_read_b64_tr_b16 v[210:211], v242 offset:1024
    v_mfma_f32_16x16x32_bf16 v[4:7], v[196:199], a[20:23], v[4:7]
    s_waitcnt lgkmcnt(10)
    s_bfe_u32 s5, s2, 0x10001
    s_lshl_b32 s5, s5, 10
    v_mfma_f32_16x16x32_bf16 v[8:11], v[192:195], a[8:11], 0
    s_add_u32 m0, s66, 36864
    s_add_u32 s64, s64, 32768
    ds_read_b64_tr_b16 v[212:213], v242 offset:8192
    v_mfma_f32_16x16x32_bf16 v[8:11], v[196:199], a[24:27], v[8:11]
    buffer_load_dwordx4 v230, s[16:19], s64 offen offset:0 lds
    v_mfma_f32_16x16x32_bf16 v[12:15], v[192:195], a[12:15], 0
    s_add_u32 s4, s4, s5
    s_add_u32 s4, s4, s66
    ds_read_b64_tr_b16 v[214:215], v242 offset:9216
    v_mfma_f32_16x16x32_bf16 v[12:15], v[196:199], a[28:31], v[12:15]
    s_waitcnt lgkmcnt(8)
    s_add_u32 s4, s4, 0x2200000
    s_lshr_b32 s5, s2, 4
    v_mfma_f32_16x16x32_bf16 v[16:19], v[200:203], a[0:3], 0
    s_lshl_b32 s5, s5, 7
    s_and_b32 s70, s2, 15
    ds_read_b64_tr_b16 v[192:193], v243 offset:0
    v_mfma_f32_16x16x32_bf16 v[16:19], v[204:207], a[16:19], v[16:19]
    buffer_load_dwordx4 v231, s[16:19], s64 offen offset:1024 lds
    v_mfma_f32_16x16x32_bf16 v[20:23], v[200:203], a[4:7], 0
    s_lshl_b32 s70, s70, 2
    s_add_u32 s5, s5, s70
    ds_read_b64_tr_b16 v[194:195], v243 offset:1024
    v_mfma_f32_16x16x32_bf16 v[20:23], v[204:207], a[20:23], v[20:23]
    s_add_u32 s5, s5, 0x4e01000
    s_waitcnt lgkmcnt(6)
    v_add_f32 v168, v160, v162
    v_mfma_f32_16x16x32_bf16 v[24:27], v[200:203], a[8:11], 0
    ds_read_b64_tr_b16 v[196:197], v243 offset:8192
    v_add_f32 v169, v161, v163
    v_mfma_f32_16x16x32_bf16 v[24:27], v[204:207], a[24:27], v[24:27]
    buffer_load_dwordx4 v223, s[16:19], s64 offen offset:2048 lds
    v_mfma_f32_16x16x32_bf16 v[28:31], v[200:203], a[12:15], 0
    ds_read_b64_tr_b16 v[198:199], v243 offset:9216
    v_add_f32 v170, v164, v166
    v_mfma_f32_16x16x32_bf16 v[28:31], v[204:207], a[28:31], v[28:31]
    s_waitcnt lgkmcnt(4)
    v_add_f32 v171, v165, v167
    v_add_f32 v168, v168, v170
    v_mfma_f32_16x16x32_bf16 v[32:35], v[208:211], a[0:3], 0
    ds_read_b64_tr_b16 v[200:201], v244 offset:0
    v_add_f32 v169, v169, v171
    v_mfma_f32_16x16x32_bf16 v[32:35], v[212:215], a[16:19], v[32:35]
    buffer_load_dwordx4 v252, s[16:19], s64 offen offset:3072 lds
    v_mfma_f32_16x16x32_bf16 v[36:39], v[208:211], a[4:7], 0
    ds_read_b64_tr_b16 v[202:203], v244 offset:1024
    v_mul_f32 v168, 0xbb000000, v168
    v_mfma_f32_16x16x32_bf16 v[36:39], v[212:215], a[20:23], v[36:39]
    v_mul_f32 v160, 0x3c000000, v160
    v_add_f32 v160, v160, v168
    v_mfma_f32_16x16x32_bf16 v[40:43], v[208:211], a[8:11], 0
    ds_read_b64_tr_b16 v[204:205], v244 offset:8192
    v_mul_f32 v162, 0x3c000000, v162
    v_mfma_f32_16x16x32_bf16 v[40:43], v[212:215], a[24:27], v[40:43]
    buffer_load_dword v176, v179, s[24:27], 0 offen
    v_mfma_f32_16x16x32_bf16 v[44:47], v[208:211], a[12:15], 0
    ds_read_b64_tr_b16 v[206:207], v244 offset:9216
    v_add_f32 v162, v162, v168
    v_mfma_f32_16x16x32_bf16 v[44:47], v[212:215], a[28:31], v[44:47]
    s_waitcnt lgkmcnt(4)
    s_add_u32 s64, s82, 256
    s_and_b32 s64, s64, 1023
    v_mfma_f32_16x16x32_bf16 v[48:51], v[192:195], a[0:3], 0
    s_add_u32 m0, s66, 65536
    s_add_u32 s64, s64, s60
    ds_read_b64_tr_b16 v[208:209], v245 offset:0
    v_mfma_f32_16x16x32_bf16 v[48:51], v[196:199], a[16:19], v[48:51]
    buffer_load_dwordx4 v230, s[16:19], s64 offen offset:0 lds
    v_mfma_f32_16x16x32_bf16 v[52:55], v[192:195], a[4:7], 0
    ds_read_b64_tr_b16 v[210:211], v245 offset:1024
    v_mul_f32 v164, 0x3c000000, v164
    v_mfma_f32_16x16x32_bf16 v[52:55], v[196:199], a[20:23], v[52:55]
    v_add_f32 v164, v164, v168
    v_mul_f32 v166, 0x3c000000, v166
    v_mfma_f32_16x16x32_bf16 v[56:59], v[192:195], a[8:11], 0
    ds_read_b64_tr_b16 v[212:213], v245 offset:8192
    v_add_f32 v166, v166, v168
    v_mfma_f32_16x16x32_bf16 v[56:59], v[196:199], a[24:27], v[56:59]
    buffer_load_dwordx4 v231, s[16:19], s64 offen offset:1024 lds
    v_mfma_f32_16x16x32_bf16 v[60:63], v[192:195], a[12:15], 0
    s_mov_b32 s3, 0x7f000000
    ds_read_b64_tr_b16 v[214:215], v245 offset:9216
    v_lshlrev_b32 v180, 3, v224
    v_mfma_f32_16x16x32_bf16 v[60:63], v[196:199], a[28:31], v[60:63]
    s_waitcnt lgkmcnt(4)
    s_waitcnt vmcnt(7)
    ds_read_b128 a[32:35], v232 offset:32768
    v_mfma_f32_16x16x32_bf16 v[64:67], v[200:203], a[0:3], 0
    ds_read_b64_tr_b16 v[192:193], v246 offset:0
    v_mul_f32 v170, v160, v160
    v_mfma_f32_16x16x32_bf16 v[64:67], v[204:207], a[16:19], v[64:67]
    buffer_load_dwordx4 v223, s[16:19], s64 offen offset:2048 lds
    v_mfma_f32_16x16x32_bf16 v[68:71], v[200:203], a[4:7], 0
    ds_read_b64_tr_b16 v[194:195], v246 offset:1024
    v_fmac_f32 v170, v162, v162
    v_mfma_f32_16x16x32_bf16 v[68:71], v[204:207], a[20:23], v[68:71]
    ds_read_b128 a[48:51], v233 offset:32768
    v_fmac_f32 v170, v164, v164
    v_mfma_f32_16x16x32_bf16 v[72:75], v[200:203], a[8:11], 0
    ds_read_b64_tr_b16 v[196:197], v246 offset:8192
    v_fmac_f32 v170, v166, v166
    v_mfma_f32_16x16x32_bf16 v[72:75], v[204:207], a[24:27], v[72:75]
    buffer_load_dwordx4 v252, s[16:19], s64 offen offset:3072 lds
    v_mfma_f32_16x16x32_bf16 v[76:79], v[200:203], a[12:15], 0
    ds_read_b64_tr_b16 v[198:199], v246 offset:9216
    v_fmac_f32 v169, 0x43000000, v170
    v_mfma_f32_16x16x32_bf16 v[76:79], v[204:207], a[28:31], v[76:79]
    s_waitcnt lgkmcnt(6)
    ds_read_b128 a[36:39], v232 offset:34816
    v_mov_b32 v170, 0x3727c5ac
    v_mfma_f32_16x16x32_bf16 v[80:83], v[208:211], a[0:3], 0
    s_cmp_lt_u32 s2, 8
    s_cselect_b32 s3, 0x4e01000, s3
    ds_read_b64_tr_b16 v[200:201], v247 offset:0
    v_mfma_f32_16x16x32_bf16 v[80:83], v[212:215], a[16:19], v[80:83]
    buffer_load_dword v181, v180, s[8:11], s3 offen sc1
    v_mfma_f32_16x16x32_bf16 v[84:87], v[208:211], a[4:7], 0
    ds_read_b64_tr_b16 v[202:203], v247 offset:1024
    v_fmac_f32 v170, 0x3b000000, v169
    v_mfma_f32_16x16x32_bf16 v[84:87], v[212:215], a[20:23], v[84:87]
    ds_read_b128 a[52:55], v233 offset:34816
    v_mfma_f32_16x16x32_bf16 v[88:91], v[208:211], a[8:11], 0
    ds_read_b64_tr_b16 v[204:205], v247 offset:8192
    v_mfma_f32_16x16x32_bf16 v[88:91], v[212:215], a[24:27], v[88:91]
    s_barrier
    v_mfma_f32_16x16x32_bf16 v[92:95], v[208:211], a[12:15], 0
    ds_read_b64_tr_b16 v[206:207], v247 offset:9216
    v_mfma_f32_16x16x32_bf16 v[92:95], v[212:215], a[28:31], v[92:95]
    s_waitcnt lgkmcnt(6)
    s_add_u32 s63, s83, 1048576
    s_waitcnt vmcnt(6)
    ds_read_b128 a[40:43], v232 offset:36864
    v_mfma_f32_16x16x32_bf16 v[96:99], v[192:195], a[0:3], 0
    s_add_u32 m0, s67, 131072
    s_and_b32 s63, s63, 0x3fffff
    ds_read_b64_tr_b16 v[208:209], v240 offset:16384
    v_mfma_f32_16x16x32_bf16 v[96:99], v[196:199], a[16:19], v[96:99]
    buffer_load_dwordx4 v226, s[20:23], s63 offen offset:0 nt lds
    v_mfma_f32_16x16x32_bf16 v[100:103], v[192:195], a[4:7], 0
    ds_read_b64_tr_b16 v[210:211], v240 offset:17408
    v_mfma_f32_16x16x32_bf16 v[100:103], v[196:199], a[20:23], v[100:103]
    ds_read_b128 a[56:59], v233 offset:36864
    v_mfma_f32_16x16x32_bf16 v[104:107], v[192:195], a[8:11], 0
    ds_read_b64_tr_b16 v[212:213], v240 offset:24576
    v_mfma_f32_16x16x32_bf16 v[104:107], v[196:199], a[24:27], v[104:107]
    buffer_load_dwordx4 v227, s[20:23], s63 offen offset:1024 nt lds
    v_mfma_f32_16x16x32_bf16 v[108:111], v[192:195], a[12:15], 0
    ds_read_b64_tr_b16 v[214:215], v240 offset:25600
    v_mfma_f32_16x16x32_bf16 v[108:111], v[196:199], a[28:31], v[108:111]
    s_waitcnt lgkmcnt(6)
    ds_read_b128 a[44:47], v232 offset:38912
    v_mfma_f32_16x16x32_bf16 v[112:115], v[200:203], a[0:3], 0
    ds_read_b64_tr_b16 v[192:193], v241 offset:16384
    v_mfma_f32_16x16x32_bf16 v[112:115], v[204:207], a[16:19], v[112:115]
    buffer_load_dwordx4 v238, s[20:23], s63 offen offset:2048 nt lds
    v_mfma_f32_16x16x32_bf16 v[116:119], v[200:203], a[4:7], 0
    ds_read_b64_tr_b16 v[194:195], v241 offset:17408
    v_mfma_f32_16x16x32_bf16 v[116:119], v[204:207], a[20:23], v[116:119]
    ds_read_b128 a[60:63], v233 offset:38912
    v_mfma_f32_16x16x32_bf16 v[120:123], v[200:203], a[8:11], 0
    ds_read_b64_tr_b16 v[196:197], v241 offset:24576
    v_mfma_f32_16x16x32_bf16 v[120:123], v[204:207], a[24:27], v[120:123]
    buffer_load_dwordx4 v239, s[20:23], s63 offen offset:3072 nt lds
    v_mfma_f32_16x16x32_bf16 v[124:127], v[200:203], a[12:15], 0
    ds_read_b64_tr_b16 v[198:199], v241 offset:25600
    v_mfma_f32_16x16x32_bf16 v[124:127], v[204:207], a[28:31], v[124:127]
    s_waitcnt lgkmcnt(6)
    v_rsq_f32 v170, v170
    v_mfma_f32_16x16x32_bf16 v[0:3], v[208:211], a[32:35], v[0:3]
    s_add_u32 m0, s66, 69632
    s_add_u32 s64, s64, 32768
    ds_read_b64_tr_b16 v[200:201], v242 offset:16384
    v_mfma_f32_16x16x32_bf16 v[0:3], v[212:215], a[48:51], v[0:3]
    buffer_load_dwordx4 v230, s[16:19], s64 offen offset:0 lds
    v_mfma_f32_16x16x32_bf16 v[4:7], v[208:211], a[36:39], v[4:7]
    ds_read_b64_tr_b16 v[202:203], v242 offset:17408
    v_sub_f32 v168, v168, v157
    v_mfma_f32_16x16x32_bf16 v[4:7], v[212:215], a[52:55], v[4:7]
    s_waitcnt lgkmcnt(4)
    v_mul_f32 v170, 0x3e0293ee, v170
    v_mul_f32 v168, v168, v170
    v_mfma_f32_16x16x32_bf16 v[8:11], v[208:211], a[40:43], v[8:11]
    ds_read_b64_tr_b16 v[204:205], v242 offset:24576
    v_fma_f32 v136, v136, v170, v168
    v_mfma_f32_16x16x32_bf16 v[8:11], v[212:215], a[56:59], v[8:11]
    buffer_load_dwordx4 v231, s[16:19], s64 offen offset:1024 lds
    v_mfma_f32_16x16x32_bf16 v[12:15], v[208:211], a[44:47], v[12:15]
    ds_read_b64_tr_b16 v[206:207], v242 offset:25600
    v_fma_f32 v137, v137, v170, v168
    v_mfma_f32_16x16x32_bf16 v[12:15], v[212:215], a[60:63], v[12:15]
    s_waitcnt lgkmcnt(4)
    v_fma_f32 v138, v138, v170, v168
    v_fma_f32 v139, v139, v170, v168
    v_mfma_f32_16x16x32_bf16 v[16:19], v[192:195], a[32:35], v[16:19]
    ds_read_b64_tr_b16 v[208:209], v243 offset:16384
    v_fma_f32 v140, v140, v170, v168
    v_mfma_f32_16x16x32_bf16 v[16:19], v[196:199], a[48:51], v[16:19]
    buffer_load_dwordx4 v223, s[16:19], s64 offen offset:2048 lds
    v_mfma_f32_16x16x32_bf16 v[20:23], v[192:195], a[36:39], v[20:23]
    ds_read_b64_tr_b16 v[210:211], v243 offset:17408
    v_fma_f32 v141, v141, v170, v168
    v_mfma_f32_16x16x32_bf16 v[20:23], v[196:199], a[52:55], v[20:23]
    v_fma_f32 v142, v142, v170, v168
    v_fma_f32 v143, v143, v170, v168
    v_mfma_f32_16x16x32_bf16 v[24:27], v[192:195], a[40:43], v[24:27]
    ds_read_b64_tr_b16 v[212:213], v243 offset:24576
    v_fma_f32 v144, v144, v170, v168
    v_mfma_f32_16x16x32_bf16 v[24:27], v[196:199], a[56:59], v[24:27]
    buffer_load_dwordx4 v252, s[16:19], s64 offen offset:3072 lds
    v_mfma_f32_16x16x32_bf16 v[28:31], v[192:195], a[44:47], v[28:31]
    ds_read_b64_tr_b16 v[214:215], v243 offset:25600
    v_fma_f32 v145, v145, v170, v168
    v_mfma_f32_16x16x32_bf16 v[28:31], v[196:199], a[60:63], v[28:31]
    s_waitcnt lgkmcnt(4)
    s_add_u32 s64, s82, 384
    s_and_b32 s64, s64, 1023
    v_mfma_f32_16x16x32_bf16 v[32:35], v[200:203], a[32:35], v[32:35]
    s_add_u32 m0, s66, 0
    s_add_u32 s64, s64, s60
    ds_read_b64_tr_b16 v[192:193], v244 offset:16384
    v_mfma_f32_16x16x32_bf16 v[32:35], v[204:207], a[48:51], v[32:35]
    buffer_load_dwordx4 v230, s[16:19], s64 offen offset:0 lds
    v_mfma_f32_16x16x32_bf16 v[36:39], v[200:203], a[36:39], v[36:39]
    ds_read_b64_tr_b16 v[194:195], v244 offset:17408
    v_fma_f32 v146, v146, v170, v168
    v_mfma_f32_16x16x32_bf16 v[36:39], v[204:207], a[52:55], v[36:39]
    v_fma_f32 v147, v147, v170, v168
    v_fma_f32 v148, v148, v170, v168
    v_mfma_f32_16x16x32_bf16 v[40:43], v[200:203], a[40:43], v[40:43]
    ds_read_b64_tr_b16 v[196:197], v244 offset:24576
    v_fma_f32 v149, v149, v170, v168
    v_mfma_f32_16x16x32_bf16 v[40:43], v[204:207], a[56:59], v[40:43]
    buffer_load_dwordx4 v231, s[16:19], s64 offen offset:1024 lds
    v_mfma_f32_16x16x32_bf16 v[44:47], v[200:203], a[44:47], v[44:47]
    ds_read_b64_tr_b16 v[198:199], v244 offset:25600
    v_fma_f32 v150, v150, v170, v168
    v_mfma_f32_16x16x32_bf16 v[44:47], v[204:207], a[60:63], v[44:47]
    s_waitcnt lgkmcnt(4)
    v_fma_f32 v151, v151, v170, v168
    v_cvt_pk_bf16_f32 v128, v136, v137
    v_mfma_f32_16x16x32_bf16 v[48:51], v[208:211], a[32:35], v[48:51]
    ds_read_b64_tr_b16 v[200:201], v245 offset:16384
    v_cvt_pk_bf16_f32 v129, v138, v139
    v_mfma_f32_16x16x32_bf16 v[48:51], v[212:215], a[48:51], v[48:51]
    buffer_load_dwordx4 v223, s[16:19], s64 offen offset:2048 lds
    v_mfma_f32_16x16x32_bf16 v[52:55], v[208:211], a[36:39], v[52:55]
    ds_read_b64_tr_b16 v[202:203], v245 offset:17408
    v_cvt_pk_bf16_f32 v130, v140, v141
    v_mfma_f32_16x16x32_bf16 v[52:55], v[212:215], a[52:55], v[52:55]
    v_cvt_pk_bf16_f32 v131, v142, v143
    v_cvt_pk_bf16_f32 v132, v144, v145
    v_mfma_f32_16x16x32_bf16 v[56:59], v[208:211], a[40:43], v[56:59]
    ds_read_b64_tr_b16 v[204:205], v245 offset:24576
    v_cvt_pk_bf16_f32 v133, v146, v147
    v_mfma_f32_16x16x32_bf16 v[56:59], v[212:215], a[56:59], v[56:59]
    buffer_load_dwordx4 v252, s[16:19], s64 offen offset:3072 lds
    v_mfma_f32_16x16x32_bf16 v[60:63], v[208:211], a[44:47], v[60:63]
    ds_read_b64_tr_b16 v[206:207], v245 offset:25600
    v_cvt_pk_bf16_f32 v134, v148, v149
    v_mfma_f32_16x16x32_bf16 v[60:63], v[212:215], a[60:63], v[60:63]
    s_waitcnt lgkmcnt(4)
    s_add_u32 s63, s83, 1572864
    s_waitcnt vmcnt(13)
    ds_read_b128 a[64:67], v228 offset:0
    v_mfma_f32_16x16x32_bf16 v[64:67], v[192:195], a[32:35], v[64:67]
    s_add_u32 m0, s67, 147456
    s_and_b32 s63, s63, 0x3fffff
    ds_read_b64_tr_b16 v[208:209], v246 offset:16384
    v_mfma_f32_16x16x32_bf16 v[64:67], v[196:199], a[48:51], v[64:67]
    buffer_load_dwordx4 v226, s[20:23], s63 offen offset:0 nt lds
    v_mfma_f32_16x16x32_bf16 v[68:71], v[192:195], a[36:39], v[68:71]
    ds_read_b64_tr_b16 v[210:211], v246 offset:17408
    v_cvt_pk_bf16_f32 v135, v150, v151
    v_mfma_f32_16x16x32_bf16 v[68:71], v[196:199], a[52:55], v[68:71]
    ds_read_b128 a[80:83], v229 offset:0
    v_mfma_f32_16x16x32_bf16 v[72:75], v[192:195], a[40:43], v[72:75]
    ds_read_b64_tr_b16 v[212:213], v246 offset:24576
    v_mfma_f32_16x16x32_bf16 v[72:75], v[196:199], a[56:59], v[72:75]
    buffer_load_dwordx4 v227, s[20:23], s63 offen offset:1024 nt lds
    v_mfma_f32_16x16x32_bf16 v[76:79], v[192:195], a[44:47], v[76:79]
    ds_read_b64_tr_b16 v[214:215], v246 offset:25600
    v_mfma_f32_16x16x32_bf16 v[76:79], v[196:199], a[60:63], v[76:79]
    s_waitcnt lgkmcnt(6)
    ds_read_b128 a[68:71], v228 offset:2048
    v_mfma_f32_16x16x32_bf16 v[80:83], v[200:203], a[32:35], v[80:83]
    ds_read_b64_tr_b16 v[192:193], v247 offset:16384
    v_mfma_f32_16x16x32_bf16 v[80:83], v[204:207], a[48:51], v[80:83]
    buffer_load_dwordx4 v238, s[20:23], s63 offen offset:2048 nt lds
    v_mfma_f32_16x16x32_bf16 v[84:87], v[200:203], a[36:39], v[84:87]
    ds_read_b64_tr_b16 v[194:195], v247 offset:17408
    v_mfma_f32_16x16x32_bf16 v[84:87], v[204:207], a[52:55], v[84:87]
    ds_read_b128 a[84:87], v229 offset:2048
    v_mfma_f32_16x16x32_bf16 v[88:91], v[200:203], a[40:43], v[88:91]
    ds_read_b64_tr_b16 v[196:197], v247 offset:24576
    v_mfma_f32_16x16x32_bf16 v[88:91], v[204:207], a[56:59], v[88:91]
    s_waitcnt vmcnt(11)
    s_barrier
    ds_bpermute_b32 v128, v172, v128
    v_mfma_f32_16x16x32_bf16 v[92:95], v[200:203], a[44:47], v[92:95]
    ds_read_b64_tr_b16 v[198:199], v247 offset:25600
    v_mfma_f32_16x16x32_bf16 v[92:95], v[204:207], a[60:63], v[92:95]
    s_waitcnt lgkmcnt(7)
    s_waitcnt vmcnt(7)
    ds_read_b128 a[72:75], v228 offset:4096
    v_mfma_f32_16x16x32_bf16 v[96:99], v[208:211], a[32:35], v[96:99]
    ds_read_b64_tr_b16 v[200:201], v240 offset:32768
    v_mfma_f32_16x16x32_bf16 v[96:99], v[212:215], a[48:51], v[96:99]
    buffer_load_dwordx4 v239, s[20:23], s63 offen offset:3072 nt lds
    v_mfma_f32_16x16x32_bf16 v[100:103], v[208:211], a[36:39], v[100:103]
    ds_read_b64_tr_b16 v[202:203], v240 offset:33792
    v_mfma_f32_16x16x32_bf16 v[100:103], v[212:215], a[52:55], v[100:103]
    ds_read_b128 a[88:91], v229 offset:4096
    v_mfma_f32_16x16x32_bf16 v[104:107], v[208:211], a[40:43], v[104:107]
    s_add_u32 m0, s66, 4096
    s_add_u32 s64, s64, 32768
    ds_read_b64_tr_b16 v[204:205], v240 offset:40960
    v_mfma_f32_16x16x32_bf16 v[104:107], v[212:215], a[56:59], v[104:107]
    buffer_load_dwordx4 v230, s[16:19], s64 offen offset:0 lds
    v_mfma_f32_16x16x32_bf16 v[108:111], v[208:211], a[44:47], v[108:111]
    ds_read_b64_tr_b16 v[206:207], v240 offset:41984
    v_mfma_f32_16x16x32_bf16 v[108:111], v[212:215], a[60:63], v[108:111]
    s_waitcnt lgkmcnt(6)
    ds_read_b128 a[76:79], v228 offset:6144
    v_mfma_f32_16x16x32_bf16 v[112:115], v[192:195], a[32:35], v[112:115]
    ds_read_b64_tr_b16 v[208:209], v241 offset:32768
    v_mfma_f32_16x16x32_bf16 v[112:115], v[196:199], a[48:51], v[112:115]
    buffer_load_dwordx4 v231, s[16:19], s64 offen offset:1024 lds
    v_mfma_f32_16x16x32_bf16 v[116:119], v[192:195], a[36:39], v[116:119]
    ds_read_b64_tr_b16 v[210:211], v241 offset:33792
    v_mfma_f32_16x16x32_bf16 v[116:119], v[196:199], a[52:55], v[116:119]
    ds_read_b128 a[92:95], v229 offset:6144
    v_mfma_f32_16x16x32_bf16 v[120:123], v[192:195], a[40:43], v[120:123]
    ds_read_b64_tr_b16 v[212:213], v241 offset:40960
    v_mfma_f32_16x16x32_bf16 v[120:123], v[196:199], a[56:59], v[120:123]
    buffer_load_dwordx4 v223, s[16:19], s64 offen offset:2048 lds
    v_mfma_f32_16x16x32_bf16 v[124:127], v[192:195], a[44:47], v[124:127]
    ds_read_b64_tr_b16 v[214:215], v241 offset:41984
    v_mfma_f32_16x16x32_bf16 v[124:127], v[196:199], a[60:63], v[124:127]
    s_waitcnt lgkmcnt(6)
    ds_bpermute_b32 v129, v172, v129
    v_mfma_f32_16x16x32_bf16 v[0:3], v[200:203], a[64:67], v[0:3]
    ds_read_b64_tr_b16 v[192:193], v242 offset:32768
    v_mfma_f32_16x16x32_bf16 v[0:3], v[204:207], a[80:83], v[0:3]
    buffer_load_dwordx4 v252, s[16:19], s64 offen offset:3072 lds
    v_mfma_f32_16x16x32_bf16 v[4:7], v[200:203], a[68:71], v[4:7]
    ds_read_b64_tr_b16 v[194:195], v242 offset:33792
    v_mfma_f32_16x16x32_bf16 v[4:7], v[204:207], a[84:87], v[4:7]
    s_waitcnt lgkmcnt(5)
    ds_bpermute_b32 v130, v172, v130
    v_mfma_f32_16x16x32_bf16 v[8:11], v[200:203], a[72:75], v[8:11]
    s_add_u32 s7, s84, 0
    s_and_b32 s7, s7, 0x3fffff
    ds_read_b64_tr_b16 v[196:197], v242 offset:40960
    v_mfma_f32_16x16x32_bf16 v[8:11], v[204:207], a[88:91], v[8:11]
    buffer_load_dword v177, v174, s[28:31], s7 offen
    v_mfma_f32_16x16x32_bf16 v[12:15], v[200:203], a[76:79], v[12:15]
    ds_read_b64_tr_b16 v[198:199], v242 offset:41984
    v_mfma_f32_16x16x32_bf16 v[12:15], v[204:207], a[92:95], v[12:15]
    s_waitcnt lgkmcnt(6)
    s_add_u32 s64, s82, 512
    s_and_b32 s64, s64, 1023
    v_mfma_f32_16x16x32_bf16 v[16:19], v[208:211], a[64:67], v[16:19]
    s_add_u32 m0, s66, 32768
    s_add_u32 s64, s64, s60
    ds_read_b64_tr_b16 v[200:201], v243 offset:32768
    v_mfma_f32_16x16x32_bf16 v[16:19], v[212:215], a[80:83], v[16:19]
    buffer_load_dwordx4 v230, s[16:19], s64 offen offset:0 lds
    v_mfma_f32_16x16x32_bf16 v[20:23], v[208:211], a[68:71], v[20:23]
    ds_read_b64_tr_b16 v[202:203], v243 offset:33792
    v_mfma_f32_16x16x32_bf16 v[20:23], v[212:215], a[84:87], v[20:23]
    ds_bpermute_b32 v131, v172, v131
    v_mfma_f32_16x16x32_bf16 v[24:27], v[208:211], a[72:75], v[24:27]
    ds_read_b64_tr_b16 v[204:205], v243 offset:40960
    v_mfma_f32_16x16x32_bf16 v[24:27], v[212:215], a[88:91], v[24:27]
    buffer_load_dwordx4 v231, s[16:19], s64 offen offset:1024 lds
    v_mfma_f32_16x16x32_bf16 v[28:31], v[208:211], a[76:79], v[28:31]
    ds_read_b64_tr_b16 v[206:207], v243 offset:41984
    v_mfma_f32_16x16x32_bf16 v[28:31], v[212:215], a[92:95], v[28:31]
    s_waitcnt lgkmcnt(5)
    ds_bpermute_b32 v132, v172, v132
    v_mfma_f32_16x16x32_bf16 v[32:35], v[192:195], a[64:67], v[32:35]
    ds_read_b64_tr_b16 v[208:209], v244 offset:32768
    v_mfma_f32_16x16x32_bf16 v[32:35], v[196:199], a[80:83], v[32:35]
    buffer_load_dwordx4 v223, s[16:19], s64 offen offset:2048 lds
    v_mfma_f32_16x16x32_bf16 v[36:39], v[192:195], a[68:71], v[36:39]
    ds_read_b64_tr_b16 v[210:211], v244 offset:33792
    v_mfma_f32_16x16x32_bf16 v[36:39], v[196:199], a[84:87], v[36:39]
    ds_bpermute_b32 v133, v172, v133
    v_mfma_f32_16x16x32_bf16 v[40:43], v[192:195], a[72:75], v[40:43]
    ds_read_b64_tr_b16 v[212:213], v244 offset:40960
    v_mfma_f32_16x16x32_bf16 v[40:43], v[196:199], a[88:91], v[40:43]
    buffer_load_dwordx4 v252, s[16:19], s64 offen offset:3072 lds
    v_mfma_f32_16x16x32_bf16 v[44:47], v[192:195], a[76:79], v[44:47]
    ds_read_b64_tr_b16 v[214:215], v244 offset:41984
    v_mfma_f32_16x16x32_bf16 v[44:47], v[196:199], a[92:95], v[44:47]
    s_waitcnt lgkmcnt(6)
    s_add_u32 s63, s83, 2097152
    ds_bpermute_b32 v134, v172, v134
    v_mfma_f32_16x16x32_bf16 v[48:51], v[200:203], a[64:67], v[48:51]
    s_add_u32 m0, s67, 98304
    s_and_b32 s63, s63, 0x3fffff
    ds_read_b64_tr_b16 v[192:193], v245 offset:32768
    v_mfma_f32_16x16x32_bf16 v[48:51], v[204:207], a[80:83], v[48:51]
    buffer_load_dwordx4 v226, s[20:23], s63 offen offset:0 nt lds
    v_mfma_f32_16x16x32_bf16 v[52:55], v[200:203], a[68:71], v[52:55]
    ds_read_b64_tr_b16 v[194:195], v245 offset:33792
    v_mfma_f32_16x16x32_bf16 v[52:55], v[204:207], a[84:87], v[52:55]
    ds_bpermute_b32 v135, v172, v135
    v_mfma_f32_16x16x32_bf16 v[56:59], v[200:203], a[72:75], v[56:59]
    ds_read_b64_tr_b16 v[196:197], v245 offset:40960
    v_mfma_f32_16x16x32_bf16 v[56:59], v[204:207], a[88:91], v[56:59]
    buffer_load_dwordx4 v227, s[20:23], s63 offen offset:1024 nt lds
    v_mfma_f32_16x16x32_bf16 v[60:63], v[200:203], a[76:79], v[60:63]
    ds_read_b64_tr_b16 v[198:199], v245 offset:41984
    v_mfma_f32_16x16x32_bf16 v[60:63], v[204:207], a[92:95], v[60:63]
    s_waitcnt lgkmcnt(6)
    s_waitcnt vmcnt(15)
    ds_read_b128 a[96:99], v232 offset:0
    v_mfma_f32_16x16x32_bf16 v[64:67], v[208:211], a[64:67], v[64:67]
    ds_read_b64_tr_b16 v[200:201], v246 offset:32768
    v_mfma_f32_16x16x32_bf16 v[64:67], v[212:215], a[80:83], v[64:67]
    buffer_load_dwordx4 v238, s[20:23], s63 offen offset:2048 nt lds
    v_mfma_f32_16x16x32_bf16 v[68:71], v[208:211], a[68:71], v[68:71]
    ds_read_b64_tr_b16 v[202:203], v246 offset:33792
    v_mfma_f32_16x16x32_bf16 v[68:71], v[212:215], a[84:87], v[68:71]
    s_waitcnt lgkmcnt(5)
    ds_read_b128 a[112:115], v233 offset:0
    v_mfma_f32_16x16x32_bf16 v[72:75], v[208:211], a[72:75], v[72:75]
    ds_read_b64_tr_b16 v[204:205], v246 offset:40960
    v_mfma_f32_16x16x32_bf16 v[72:75], v[212:215], a[88:91], v[72:75]
    buffer_load_dwordx4 v239, s[20:23], s63 offen offset:3072 nt lds
    v_mfma_f32_16x16x32_bf16 v[76:79], v[208:211], a[76:79], v[76:79]
    ds_read_b64_tr_b16 v[206:207], v246 offset:41984
    v_mfma_f32_16x16x32_bf16 v[76:79], v[212:215], a[92:95], v[76:79]
    s_waitcnt lgkmcnt(6)
    ds_read_b128 a[100:103], v232 offset:2048
    v_mfma_f32_16x16x32_bf16 v[80:83], v[192:195], a[64:67], v[80:83]
    s_add_u32 m0, s66, 36864
    s_add_u32 s64, s64, 32768
    ds_read_b64_tr_b16 v[208:209], v247 offset:32768
    v_mfma_f32_16x16x32_bf16 v[80:83], v[196:199], a[80:83], v[80:83]
    buffer_load_dwordx4 v230, s[16:19], s64 offen offset:0 lds
    v_mfma_f32_16x16x32_bf16 v[84:87], v[192:195], a[68:71], v[84:87]
    ds_read_b64_tr_b16 v[210:211], v247 offset:33792
    v_mfma_f32_16x16x32_bf16 v[84:87], v[196:199], a[84:87], v[84:87]
    ds_read_b128 a[116:119], v233 offset:2048
    v_mfma_f32_16x16x32_bf16 v[88:91], v[192:195], a[72:75], v[88:91]
    ds_read_b64_tr_b16 v[212:213], v247 offset:40960
    v_mfma_f32_16x16x32_bf16 v[88:91], v[196:199], a[88:91], v[88:91]
    s_waitcnt vmcnt(14)
    s_barrier
    v_mfma_f32_16x16x32_bf16 v[92:95], v[192:195], a[76:79], v[92:95]
    ds_read_b64_tr_b16 v[214:215], v247 offset:41984
    v_mfma_f32_16x16x32_bf16 v[92:95], v[196:199], a[92:95], v[92:95]
    s_waitcnt lgkmcnt(6)
    s_waitcnt vmcnt(10)
    ds_read_b128 a[104:107], v232 offset:4096
    v_mfma_f32_16x16x32_bf16 v[96:99], v[200:203], a[64:67], v[96:99]
    ds_read_b64_tr_b16 v[192:193], v240 offset:49152
    v_mfma_f32_16x16x32_bf16 v[96:99], v[204:207], a[80:83], v[96:99]
    buffer_load_dwordx4 v231, s[16:19], s64 offen offset:1024 lds
    v_mfma_f32_16x16x32_bf16 v[100:103], v[200:203], a[68:71], v[100:103]
    ds_read_b64_tr_b16 v[194:195], v240 offset:50176
    v_mfma_f32_16x16x32_bf16 v[100:103], v[204:207], a[84:87], v[100:103]
    ds_read_b128 a[120:123], v233 offset:4096
    v_mfma_f32_16x16x32_bf16 v[104:107], v[200:203], a[72:75], v[104:107]
    ds_read_b64_tr_b16 v[196:197], v240 offset:57344
    v_mfma_f32_16x16x32_bf16 v[104:107], v[204:207], a[88:91], v[104:107]
    buffer_load_dwordx4 v223, s[16:19], s64 offen offset:2048 lds
    v_mfma_f32_16x16x32_bf16 v[108:111], v[200:203], a[76:79], v[108:111]
    ds_read_b64_tr_b16 v[198:199], v240 offset:58368
    v_mfma_f32_16x16x32_bf16 v[108:111], v[204:207], a[92:95], v[108:111]
    s_waitcnt lgkmcnt(6)
    ds_read_b128 a[108:111], v232 offset:6144
    v_mfma_f32_16x16x32_bf16 v[112:115], v[208:211], a[64:67], v[112:115]
    ds_read_b64_tr_b16 v[200:201], v241 offset:49152
    v_mfma_f32_16x16x32_bf16 v[112:115], v[212:215], a[80:83], v[112:115]
    buffer_load_dwordx4 v252, s[16:19], s64 offen offset:3072 lds
    v_mfma_f32_16x16x32_bf16 v[116:119], v[208:211], a[68:71], v[116:119]
    ds_read_b64_tr_b16 v[202:203], v241 offset:50176
    v_mfma_f32_16x16x32_bf16 v[116:119], v[212:215], a[84:87], v[116:119]
    ds_read_b128 a[124:127], v233 offset:6144
    v_mfma_f32_16x16x32_bf16 v[120:123], v[208:211], a[72:75], v[120:123]
    ds_read_b64_tr_b16 v[204:205], v241 offset:57344
    v_mfma_f32_16x16x32_bf16 v[120:123], v[212:215], a[88:91], v[120:123]
    v_mfma_f32_16x16x32_bf16 v[124:127], v[208:211], a[76:79], v[124:127]
    ds_read_b64_tr_b16 v[206:207], v241 offset:58368
    v_mfma_f32_16x16x32_bf16 v[124:127], v[212:215], a[92:95], v[124:127]
    s_waitcnt lgkmcnt(6)
    v_mfma_f32_16x16x32_bf16 v[0:3], v[192:195], a[96:99], v[0:3]
    ds_read_b64_tr_b16 v[208:209], v242 offset:49152
    v_mfma_f32_16x16x32_bf16 v[0:3], v[196:199], a[112:115], v[0:3]
    buffer_load_dwordx2 v[218:219], v221, s[36:39], 0 offen sc1
    v_mfma_f32_16x16x32_bf16 v[4:7], v[192:195], a[100:103], v[4:7]
    ds_read_b64_tr_b16 v[210:211], v242 offset:50176
    v_mfma_f32_16x16x32_bf16 v[4:7], v[196:199], a[116:119], v[4:7]
    s_waitcnt lgkmcnt(4)
    s_add_u32 s64, s82, 640
    s_and_b32 s64, s64, 1023
    v_mfma_f32_16x16x32_bf16 v[8:11], v[192:195], a[104:107], v[8:11]
    s_add_u32 m0, s66, 65536
    s_add_u32 s64, s64, s60
    ds_read_b64_tr_b16 v[212:213], v242 offset:57344
    v_mfma_f32_16x16x32_bf16 v[8:11], v[196:199], a[120:123], v[8:11]
    buffer_load_dwordx4 v230, s[16:19], s64 offen offset:0 lds
    v_mfma_f32_16x16x32_bf16 v[12:15], v[192:195], a[108:111], v[12:15]
    ds_read_b64_tr_b16 v[214:215], v242 offset:58368
    v_mfma_f32_16x16x32_bf16 v[12:15], v[196:199], a[124:127], v[12:15]
    s_waitcnt lgkmcnt(4)
    v_mfma_f32_16x16x32_bf16 v[16:19], v[200:203], a[96:99], v[16:19]
    ds_read_b64_tr_b16 v[192:193], v243 offset:49152
    v_mfma_f32_16x16x32_bf16 v[16:19], v[204:207], a[112:115], v[16:19]
    buffer_load_dwordx4 v231, s[16:19], s64 offen offset:1024 lds
    v_mfma_f32_16x16x32_bf16 v[20:23], v[200:203], a[100:103], v[20:23]
    ds_read_b64_tr_b16 v[194:195], v243 offset:50176
    v_mfma_f32_16x16x32_bf16 v[20:23], v[204:207], a[116:119], v[20:23]
    v_mfma_f32_16x16x32_bf16 v[24:27], v[200:203], a[104:107], v[24:27]
    ds_read_b64_tr_b16 v[196:197], v243 offset:57344
    v_mfma_f32_16x16x32_bf16 v[24:27], v[204:207], a[120:123], v[24:27]
    buffer_load_dwordx4 v223, s[16:19], s64 offen offset:2048 lds
    v_mfma_f32_16x16x32_bf16 v[28:31], v[200:203], a[108:111], v[28:31]
    ds_read_b64_tr_b16 v[198:199], v243 offset:58368
    v_mfma_f32_16x16x32_bf16 v[28:31], v[204:207], a[124:127], v[28:31]
    s_waitcnt lgkmcnt(4)
    v_mfma_f32_16x16x32_bf16 v[32:35], v[208:211], a[96:99], v[32:35]
    ds_read_b64_tr_b16 v[200:201], v244 offset:49152
    v_mfma_f32_16x16x32_bf16 v[32:35], v[212:215], a[112:115], v[32:35]
    buffer_load_dwordx4 v252, s[16:19], s64 offen offset:3072 lds
    v_mfma_f32_16x16x32_bf16 v[36:39], v[208:211], a[100:103], v[36:39]
    ds_read_b64_tr_b16 v[202:203], v244 offset:50176
    v_mfma_f32_16x16x32_bf16 v[36:39], v[212:215], a[116:119], v[36:39]
    s_add_u32 s63, s83, 2621440
    v_mfma_f32_16x16x32_bf16 v[40:43], v[208:211], a[104:107], v[40:43]
    s_add_u32 m0, s67, 114688
    s_and_b32 s63, s63, 0x3fffff
    ds_read_b64_tr_b16 v[204:205], v244 offset:57344
    v_mfma_f32_16x16x32_bf16 v[40:43], v[212:215], a[120:123], v[40:43]
    buffer_load_dwordx4 v226, s[20:23], s63 offen offset:0 nt lds
    v_mfma_f32_16x16x32_bf16 v[44:47], v[208:211], a[108:111], v[44:47]
    ds_read_b64_tr_b16 v[206:207], v244 offset:58368
    v_mfma_f32_16x16x32_bf16 v[44:47], v[212:215], a[124:127], v[44:47]
    s_waitcnt lgkmcnt(4)
    v_mfma_f32_16x16x32_bf16 v[48:51], v[192:195], a[96:99], v[48:51]
    ds_read_b64_tr_b16 v[208:209], v245 offset:49152
    v_mfma_f32_16x16x32_bf16 v[48:51], v[196:199], a[112:115], v[48:51]
    buffer_load_dwordx4 v227, s[20:23], s63 offen offset:1024 nt lds
    v_mfma_f32_16x16x32_bf16 v[52:55], v[192:195], a[100:103], v[52:55]
    ds_read_b64_tr_b16 v[210:211], v245 offset:50176
    v_mfma_f32_16x16x32_bf16 v[52:55], v[196:199], a[116:119], v[52:55]
    v_mfma_f32_16x16x32_bf16 v[56:59], v[192:195], a[104:107], v[56:59]
    ds_read_b64_tr_b16 v[212:213], v245 offset:57344
    v_mfma_f32_16x16x32_bf16 v[56:59], v[196:199], a[120:123], v[56:59]
    buffer_load_dwordx4 v238, s[20:23], s63 offen offset:2048 nt lds
    v_mfma_f32_16x16x32_bf16 v[60:63], v[192:195], a[108:111], v[60:63]
    ds_read_b64_tr_b16 v[214:215], v245 offset:58368
    v_mfma_f32_16x16x32_bf16 v[60:63], v[196:199], a[124:127], v[60:63]
    s_waitcnt lgkmcnt(4)
    s_waitcnt vmcnt(16)
    ds_read_b128 a[128:131], v232 offset:32768
    v_mfma_f32_16x16x32_bf16 v[64:67], v[200:203], a[96:99], v[64:67]
    ds_read_b64_tr_b16 v[192:193], v246 offset:49152
    v_mfma_f32_16x16x32_bf16 v[64:67], v[204:207], a[112:115], v[64:67]
    buffer_load_dwordx4 v239, s[20:23], s63 offen offset:3072 nt lds
    v_mfma_f32_16x16x32_bf16 v[68:71], v[200:203], a[100:103], v[68:71]
    ds_read_b64_tr_b16 v[194:195], v246 offset:50176
    v_mfma_f32_16x16x32_bf16 v[68:71], v[204:207], a[116:119], v[68:71]
    ds_read_b128 a[144:147], v233 offset:32768
    v_mfma_f32_16x16x32_bf16 v[72:75], v[200:203], a[104:107], v[72:75]
    s_add_u32 m0, s66, 69632
    s_add_u32 s64, s64, 32768
    ds_read_b64_tr_b16 v[196:197], v246 offset:57344
    v_mfma_f32_16x16x32_bf16 v[72:75], v[204:207], a[120:123], v[72:75]
    buffer_load_dwordx4 v230, s[16:19], s64 offen offset:0 lds
    v_mfma_f32_16x16x32_bf16 v[76:79], v[200:203], a[108:111], v[76:79]
    ds_read_b64_tr_b16 v[198:199], v246 offset:58368
    v_mfma_f32_16x16x32_bf16 v[76:79], v[204:207], a[124:127], v[76:79]
    s_waitcnt lgkmcnt(6)
    ds_read_b128 a[132:135], v232 offset:34816
    v_mfma_f32_16x16x32_bf16 v[80:83], v[208:211], a[96:99], v[80:83]
    ds_read_b64_tr_b16 v[200:201], v247 offset:49152
    v_mfma_f32_16x16x32_bf16 v[80:83], v[212:215], a[112:115], v[80:83]
    buffer_load_dwordx4 v231, s[16:19], s64 offen offset:1024 lds
    v_mfma_f32_16x16x32_bf16 v[84:87], v[208:211], a[100:103], v[84:87]
    ds_read_b64_tr_b16 v[202:203], v247 offset:50176
    v_mfma_f32_16x16x32_bf16 v[84:87], v[212:215], a[116:119], v[84:87]
    ds_read_b128 a[148:151], v233 offset:34816
    v_mfma_f32_16x16x32_bf16 v[88:91], v[208:211], a[104:107], v[88:91]
    ds_read_b64_tr_b16 v[204:205], v247 offset:57344
    v_mfma_f32_16x16x32_bf16 v[88:91], v[212:215], a[120:123], v[88:91]
    s_waitcnt vmcnt(15)
    s_barrier
    v_mfma_f32_16x16x32_bf16 v[92:95], v[208:211], a[108:111], v[92:95]
    ds_read_b64_tr_b16 v[206:207], v247 offset:58368
    v_mfma_f32_16x16x32_bf16 v[92:95], v[212:215], a[124:127], v[92:95]
    s_waitcnt lgkmcnt(6)
    s_waitcnt vmcnt(11)
    ds_read_b128 a[136:139], v232 offset:36864
    v_mfma_f32_16x16x32_bf16 v[96:99], v[192:195], a[96:99], v[96:99]
    ds_read_b64_tr_b16 v[208:209], v240 offset:0
    v_mfma_f32_16x16x32_bf16 v[96:99], v[196:199], a[112:115], v[96:99]
    buffer_load_dwordx4 v223, s[16:19], s64 offen offset:2048 lds
    v_mfma_f32_16x16x32_bf16 v[100:103], v[192:195], a[100:103], v[100:103]
    ds_read_b64_tr_b16 v[210:211], v240 offset:1024
    v_mfma_f32_16x16x32_bf16 v[100:103], v[196:199], a[116:119], v[100:103]
    ds_read_b128 a[152:155], v233 offset:36864
    v_mfma_f32_16x16x32_bf16 v[104:107], v[192:195], a[104:107], v[104:107]
    ds_read_b64_tr_b16 v[212:213], v240 offset:8192
    v_mfma_f32_16x16x32_bf16 v[104:107], v[196:199], a[120:123], v[104:107]
    buffer_load_dwordx4 v252, s[16:19], s64 offen offset:3072 lds
    v_mfma_f32_16x16x32_bf16 v[108:111], v[192:195], a[108:111], v[108:111]
    ds_read_b64_tr_b16 v[214:215], v240 offset:9216
    v_mfma_f32_16x16x32_bf16 v[108:111], v[196:199], a[124:127], v[108:111]
    s_waitcnt lgkmcnt(6)
    ds_read_b128 a[140:143], v232 offset:38912
    v_mfma_f32_16x16x32_bf16 v[112:115], v[200:203], a[96:99], v[112:115]
    ds_read_b64_tr_b16 v[192:193], v241 offset:0
    v_mfma_f32_16x16x32_bf16 v[112:115], v[204:207], a[112:115], v[112:115]
    v_mfma_f32_16x16x32_bf16 v[116:119], v[200:203], a[100:103], v[116:119]
    ds_read_b64_tr_b16 v[194:195], v241 offset:1024
    v_mfma_f32_16x16x32_bf16 v[116:119], v[204:207], a[116:119], v[116:119]
    ds_read_b128 a[156:159], v233 offset:38912
    v_mfma_f32_16x16x32_bf16 v[120:123], v[200:203], a[104:107], v[120:123]
    ds_read_b64_tr_b16 v[196:197], v241 offset:8192
    v_mfma_f32_16x16x32_bf16 v[120:123], v[204:207], a[120:123], v[120:123]
    v_mfma_f32_16x16x32_bf16 v[124:127], v[200:203], a[108:111], v[124:127]
    ds_read_b64_tr_b16 v[198:199], v241 offset:9216
    v_mfma_f32_16x16x32_bf16 v[124:127], v[204:207], a[124:127], v[124:127]
    s_waitcnt lgkmcnt(6)
    v_mfma_f32_16x16x32_bf16 v[0:3], v[208:211], a[128:131], v[0:3]
    ds_read_b64_tr_b16 v[200:201], v242 offset:0
    v_mfma_f32_16x16x32_bf16 v[0:3], v[212:215], a[144:147], v[0:3]
    v_mfma_f32_16x16x32_bf16 v[4:7], v[208:211], a[132:135], v[4:7]
    ds_read_b64_tr_b16 v[202:203], v242 offset:1024
    v_mfma_f32_16x16x32_bf16 v[4:7], v[212:215], a[148:151], v[4:7]
    s_waitcnt lgkmcnt(4)
    s_add_u32 s64, s82, 768
    s_and_b32 s64, s64, 1023
    v_mfma_f32_16x16x32_bf16 v[8:11], v[208:211], a[136:139], v[8:11]
    s_add_u32 m0, s66, 0
    s_add_u32 s64, s64, s60
    ds_read_b64_tr_b16 v[204:205], v242 offset:8192
    v_mfma_f32_16x16x32_bf16 v[8:11], v[212:215], a[152:155], v[8:11]
    buffer_load_dwordx4 v230, s[16:19], s64 offen offset:0 lds
    v_mfma_f32_16x16x32_bf16 v[12:15], v[208:211], a[140:143], v[12:15]
    ds_read_b64_tr_b16 v[206:207], v242 offset:9216
    v_mfma_f32_16x16x32_bf16 v[12:15], v[212:215], a[156:159], v[12:15]
    s_waitcnt lgkmcnt(4)
    v_mfma_f32_16x16x32_bf16 v[16:19], v[192:195], a[128:131], v[16:19]
    ds_read_b64_tr_b16 v[208:209], v243 offset:0
    v_mfma_f32_16x16x32_bf16 v[16:19], v[196:199], a[144:147], v[16:19]
    buffer_load_dwordx4 v231, s[16:19], s64 offen offset:1024 lds
    v_mfma_f32_16x16x32_bf16 v[20:23], v[192:195], a[132:135], v[20:23]
    ds_read_b64_tr_b16 v[210:211], v243 offset:1024
    v_mfma_f32_16x16x32_bf16 v[20:23], v[196:199], a[148:151], v[20:23]
    v_mfma_f32_16x16x32_bf16 v[24:27], v[192:195], a[136:139], v[24:27]
    ds_read_b64_tr_b16 v[212:213], v243 offset:8192
    v_mfma_f32_16x16x32_bf16 v[24:27], v[196:199], a[152:155], v[24:27]
    buffer_load_dwordx4 v223, s[16:19], s64 offen offset:2048 lds
    v_mfma_f32_16x16x32_bf16 v[28:31], v[192:195], a[140:143], v[28:31]
    ds_read_b64_tr_b16 v[214:215], v243 offset:9216
    v_mfma_f32_16x16x32_bf16 v[28:31], v[196:199], a[156:159], v[28:31]
    s_waitcnt lgkmcnt(4)
    v_mfma_f32_16x16x32_bf16 v[32:35], v[200:203], a[128:131], v[32:35]
    ds_read_b64_tr_b16 v[192:193], v244 offset:0
    v_mfma_f32_16x16x32_bf16 v[32:35], v[204:207], a[144:147], v[32:35]
    buffer_load_dwordx4 v252, s[16:19], s64 offen offset:3072 lds
    v_mfma_f32_16x16x32_bf16 v[36:39], v[200:203], a[132:135], v[36:39]
    ds_read_b64_tr_b16 v[194:195], v244 offset:1024
    v_mfma_f32_16x16x32_bf16 v[36:39], v[204:207], a[148:151], v[36:39]
    s_add_u32 s63, s83, 3145728
    v_mfma_f32_16x16x32_bf16 v[40:43], v[200:203], a[136:139], v[40:43]
    s_add_u32 m0, s67, 131072
    s_and_b32 s63, s63, 0x3fffff
    ds_read_b64_tr_b16 v[196:197], v244 offset:8192
    v_mfma_f32_16x16x32_bf16 v[40:43], v[204:207], a[152:155], v[40:43]
    buffer_load_dwordx4 v226, s[20:23], s63 offen offset:0 nt lds
    v_mfma_f32_16x16x32_bf16 v[44:47], v[200:203], a[140:143], v[44:47]
    ds_read_b64_tr_b16 v[198:199], v244 offset:9216
    v_mfma_f32_16x16x32_bf16 v[44:47], v[204:207], a[156:159], v[44:47]
    s_waitcnt lgkmcnt(4)
    v_mfma_f32_16x16x32_bf16 v[48:51], v[208:211], a[128:131], v[48:51]
    ds_read_b64_tr_b16 v[200:201], v245 offset:0
    v_mfma_f32_16x16x32_bf16 v[48:51], v[212:215], a[144:147], v[48:51]
    buffer_load_dwordx4 v227, s[20:23], s63 offen offset:1024 nt lds
    v_mfma_f32_16x16x32_bf16 v[52:55], v[208:211], a[132:135], v[52:55]
    ds_read_b64_tr_b16 v[202:203], v245 offset:1024
    v_mfma_f32_16x16x32_bf16 v[52:55], v[212:215], a[148:151], v[52:55]
    v_mfma_f32_16x16x32_bf16 v[56:59], v[208:211], a[136:139], v[56:59]
    ds_read_b64_tr_b16 v[204:205], v245 offset:8192
    v_mfma_f32_16x16x32_bf16 v[56:59], v[212:215], a[152:155], v[56:59]
    buffer_load_dwordx4 v238, s[20:23], s63 offen offset:2048 nt lds
    v_mfma_f32_16x16x32_bf16 v[60:63], v[208:211], a[140:143], v[60:63]
    ds_read_b64_tr_b16 v[206:207], v245 offset:9216
    v_mfma_f32_16x16x32_bf16 v[60:63], v[212:215], a[156:159], v[60:63]
    s_waitcnt lgkmcnt(4)
    s_waitcnt vmcnt(15)
    ds_read_b128 a[160:163], v228 offset:0
    v_mfma_f32_16x16x32_bf16 v[64:67], v[192:195], a[128:131], v[64:67]
    ds_read_b64_tr_b16 v[208:209], v246 offset:0
    v_mfma_f32_16x16x32_bf16 v[64:67], v[196:199], a[144:147], v[64:67]
    buffer_load_dwordx4 v239, s[20:23], s63 offen offset:3072 nt lds
    v_mfma_f32_16x16x32_bf16 v[68:71], v[192:195], a[132:135], v[68:71]
    ds_read_b64_tr_b16 v[210:211], v246 offset:1024
    v_mfma_f32_16x16x32_bf16 v[68:71], v[196:199], a[148:151], v[68:71]
    ds_read_b128 a[176:179], v229 offset:0
    v_mfma_f32_16x16x32_bf16 v[72:75], v[192:195], a[136:139], v[72:75]
    s_add_u32 m0, s66, 4096
    s_add_u32 s64, s64, 32768
    ds_read_b64_tr_b16 v[212:213], v246 offset:8192
    v_mfma_f32_16x16x32_bf16 v[72:75], v[196:199], a[152:155], v[72:75]
    buffer_load_dwordx4 v230, s[16:19], s64 offen offset:0 lds
    v_mfma_f32_16x16x32_bf16 v[76:79], v[192:195], a[140:143], v[76:79]
    ds_read_b64_tr_b16 v[214:215], v246 offset:9216
    v_mfma_f32_16x16x32_bf16 v[76:79], v[196:199], a[156:159], v[76:79]
    s_waitcnt lgkmcnt(6)
    ds_read_b128 a[164:167], v228 offset:2048
    v_mfma_f32_16x16x32_bf16 v[80:83], v[200:203], a[128:131], v[80:83]
    ds_read_b64_tr_b16 v[192:193], v247 offset:0
    v_mfma_f32_16x16x32_bf16 v[80:83], v[204:207], a[144:147], v[80:83]
    buffer_load_dwordx4 v231, s[16:19], s64 offen offset:1024 lds
    v_mfma_f32_16x16x32_bf16 v[84:87], v[200:203], a[132:135], v[84:87]
    ds_read_b64_tr_b16 v[194:195], v247 offset:1024
    v_mfma_f32_16x16x32_bf16 v[84:87], v[204:207], a[148:151], v[84:87]
    ds_read_b128 a[180:183], v229 offset:2048
    v_mfma_f32_16x16x32_bf16 v[88:91], v[200:203], a[136:139], v[88:91]
    ds_read_b64_tr_b16 v[196:197], v247 offset:8192
    v_mfma_f32_16x16x32_bf16 v[88:91], v[204:207], a[152:155], v[88:91]
    s_waitcnt vmcnt(14)
    s_barrier
    v_mfma_f32_16x16x32_bf16 v[92:95], v[200:203], a[140:143], v[92:95]
    ds_read_b64_tr_b16 v[198:199], v247 offset:9216
    v_mfma_f32_16x16x32_bf16 v[92:95], v[204:207], a[156:159], v[92:95]
    s_waitcnt lgkmcnt(6)
    s_waitcnt vmcnt(10)
    ds_read_b128 a[168:171], v228 offset:4096
    v_mfma_f32_16x16x32_bf16 v[96:99], v[208:211], a[128:131], v[96:99]
    ds_read_b64_tr_b16 v[200:201], v240 offset:16384
    v_mfma_f32_16x16x32_bf16 v[96:99], v[212:215], a[144:147], v[96:99]
    buffer_load_dwordx4 v223, s[16:19], s64 offen offset:2048 lds
    v_mfma_f32_16x16x32_bf16 v[100:103], v[208:211], a[132:135], v[100:103]
    ds_read_b64_tr_b16 v[202:203], v240 offset:17408
    v_mfma_f32_16x16x32_bf16 v[100:103], v[212:215], a[148:151], v[100:103]
    ds_read_b128 a[184:187], v229 offset:4096
    v_mfma_f32_16x16x32_bf16 v[104:107], v[208:211], a[136:139], v[104:107]
    ds_read_b64_tr_b16 v[204:205], v240 offset:24576
    v_mfma_f32_16x16x32_bf16 v[104:107], v[212:215], a[152:155], v[104:107]
    buffer_load_dwordx4 v252, s[16:19], s64 offen offset:3072 lds
    v_mfma_f32_16x16x32_bf16 v[108:111], v[208:211], a[140:143], v[108:111]
    ds_read_b64_tr_b16 v[206:207], v240 offset:25600
    v_mfma_f32_16x16x32_bf16 v[108:111], v[212:215], a[156:159], v[108:111]
    s_waitcnt lgkmcnt(6)
    ds_read_b128 a[172:175], v228 offset:6144
    v_mfma_f32_16x16x32_bf16 v[112:115], v[192:195], a[128:131], v[112:115]
    ds_read_b64_tr_b16 v[208:209], v241 offset:16384
    v_mfma_f32_16x16x32_bf16 v[112:115], v[196:199], a[144:147], v[112:115]
    v_mfma_f32_16x16x32_bf16 v[116:119], v[192:195], a[132:135], v[116:119]
    ds_read_b64_tr_b16 v[210:211], v241 offset:17408
    v_mfma_f32_16x16x32_bf16 v[116:119], v[196:199], a[148:151], v[116:119]
    s_add_u32 s63, s62, 0
    ds_read_b128 a[188:191], v229 offset:6144
    v_cmp_ne_u32 vcc, 1, v219
    s_nop 1
    s_cbranch_vccnz L_tagsp_sequential_preLN__compressed_kv_cla__geglu_ffn__prompt_kernel
L_tagok_sequential_preLN__compressed_kv_cla__geglu_ffn__prompt_kernel:
    v_readfirstlane_b32 s73, v218
    v_mov_b32 v253, v218
    v_mfma_f32_16x16x32_bf16 v[120:123], v[192:195], a[136:139], v[120:123]
    s_add_u32 m0, s66, 65536
    s_and_b32 s63, s63, 0x3fffff
    ds_read_b64_tr_b16 v[212:213], v241 offset:24576
    v_mfma_f32_16x16x32_bf16 v[120:123], v[196:199], a[152:155], v[120:123]
    buffer_load_dwordx4 v248, s[24:27], s63 offen offset:0 nt lds
    v_mfma_f32_16x16x32_bf16 v[124:127], v[192:195], a[140:143], v[124:127]
    ds_read_b64_tr_b16 v[214:215], v241 offset:25600
    v_mfma_f32_16x16x32_bf16 v[124:127], v[196:199], a[156:159], v[124:127]
    s_waitcnt lgkmcnt(6)
    v_mfma_f32_16x16x32_bf16 v[0:3], v[200:203], a[160:163], v[0:3]
    ds_read_b64_tr_b16 v[192:193], v242 offset:16384
    v_mfma_f32_16x16x32_bf16 v[0:3], v[204:207], a[176:179], v[0:3]
    buffer_load_dwordx4 v249, s[24:27], s63 offen offset:1024 nt lds
    v_mfma_f32_16x16x32_bf16 v[4:7], v[200:203], a[164:167], v[4:7]
    ds_read_b64_tr_b16 v[194:195], v242 offset:17408
    v_mfma_f32_16x16x32_bf16 v[4:7], v[204:207], a[180:183], v[4:7]
    s_waitcnt lgkmcnt(4)
    v_mfma_f32_16x16x32_bf16 v[8:11], v[200:203], a[168:171], v[8:11]
    ds_read_b64_tr_b16 v[196:197], v242 offset:24576
    v_mfma_f32_16x16x32_bf16 v[8:11], v[204:207], a[184:187], v[8:11]
    buffer_load_dwordx4 v250, s[24:27], s63 offen offset:2048 nt lds
    v_mfma_f32_16x16x32_bf16 v[12:15], v[200:203], a[172:175], v[12:15]
    ds_read_b64_tr_b16 v[198:199], v242 offset:25600
    v_mfma_f32_16x16x32_bf16 v[12:15], v[204:207], a[188:191], v[12:15]
    s_waitcnt lgkmcnt(4)
    v_mfma_f32_16x16x32_bf16 v[16:19], v[208:211], a[160:163], v[16:19]
    ds_read_b64_tr_b16 v[200:201], v243 offset:16384
    v_mfma_f32_16x16x32_bf16 v[16:19], v[212:215], a[176:179], v[16:19]
    buffer_load_dwordx4 v251, s[24:27], s63 offen offset:3072 nt lds
    v_mfma_f32_16x16x32_bf16 v[20:23], v[208:211], a[164:167], v[20:23]
    ds_read_b64_tr_b16 v[202:203], v243 offset:17408
    v_mfma_f32_16x16x32_bf16 v[20:23], v[212:215], a[180:183], v[20:23]
    s_add_u32 s64, s82, 896
    s_and_b32 s64, s64, 1023
    v_mfma_f32_16x16x32_bf16 v[24:27], v[208:211], a[168:171], v[24:27]
    s_add_u32 m0, s66, 32768
    s_add_u32 s64, s64, s60
    ds_read_b64_tr_b16 v[204:205], v243 offset:24576
    v_mfma_f32_16x16x32_bf16 v[24:27], v[212:215], a[184:187], v[24:27]
    buffer_load_dwordx4 v230, s[16:19], s64 offen offset:0 lds
    v_mfma_f32_16x16x32_bf16 v[28:31], v[208:211], a[172:175], v[28:31]
    ds_read_b64_tr_b16 v[206:207], v243 offset:25600
    v_mfma_f32_16x16x32_bf16 v[28:31], v[212:215], a[188:191], v[28:31]
    s_waitcnt lgkmcnt(4)
    v_mfma_f32_16x16x32_bf16 v[32:35], v[192:195], a[160:163], v[32:35]
    ds_read_b64_tr_b16 v[208:209], v244 offset:16384
    v_mfma_f32_16x16x32_bf16 v[32:35], v[196:199], a[176:179], v[32:35]
    buffer_load_dwordx4 v231, s[16:19], s64 offen offset:1024 lds
    v_mfma_f32_16x16x32_bf16 v[36:39], v[192:195], a[164:167], v[36:39]
    ds_read_b64_tr_b16 v[210:211], v244 offset:17408
    v_mfma_f32_16x16x32_bf16 v[36:39], v[196:199], a[180:183], v[36:39]
    v_mfma_f32_16x16x32_bf16 v[40:43], v[192:195], a[168:171], v[40:43]
    ds_read_b64_tr_b16 v[212:213], v244 offset:24576
    v_mfma_f32_16x16x32_bf16 v[40:43], v[196:199], a[184:187], v[40:43]
    buffer_load_dwordx4 v223, s[16:19], s64 offen offset:2048 lds
    v_mfma_f32_16x16x32_bf16 v[44:47], v[192:195], a[172:175], v[44:47]
    ds_read_b64_tr_b16 v[214:215], v244 offset:25600
    v_mfma_f32_16x16x32_bf16 v[44:47], v[196:199], a[188:191], v[44:47]
    s_waitcnt lgkmcnt(4)
    v_mfma_f32_16x16x32_bf16 v[48:51], v[200:203], a[160:163], v[48:51]
    ds_read_b64_tr_b16 v[192:193], v245 offset:16384
    v_mfma_f32_16x16x32_bf16 v[48:51], v[204:207], a[176:179], v[48:51]
    buffer_load_dwordx4 v252, s[16:19], s64 offen offset:3072 lds
    v_mfma_f32_16x16x32_bf16 v[52:55], v[200:203], a[164:167], v[52:55]
    ds_read_b64_tr_b16 v[194:195], v245 offset:17408
    v_mfma_f32_16x16x32_bf16 v[52:55], v[204:207], a[180:183], v[52:55]
    s_add_u32 s63, s83, 3670016
    v_mfma_f32_16x16x32_bf16 v[56:59], v[200:203], a[168:171], v[56:59]
    s_add_u32 m0, s67, 147456
    s_and_b32 s63, s63, 0x3fffff
    ds_read_b64_tr_b16 v[196:197], v245 offset:24576
    v_mfma_f32_16x16x32_bf16 v[56:59], v[204:207], a[184:187], v[56:59]
    buffer_load_dwordx4 v226, s[20:23], s63 offen offset:0 nt lds
    v_mfma_f32_16x16x32_bf16 v[60:63], v[200:203], a[172:175], v[60:63]
    ds_read_b64_tr_b16 v[198:199], v245 offset:25600
    v_mfma_f32_16x16x32_bf16 v[60:63], v[204:207], a[188:191], v[60:63]
    s_waitcnt lgkmcnt(4)
    s_waitcnt vmcnt(17)
    ds_read_b128 a[192:195], v232 offset:0
    v_mfma_f32_16x16x32_bf16 v[64:67], v[208:211], a[160:163], v[64:67]
    ds_read_b64_tr_b16 v[200:201], v246 offset:16384
    v_mfma_f32_16x16x32_bf16 v[64:67], v[212:215], a[176:179], v[64:67]
    buffer_load_dwordx4 v227, s[20:23], s63 offen offset:1024 nt lds
    v_mfma_f32_16x16x32_bf16 v[68:71], v[208:211], a[164:167], v[68:71]
    ds_read_b64_tr_b16 v[202:203], v246 offset:17408
    v_mfma_f32_16x16x32_bf16 v[68:71], v[212:215], a[180:183], v[68:71]
    ds_read_b128 a[208:211], v233 offset:0
    v_mfma_f32_16x16x32_bf16 v[72:75], v[208:211], a[168:171], v[72:75]
    ds_read_b64_tr_b16 v[204:205], v246 offset:24576
    v_mfma_f32_16x16x32_bf16 v[72:75], v[212:215], a[184:187], v[72:75]
    buffer_load_dwordx4 v238, s[20:23], s63 offen offset:2048 nt lds
    v_mfma_f32_16x16x32_bf16 v[76:79], v[208:211], a[172:175], v[76:79]
    ds_read_b64_tr_b16 v[206:207], v246 offset:25600
    v_mfma_f32_16x16x32_bf16 v[76:79], v[212:215], a[188:191], v[76:79]
    s_waitcnt lgkmcnt(6)
    ds_read_b128 a[196:199], v232 offset:2048
    v_mfma_f32_16x16x32_bf16 v[80:83], v[192:195], a[160:163], v[80:83]
    ds_read_b64_tr_b16 v[208:209], v247 offset:16384
    v_mfma_f32_16x16x32_bf16 v[80:83], v[196:199], a[176:179], v[80:83]
    buffer_load_dwordx4 v239, s[20:23], s63 offen offset:3072 nt lds
    v_mfma_f32_16x16x32_bf16 v[84:87], v[192:195], a[164:167], v[84:87]
    ds_read_b64_tr_b16 v[210:211], v247 offset:17408
    v_mfma_f32_16x16x32_bf16 v[84:87], v[196:199], a[180:183], v[84:87]
    ds_read_b128 a[212:215], v233 offset:2048
    v_mfma_f32_16x16x32_bf16 v[88:91], v[192:195], a[168:171], v[88:91]
    ds_read_b64_tr_b16 v[212:213], v247 offset:24576
    v_mfma_f32_16x16x32_bf16 v[88:91], v[196:199], a[184:187], v[88:91]
    s_waitcnt vmcnt(16)
    s_barrier
    v_mfma_f32_16x16x32_bf16 v[92:95], v[192:195], a[172:175], v[92:95]
    ds_read_b64_tr_b16 v[214:215], v247 offset:25600
    v_mfma_f32_16x16x32_bf16 v[92:95], v[196:199], a[188:191], v[92:95]
    s_waitcnt lgkmcnt(6)
    s_waitcnt vmcnt(12)
    ds_read_b128 a[200:203], v232 offset:4096
    v_mfma_f32_16x16x32_bf16 v[96:99], v[200:203], a[160:163], v[96:99]
    s_add_u32 m0, s66, 36864
    s_add_u32 s64, s64, 32768
    ds_read_b64_tr_b16 v[192:193], v240 offset:32768
    v_mfma_f32_16x16x32_bf16 v[96:99], v[204:207], a[176:179], v[96:99]
    buffer_load_dwordx4 v230, s[16:19], s64 offen offset:0 lds
    v_mfma_f32_16x16x32_bf16 v[100:103], v[200:203], a[164:167], v[100:103]
    ds_read_b64_tr_b16 v[194:195], v240 offset:33792
    v_mfma_f32_16x16x32_bf16 v[100:103], v[204:207], a[180:183], v[100:103]
    ds_read_b128 a[216:219], v233 offset:4096
    v_mfma_f32_16x16x32_bf16 v[104:107], v[200:203], a[168:171], v[104:107]
    ds_read_b64_tr_b16 v[196:197], v240 offset:40960
    v_mfma_f32_16x16x32_bf16 v[104:107], v[204:207], a[184:187], v[104:107]
    buffer_load_dwordx4 v231, s[16:19], s64 offen offset:1024 lds
    v_mfma_f32_16x16x32_bf16 v[108:111], v[200:203], a[172:175], v[108:111]
    ds_read_b64_tr_b16 v[198:199], v240 offset:41984
    v_mfma_f32_16x16x32_bf16 v[108:111], v[204:207], a[188:191], v[108:111]
    s_waitcnt lgkmcnt(6)
    ds_read_b128 a[204:207], v232 offset:6144
    v_mfma_f32_16x16x32_bf16 v[112:115], v[208:211], a[160:163], v[112:115]
    ds_read_b64_tr_b16 v[200:201], v241 offset:32768
    v_mfma_f32_16x16x32_bf16 v[112:115], v[212:215], a[176:179], v[112:115]
    buffer_load_dwordx4 v223, s[16:19], s64 offen offset:2048 lds
    v_mfma_f32_16x16x32_bf16 v[116:119], v[208:211], a[164:167], v[116:119]
    ds_read_b64_tr_b16 v[202:203], v241 offset:33792
    v_mfma_f32_16x16x32_bf16 v[116:119], v[212:215], a[180:183], v[116:119]
    ds_read_b128 a[220:223], v233 offset:6144
    v_mfma_f32_16x16x32_bf16 v[120:123], v[208:211], a[168:171], v[120:123]
    ds_read_b64_tr_b16 v[204:205], v241 offset:40960
    v_mfma_f32_16x16x32_bf16 v[120:123], v[212:215], a[184:187], v[120:123]
    buffer_load_dwordx4 v252, s[16:19], s64 offen offset:3072 lds
    v_mfma_f32_16x16x32_bf16 v[124:127], v[208:211], a[172:175], v[124:127]
    ds_read_b64_tr_b16 v[206:207], v241 offset:41984
    v_mfma_f32_16x16x32_bf16 v[124:127], v[212:215], a[188:191], v[124:127]
    s_waitcnt lgkmcnt(6)
    v_mfma_f32_16x16x32_bf16 v[0:3], v[192:195], a[192:195], v[0:3]
    ds_read_b64_tr_b16 v[208:209], v242 offset:32768
    v_mfma_f32_16x16x32_bf16 v[0:3], v[196:199], a[208:211], v[0:3]
    buffer_store_dwordx4 v[128:131], v216, s[8:11], s4 offen sc1
    v_mfma_f32_16x16x32_bf16 v[4:7], v[192:195], a[196:199], v[4:7]
    s_add_u32 s4, s4, 4096
    ds_read_b64_tr_b16 v[210:211], v242 offset:33792
    v_mfma_f32_16x16x32_bf16 v[4:7], v[196:199], a[212:215], v[4:7]
    s_waitcnt lgkmcnt(4)
    v_mfma_f32_16x16x32_bf16 v[8:11], v[192:195], a[200:203], v[8:11]
    ds_read_b64_tr_b16 v[212:213], v242 offset:40960
    v_mfma_f32_16x16x32_bf16 v[8:11], v[196:199], a[216:219], v[8:11]
    v_mfma_f32_16x16x32_bf16 v[12:15], v[192:195], a[204:207], v[12:15]
    ds_read_b64_tr_b16 v[214:215], v242 offset:41984
    v_mfma_f32_16x16x32_bf16 v[12:15], v[196:199], a[220:223], v[12:15]
    s_waitcnt lgkmcnt(4)
    v_mfma_f32_16x16x32_bf16 v[16:19], v[200:203], a[192:195], v[16:19]
    ds_read_b64_tr_b16 v[192:193], v243 offset:32768
    v_mfma_f32_16x16x32_bf16 v[16:19], v[204:207], a[208:211], v[16:19]
    buffer_store_dwordx4 v[132:135], v216, s[8:11], s4 offen sc1
    v_mfma_f32_16x16x32_bf16 v[20:23], v[200:203], a[196:199], v[20:23]
    ds_read_b64_tr_b16 v[194:195], v243 offset:33792
    v_mfma_f32_16x16x32_bf16 v[20:23], v[204:207], a[212:215], v[20:23]
    v_mfma_f32_16x16x32_bf16 v[24:27], v[200:203], a[200:203], v[24:27]
    ds_read_b64_tr_b16 v[196:197], v243 offset:40960
    v_mfma_f32_16x16x32_bf16 v[24:27], v[204:207], a[216:219], v[24:27]
    v_mfma_f32_16x16x32_bf16 v[28:31], v[200:203], a[204:207], v[28:31]
    ds_read_b64_tr_b16 v[198:199], v243 offset:41984
    v_mfma_f32_16x16x32_bf16 v[28:31], v[204:207], a[220:223], v[28:31]
    s_waitcnt lgkmcnt(4)
    s_add_u32 s63, s62, 1048576
    v_mfma_f32_16x16x32_bf16 v[32:35], v[208:211], a[192:195], v[32:35]
    s_add_u32 m0, s66, 69632
    s_and_b32 s63, s63, 0x3fffff
    ds_read_b64_tr_b16 v[200:201], v244 offset:32768
    v_mfma_f32_16x16x32_bf16 v[32:35], v[212:215], a[208:211], v[32:35]
    buffer_load_dwordx4 v248, s[24:27], s63 offen offset:0 nt lds
    v_mfma_f32_16x16x32_bf16 v[36:39], v[208:211], a[196:199], v[36:39]
    ds_read_b64_tr_b16 v[202:203], v244 offset:33792
    v_mfma_f32_16x16x32_bf16 v[36:39], v[212:215], a[212:215], v[36:39]
    v_mfma_f32_16x16x32_bf16 v[40:43], v[208:211], a[200:203], v[40:43]
    ds_read_b64_tr_b16 v[204:205], v244 offset:40960
    v_mfma_f32_16x16x32_bf16 v[40:43], v[212:215], a[216:219], v[40:43]
    buffer_load_dwordx4 v249, s[24:27], s63 offen offset:1024 nt lds
    v_mfma_f32_16x16x32_bf16 v[44:47], v[208:211], a[204:207], v[44:47]
    ds_read_b64_tr_b16 v[206:207], v244 offset:41984
    v_mfma_f32_16x16x32_bf16 v[44:47], v[212:215], a[220:223], v[44:47]
    s_waitcnt lgkmcnt(4)
    v_mfma_f32_16x16x32_bf16 v[48:51], v[192:195], a[192:195], v[48:51]
    ds_read_b64_tr_b16 v[208:209], v245 offset:32768
    v_mfma_f32_16x16x32_bf16 v[48:51], v[196:199], a[208:211], v[48:51]
    buffer_load_dwordx4 v250, s[24:27], s63 offen offset:2048 nt lds
    v_mfma_f32_16x16x32_bf16 v[52:55], v[192:195], a[196:199], v[52:55]
    ds_read_b64_tr_b16 v[210:211], v245 offset:33792
    v_mfma_f32_16x16x32_bf16 v[52:55], v[196:199], a[212:215], v[52:55]
    v_mfma_f32_16x16x32_bf16 v[56:59], v[192:195], a[200:203], v[56:59]
    ds_read_b64_tr_b16 v[212:213], v245 offset:40960
    v_mfma_f32_16x16x32_bf16 v[56:59], v[196:199], a[216:219], v[56:59]
    buffer_load_dwordx4 v251, s[24:27], s63 offen offset:3072 nt lds
    v_mfma_f32_16x16x32_bf16 v[60:63], v[192:195], a[204:207], v[60:63]
    ds_read_b64_tr_b16 v[214:215], v245 offset:41984
    v_mfma_f32_16x16x32_bf16 v[60:63], v[196:199], a[220:223], v[60:63]
    s_waitcnt lgkmcnt(4)
    s_add_u32 s63, s62, 2097152
    s_waitcnt vmcnt(14)
    ds_read_b128 a[224:227], v232 offset:32768
    v_mfma_f32_16x16x32_bf16 v[64:67], v[200:203], a[192:195], v[64:67]
    s_add_u32 m0, s67, 98304
    s_and_b32 s63, s63, 0x3fffff
    ds_read_b64_tr_b16 v[192:193], v246 offset:32768
    v_mfma_f32_16x16x32_bf16 v[64:67], v[204:207], a[208:211], v[64:67]
    buffer_load_dwordx4 v248, s[24:27], s63 offen offset:0 nt lds
    v_mfma_f32_16x16x32_bf16 v[68:71], v[200:203], a[196:199], v[68:71]
    ds_read_b64_tr_b16 v[194:195], v246 offset:33792
    v_mfma_f32_16x16x32_bf16 v[68:71], v[204:207], a[212:215], v[68:71]
    ds_read_b128 a[240:243], v233 offset:32768
    v_mfma_f32_16x16x32_bf16 v[72:75], v[200:203], a[200:203], v[72:75]
    ds_read_b64_tr_b16 v[196:197], v246 offset:40960
    v_mfma_f32_16x16x32_bf16 v[72:75], v[204:207], a[216:219], v[72:75]
    buffer_load_dwordx4 v249, s[24:27], s63 offen offset:1024 nt lds
    v_mfma_f32_16x16x32_bf16 v[76:79], v[200:203], a[204:207], v[76:79]
    ds_read_b64_tr_b16 v[198:199], v246 offset:41984
    v_mfma_f32_16x16x32_bf16 v[76:79], v[204:207], a[220:223], v[76:79]
    s_waitcnt lgkmcnt(6)
    ds_read_b128 a[228:231], v232 offset:34816
    v_mfma_f32_16x16x32_bf16 v[80:83], v[208:211], a[192:195], v[80:83]
    ds_read_b64_tr_b16 v[200:201], v247 offset:32768
    v_mfma_f32_16x16x32_bf16 v[80:83], v[212:215], a[208:211], v[80:83]
    buffer_load_dwordx4 v250, s[24:27], s63 offen offset:2048 nt lds
    v_mfma_f32_16x16x32_bf16 v[84:87], v[208:211], a[196:199], v[84:87]
    ds_read_b64_tr_b16 v[202:203], v247 offset:33792
    v_mfma_f32_16x16x32_bf16 v[84:87], v[212:215], a[212:215], v[84:87]
    ds_read_b128 a[244:247], v233 offset:34816
    v_mfma_f32_16x16x32_bf16 v[88:91], v[208:211], a[200:203], v[88:91]
    ds_read_b64_tr_b16 v[204:205], v247 offset:40960
    v_mfma_f32_16x16x32_bf16 v[88:91], v[212:215], a[216:219], v[88:91]
    s_waitcnt vmcnt(13)
    s_barrier
    v_mfma_f32_16x16x32_bf16 v[92:95], v[208:211], a[204:207], v[92:95]
    ds_read_b64_tr_b16 v[206:207], v247 offset:41984
    v_mfma_f32_16x16x32_bf16 v[92:95], v[212:215], a[220:223], v[92:95]
    s_waitcnt lgkmcnt(6)
    s_waitcnt vmcnt(9)
    ds_read_b128 a[232:235], v232 offset:36864
    v_mfma_f32_16x16x32_bf16 v[96:99], v[192:195], a[192:195], v[96:99]
    ds_read_b64_tr_b16 v[208:209], v240 offset:49152
    v_mfma_f32_16x16x32_bf16 v[96:99], v[196:199], a[208:211], v[96:99]
    buffer_load_dwordx4 v251, s[24:27], s63 offen offset:3072 nt lds
    v_mfma_f32_16x16x32_bf16 v[100:103], v[192:195], a[196:199], v[100:103]
    ds_read_b64_tr_b16 v[210:211], v240 offset:50176
    v_mfma_f32_16x16x32_bf16 v[100:103], v[196:199], a[212:215], v[100:103]
    s_add_u32 s63, s62, 128
    ds_read_b128 a[248:251], v233 offset:36864
    v_mfma_f32_16x16x32_bf16 v[104:107], v[192:195], a[200:203], v[104:107]
    s_add_u32 m0, s66, 0
    s_and_b32 s63, s63, 0x3fffff
    ds_read_b64_tr_b16 v[212:213], v240 offset:57344
    v_mfma_f32_16x16x32_bf16 v[104:107], v[196:199], a[216:219], v[104:107]
    buffer_load_dwordx4 v248, s[24:27], s63 offen offset:0 nt lds
    v_mfma_f32_16x16x32_bf16 v[108:111], v[192:195], a[204:207], v[108:111]
    ds_read_b64_tr_b16 v[214:215], v240 offset:58368
    v_mfma_f32_16x16x32_bf16 v[108:111], v[196:199], a[220:223], v[108:111]
    s_waitcnt lgkmcnt(6)
    ds_read_b128 a[236:239], v232 offset:38912
    v_add_u32 v240, 0xffff8000, v240
    v_mfma_f32_16x16x32_bf16 v[112:115], v[200:203], a[192:195], v[112:115]
    ds_read_b64_tr_b16 v[192:193], v241 offset:49152
    v_mfma_f32_16x16x32_bf16 v[112:115], v[204:207], a[208:211], v[112:115]
    buffer_load_dwordx4 v249, s[24:27], s63 offen offset:1024 nt lds
    v_mfma_f32_16x16x32_bf16 v[116:119], v[200:203], a[196:199], v[116:119]
    ds_read_b64_tr_b16 v[194:195], v241 offset:50176
    v_mfma_f32_16x16x32_bf16 v[116:119], v[204:207], a[212:215], v[116:119]
    ds_read_b128 a[252:255], v233 offset:38912
    v_mfma_f32_16x16x32_bf16 v[120:123], v[200:203], a[200:203], v[120:123]
    ds_read_b64_tr_b16 v[196:197], v241 offset:57344
    v_mfma_f32_16x16x32_bf16 v[120:123], v[204:207], a[216:219], v[120:123]
    buffer_load_dwordx4 v250, s[24:27], s63 offen offset:2048 nt lds
    v_mfma_f32_16x16x32_bf16 v[124:127], v[200:203], a[204:207], v[124:127]
    ds_read_b64_tr_b16 v[198:199], v241 offset:58368
    v_mfma_f32_16x16x32_bf16 v[124:127], v[204:207], a[220:223], v[124:127]
    s_waitcnt lgkmcnt(6)
    v_add_u32 v241, 0xffff8000, v241
    v_mfma_f32_16x16x32_bf16 v[0:3], v[208:211], a[224:227], v[0:3]
    ds_read_b64_tr_b16 v[200:201], v242 offset:49152
    v_mfma_f32_16x16x32_bf16 v[0:3], v[212:215], a[240:243], v[0:3]
    buffer_load_dwordx4 v251, s[24:27], s63 offen offset:3072 nt lds
    v_mfma_f32_16x16x32_bf16 v[4:7], v[208:211], a[228:231], v[4:7]
    ds_read_b64_tr_b16 v[202:203], v242 offset:50176
    v_mfma_f32_16x16x32_bf16 v[4:7], v[212:215], a[244:247], v[4:7]
    s_waitcnt lgkmcnt(4)
    s_add_u32 s63, s62, 1048704
    v_mfma_f32_16x16x32_bf16 v[8:11], v[208:211], a[232:235], v[8:11]
    s_add_u32 m0, s66, 4096
    s_and_b32 s63, s63, 0x3fffff
    ds_read_b64_tr_b16 v[204:205], v242 offset:57344
    v_mfma_f32_16x16x32_bf16 v[8:11], v[212:215], a[248:251], v[8:11]
    buffer_load_dwordx4 v248, s[24:27], s63 offen offset:0 nt lds
    v_mfma_f32_16x16x32_bf16 v[12:15], v[208:211], a[236:239], v[12:15]
    ds_read_b64_tr_b16 v[206:207], v242 offset:58368
    v_mfma_f32_16x16x32_bf16 v[12:15], v[212:215], a[252:255], v[12:15]
    s_waitcnt lgkmcnt(4)
    v_add_u32 v242, 0xffff8000, v242
    v_mfma_f32_16x16x32_bf16 v[16:19], v[192:195], a[224:227], v[16:19]
    ds_read_b64_tr_b16 v[208:209], v243 offset:49152
    v_mfma_f32_16x16x32_bf16 v[16:19], v[196:199], a[240:243], v[16:19]
    buffer_load_dwordx4 v249, s[24:27], s63 offen offset:1024 nt lds
    v_mfma_f32_16x16x32_bf16 v[20:23], v[192:195], a[228:231], v[20:23]
    ds_read_b64_tr_b16 v[210:211], v243 offset:50176
    v_cvt_pk_bf16_f32 v0, v0, v1
    v_mfma_f32_16x16x32_bf16 v[20:23], v[196:199], a[244:247], v[20:23]
    v_cvt_pk_bf16_f32 v1, v2, v3
    v_cvt_pk_bf16_f32 v2, v4, v5
    v_mfma_f32_16x16x32_bf16 v[24:27], v[192:195], a[232:235], v[24:27]
    ds_read_b64_tr_b16 v[212:213], v243 offset:57344
    v_cvt_pk_bf16_f32 v3, v6, v7
    v_mfma_f32_16x16x32_bf16 v[24:27], v[196:199], a[248:251], v[24:27]
    buffer_load_dwordx4 v250, s[24:27], s63 offen offset:2048 nt lds
    v_mfma_f32_16x16x32_bf16 v[28:31], v[192:195], a[236:239], v[28:31]
    ds_read_b64_tr_b16 v[214:215], v243 offset:58368
    v_permlane16_swap_b32 v0, v2
    v_mfma_f32_16x16x32_bf16 v[28:31], v[196:199], a[252:255], v[28:31]
    s_waitcnt lgkmcnt(4)
    v_add_u32 v243, 0xffff8000, v243
    v_permlane16_swap_b32 v1, v3
    v_mfma_f32_16x16x32_bf16 v[32:35], v[200:203], a[224:227], v[32:35]
    ds_read_b64_tr_b16 v[192:193], v244 offset:49152
    v_mfma_f32_16x16x32_bf16 v[32:35], v[204:207], a[240:243], v[32:35]
    v_cvt_pk_bf16_f32 v8, v8, v9
    v_cvt_pk_bf16_f32 v9, v10, v11
    v_mfma_f32_16x16x32_bf16 v[36:39], v[200:203], a[228:231], v[36:39]
    ds_read_b64_tr_b16 v[194:195], v244 offset:50176
    v_cvt_pk_bf16_f32 v10, v12, v13
    v_mfma_f32_16x16x32_bf16 v[36:39], v[204:207], a[244:247], v[36:39]
    v_cvt_pk_bf16_f32 v11, v14, v15
    v_mfma_f32_16x16x32_bf16 v[40:43], v[200:203], a[232:235], v[40:43]
    ds_read_b64_tr_b16 v[196:197], v244 offset:57344
    v_mfma_f32_16x16x32_bf16 v[40:43], v[204:207], a[248:251], v[40:43]
    buffer_load_dwordx4 v251, s[24:27], s63 offen offset:3072 nt lds
    v_mfma_f32_16x16x32_bf16 v[44:47], v[200:203], a[236:239], v[44:47]
    ds_read_b64_tr_b16 v[198:199], v244 offset:58368
    v_permlane16_swap_b32 v8, v10
    v_mfma_f32_16x16x32_bf16 v[44:47], v[204:207], a[252:255], v[44:47]
    s_waitcnt lgkmcnt(4)
    v_add_u32 v244, 0xffff8000, v244
    v_permlane16_swap_b32 v9, v11
    v_mfma_f32_16x16x32_bf16 v[48:51], v[208:211], a[224:227], v[48:51]
    s_add_u32 s3, s65, 0
    ds_read_b64_tr_b16 v[200:201], v245 offset:49152
    v_cvt_pk_bf16_f32 v16, v16, v17
    v_mfma_f32_16x16x32_bf16 v[48:51], v[212:215], a[240:243], v[48:51]
    buffer_store_dwordx4 v[0:3], v225, s[8:11], s3 offen offset:0 sc1
    v_mfma_f32_16x16x32_bf16 v[52:55], v[208:211], a[228:231], v[52:55]
    ds_read_b64_tr_b16 v[202:203], v245 offset:50176
    v_cvt_pk_bf16_f32 v17, v18, v19
    v_mfma_f32_16x16x32_bf16 v[52:55], v[212:215], a[244:247], v[52:55]
    v_cvt_pk_bf16_f32 v18, v20, v21
    v_cvt_pk_bf16_f32 v19, v22, v23
    v_mfma_f32_16x16x32_bf16 v[56:59], v[208:211], a[232:235], v[56:59]
    ds_read_b64_tr_b16 v[204:205], v245 offset:57344
    v_mfma_f32_16x16x32_bf16 v[56:59], v[212:215], a[248:251], v[56:59]
    v_permlane16_swap_b32 v16, v18
    v_permlane16_swap_b32 v17, v19
    v_mfma_f32_16x16x32_bf16 v[60:63], v[208:211], a[236:239], v[60:63]
    ds_read_b64_tr_b16 v[206:207], v245 offset:58368
    v_mfma_f32_16x16x32_bf16 v[60:63], v[212:215], a[252:255], v[60:63]
    s_waitcnt lgkmcnt(4)
    s_add_u32 s63, s62, 3145728
    v_add_u32 v245, 0xffff8000, v245
    v_mfma_f32_16x16x32_bf16 v[64:67], v[192:195], a[224:227], v[64:67]
    s_add_u32 m0, s67, 114688
    s_and_b32 s63, s63, 0x3fffff
    ds_read_b64_tr_b16 v[208:209], v246 offset:49152
    v_mfma_f32_16x16x32_bf16 v[64:67], v[196:199], a[240:243], v[64:67]
    buffer_load_dwordx4 v248, s[24:27], s63 offen offset:0 nt lds
    v_mfma_f32_16x16x32_bf16 v[68:71], v[192:195], a[228:231], v[68:71]
    ds_read_b64_tr_b16 v[210:211], v246 offset:50176
    v_mfma_f32_16x16x32_bf16 v[68:71], v[196:199], a[244:247], v[68:71]
    v_mfma_f32_16x16x32_bf16 v[72:75], v[192:195], a[232:235], v[72:75]
    ds_read_b64_tr_b16 v[212:213], v246 offset:57344
    v_mfma_f32_16x16x32_bf16 v[72:75], v[196:199], a[248:251], v[72:75]
    buffer_load_dwordx4 v249, s[24:27], s63 offen offset:1024 nt lds
    v_mfma_f32_16x16x32_bf16 v[76:79], v[192:195], a[236:239], v[76:79]
    ds_read_b64_tr_b16 v[214:215], v246 offset:58368
    v_mfma_f32_16x16x32_bf16 v[76:79], v[196:199], a[252:255], v[76:79]
    s_waitcnt lgkmcnt(4)
    v_add_u32 v246, 0xffff8000, v246
    v_mfma_f32_16x16x32_bf16 v[80:83], v[200:203], a[224:227], v[80:83]
    ds_read_b64_tr_b16 v[192:193], v247 offset:49152
    v_mfma_f32_16x16x32_bf16 v[80:83], v[204:207], a[240:243], v[80:83]
    buffer_load_dwordx4 v250, s[24:27], s63 offen offset:2048 nt lds
    v_mfma_f32_16x16x32_bf16 v[84:87], v[200:203], a[228:231], v[84:87]
    ds_read_b64_tr_b16 v[194:195], v247 offset:50176
    v_mfma_f32_16x16x32_bf16 v[84:87], v[204:207], a[244:247], v[84:87]
    v_mfma_f32_16x16x32_bf16 v[88:91], v[200:203], a[232:235], v[88:91]
    ds_read_b64_tr_b16 v[196:197], v247 offset:57344
    v_mfma_f32_16x16x32_bf16 v[88:91], v[204:207], a[248:251], v[88:91]
    s_waitcnt vmcnt(20)
    s_barrier
    v_cvt_pk_bf16_f32 v24, v24, v25
    v_mfma_f32_16x16x32_bf16 v[92:95], v[200:203], a[236:239], v[92:95]
    ds_read_b64_tr_b16 v[198:199], v247 offset:58368
    v_cvt_pk_bf16_f32 v25, v26, v27
    v_mfma_f32_16x16x32_bf16 v[92:95], v[204:207], a[252:255], v[92:95]
    s_waitcnt lgkmcnt(4)
    v_add_u32 v247, 0xffff8000, v247
    v_cvt_pk_bf16_f32 v26, v28, v29
    v_mfma_f32_16x16x32_bf16 v[96:99], v[208:211], a[224:227], v[96:99]
    ds_read_b64_tr_b16 v[200:201], v234 offset:0
    v_cvt_pk_bf16_f32 v27, v30, v31
    v_mfma_f32_16x16x32_bf16 v[96:99], v[212:215], a[240:243], v[96:99]
    buffer_load_dwordx4 v251, s[24:27], s63 offen offset:3072 nt lds
    v_mfma_f32_16x16x32_bf16 v[100:103], v[208:211], a[228:231], v[100:103]
    ds_read_b64_tr_b16 v[202:203], v234 offset:512
    v_permlane16_swap_b32 v24, v26
    v_mfma_f32_16x16x32_bf16 v[100:103], v[212:215], a[244:247], v[100:103]
    v_permlane16_swap_b32 v25, v27
    v_mfma_f32_16x16x32_bf16 v[104:107], v[208:211], a[232:235], v[104:107]
    ds_read_b64_tr_b16 v[204:205], v234 offset:8192
    v_mfma_f32_16x16x32_bf16 v[104:107], v[212:215], a[248:251], v[104:107]
    buffer_store_dword v253, v255, s[8:11], s5 offen sc1
    v_mfma_f32_16x16x32_bf16 v[108:111], v[208:211], a[236:239], v[108:111]
    ds_read_b64_tr_b16 v[206:207], v234 offset:8704
    v_cvt_pk_bf16_f32 v32, v32, v33
    v_mfma_f32_16x16x32_bf16 v[108:111], v[212:215], a[252:255], v[108:111]
    s_waitcnt lgkmcnt(4)
    v_cvt_pk_bf16_f32 v33, v34, v35
    v_cvt_pk_bf16_f32 v34, v36, v37
    v_mfma_f32_16x16x32_bf16 v[112:115], v[192:195], a[224:227], v[112:115]
    s_add_u32 s3, s65, 8192
    ds_read_b64_tr_b16 v[208:209], v234 offset:16384
    v_cvt_pk_bf16_f32 v35, v38, v39
    v_mfma_f32_16x16x32_bf16 v[112:115], v[196:199], a[240:243], v[112:115]
    buffer_store_dwordx4 v[8:11], v225, s[8:11], s3 offen offset:0 sc1
    v_mfma_f32_16x16x32_bf16 v[116:119], v[192:195], a[228:231], v[116:119]
    ds_read_b64_tr_b16 v[210:211], v234 offset:16896
    v_permlane16_swap_b32 v32, v34
    v_mfma_f32_16x16x32_bf16 v[116:119], v[196:199], a[244:247], v[116:119]
    v_permlane16_swap_b32 v33, v35
    v_mfma_f32_16x16x32_bf16 v[120:123], v[192:195], a[232:235], v[120:123]
    s_add_u32 s3, s65, 0
    ds_read_b64_tr_b16 v[212:213], v234 offset:24576
    v_mfma_f32_16x16x32_bf16 v[120:123], v[196:199], a[248:251], v[120:123]
    buffer_store_dwordx4 v[16:19], v225, s[8:11], s3 offen offset:1024 sc1
    v_mfma_f32_16x16x32_bf16 v[124:127], v[192:195], a[236:239], v[124:127]
    ds_read_b64_tr_b16 v[214:215], v234 offset:25088
    v_mfma_f32_16x16x32_bf16 v[124:127], v[196:199], a[252:255], v[124:127]
    s_waitcnt lgkmcnt(4)
    v_mfma_f32_16x16x32_bf16 v[128:131], a[0:3], v[200:203], 0
    ds_read_b64_tr_b16 v[192:193], v235 offset:0
    v_mfma_f32_16x16x32_bf16 v[128:131], a[16:19], v[204:207], v[128:131]
    v_cvt_pk_bf16_f32 v40, v40, v41
    v_cvt_pk_bf16_f32 v41, v42, v43
    v_mfma_f32_16x16x32_bf16 v[136:139], a[4:7], v[200:203], 0
    ds_read_b64_tr_b16 v[194:195], v235 offset:512
    v_cvt_pk_bf16_f32 v42, v44, v45
    v_mfma_f32_16x16x32_bf16 v[136:139], a[20:23], v[204:207], v[136:139]
    s_add_u32 s63, s62, 2097280
    v_cvt_pk_bf16_f32 v43, v46, v47
    v_mfma_f32_16x16x32_bf16 v[144:147], a[8:11], v[200:203], 0
    s_add_u32 m0, s66, 32768
    s_and_b32 s63, s63, 0x3fffff
    ds_read_b64_tr_b16 v[196:197], v235 offset:8192
    v_mfma_f32_16x16x32_bf16 v[144:147], a[24:27], v[204:207], v[144:147]
    buffer_load_dwordx4 v248, s[24:27], s63 offen offset:0 nt lds
    v_mfma_f32_16x16x32_bf16 v[152:155], a[12:15], v[200:203], 0
    ds_read_b64_tr_b16 v[198:199], v235 offset:8704
    v_permlane16_swap_b32 v40, v42
    v_mfma_f32_16x16x32_bf16 v[152:155], a[28:31], v[204:207], v[152:155]
    s_waitcnt lgkmcnt(4)
    v_permlane16_swap_b32 v41, v43
    v_mfma_f32_16x16x32_bf16 v[128:131], a[32:35], v[208:211], v[128:131]
    ds_read_b64_tr_b16 v[200:201], v235 offset:16384
    v_mfma_f32_16x16x32_bf16 v[128:131], a[48:51], v[212:215], v[128:131]
    buffer_load_dwordx4 v249, s[24:27], s63 offen offset:1024 nt lds
    v_mfma_f32_16x16x32_bf16 v[136:139], a[36:39], v[208:211], v[136:139]
    ds_read_b64_tr_b16 v[202:203], v235 offset:16896
    v_mfma_f32_16x16x32_bf16 v[136:139], a[52:55], v[212:215], v[136:139]
    v_mfma_f32_16x16x32_bf16 v[144:147], a[40:43], v[208:211], v[144:147]
    ds_read_b64_tr_b16 v[204:205], v235 offset:24576
    v_mfma_f32_16x16x32_bf16 v[144:147], a[56:59], v[212:215], v[144:147]
    buffer_load_dwordx4 v250, s[24:27], s63 offen offset:2048 nt lds
    v_mfma_f32_16x16x32_bf16 v[152:155], a[44:47], v[208:211], v[152:155]
    ds_read_b64_tr_b16 v[206:207], v235 offset:25088
    v_mfma_f32_16x16x32_bf16 v[152:155], a[60:63], v[212:215], v[152:155]
    s_waitcnt lgkmcnt(4)
    v_mfma_f32_16x16x32_bf16 v[132:135], a[0:3], v[192:195], 0
    ds_read_b64_tr_b16 v[208:209], v236 offset:0
    v_mfma_f32_16x16x32_bf16 v[132:135], a[16:19], v[196:199], v[132:135]
    buffer_load_dwordx4 v251, s[24:27], s63 offen offset:3072 nt lds
    v_mfma_f32_16x16x32_bf16 v[140:143], a[4:7], v[192:195], 0
    ds_read_b64_tr_b16 v[210:211], v236 offset:512
    v_mfma_f32_16x16x32_bf16 v[140:143], a[20:23], v[196:199], v[140:143]
    v_mfma_f32_16x16x32_bf16 v[148:151], a[8:11], v[192:195], 0
    s_add_u32 s3, s65, 8192
    ds_read_b64_tr_b16 v[212:213], v236 offset:8192
    v_mfma_f32_16x16x32_bf16 v[148:151], a[24:27], v[196:199], v[148:151]
    buffer_store_dwordx4 v[24:27], v225, s[8:11], s3 offen offset:1024 sc1
    v_mfma_f32_16x16x32_bf16 v[156:159], a[12:15], v[192:195], 0
    ds_read_b64_tr_b16 v[214:215], v236 offset:8704
    v_mfma_f32_16x16x32_bf16 v[156:159], a[28:31], v[196:199], v[156:159]
    s_waitcnt lgkmcnt(4)
    v_mfma_f32_16x16x32_bf16 v[132:135], a[32:35], v[200:203], v[132:135]
    ds_read_b64_tr_b16 v[192:193], v236 offset:16384
    v_mfma_f32_16x16x32_bf16 v[132:135], a[48:51], v[204:207], v[132:135]
    v_cvt_pk_bf16_f32 v48, v48, v49
    v_cvt_pk_bf16_f32 v49, v50, v51
    v_mfma_f32_16x16x32_bf16 v[140:143], a[36:39], v[200:203], v[140:143]
    ds_read_b64_tr_b16 v[194:195], v236 offset:16896
    v_cvt_pk_bf16_f32 v50, v52, v53
    v_mfma_f32_16x16x32_bf16 v[140:143], a[52:55], v[204:207], v[140:143]
    v_cvt_pk_bf16_f32 v51, v54, v55
    v_mfma_f32_16x16x32_bf16 v[148:151], a[40:43], v[200:203], v[148:151]
    s_add_u32 s3, s65, 0
    ds_read_b64_tr_b16 v[196:197], v236 offset:24576
    v_mfma_f32_16x16x32_bf16 v[148:151], a[56:59], v[204:207], v[148:151]
    buffer_store_dwordx4 v[32:35], v225, s[8:11], s3 offen offset:2048 sc1
    v_mfma_f32_16x16x32_bf16 v[156:159], a[44:47], v[200:203], v[156:159]
    ds_read_b64_tr_b16 v[198:199], v236 offset:25088
    v_permlane16_swap_b32 v48, v50
    v_mfma_f32_16x16x32_bf16 v[156:159], a[60:63], v[204:207], v[156:159]
    s_waitcnt lgkmcnt(4)
    v_permlane16_swap_b32 v49, v51
    v_mfma_f32_16x16x32_bf16 v[160:163], a[0:3], v[208:211], 0
    ds_read_b64_tr_b16 v[200:201], v237 offset:0
    v_mfma_f32_16x16x32_bf16 v[160:163], a[16:19], v[212:215], v[160:163]
    v_cvt_pk_bf16_f32 v56, v56, v57
    v_cvt_pk_bf16_f32 v57, v58, v59
    v_mfma_f32_16x16x32_bf16 v[168:171], a[4:7], v[208:211], 0
    ds_read_b64_tr_b16 v[202:203], v237 offset:512
    v_cvt_pk_bf16_f32 v58, v60, v61
    v_mfma_f32_16x16x32_bf16 v[168:171], a[20:23], v[212:215], v[168:171]
    v_cvt_pk_bf16_f32 v59, v62, v63
    v_mfma_f32_16x16x32_bf16 v[176:179], a[8:11], v[208:211], 0
    ds_read_b64_tr_b16 v[204:205], v237 offset:8192
    v_mfma_f32_16x16x32_bf16 v[176:179], a[24:27], v[212:215], v[176:179]
    v_permlane16_swap_b32 v56, v58
    v_permlane16_swap_b32 v57, v59
    v_mfma_f32_16x16x32_bf16 v[184:187], a[12:15], v[208:211], 0
    ds_read_b64_tr_b16 v[206:207], v237 offset:8704
    v_mfma_f32_16x16x32_bf16 v[184:187], a[28:31], v[212:215], v[184:187]
    s_waitcnt lgkmcnt(4)
    v_mfma_f32_16x16x32_bf16 v[160:163], a[32:35], v[192:195], v[160:163]
    s_add_u32 s3, s65, 8192
    ds_read_b64_tr_b16 v[208:209], v237 offset:16384
    v_mfma_f32_16x16x32_bf16 v[160:163], a[48:51], v[196:199], v[160:163]
    buffer_store_dwordx4 v[40:43], v225, s[8:11], s3 offen offset:2048 sc1
    v_mfma_f32_16x16x32_bf16 v[168:171], a[36:39], v[192:195], v[168:171]
    ds_read_b64_tr_b16 v[210:211], v237 offset:16896
    v_mfma_f32_16x16x32_bf16 v[168:171], a[52:55], v[196:199], v[168:171]
    v_mfma_f32_16x16x32_bf16 v[176:179], a[40:43], v[192:195], v[176:179]
    ds_read_b64_tr_b16 v[212:213], v237 offset:24576
    v_mfma_f32_16x16x32_bf16 v[176:179], a[56:59], v[196:199], v[176:179]
    s_waitcnt vmcnt(27)
    s_barrier
    v_mfma_f32_16x16x32_bf16 v[184:187], a[44:47], v[192:195], v[184:187]
    ds_read_b64_tr_b16 v[214:215], v237 offset:25088
    v_mfma_f32_16x16x32_bf16 v[184:187], a[60:63], v[196:199], v[184:187]
    s_waitcnt lgkmcnt(4)
    s_add_u32 s63, s62, 3145856
    v_mfma_f32_16x16x32_bf16 v[164:167], a[0:3], v[200:203], 0
    s_add_u32 m0, s66, 36864
    s_and_b32 s63, s63, 0x3fffff
    ds_read_b64_tr_b16 v[192:193], v234 offset:4096
    v_mfma_f32_16x16x32_bf16 v[164:167], a[16:19], v[204:207], v[164:167]
    buffer_load_dwordx4 v248, s[24:27], s63 offen offset:0 nt lds
    v_mfma_f32_16x16x32_bf16 v[172:175], a[4:7], v[200:203], 0
    ds_read_b64_tr_b16 v[194:195], v234 offset:4608
    v_mfma_f32_16x16x32_bf16 v[172:175], a[20:23], v[204:207], v[172:175]
    v_mfma_f32_16x16x32_bf16 v[180:183], a[8:11], v[200:203], 0
    ds_read_b64_tr_b16 v[196:197], v234 offset:12288
    v_mfma_f32_16x16x32_bf16 v[180:183], a[24:27], v[204:207], v[180:183]
    buffer_load_dwordx4 v249, s[24:27], s63 offen offset:1024 nt lds
    v_mfma_f32_16x16x32_bf16 v[188:191], a[12:15], v[200:203], 0
    ds_read_b64_tr_b16 v[198:199], v234 offset:12800
    v_mfma_f32_16x16x32_bf16 v[188:191], a[28:31], v[204:207], v[188:191]
    s_waitcnt lgkmcnt(4)
    v_mfma_f32_16x16x32_bf16 v[164:167], a[32:35], v[208:211], v[164:167]
    ds_read_b64_tr_b16 v[200:201], v234 offset:20480
    v_mfma_f32_16x16x32_bf16 v[164:167], a[48:51], v[212:215], v[164:167]
    buffer_load_dwordx4 v250, s[24:27], s63 offen offset:2048 nt lds
    v_mfma_f32_16x16x32_bf16 v[172:175], a[36:39], v[208:211], v[172:175]
    ds_read_b64_tr_b16 v[202:203], v234 offset:20992
    v_mfma_f32_16x16x32_bf16 v[172:175], a[52:55], v[212:215], v[172:175]
    v_mfma_f32_16x16x32_bf16 v[180:183], a[40:43], v[208:211], v[180:183]
    ds_read_b64_tr_b16 v[204:205], v234 offset:28672
    v_mfma_f32_16x16x32_bf16 v[180:183], a[56:59], v[212:215], v[180:183]
    buffer_load_dwordx4 v251, s[24:27], s63 offen offset:3072 nt lds
    v_mfma_f32_16x16x32_bf16 v[188:191], a[44:47], v[208:211], v[188:191]
    ds_read_b64_tr_b16 v[206:207], v234 offset:29184
    v_cvt_pk_bf16_f32 v64, v64, v65
    v_mfma_f32_16x16x32_bf16 v[188:191], a[60:63], v[212:215], v[188:191]
    s_waitcnt lgkmcnt(4)
    v_cvt_pk_bf16_f32 v65, v66, v67
    v_cvt_pk_bf16_f32 v66, v68, v69
    v_mfma_f32_16x16x32_bf16 v[128:131], a[64:67], v[192:195], v[128:131]
    s_add_u32 s3, s65, 0
    ds_read_b64_tr_b16 v[208:209], v235 offset:4096
    v_cvt_pk_bf16_f32 v67, v70, v71
    v_mfma_f32_16x16x32_bf16 v[128:131], a[80:83], v[196:199], v[128:131]
    buffer_store_dwordx4 v[48:51], v225, s[8:11], s3 offen offset:3072 sc1
    v_mfma_f32_16x16x32_bf16 v[136:139], a[68:71], v[192:195], v[136:139]
    ds_read_b64_tr_b16 v[210:211], v235 offset:4608
    v_permlane16_swap_b32 v64, v66
    v_mfma_f32_16x16x32_bf16 v[136:139], a[84:87], v[196:199], v[136:139]
    v_permlane16_swap_b32 v65, v67
    v_mfma_f32_16x16x32_bf16 v[144:147], a[72:75], v[192:195], v[144:147]
    ds_read_b64_tr_b16 v[212:213], v235 offset:12288
    v_mfma_f32_16x16x32_bf16 v[144:147], a[88:91], v[196:199], v[144:147]
    v_mfma_f32_16x16x32_bf16 v[152:155], a[76:79], v[192:195], v[152:155]
    ds_read_b64_tr_b16 v[214:215], v235 offset:12800
    v_mfma_f32_16x16x32_bf16 v[152:155], a[92:95], v[196:199], v[152:155]
    s_waitcnt lgkmcnt(4)
    v_mfma_f32_16x16x32_bf16 v[128:131], a[96:99], v[200:203], v[128:131]
    s_add_u32 s3, s65, 8192
    ds_read_b64_tr_b16 v[192:193], v235 offset:20480
    v_mfma_f32_16x16x32_bf16 v[128:131], a[112:115], v[204:207], v[128:131]
    buffer_store_dwordx4 v[56:59], v225, s[8:11], s3 offen offset:3072 sc1
    v_mfma_f32_16x16x32_bf16 v[136:139], a[100:103], v[200:203], v[136:139]
    ds_read_b64_tr_b16 v[194:195], v235 offset:20992
    v_cvt_pk_bf16_f32 v72, v72, v73
    v_mfma_f32_16x16x32_bf16 v[136:139], a[116:119], v[204:207], v[136:139]
    v_cvt_pk_bf16_f32 v73, v74, v75
    v_cvt_pk_bf16_f32 v74, v76, v77
    v_mfma_f32_16x16x32_bf16 v[144:147], a[104:107], v[200:203], v[144:147]
    ds_read_b64_tr_b16 v[196:197], v235 offset:28672
    v_cvt_pk_bf16_f32 v75, v78, v79
    v_mfma_f32_16x16x32_bf16 v[144:147], a[120:123], v[204:207], v[144:147]
    v_mfma_f32_16x16x32_bf16 v[152:155], a[108:111], v[200:203], v[152:155]
    ds_read_b64_tr_b16 v[198:199], v235 offset:29184
    v_permlane16_swap_b32 v72, v74
    v_mfma_f32_16x16x32_bf16 v[152:155], a[124:127], v[204:207], v[152:155]
    s_waitcnt lgkmcnt(4)
    v_permlane16_swap_b32 v73, v75
    v_mfma_f32_16x16x32_bf16 v[132:135], a[64:67], v[208:211], v[132:135]
    s_add_u32 m0, s67, 131072
    s_add_u32 s63, s61, 2097152
    ds_read_b64_tr_b16 v[200:201], v236 offset:4096
    v_mfma_f32_16x16x32_bf16 v[132:135], a[80:83], v[212:215], v[132:135]
    buffer_load_dwordx4 v226, s[28:31], s63 offen offset:0 nt lds
    v_mfma_f32_16x16x32_bf16 v[140:143], a[68:71], v[208:211], v[140:143]
    ds_read_b64_tr_b16 v[202:203], v236 offset:4608
    v_mfma_f32_16x16x32_bf16 v[140:143], a[84:87], v[212:215], v[140:143]
    v_mfma_f32_16x16x32_bf16 v[148:151], a[72:75], v[208:211], v[148:151]
    ds_read_b64_tr_b16 v[204:205], v236 offset:12288
    v_mfma_f32_16x16x32_bf16 v[148:151], a[88:91], v[212:215], v[148:151]
    v_mfma_f32_16x16x32_bf16 v[156:159], a[76:79], v[208:211], v[156:159]
    ds_read_b64_tr_b16 v[206:207], v236 offset:12800
    v_mfma_f32_16x16x32_bf16 v[156:159], a[92:95], v[212:215], v[156:159]
    s_waitcnt lgkmcnt(4)
    v_mfma_f32_16x16x32_bf16 v[132:135], a[96:99], v[192:195], v[132:135]
    ds_read_b64_tr_b16 v[208:209], v236 offset:20480
    v_mfma_f32_16x16x32_bf16 v[132:135], a[112:115], v[196:199], v[132:135]
    buffer_load_dwordx4 v227, s[28:31], s63 offen offset:1024 nt lds
    v_mfma_f32_16x16x32_bf16 v[140:143], a[100:103], v[192:195], v[140:143]
    ds_read_b64_tr_b16 v[210:211], v236 offset:20992
    v_mfma_f32_16x16x32_bf16 v[140:143], a[116:119], v[196:199], v[140:143]
    v_mfma_f32_16x16x32_bf16 v[148:151], a[104:107], v[192:195], v[148:151]
    ds_read_b64_tr_b16 v[212:213], v236 offset:28672
    v_mfma_f32_16x16x32_bf16 v[148:151], a[120:123], v[196:199], v[148:151]
    buffer_load_dwordx4 v238, s[28:31], s63 offen offset:2048 nt lds
    v_mfma_f32_16x16x32_bf16 v[156:159], a[108:111], v[192:195], v[156:159]
    ds_read_b64_tr_b16 v[214:215], v236 offset:29184
    v_mfma_f32_16x16x32_bf16 v[156:159], a[124:127], v[196:199], v[156:159]
    s_waitcnt lgkmcnt(4)
    v_mfma_f32_16x16x32_bf16 v[160:163], a[64:67], v[200:203], v[160:163]
    ds_read_b64_tr_b16 v[192:193], v237 offset:4096
    v_mfma_f32_16x16x32_bf16 v[160:163], a[80:83], v[204:207], v[160:163]
    buffer_load_dwordx4 v239, s[28:31], s63 offen offset:3072 nt lds
    v_mfma_f32_16x16x32_bf16 v[168:171], a[68:71], v[200:203], v[168:171]
    ds_read_b64_tr_b16 v[194:195], v237 offset:4608
    v_cvt_pk_bf16_f32 v80, v80, v81
    v_mfma_f32_16x16x32_bf16 v[168:171], a[84:87], v[204:207], v[168:171]
    v_cvt_pk_bf16_f32 v81, v82, v83
    v_cvt_pk_bf16_f32 v82, v84, v85
    v_mfma_f32_16x16x32_bf16 v[176:179], a[72:75], v[200:203], v[176:179]
    s_add_u32 s3, s65, 4096
    ds_read_b64_tr_b16 v[196:197], v237 offset:12288
    v_cvt_pk_bf16_f32 v83, v86, v87
    v_mfma_f32_16x16x32_bf16 v[176:179], a[88:91], v[204:207], v[176:179]
    buffer_store_dwordx4 v[64:67], v225, s[8:11], s3 offen offset:0 sc1
    v_mfma_f32_16x16x32_bf16 v[184:187], a[76:79], v[200:203], v[184:187]
    ds_read_b64_tr_b16 v[198:199], v237 offset:12800
    v_permlane16_swap_b32 v80, v82
    v_mfma_f32_16x16x32_bf16 v[184:187], a[92:95], v[204:207], v[184:187]
    s_waitcnt lgkmcnt(4)
    v_permlane16_swap_b32 v81, v83
    v_mfma_f32_16x16x32_bf16 v[160:163], a[96:99], v[208:211], v[160:163]
    ds_read_b64_tr_b16 v[200:201], v237 offset:20480
    v_mfma_f32_16x16x32_bf16 v[160:163], a[112:115], v[212:215], v[160:163]
    v_mfma_f32_16x16x32_bf16 v[168:171], a[100:103], v[208:211], v[168:171]
    ds_read_b64_tr_b16 v[202:203], v237 offset:20992
    v_mfma_f32_16x16x32_bf16 v[168:171], a[116:119], v[212:215], v[168:171]
    v_mfma_f32_16x16x32_bf16 v[176:179], a[104:107], v[208:211], v[176:179]
    ds_read_b64_tr_b16 v[204:205], v237 offset:28672
    v_mfma_f32_16x16x32_bf16 v[176:179], a[120:123], v[212:215], v[176:179]
    s_waitcnt vmcnt(34)
    s_barrier
    v_cvt_pk_bf16_f32 v88, v88, v89
    v_mfma_f32_16x16x32_bf16 v[184:187], a[108:111], v[208:211], v[184:187]
    ds_read_b64_tr_b16 v[206:207], v237 offset:29184
    v_cvt_pk_bf16_f32 v89, v90, v91
    v_mfma_f32_16x16x32_bf16 v[184:187], a[124:127], v[212:215], v[184:187]
    s_waitcnt lgkmcnt(4)
    v_cvt_pk_bf16_f32 v90, v92, v93
    v_cvt_pk_bf16_f32 v91, v94, v95
    v_mfma_f32_16x16x32_bf16 v[164:167], a[64:67], v[192:195], v[164:167]
    s_add_u32 s3, s65, 12288
    ds_read_b64_tr_b16 v[208:209], v234 offset:32768
    v_mfma_f32_16x16x32_bf16 v[164:167], a[80:83], v[196:199], v[164:167]
    buffer_store_dwordx4 v[72:75], v225, s[8:11], s3 offen offset:0 sc1
    v_mfma_f32_16x16x32_bf16 v[172:175], a[68:71], v[192:195], v[172:175]
    ds_read_b64_tr_b16 v[210:211], v234 offset:33280
    v_permlane16_swap_b32 v88, v90
    v_mfma_f32_16x16x32_bf16 v[172:175], a[84:87], v[196:199], v[172:175]
    v_permlane16_swap_b32 v89, v91
    v_cvt_pk_bf16_f32 v96, v96, v97
    v_mfma_f32_16x16x32_bf16 v[180:183], a[72:75], v[192:195], v[180:183]
    s_add_u32 m0, s67, 147456
    s_add_u32 s63, s61, 2621440
    ds_read_b64_tr_b16 v[212:213], v234 offset:36864
    v_mfma_f32_16x16x32_bf16 v[180:183], a[88:91], v[196:199], v[180:183]
    buffer_load_dwordx4 v226, s[28:31], s63 offen offset:0 nt lds
    v_mfma_f32_16x16x32_bf16 v[188:191], a[76:79], v[192:195], v[188:191]
    ds_read_b64_tr_b16 v[214:215], v234 offset:37376
    v_cvt_pk_bf16_f32 v97, v98, v99
    v_mfma_f32_16x16x32_bf16 v[188:191], a[92:95], v[196:199], v[188:191]
    s_waitcnt lgkmcnt(4)
    v_cvt_pk_bf16_f32 v98, v100, v101
    v_cvt_pk_bf16_f32 v99, v102, v103
    v_mfma_f32_16x16x32_bf16 v[164:167], a[96:99], v[200:203], v[164:167]
    ds_read_b64_tr_b16 v[192:193], v234 offset:40960
    v_mfma_f32_16x16x32_bf16 v[164:167], a[112:115], v[204:207], v[164:167]
    buffer_load_dwordx4 v227, s[28:31], s63 offen offset:1024 nt lds
    v_mfma_f32_16x16x32_bf16 v[172:175], a[100:103], v[200:203], v[172:175]
    ds_read_b64_tr_b16 v[194:195], v234 offset:41472
    v_permlane16_swap_b32 v96, v98
    v_mfma_f32_16x16x32_bf16 v[172:175], a[116:119], v[204:207], v[172:175]
    v_permlane16_swap_b32 v97, v99
    v_mfma_f32_16x16x32_bf16 v[180:183], a[104:107], v[200:203], v[180:183]
    ds_read_b64_tr_b16 v[196:197], v234 offset:45056
    v_mfma_f32_16x16x32_bf16 v[180:183], a[120:123], v[204:207], v[180:183]
    buffer_load_dwordx4 v238, s[28:31], s63 offen offset:2048 nt lds
    v_mfma_f32_16x16x32_bf16 v[188:191], a[108:111], v[200:203], v[188:191]
    ds_read_b64_tr_b16 v[198:199], v234 offset:45568
    v_mfma_f32_16x16x32_bf16 v[188:191], a[124:127], v[204:207], v[188:191]
    s_waitcnt lgkmcnt(4)
    v_mfma_f32_16x16x32_bf16 v[128:131], a[128:131], v[208:211], v[128:131]
    ds_read_b64_tr_b16 v[200:201], v235 offset:32768
    v_mfma_f32_16x16x32_bf16 v[128:131], a[144:147], v[212:215], v[128:131]
    v_cvt_pk_bf16_f32 v104, v104, v105
    v_cvt_pk_bf16_f32 v105, v106, v107
    v_mfma_f32_16x16x32_bf16 v[136:139], a[132:135], v[208:211], v[136:139]
    ds_read_b64_tr_b16 v[202:203], v235 offset:33280
    v_cvt_pk_bf16_f32 v106, v108, v109
    v_mfma_f32_16x16x32_bf16 v[136:139], a[148:151], v[212:215], v[136:139]
    v_cvt_pk_bf16_f32 v107, v110, v111
    v_mfma_f32_16x16x32_bf16 v[144:147], a[136:139], v[208:211], v[144:147]
    ds_read_b64_tr_b16 v[204:205], v235 offset:36864
    v_mfma_f32_16x16x32_bf16 v[144:147], a[152:155], v[212:215], v[144:147]
    buffer_load_dwordx4 v239, s[28:31], s63 offen offset:3072 nt lds
    v_mfma_f32_16x16x32_bf16 v[152:155], a[140:143], v[208:211], v[152:155]
    ds_read_b64_tr_b16 v[206:207], v235 offset:37376
    v_permlane16_swap_b32 v104, v106
    v_mfma_f32_16x16x32_bf16 v[152:155], a[156:159], v[212:215], v[152:155]
    s_waitcnt lgkmcnt(4)
    v_permlane16_swap_b32 v105, v107
    v_mfma_f32_16x16x32_bf16 v[128:131], a[160:163], v[192:195], v[128:131]
    s_add_u32 s3, s65, 4096
    ds_read_b64_tr_b16 v[208:209], v235 offset:40960
    v_mfma_f32_16x16x32_bf16 v[128:131], a[176:179], v[196:199], v[128:131]
    buffer_store_dwordx4 v[80:83], v225, s[8:11], s3 offen offset:1024 sc1
    v_mfma_f32_16x16x32_bf16 v[136:139], a[164:167], v[192:195], v[136:139]
    ds_read_b64_tr_b16 v[210:211], v235 offset:41472
    v_mfma_f32_16x16x32_bf16 v[136:139], a[180:183], v[196:199], v[136:139]
    v_mfma_f32_16x16x32_bf16 v[144:147], a[168:171], v[192:195], v[144:147]
    ds_read_b64_tr_b16 v[212:213], v235 offset:45056
    v_mfma_f32_16x16x32_bf16 v[144:147], a[184:187], v[196:199], v[144:147]
    v_mfma_f32_16x16x32_bf16 v[152:155], a[172:175], v[192:195], v[152:155]
    ds_read_b64_tr_b16 v[214:215], v235 offset:45568
    v_mfma_f32_16x16x32_bf16 v[152:155], a[188:191], v[196:199], v[152:155]
    s_waitcnt lgkmcnt(4)
    v_mfma_f32_16x16x32_bf16 v[132:135], a[128:131], v[200:203], v[132:135]
    s_mov_b32 s6, 0x4e01000
    ds_read_b64_tr_b16 v[192:193], v236 offset:32768
    v_mfma_f32_16x16x32_bf16 v[132:135], a[144:147], v[204:207], v[132:135]
    buffer_load_dword v218, v217, s[8:11], s6 offen sc1
    v_mfma_f32_16x16x32_bf16 v[140:143], a[132:135], v[200:203], v[140:143]
    ds_read_b64_tr_b16 v[194:195], v236 offset:33280
    v_mfma_f32_16x16x32_bf16 v[140:143], a[148:151], v[204:207], v[140:143]
    v_mfma_f32_16x16x32_bf16 v[148:151], a[136:139], v[200:203], v[148:151]
    s_add_u32 s3, s65, 12288
    ds_read_b64_tr_b16 v[196:197], v236 offset:36864
    v_mfma_f32_16x16x32_bf16 v[148:151], a[152:155], v[204:207], v[148:151]
    buffer_store_dwordx4 v[88:91], v225, s[8:11], s3 offen offset:1024 sc1
    v_mfma_f32_16x16x32_bf16 v[156:159], a[140:143], v[200:203], v[156:159]
    ds_read_b64_tr_b16 v[198:199], v236 offset:37376
    v_mfma_f32_16x16x32_bf16 v[156:159], a[156:159], v[204:207], v[156:159]
    s_waitcnt lgkmcnt(4)
    v_mfma_f32_16x16x32_bf16 v[132:135], a[160:163], v[208:211], v[132:135]
    s_add_u32 s3, s65, 4096
    ds_read_b64_tr_b16 v[200:201], v236 offset:40960
    v_mfma_f32_16x16x32_bf16 v[132:135], a[176:179], v[212:215], v[132:135]
    buffer_store_dwordx4 v[96:99], v225, s[8:11], s3 offen offset:2048 sc1
    v_mfma_f32_16x16x32_bf16 v[140:143], a[164:167], v[208:211], v[140:143]
    ds_read_b64_tr_b16 v[202:203], v236 offset:41472
    v_cvt_pk_bf16_f32 v112, v112, v113
    v_mfma_f32_16x16x32_bf16 v[140:143], a[180:183], v[212:215], v[140:143]
    v_cvt_pk_bf16_f32 v113, v114, v115
    v_cvt_pk_bf16_f32 v114, v116, v117
    v_mfma_f32_16x16x32_bf16 v[148:151], a[168:171], v[208:211], v[148:151]
    ds_read_b64_tr_b16 v[204:205], v236 offset:45056
    v_cvt_pk_bf16_f32 v115, v118, v119
    v_mfma_f32_16x16x32_bf16 v[148:151], a[184:187], v[212:215], v[148:151]
    v_mfma_f32_16x16x32_bf16 v[156:159], a[172:175], v[208:211], v[156:159]
    ds_read_b64_tr_b16 v[206:207], v236 offset:45568
    v_permlane16_swap_b32 v112, v114
    v_mfma_f32_16x16x32_bf16 v[156:159], a[188:191], v[212:215], v[156:159]
    s_waitcnt lgkmcnt(4)
    v_permlane16_swap_b32 v113, v115
    v_mfma_f32_16x16x32_bf16 v[160:163], a[128:131], v[192:195], v[160:163]
    ds_read_b64_tr_b16 v[208:209], v237 offset:32768
    v_mfma_f32_16x16x32_bf16 v[160:163], a[144:147], v[196:199], v[160:163]
    v_mfma_f32_16x16x32_bf16 v[168:171], a[132:135], v[192:195], v[168:171]
    ds_read_b64_tr_b16 v[210:211], v237 offset:33280
    v_mfma_f32_16x16x32_bf16 v[168:171], a[148:151], v[196:199], v[168:171]
    v_mfma_f32_16x16x32_bf16 v[176:179], a[136:139], v[192:195], v[176:179]
    ds_read_b64_tr_b16 v[212:213], v237 offset:36864
    v_mfma_f32_16x16x32_bf16 v[176:179], a[152:155], v[196:199], v[176:179]
    v_mfma_f32_16x16x32_bf16 v[184:187], a[140:143], v[192:195], v[184:187]
    ds_read_b64_tr_b16 v[214:215], v237 offset:37376
    v_mfma_f32_16x16x32_bf16 v[184:187], a[156:159], v[196:199], v[184:187]
    s_waitcnt lgkmcnt(4)
    v_mfma_f32_16x16x32_bf16 v[160:163], a[160:163], v[200:203], v[160:163]
    s_add_u32 s3, s65, 12288
    ds_read_b64_tr_b16 v[192:193], v237 offset:40960
    v_mfma_f32_16x16x32_bf16 v[160:163], a[176:179], v[204:207], v[160:163]
    buffer_store_dwordx4 v[104:107], v225, s[8:11], s3 offen offset:2048 sc1
    v_mfma_f32_16x16x32_bf16 v[168:171], a[164:167], v[200:203], v[168:171]
    ds_read_b64_tr_b16 v[194:195], v237 offset:41472
    v_mfma_f32_16x16x32_bf16 v[168:171], a[180:183], v[204:207], v[168:171]
    v_mfma_f32_16x16x32_bf16 v[176:179], a[168:171], v[200:203], v[176:179]
    ds_read_b64_tr_b16 v[196:197], v237 offset:45056
    v_mfma_f32_16x16x32_bf16 v[176:179], a[184:187], v[204:207], v[176:179]
    s_waitcnt vmcnt(31)
    s_barrier
    v_mfma_f32_16x16x32_bf16 v[184:187], a[172:175], v[200:203], v[184:187]
    ds_read_b64_tr_b16 v[198:199], v237 offset:45568
    v_mfma_f32_16x16x32_bf16 v[184:187], a[188:191], v[204:207], v[184:187]
    s_waitcnt lgkmcnt(4)
    v_mfma_f32_16x16x32_bf16 v[164:167], a[128:131], v[208:211], v[164:167]
    s_add_u32 m0, s67, 65536
    s_add_u32 s63, s61, 0
    ds_read_b64_tr_b16 v[200:201], v234 offset:49152
    v_mfma_f32_16x16x32_bf16 v[164:167], a[144:147], v[212:215], v[164:167]
    buffer_load_dwordx4 v226, s[28:31], s63 offen offset:0 nt lds
    v_mfma_f32_16x16x32_bf16 v[172:175], a[132:135], v[208:211], v[172:175]
    ds_read_b64_tr_b16 v[202:203], v234 offset:49664
    v_cvt_pk_bf16_f32 v120, v120, v121
    v_mfma_f32_16x16x32_bf16 v[172:175], a[148:151], v[212:215], v[172:175]
    v_cvt_pk_bf16_f32 v121, v122, v123
    v_cvt_pk_bf16_f32 v122, v124, v125
    v_mfma_f32_16x16x32_bf16 v[180:183], a[136:139], v[208:211], v[180:183]
    ds_read_b64_tr_b16 v[204:205], v234 offset:53248
    v_cvt_pk_bf16_f32 v123, v126, v127
    v_mfma_f32_16x16x32_bf16 v[180:183], a[152:155], v[212:215], v[180:183]
    buffer_load_dwordx4 v227, s[28:31], s63 offen offset:1024 nt lds
    v_mfma_f32_16x16x32_bf16 v[188:191], a[140:143], v[208:211], v[188:191]
    ds_read_b64_tr_b16 v[206:207], v234 offset:53760
    v_permlane16_swap_b32 v120, v122
    v_mfma_f32_16x16x32_bf16 v[188:191], a[156:159], v[212:215], v[188:191]
    s_waitcnt lgkmcnt(4)
    v_permlane16_swap_b32 v121, v123
    v_mfma_f32_16x16x32_bf16 v[164:167], a[160:163], v[192:195], v[164:167]
    ds_read_b64_tr_b16 v[208:209], v234 offset:57344
    v_mfma_f32_16x16x32_bf16 v[164:167], a[176:179], v[196:199], v[164:167]
    buffer_load_dwordx4 v238, s[28:31], s63 offen offset:2048 nt lds
    v_mfma_f32_16x16x32_bf16 v[172:175], a[164:167], v[192:195], v[172:175]
    ds_read_b64_tr_b16 v[210:211], v234 offset:57856
    v_mfma_f32_16x16x32_bf16 v[172:175], a[180:183], v[196:199], v[172:175]
    v_mfma_f32_16x16x32_bf16 v[180:183], a[168:171], v[192:195], v[180:183]
    ds_read_b64_tr_b16 v[212:213], v234 offset:61440
    v_mfma_f32_16x16x32_bf16 v[180:183], a[184:187], v[196:199], v[180:183]
    buffer_load_dwordx4 v239, s[28:31], s63 offen offset:3072 nt lds
    v_mfma_f32_16x16x32_bf16 v[188:191], a[172:175], v[192:195], v[188:191]
    ds_read_b64_tr_b16 v[214:215], v234 offset:61952
    v_mfma_f32_16x16x32_bf16 v[188:191], a[188:191], v[196:199], v[188:191]
    s_waitcnt lgkmcnt(4)
    v_add_u32 v234, 0xffff0000, v234
    v_mfma_f32_16x16x32_bf16 v[128:131], a[192:195], v[200:203], v[128:131]
    s_add_u32 s3, s65, 4096
    ds_read_b64_tr_b16 v[192:193], v235 offset:49152
    v_mfma_f32_16x16x32_bf16 v[128:131], a[208:211], v[204:207], v[128:131]
    buffer_store_dwordx4 v[112:115], v225, s[8:11], s3 offen offset:3072 sc1
    v_mfma_f32_16x16x32_bf16 v[136:139], a[196:199], v[200:203], v[136:139]
    ds_read_b64_tr_b16 v[194:195], v235 offset:49664
    v_mfma_f32_16x16x32_bf16 v[136:139], a[212:215], v[204:207], v[136:139]
    v_mfma_f32_16x16x32_bf16 v[144:147], a[200:203], v[200:203], v[144:147]
    s_add_u32 m0, s67, 81920
    s_add_u32 s63, s61, 524288
    ds_read_b64_tr_b16 v[196:197], v235 offset:53248
    v_mfma_f32_16x16x32_bf16 v[144:147], a[216:219], v[204:207], v[144:147]
    buffer_load_dwordx4 v226, s[28:31], s63 offen offset:0 nt lds
    v_mfma_f32_16x16x32_bf16 v[152:155], a[204:207], v[200:203], v[152:155]
    ds_read_b64_tr_b16 v[198:199], v235 offset:53760
    v_mfma_f32_16x16x32_bf16 v[152:155], a[220:223], v[204:207], v[152:155]
    s_waitcnt lgkmcnt(4)
    v_mfma_f32_16x16x32_bf16 v[128:131], a[224:227], v[208:211], v[128:131]
    ds_read_b64_tr_b16 v[200:201], v235 offset:57344
    v_mfma_f32_16x16x32_bf16 v[128:131], a[240:243], v[212:215], v[128:131]
    buffer_load_dwordx4 v227, s[28:31], s63 offen offset:1024 nt lds
    v_mfma_f32_16x16x32_bf16 v[136:139], a[228:231], v[208:211], v[136:139]
    ds_read_b64_tr_b16 v[202:203], v235 offset:57856
    v_mfma_f32_16x16x32_bf16 v[136:139], a[244:247], v[212:215], v[136:139]
    v_mfma_f32_16x16x32_bf16 v[144:147], a[232:235], v[208:211], v[144:147]
    ds_read_b64_tr_b16 v[204:205], v235 offset:61440
    v_mfma_f32_16x16x32_bf16 v[144:147], a[248:251], v[212:215], v[144:147]
    buffer_load_dwordx4 v238, s[28:31], s63 offen offset:2048 nt lds
    v_mfma_f32_16x16x32_bf16 v[152:155], a[236:239], v[208:211], v[152:155]
    ds_read_b64_tr_b16 v[206:207], v235 offset:61952
    v_mfma_f32_16x16x32_bf16 v[152:155], a[252:255], v[212:215], v[152:155]
    s_waitcnt lgkmcnt(4)
    v_add_u32 v235, 0xffff0000, v235
    v_mfma_f32_16x16x32_bf16 v[132:135], a[192:195], v[192:195], v[132:135]
    ds_read_b64_tr_b16 v[208:209], v236 offset:49152
    v_mfma_f32_16x16x32_bf16 v[132:135], a[208:211], v[196:199], v[132:135]
    v_mfma_f32_16x16x32_bf16 v[140:143], a[196:199], v[192:195], v[140:143]
    ds_read_b64_tr_b16 v[210:211], v236 offset:49664
    v_mfma_f32_16x16x32_bf16 v[140:143], a[212:215], v[196:199], v[140:143]
    v_mfma_f32_16x16x32_bf16 v[148:151], a[200:203], v[192:195], v[148:151]
    ds_read_b64_tr_b16 v[212:213], v236 offset:53248
    v_mfma_f32_16x16x32_bf16 v[148:151], a[216:219], v[196:199], v[148:151]
    buffer_load_dwordx4 v239, s[28:31], s63 offen offset:3072 nt lds
    v_mfma_f32_16x16x32_bf16 v[156:159], a[204:207], v[192:195], v[156:159]
    ds_read_b64_tr_b16 v[214:215], v236 offset:53760
    v_mfma_f32_16x16x32_bf16 v[156:159], a[220:223], v[196:199], v[156:159]
    s_waitcnt lgkmcnt(4)
    v_mfma_f32_16x16x32_bf16 v[132:135], a[224:227], v[200:203], v[132:135]
    s_add_u32 s3, s65, 12288
    ds_read_b64_tr_b16 v[192:193], v236 offset:57344
    v_mfma_f32_16x16x32_bf16 v[132:135], a[240:243], v[204:207], v[132:135]
    buffer_store_dwordx4 v[120:123], v225, s[8:11], s3 offen offset:3072 sc1
    v_mfma_f32_16x16x32_bf16 v[140:143], a[228:231], v[200:203], v[140:143]
    ds_read_b64_tr_b16 v[194:195], v236 offset:57856
    v_mfma_f32_16x16x32_bf16 v[140:143], a[244:247], v[204:207], v[140:143]
    v_mfma_f32_16x16x32_bf16 v[148:151], a[232:235], v[200:203], v[148:151]
    ds_read_b64_tr_b16 v[196:197], v236 offset:61440
    v_mfma_f32_16x16x32_bf16 v[148:151], a[248:251], v[204:207], v[148:151]
    v_mfma_f32_16x16x32_bf16 v[156:159], a[236:239], v[200:203], v[156:159]
    ds_read_b64_tr_b16 v[198:199], v236 offset:61952
    v_mfma_f32_16x16x32_bf16 v[156:159], a[252:255], v[204:207], v[156:159]
    s_waitcnt lgkmcnt(4)
    v_add_u32 v236, 0xffff0000, v236
    v_mfma_f32_16x16x32_bf16 v[160:163], a[192:195], v[208:211], v[160:163]
    ds_read_b64_tr_b16 v[200:201], v237 offset:49152
    v_mfma_f32_16x16x32_bf16 v[160:163], a[208:211], v[212:215], v[160:163]
    v_mfma_f32_16x16x32_bf16 v[168:171], a[196:199], v[208:211], v[168:171]
    ds_read_b64_tr_b16 v[202:203], v237 offset:49664
    v_cvt_pk_bf16_f32 v128, v128, v129
    v_mfma_f32_16x16x32_bf16 v[168:171], a[212:215], v[212:215], v[168:171]
    v_cvt_pk_bf16_f32 v129, v130, v131
    v_cvt_pk_bf16_f32 v130, v132, v133
    v_mfma_f32_16x16x32_bf16 v[176:179], a[200:203], v[208:211], v[176:179]
    ds_read_b64_tr_b16 v[204:205], v237 offset:53248
    v_cvt_pk_bf16_f32 v131, v134, v135
    v_mfma_f32_16x16x32_bf16 v[176:179], a[216:219], v[212:215], v[176:179]
    v_mfma_f32_16x16x32_bf16 v[184:187], a[204:207], v[208:211], v[184:187]
    ds_read_b64_tr_b16 v[206:207], v237 offset:53760
    v_permlane16_swap_b32 v128, v130
    v_mfma_f32_16x16x32_bf16 v[184:187], a[220:223], v[212:215], v[184:187]
    s_waitcnt lgkmcnt(4)
    v_permlane16_swap_b32 v129, v131
    v_cvt_pk_bf16_f32 v136, v136, v137
    v_mfma_f32_16x16x32_bf16 v[160:163], a[224:227], v[192:195], v[160:163]
    ds_read_b64_tr_b16 v[208:209], v237 offset:57344
    v_cvt_pk_bf16_f32 v137, v138, v139
    v_mfma_f32_16x16x32_bf16 v[160:163], a[240:243], v[196:199], v[160:163]
    v_cvt_pk_bf16_f32 v138, v140, v141
    v_cvt_pk_bf16_f32 v139, v142, v143
    v_mfma_f32_16x16x32_bf16 v[168:171], a[228:231], v[192:195], v[168:171]
    ds_read_b64_tr_b16 v[210:211], v237 offset:57856
    v_mfma_f32_16x16x32_bf16 v[168:171], a[244:247], v[196:199], v[168:171]
    v_permlane16_swap_b32 v136, v138
    v_permlane16_swap_b32 v137, v139
    v_mfma_f32_16x16x32_bf16 v[176:179], a[232:235], v[192:195], v[176:179]
    ds_read_b64_tr_b16 v[212:213], v237 offset:61440
    v_cvt_pk_bf16_f32 v144, v144, v145
    v_mfma_f32_16x16x32_bf16 v[176:179], a[248:251], v[196:199], v[176:179]
    s_waitcnt vmcnt(34)
    s_barrier
    v_cvt_pk_bf16_f32 v145, v146, v147
    v_mfma_f32_16x16x32_bf16 v[184:187], a[236:239], v[192:195], v[184:187]
    ds_read_b64_tr_b16 v[214:215], v237 offset:61952
    v_cvt_pk_bf16_f32 v146, v148, v149
    v_mfma_f32_16x16x32_bf16 v[184:187], a[252:255], v[196:199], v[184:187]
    s_waitcnt lgkmcnt(4)
    v_add_u32 v237, 0xffff0000, v237
    v_cvt_pk_bf16_f32 v147, v150, v151
    v_mfma_f32_16x16x32_bf16 v[164:167], a[192:195], v[200:203], v[164:167]
    s_add_u32 s3, s65, 16384
    ds_read_b64_tr_b16 v[192:193], v234 offset:0
    v_mfma_f32_16x16x32_bf16 v[164:167], a[208:211], v[204:207], v[164:167]
    buffer_store_dwordx4 v[128:131], v224, s[8:11], s3 offen offset:0 sc1
    v_mfma_f32_16x16x32_bf16 v[172:175], a[196:199], v[200:203], v[172:175]
    ds_read_b64_tr_b16 v[194:195], v234 offset:512
    v_permlane16_swap_b32 v144, v146
    v_mfma_f32_16x16x32_bf16 v[172:175], a[212:215], v[204:207], v[172:175]
    v_permlane16_swap_b32 v145, v147
    v_cvt_pk_bf16_f32 v152, v152, v153
    v_mfma_f32_16x16x32_bf16 v[180:183], a[200:203], v[200:203], v[180:183]
    s_add_u32 m0, s67, 98304
    s_add_u32 s63, s61, 3145728
    ds_read_b64_tr_b16 v[196:197], v234 offset:8192
    v_mfma_f32_16x16x32_bf16 v[180:183], a[216:219], v[204:207], v[180:183]
    buffer_load_dwordx4 v226, s[28:31], s63 offen offset:0 nt lds
    v_mfma_f32_16x16x32_bf16 v[188:191], a[204:207], v[200:203], v[188:191]
    ds_read_b64_tr_b16 v[198:199], v234 offset:8704
    v_cvt_pk_bf16_f32 v153, v154, v155
    v_mfma_f32_16x16x32_bf16 v[188:191], a[220:223], v[204:207], v[188:191]
    s_waitcnt lgkmcnt(4)
    v_cvt_pk_bf16_f32 v154, v156, v157
    v_cvt_pk_bf16_f32 v155, v158, v159
    v_mfma_f32_16x16x32_bf16 v[164:167], a[224:227], v[208:211], v[164:167]
    ds_read_b64_tr_b16 v[200:201], v234 offset:16384
    v_mfma_f32_16x16x32_bf16 v[164:167], a[240:243], v[212:215], v[164:167]
    buffer_load_dwordx4 v227, s[28:31], s63 offen offset:1024 nt lds
    v_mfma_f32_16x16x32_bf16 v[172:175], a[228:231], v[208:211], v[172:175]
    ds_read_b64_tr_b16 v[202:203], v234 offset:16896
    v_permlane16_swap_b32 v152, v154
    v_mfma_f32_16x16x32_bf16 v[172:175], a[244:247], v[212:215], v[172:175]
    v_permlane16_swap_b32 v153, v155
    v_mfma_f32_16x16x32_bf16 v[180:183], a[232:235], v[208:211], v[180:183]
    ds_read_b64_tr_b16 v[204:205], v234 offset:24576
    v_mfma_f32_16x16x32_bf16 v[180:183], a[248:251], v[212:215], v[180:183]
    buffer_load_dwordx4 v238, s[28:31], s63 offen offset:2048 nt lds
    v_mfma_f32_16x16x32_bf16 v[188:191], a[236:239], v[208:211], v[188:191]
    ds_read_b64_tr_b16 v[206:207], v234 offset:25088
    v_mfma_f32_16x16x32_bf16 v[188:191], a[252:255], v[212:215], v[188:191]
    s_waitcnt lgkmcnt(4)
    v_mfma_f32_16x16x32_bf16 v[0:3], a[0:3], v[192:195], 0
    ds_read_b64_tr_b16 v[208:209], v235 offset:0
    v_mfma_f32_16x16x32_bf16 v[0:3], a[16:19], v[196:199], v[0:3]
    buffer_load_dwordx4 v239, s[28:31], s63 offen offset:3072 nt lds
    v_mfma_f32_16x16x32_bf16 v[8:11], a[4:7], v[192:195], 0
    ds_read_b64_tr_b16 v[210:211], v235 offset:512
    v_cvt_pk_bf16_f32 v160, v160, v161
    v_mfma_f32_16x16x32_bf16 v[8:11], a[20:23], v[196:199], v[8:11]
    v_cvt_pk_bf16_f32 v161, v162, v163
    v_cvt_pk_bf16_f32 v162, v164, v165
    v_mfma_f32_16x16x32_bf16 v[16:19], a[8:11], v[192:195], 0
    s_add_u32 s3, s65, 20480
    ds_read_b64_tr_b16 v[212:213], v235 offset:8192
    v_cvt_pk_bf16_f32 v163, v166, v167
    v_mfma_f32_16x16x32_bf16 v[16:19], a[24:27], v[196:199], v[16:19]
    buffer_store_dwordx4 v[136:139], v224, s[8:11], s3 offen offset:0 sc1
    v_mfma_f32_16x16x32_bf16 v[24:27], a[12:15], v[192:195], 0
    ds_read_b64_tr_b16 v[214:215], v235 offset:8704
    v_permlane16_swap_b32 v160, v162
    v_mfma_f32_16x16x32_bf16 v[24:27], a[28:31], v[196:199], v[24:27]
    s_waitcnt lgkmcnt(4)
    v_permlane16_swap_b32 v161, v163
    v_cvt_pk_bf16_f32 v168, v168, v169
    v_mfma_f32_16x16x32_bf16 v[0:3], a[32:35], v[200:203], v[0:3]
    ds_read_b64_tr_b16 v[192:193], v235 offset:16384
    v_cvt_pk_bf16_f32 v169, v170, v171
    v_mfma_f32_16x16x32_bf16 v[0:3], a[48:51], v[204:207], v[0:3]
    v_cvt_pk_bf16_f32 v170, v172, v173
    v_cvt_pk_bf16_f32 v171, v174, v175
    v_mfma_f32_16x16x32_bf16 v[8:11], a[36:39], v[200:203], v[8:11]
    ds_read_b64_tr_b16 v[194:195], v235 offset:16896
    v_mfma_f32_16x16x32_bf16 v[8:11], a[52:55], v[204:207], v[8:11]
    v_permlane16_swap_b32 v168, v170
    v_permlane16_swap_b32 v169, v171
    v_mfma_f32_16x16x32_bf16 v[16:19], a[40:43], v[200:203], v[16:19]
    s_add_u32 s3, s65, 24576
    ds_read_b64_tr_b16 v[196:197], v235 offset:24576
    v_cvt_pk_bf16_f32 v176, v176, v177
    v_mfma_f32_16x16x32_bf16 v[16:19], a[56:59], v[204:207], v[16:19]
    buffer_store_dwordx4 v[144:147], v224, s[8:11], s3 offen offset:0 sc1
    v_mfma_f32_16x16x32_bf16 v[24:27], a[44:47], v[200:203], v[24:27]
    ds_read_b64_tr_b16 v[198:199], v235 offset:25088
    v_cvt_pk_bf16_f32 v177, v178, v179
    v_mfma_f32_16x16x32_bf16 v[24:27], a[60:63], v[204:207], v[24:27]
    s_waitcnt lgkmcnt(4)
    v_cvt_pk_bf16_f32 v178, v180, v181
    v_cvt_pk_bf16_f32 v179, v182, v183
    v_mfma_f32_16x16x32_bf16 v[4:7], a[0:3], v[208:211], 0
    ds_read_b64_tr_b16 v[200:201], v236 offset:0
    v_mfma_f32_16x16x32_bf16 v[4:7], a[16:19], v[212:215], v[4:7]
    v_permlane16_swap_b32 v176, v178
    v_permlane16_swap_b32 v177, v179
    v_mfma_f32_16x16x32_bf16 v[12:15], a[4:7], v[208:211], 0
    ds_read_b64_tr_b16 v[202:203], v236 offset:512
    v_cvt_pk_bf16_f32 v184, v184, v185
    v_mfma_f32_16x16x32_bf16 v[12:15], a[20:23], v[212:215], v[12:15]
    v_cvt_pk_bf16_f32 v185, v186, v187
    v_cvt_pk_bf16_f32 v186, v188, v189
    v_mfma_f32_16x16x32_bf16 v[20:23], a[8:11], v[208:211], 0
    s_add_u32 s3, s65, 28672
    ds_read_b64_tr_b16 v[204:205], v236 offset:8192
    v_cvt_pk_bf16_f32 v187, v190, v191
    v_mfma_f32_16x16x32_bf16 v[20:23], a[24:27], v[212:215], v[20:23]
    buffer_store_dwordx4 v[152:155], v224, s[8:11], s3 offen offset:0 sc1
    v_mfma_f32_16x16x32_bf16 v[28:31], a[12:15], v[208:211], 0
    ds_read_b64_tr_b16 v[206:207], v236 offset:8704
    v_permlane16_swap_b32 v184, v186
    v_mfma_f32_16x16x32_bf16 v[28:31], a[28:31], v[212:215], v[28:31]
    s_waitcnt lgkmcnt(4)
    v_permlane16_swap_b32 v185, v187
    v_mfma_f32_16x16x32_bf16 v[4:7], a[32:35], v[192:195], v[4:7]
    ds_read_b64_tr_b16 v[208:209], v236 offset:16384
    v_mfma_f32_16x16x32_bf16 v[4:7], a[48:51], v[196:199], v[4:7]
    v_mfma_f32_16x16x32_bf16 v[12:15], a[36:39], v[192:195], v[12:15]
    ds_read_b64_tr_b16 v[210:211], v236 offset:16896
    v_mfma_f32_16x16x32_bf16 v[12:15], a[52:55], v[196:199], v[12:15]
    v_mfma_f32_16x16x32_bf16 v[20:23], a[40:43], v[192:195], v[20:23]
    s_add_u32 s3, s65, 16384
    ds_read_b64_tr_b16 v[212:213], v236 offset:24576
    v_mfma_f32_16x16x32_bf16 v[20:23], a[56:59], v[196:199], v[20:23]
    buffer_store_dwordx4 v[160:163], v224, s[8:11], s3 offen offset:1024 sc1
    v_mfma_f32_16x16x32_bf16 v[28:31], a[44:47], v[192:195], v[28:31]
    ds_read_b64_tr_b16 v[214:215], v236 offset:25088
    v_mfma_f32_16x16x32_bf16 v[28:31], a[60:63], v[196:199], v[28:31]
    s_waitcnt lgkmcnt(4)
    v_mfma_f32_16x16x32_bf16 v[32:35], a[0:3], v[200:203], 0
    ds_read_b64_tr_b16 v[192:193], v237 offset:0
    v_mfma_f32_16x16x32_bf16 v[32:35], a[16:19], v[204:207], v[32:35]
    v_mfma_f32_16x16x32_bf16 v[40:43], a[4:7], v[200:203], 0
    ds_read_b64_tr_b16 v[194:195], v237 offset:512
    v_mfma_f32_16x16x32_bf16 v[40:43], a[20:23], v[204:207], v[40:43]
    v_mfma_f32_16x16x32_bf16 v[48:51], a[8:11], v[200:203], 0
    ds_read_b64_tr_b16 v[196:197], v237 offset:8192
    v_mfma_f32_16x16x32_bf16 v[48:51], a[24:27], v[204:207], v[48:51]
    v_mfma_f32_16x16x32_bf16 v[56:59], a[12:15], v[200:203], 0
    ds_read_b64_tr_b16 v[198:199], v237 offset:8704
    v_mfma_f32_16x16x32_bf16 v[56:59], a[28:31], v[204:207], v[56:59]
    s_waitcnt lgkmcnt(4)
    v_mfma_f32_16x16x32_bf16 v[32:35], a[32:35], v[208:211], v[32:35]
    s_add_u32 s3, s65, 20480
    ds_read_b64_tr_b16 v[200:201], v237 offset:16384
    v_mfma_f32_16x16x32_bf16 v[32:35], a[48:51], v[212:215], v[32:35]
    buffer_store_dwordx4 v[168:171], v224, s[8:11], s3 offen offset:1024 sc1
    v_mfma_f32_16x16x32_bf16 v[40:43], a[36:39], v[208:211], v[40:43]
    ds_read_b64_tr_b16 v[202:203], v237 offset:16896
    v_mfma_f32_16x16x32_bf16 v[40:43], a[52:55], v[212:215], v[40:43]
    v_mfma_f32_16x16x32_bf16 v[48:51], a[40:43], v[208:211], v[48:51]
    ds_read_b64_tr_b16 v[204:205], v237 offset:24576
    v_mfma_f32_16x16x32_bf16 v[48:51], a[56:59], v[212:215], v[48:51]
    s_waitcnt vmcnt(31)
    s_barrier
    v_mfma_f32_16x16x32_bf16 v[56:59], a[44:47], v[208:211], v[56:59]
    ds_read_b64_tr_b16 v[206:207], v237 offset:25088
    v_mfma_f32_16x16x32_bf16 v[56:59], a[60:63], v[212:215], v[56:59]
    s_waitcnt lgkmcnt(4)
    v_mfma_f32_16x16x32_bf16 v[36:39], a[0:3], v[192:195], 0
    s_add_u32 s3, s65, 24576
    ds_read_b64_tr_b16 v[208:209], v234 offset:4096
    v_mfma_f32_16x16x32_bf16 v[36:39], a[16:19], v[196:199], v[36:39]
    buffer_store_dwordx4 v[176:179], v224, s[8:11], s3 offen offset:1024 sc1
    v_mfma_f32_16x16x32_bf16 v[44:47], a[4:7], v[192:195], 0
    ds_read_b64_tr_b16 v[210:211], v234 offset:4608
    v_mfma_f32_16x16x32_bf16 v[44:47], a[20:23], v[196:199], v[44:47]
    v_mfma_f32_16x16x32_bf16 v[52:55], a[8:11], v[192:195], 0
    ds_read_b64_tr_b16 v[212:213], v234 offset:12288
    v_mfma_f32_16x16x32_bf16 v[52:55], a[24:27], v[196:199], v[52:55]
    v_mfma_f32_16x16x32_bf16 v[60:63], a[12:15], v[192:195], 0
    ds_read_b64_tr_b16 v[214:215], v234 offset:12800
    v_mfma_f32_16x16x32_bf16 v[60:63], a[28:31], v[196:199], v[60:63]
    s_waitcnt lgkmcnt(4)
    v_mfma_f32_16x16x32_bf16 v[36:39], a[32:35], v[200:203], v[36:39]
    s_add_u32 s3, s65, 28672
    ds_read_b64_tr_b16 v[192:193], v234 offset:20480
    v_mfma_f32_16x16x32_bf16 v[36:39], a[48:51], v[204:207], v[36:39]
    buffer_store_dwordx4 v[184:187], v224, s[8:11], s3 offen offset:1024 sc1
    v_mfma_f32_16x16x32_bf16 v[44:47], a[36:39], v[200:203], v[44:47]
    ds_read_b64_tr_b16 v[194:195], v234 offset:20992
    v_mfma_f32_16x16x32_bf16 v[44:47], a[52:55], v[204:207], v[44:47]
    s_waitcnt vmcnt(25)
    v_cmp_ne_u32 vcc, s73, v218
    s_nop 1
    s_cbranch_vccnz L_poll1_sequential_preLN__compressed_kv_cla__geglu_ffn__prompt_kernel
L_poll1_sequential_preLN__compressed_kv_cla__geglu_ffn__prompt_kernel_ok:
    v_mfma_f32_16x16x32_bf16 v[52:55], a[40:43], v[200:203], v[52:55]
    ds_read_b64_tr_b16 v[196:197], v234 offset:28672
    v_mfma_f32_16x16x32_bf16 v[52:55], a[56:59], v[204:207], v[52:55]
    v_mfma_f32_16x16x32_bf16 v[60:63], a[44:47], v[200:203], v[60:63]
    ds_read_b64_tr_b16 v[198:199], v234 offset:29184
    v_mfma_f32_16x16x32_bf16 v[60:63], a[60:63], v[204:207], v[60:63]
    s_waitcnt lgkmcnt(4)
    v_mfma_f32_16x16x32_bf16 v[0:3], a[64:67], v[208:211], v[0:3]
    s_lshl_b32 s6, s75, 7
    s_add_u32 s6, s6, 0x4e01800
    ds_read_b64_tr_b16 v[200:201], v235 offset:4096
    v_mfma_f32_16x16x32_bf16 v[0:3], a[80:83], v[212:215], v[0:3]
    buffer_load_dwordx4 a[0:3], v224, s[8:11], s68 offen offset:0 sc1
    v_mfma_f32_16x16x32_bf16 v[8:11], a[68:71], v[208:211], v[8:11]
    s_lshl_b32 s5, s80, 5
    s_add_u32 s5, s5, s81
    ds_read_b64_tr_b16 v[202:203], v235 offset:4608
    v_mfma_f32_16x16x32_bf16 v[8:11], a[84:87], v[212:215], v[8:11]
    s_lshl_b32 s5, s5, 2
    s_add_u32 s5, s5, 0x4e01800
    v_mfma_f32_16x16x32_bf16 v[16:19], a[72:75], v[208:211], v[16:19]
    ds_read_b64_tr_b16 v[204:205], v235 offset:12288
    v_mfma_f32_16x16x32_bf16 v[16:19], a[88:91], v[212:215], v[16:19]
    buffer_load_dwordx4 a[4:7], v224, s[8:11], s68 offen offset:1024 sc1
    v_mfma_f32_16x16x32_bf16 v[24:27], a[76:79], v[208:211], v[24:27]
    ds_read_b64_tr_b16 v[206:207], v235 offset:12800
    v_mfma_f32_16x16x32_bf16 v[24:27], a[92:95], v[212:215], v[24:27]
    s_waitcnt lgkmcnt(4)
    v_mfma_f32_16x16x32_bf16 v[0:3], a[96:99], v[192:195], v[0:3]
    ds_read_b64_tr_b16 v[208:209], v235 offset:20480
    v_mfma_f32_16x16x32_bf16 v[0:3], a[112:115], v[196:199], v[0:3]
    v_mfma_f32_16x16x32_bf16 v[8:11], a[100:103], v[192:195], v[8:11]
    ds_read_b64_tr_b16 v[210:211], v235 offset:20992
    v_mfma_f32_16x16x32_bf16 v[8:11], a[116:119], v[196:199], v[8:11]
    v_mfma_f32_16x16x32_bf16 v[16:19], a[104:107], v[192:195], v[16:19]
    ds_read_b64_tr_b16 v[212:213], v235 offset:28672
    v_mfma_f32_16x16x32_bf16 v[16:19], a[120:123], v[196:199], v[16:19]
    buffer_load_dwordx4 a[16:19], v224, s[8:11], s68 offen offset:2048 sc1
    v_mfma_f32_16x16x32_bf16 v[24:27], a[108:111], v[192:195], v[24:27]
    ds_read_b64_tr_b16 v[214:215], v235 offset:29184
    v_mfma_f32_16x16x32_bf16 v[24:27], a[124:127], v[196:199], v[24:27]
    s_waitcnt lgkmcnt(4)
    v_mfma_f32_16x16x32_bf16 v[4:7], a[64:67], v[200:203], v[4:7]
    ds_read_b64_tr_b16 v[192:193], v236 offset:4096
    v_mfma_f32_16x16x32_bf16 v[4:7], a[80:83], v[204:207], v[4:7]
    buffer_load_dwordx4 a[20:23], v224, s[8:11], s68 offen offset:3072 sc1
    v_mfma_f32_16x16x32_bf16 v[12:15], a[68:71], v[200:203], v[12:15]
    s_add_u32 s68, s68, 4096
    ds_read_b64_tr_b16 v[194:195], v236 offset:4608
    v_mfma_f32_16x16x32_bf16 v[12:15], a[84:87], v[204:207], v[12:15]
    v_mfma_f32_16x16x32_bf16 v[20:23], a[72:75], v[200:203], v[20:23]
    ds_read_b64_tr_b16 v[196:197], v236 offset:12288
    v_mfma_f32_16x16x32_bf16 v[20:23], a[88:91], v[204:207], v[20:23]
    buffer_load_dwordx4 a[8:11], v224, s[8:11], s69 offen offset:0 sc1
    v_mfma_f32_16x16x32_bf16 v[28:31], a[76:79], v[200:203], v[28:31]
    ds_read_b64_tr_b16 v[198:199], v236 offset:12800
    v_mfma_f32_16x16x32_bf16 v[28:31], a[92:95], v[204:207], v[28:31]
    s_waitcnt lgkmcnt(4)
    v_mfma_f32_16x16x32_bf16 v[4:7], a[96:99], v[208:211], v[4:7]
    ds_read_b64_tr_b16 v[200:201], v236 offset:20480
    v_mfma_f32_16x16x32_bf16 v[4:7], a[112:115], v[212:215], v[4:7]
    v_mfma_f32_16x16x32_bf16 v[12:15], a[100:103], v[208:211], v[12:15]
    ds_read_b64_tr_b16 v[202:203], v236 offset:20992
    v_mfma_f32_16x16x32_bf16 v[12:15], a[116:119], v[212:215], v[12:15]
    v_mfma_f32_16x16x32_bf16 v[20:23], a[104:107], v[208:211], v[20:23]
    ds_read_b64_tr_b16 v[204:205], v236 offset:28672
    v_mfma_f32_16x16x32_bf16 v[20:23], a[120:123], v[212:215], v[20:23]
    buffer_load_dwordx4 a[12:15], v224, s[8:11], s69 offen offset:1024 sc1
    v_mfma_f32_16x16x32_bf16 v[28:31], a[108:111], v[208:211], v[28:31]
    ds_read_b64_tr_b16 v[206:207], v236 offset:29184
    v_mfma_f32_16x16x32_bf16 v[28:31], a[124:127], v[212:215], v[28:31]
    s_waitcnt lgkmcnt(4)
    v_mfma_f32_16x16x32_bf16 v[32:35], a[64:67], v[192:195], v[32:35]
    ds_read_b64_tr_b16 v[208:209], v237 offset:4096
    v_mfma_f32_16x16x32_bf16 v[32:35], a[80:83], v[196:199], v[32:35]
    buffer_load_dwordx4 a[24:27], v224, s[8:11], s69 offen offset:2048 sc1
    v_mfma_f32_16x16x32_bf16 v[40:43], a[68:71], v[192:195], v[40:43]
    ds_read_b64_tr_b16 v[210:211], v237 offset:4608
    v_mfma_f32_16x16x32_bf16 v[40:43], a[84:87], v[196:199], v[40:43]
    v_mfma_f32_16x16x32_bf16 v[48:51], a[72:75], v[192:195], v[48:51]
    ds_read_b64_tr_b16 v[212:213], v237 offset:12288
    v_mfma_f32_16x16x32_bf16 v[48:51], a[88:91], v[196:199], v[48:51]
    v_mfma_f32_16x16x32_bf16 v[56:59], a[76:79], v[192:195], v[56:59]
    ds_read_b64_tr_b16 v[214:215], v237 offset:12800
    v_mfma_f32_16x16x32_bf16 v[56:59], a[92:95], v[196:199], v[56:59]
    s_waitcnt lgkmcnt(4)
    v_mfma_f32_16x16x32_bf16 v[32:35], a[96:99], v[200:203], v[32:35]
    ds_read_b64_tr_b16 v[192:193], v237 offset:20480
    v_mfma_f32_16x16x32_bf16 v[32:35], a[112:115], v[204:207], v[32:35]
    buffer_load_dwordx4 a[28:31], v224, s[8:11], s69 offen offset:3072 sc1
    v_mfma_f32_16x16x32_bf16 v[40:43], a[100:103], v[200:203], v[40:43]
    s_add_u32 s69, s69, 4096
    ds_read_b64_tr_b16 v[194:195], v237 offset:20992
    v_mfma_f32_16x16x32_bf16 v[40:43], a[116:119], v[204:207], v[40:43]
    v_mfma_f32_16x16x32_bf16 v[48:51], a[104:107], v[200:203], v[48:51]
    ds_read_b64_tr_b16 v[196:197], v237 offset:28672
    v_mfma_f32_16x16x32_bf16 v[48:51], a[120:123], v[204:207], v[48:51]
    s_barrier
    v_mfma_f32_16x16x32_bf16 v[56:59], a[108:111], v[200:203], v[56:59]
    ds_read_b64_tr_b16 v[198:199], v237 offset:29184
    v_mfma_f32_16x16x32_bf16 v[56:59], a[124:127], v[204:207], v[56:59]
    s_waitcnt lgkmcnt(4)
    v_mfma_f32_16x16x32_bf16 v[36:39], a[64:67], v[208:211], v[36:39]
    ds_read_b64_tr_b16 v[200:201], v234 offset:32768
    v_mfma_f32_16x16x32_bf16 v[36:39], a[80:83], v[212:215], v[36:39]
    buffer_load_dwordx4 a[32:35], v224, s[8:11], s68 offen offset:0 sc1
    v_mfma_f32_16x16x32_bf16 v[44:47], a[68:71], v[208:211], v[44:47]
    ds_read_b64_tr_b16 v[202:203], v234 offset:33280
    v_mfma_f32_16x16x32_bf16 v[44:47], a[84:87], v[212:215], v[44:47]
    v_mfma_f32_16x16x32_bf16 v[52:55], a[72:75], v[208:211], v[52:55]
    ds_read_b64_tr_b16 v[204:205], v234 offset:40960
    v_mfma_f32_16x16x32_bf16 v[52:55], a[88:91], v[212:215], v[52:55]
    buffer_load_dwordx4 a[36:39], v224, s[8:11], s68 offen offset:1024 sc1
    v_mfma_f32_16x16x32_bf16 v[60:63], a[76:79], v[208:211], v[60:63]
    ds_read_b64_tr_b16 v[206:207], v234 offset:41472
    v_mfma_f32_16x16x32_bf16 v[60:63], a[92:95], v[212:215], v[60:63]
    s_waitcnt lgkmcnt(4)
    v_mfma_f32_16x16x32_bf16 v[36:39], a[96:99], v[192:195], v[36:39]
    ds_read_b64_tr_b16 v[208:209], v234 offset:49152
    v_mfma_f32_16x16x32_bf16 v[36:39], a[112:115], v[196:199], v[36:39]
    buffer_load_dwordx4 a[48:51], v224, s[8:11], s68 offen offset:2048 sc1
    v_mfma_f32_16x16x32_bf16 v[44:47], a[100:103], v[192:195], v[44:47]
    ds_read_b64_tr_b16 v[210:211], v234 offset:49664
    v_mfma_f32_16x16x32_bf16 v[44:47], a[116:119], v[196:199], v[44:47]
    v_mfma_f32_16x16x32_bf16 v[52:55], a[104:107], v[192:195], v[52:55]
    ds_read_b64_tr_b16 v[212:213], v234 offset:57344
    v_mfma_f32_16x16x32_bf16 v[52:55], a[120:123], v[196:199], v[52:55]
    buffer_load_dwordx4 a[52:55], v224, s[8:11], s68 offen offset:3072 sc1
    v_mfma_f32_16x16x32_bf16 v[60:63], a[108:111], v[192:195], v[60:63]
    s_add_u32 s68, s68, 4096
    ds_read_b64_tr_b16 v[214:215], v234 offset:57856
    v_mfma_f32_16x16x32_bf16 v[60:63], a[124:127], v[196:199], v[60:63]
    s_waitcnt lgkmcnt(4)
    v_mfma_f32_16x16x32_bf16 v[0:3], a[128:131], v[200:203], v[0:3]
    ds_read_b64_tr_b16 v[192:193], v235 offset:32768
    v_mfma_f32_16x16x32_bf16 v[0:3], a[144:147], v[204:207], v[0:3]
    buffer_load_dwordx4 a[40:43], v224, s[8:11], s69 offen offset:0 sc1
    v_mfma_f32_16x16x32_bf16 v[8:11], a[132:135], v[200:203], v[8:11]
    ds_read_b64_tr_b16 v[194:195], v235 offset:33280
    v_mfma_f32_16x16x32_bf16 v[8:11], a[148:151], v[204:207], v[8:11]
    v_mfma_f32_16x16x32_bf16 v[16:19], a[136:139], v[200:203], v[16:19]
    ds_read_b64_tr_b16 v[196:197], v235 offset:40960
    v_mfma_f32_16x16x32_bf16 v[16:19], a[152:155], v[204:207], v[16:19]
    v_mfma_f32_16x16x32_bf16 v[24:27], a[140:143], v[200:203], v[24:27]
    ds_read_b64_tr_b16 v[198:199], v235 offset:41472
    v_mfma_f32_16x16x32_bf16 v[24:27], a[156:159], v[204:207], v[24:27]
    s_waitcnt lgkmcnt(4)
    v_mfma_f32_16x16x32_bf16 v[0:3], a[160:163], v[208:211], v[0:3]
    ds_read_b64_tr_b16 v[200:201], v235 offset:49152
    v_mfma_f32_16x16x32_bf16 v[0:3], a[176:179], v[212:215], v[0:3]
    buffer_load_dwordx4 a[44:47], v224, s[8:11], s69 offen offset:1024 sc1
    v_mfma_f32_16x16x32_bf16 v[8:11], a[164:167], v[208:211], v[8:11]
    ds_read_b64_tr_b16 v[202:203], v235 offset:49664
    v_mfma_f32_16x16x32_bf16 v[8:11], a[180:183], v[212:215], v[8:11]
    v_mfma_f32_16x16x32_bf16 v[16:19], a[168:171], v[208:211], v[16:19]
    ds_read_b64_tr_b16 v[204:205], v235 offset:57344
    v_mfma_f32_16x16x32_bf16 v[16:19], a[184:187], v[212:215], v[16:19]
    buffer_load_dwordx4 a[56:59], v224, s[8:11], s69 offen offset:2048 sc1
    v_mfma_f32_16x16x32_bf16 v[24:27], a[172:175], v[208:211], v[24:27]
    ds_read_b64_tr_b16 v[206:207], v235 offset:57856
    v_mfma_f32_16x16x32_bf16 v[24:27], a[188:191], v[212:215], v[24:27]
    s_waitcnt lgkmcnt(4)
    v_mfma_f32_16x16x32_bf16 v[4:7], a[128:131], v[192:195], v[4:7]
    ds_read_b64_tr_b16 v[208:209], v236 offset:32768
    v_mfma_f32_16x16x32_bf16 v[4:7], a[144:147], v[196:199], v[4:7]
    v_mfma_f32_16x16x32_bf16 v[12:15], a[132:135], v[192:195], v[12:15]
    ds_read_b64_tr_b16 v[210:211], v236 offset:33280
    v_mfma_f32_16x16x32_bf16 v[12:15], a[148:151], v[196:199], v[12:15]
    v_mfma_f32_16x16x32_bf16 v[20:23], a[136:139], v[192:195], v[20:23]
    ds_read_b64_tr_b16 v[212:213], v236 offset:40960
    v_mfma_f32_16x16x32_bf16 v[20:23], a[152:155], v[196:199], v[20:23]
    buffer_load_dwordx4 a[60:63], v224, s[8:11], s69 offen offset:3072 sc1
    v_mfma_f32_16x16x32_bf16 v[28:31], a[140:143], v[192:195], v[28:31]
    s_add_u32 s69, s69, 4096
    ds_read_b64_tr_b16 v[214:215], v236 offset:41472
    v_mfma_f32_16x16x32_bf16 v[28:31], a[156:159], v[196:199], v[28:31]
    s_waitcnt lgkmcnt(4)
    v_mfma_f32_16x16x32_bf16 v[4:7], a[160:163], v[200:203], v[4:7]
    s_add_u32 m0, s67, 114688
    s_add_u32 s63, s61, 3670016
    ds_read_b64_tr_b16 v[192:193], v236 offset:49152
    v_mfma_f32_16x16x32_bf16 v[4:7], a[176:179], v[204:207], v[4:7]
    buffer_load_dwordx4 v226, s[28:31], s63 offen offset:0 nt lds
    v_mfma_f32_16x16x32_bf16 v[12:15], a[164:167], v[200:203], v[12:15]
    ds_read_b64_tr_b16 v[194:195], v236 offset:49664
    v_mfma_f32_16x16x32_bf16 v[12:15], a[180:183], v[204:207], v[12:15]
    v_mfma_f32_16x16x32_bf16 v[20:23], a[168:171], v[200:203], v[20:23]
    ds_read_b64_tr_b16 v[196:197], v236 offset:57344
    v_mfma_f32_16x16x32_bf16 v[20:23], a[184:187], v[204:207], v[20:23]
    buffer_load_dwordx4 v227, s[28:31], s63 offen offset:1024 nt lds
    v_mfma_f32_16x16x32_bf16 v[28:31], a[172:175], v[200:203], v[28:31]
    ds_read_b64_tr_b16 v[198:199], v236 offset:57856
    v_mfma_f32_16x16x32_bf16 v[28:31], a[188:191], v[204:207], v[28:31]
    s_waitcnt lgkmcnt(4)
    v_mfma_f32_16x16x32_bf16 v[32:35], a[128:131], v[208:211], v[32:35]
    ds_read_b64_tr_b16 v[200:201], v237 offset:32768
    v_mfma_f32_16x16x32_bf16 v[32:35], a[144:147], v[212:215], v[32:35]
    buffer_load_dwordx4 v238, s[28:31], s63 offen offset:2048 nt lds
    v_mfma_f32_16x16x32_bf16 v[40:43], a[132:135], v[208:211], v[40:43]
    ds_read_b64_tr_b16 v[202:203], v237 offset:33280
    v_mfma_f32_16x16x32_bf16 v[40:43], a[148:151], v[212:215], v[40:43]
    v_mfma_f32_16x16x32_bf16 v[48:51], a[136:139], v[208:211], v[48:51]
    ds_read_b64_tr_b16 v[204:205], v237 offset:40960
    v_mfma_f32_16x16x32_bf16 v[48:51], a[152:155], v[212:215], v[48:51]
    buffer_load_dwordx4 v239, s[28:31], s63 offen offset:3072 nt lds
    v_mfma_f32_16x16x32_bf16 v[56:59], a[140:143], v[208:211], v[56:59]
    ds_read_b64_tr_b16 v[206:207], v237 offset:41472
    v_mfma_f32_16x16x32_bf16 v[56:59], a[156:159], v[212:215], v[56:59]
    s_waitcnt lgkmcnt(4)
    v_mfma_f32_16x16x32_bf16 v[32:35], a[160:163], v[192:195], v[32:35]
    ds_read_b64_tr_b16 v[208:209], v237 offset:49152
    v_mfma_f32_16x16x32_bf16 v[32:35], a[176:179], v[196:199], v[32:35]
    buffer_load_dwordx4 a[64:67], v224, s[8:11], s68 offen offset:0 sc1
    v_mfma_f32_16x16x32_bf16 v[40:43], a[164:167], v[192:195], v[40:43]
    ds_read_b64_tr_b16 v[210:211], v237 offset:49664
    v_mfma_f32_16x16x32_bf16 v[40:43], a[180:183], v[196:199], v[40:43]
    v_mfma_f32_16x16x32_bf16 v[48:51], a[168:171], v[192:195], v[48:51]
    ds_read_b64_tr_b16 v[212:213], v237 offset:57344
    v_mfma_f32_16x16x32_bf16 v[48:51], a[184:187], v[196:199], v[48:51]
    s_waitcnt vmcnt(34)
    s_barrier
    v_mfma_f32_16x16x32_bf16 v[56:59], a[172:175], v[192:195], v[56:59]
    ds_read_b64_tr_b16 v[214:215], v237 offset:57856
    v_mfma_f32_16x16x32_bf16 v[56:59], a[188:191], v[196:199], v[56:59]
    s_waitcnt lgkmcnt(4)
    v_mfma_f32_16x16x32_bf16 v[36:39], a[128:131], v[200:203], v[36:39]
    ds_read_b64_tr_b16 v[192:193], v234 offset:36864
    v_mfma_f32_16x16x32_bf16 v[36:39], a[144:147], v[204:207], v[36:39]
    buffer_load_dwordx4 a[68:71], v224, s[8:11], s68 offen offset:1024 sc1
    v_mfma_f32_16x16x32_bf16 v[44:47], a[132:135], v[200:203], v[44:47]
    ds_read_b64_tr_b16 v[194:195], v234 offset:37376
    v_mfma_f32_16x16x32_bf16 v[44:47], a[148:151], v[204:207], v[44:47]
    v_mfma_f32_16x16x32_bf16 v[52:55], a[136:139], v[200:203], v[52:55]
    ds_read_b64_tr_b16 v[196:197], v234 offset:45056
    v_mfma_f32_16x16x32_bf16 v[52:55], a[152:155], v[204:207], v[52:55]
    buffer_load_dwordx4 a[80:83], v224, s[8:11], s68 offen offset:2048 sc1
    v_mfma_f32_16x16x32_bf16 v[60:63], a[140:143], v[200:203], v[60:63]
    ds_read_b64_tr_b16 v[198:199], v234 offset:45568
    v_mfma_f32_16x16x32_bf16 v[60:63], a[156:159], v[204:207], v[60:63]
    s_waitcnt lgkmcnt(4)
    v_mfma_f32_16x16x32_bf16 v[36:39], a[160:163], v[208:211], v[36:39]
    ds_read_b64_tr_b16 v[200:201], v234 offset:53248
    v_mfma_f32_16x16x32_bf16 v[36:39], a[176:179], v[212:215], v[36:39]
    v_mfma_f32_16x16x32_bf16 v[44:47], a[164:167], v[208:211], v[44:47]
    ds_read_b64_tr_b16 v[202:203], v234 offset:53760
    v_mfma_f32_16x16x32_bf16 v[44:47], a[180:183], v[212:215], v[44:47]
    v_mfma_f32_16x16x32_bf16 v[52:55], a[168:171], v[208:211], v[52:55]
    ds_read_b64_tr_b16 v[204:205], v234 offset:61440
    v_mfma_f32_16x16x32_bf16 v[52:55], a[184:187], v[212:215], v[52:55]
    buffer_load_dwordx4 a[84:87], v224, s[8:11], s68 offen offset:3072 sc1
    v_mfma_f32_16x16x32_bf16 v[60:63], a[172:175], v[208:211], v[60:63]
    s_add_u32 s68, s68, 4096
    ds_read_b64_tr_b16 v[206:207], v234 offset:61952
    v_mfma_f32_16x16x32_bf16 v[60:63], a[188:191], v[212:215], v[60:63]
    s_waitcnt lgkmcnt(4)
    v_mfma_f32_16x16x32_bf16 v[0:3], a[192:195], v[192:195], v[0:3]
    ds_read_b64_tr_b16 v[208:209], v235 offset:36864
    v_mfma_f32_16x16x32_bf16 v[0:3], a[208:211], v[196:199], v[0:3]
    buffer_load_dwordx4 a[72:75], v224, s[8:11], s69 offen offset:0 sc1
    v_mfma_f32_16x16x32_bf16 v[8:11], a[196:199], v[192:195], v[8:11]
    ds_read_b64_tr_b16 v[210:211], v235 offset:37376
    v_mfma_f32_16x16x32_bf16 v[8:11], a[212:215], v[196:199], v[8:11]
    v_mfma_f32_16x16x32_bf16 v[16:19], a[200:203], v[192:195], v[16:19]
    ds_read_b64_tr_b16 v[212:213], v235 offset:45056
    v_mfma_f32_16x16x32_bf16 v[16:19], a[216:219], v[196:199], v[16:19]
    buffer_load_dwordx4 a[76:79], v224, s[8:11], s69 offen offset:1024 sc1
    v_mfma_f32_16x16x32_bf16 v[24:27], a[204:207], v[192:195], v[24:27]
    ds_read_b64_tr_b16 v[214:215], v235 offset:45568
    v_mfma_f32_16x16x32_bf16 v[24:27], a[220:223], v[196:199], v[24:27]
    s_waitcnt lgkmcnt(4)
    v_mfma_f32_16x16x32_bf16 v[0:3], a[224:227], v[200:203], v[0:3]
    ds_read_b64_tr_b16 v[192:193], v235 offset:53248
    v_mfma_f32_16x16x32_bf16 v[0:3], a[240:243], v[204:207], v[0:3]
    v_mfma_f32_16x16x32_bf16 v[8:11], a[228:231], v[200:203], v[8:11]
    ds_read_b64_tr_b16 v[194:195], v235 offset:53760
    v_mfma_f32_16x16x32_bf16 v[8:11], a[244:247], v[204:207], v[8:11]
    v_mfma_f32_16x16x32_bf16 v[16:19], a[232:235], v[200:203], v[16:19]
    ds_read_b64_tr_b16 v[196:197], v235 offset:61440
    v_mfma_f32_16x16x32_bf16 v[16:19], a[248:251], v[204:207], v[16:19]
    buffer_load_dwordx4 a[88:91], v224, s[8:11], s69 offen offset:2048 sc1
    v_mfma_f32_16x16x32_bf16 v[24:27], a[236:239], v[200:203], v[24:27]
    ds_read_b64_tr_b16 v[198:199], v235 offset:61952
    v_mfma_f32_16x16x32_bf16 v[24:27], a[252:255], v[204:207], v[24:27]
    s_waitcnt lgkmcnt(4)
    v_mfma_f32_16x16x32_bf16 v[4:7], a[192:195], v[208:211], v[4:7]
    ds_read_b64_tr_b16 v[200:201], v236 offset:36864
    v_mfma_f32_16x16x32_bf16 v[4:7], a[208:211], v[212:215], v[4:7]
    buffer_load_dwordx4 a[92:95], v224, s[8:11], s69 offen offset:3072 sc1
    v_mfma_f32_16x16x32_bf16 v[12:15], a[196:199], v[208:211], v[12:15]
    s_add_u32 s69, s69, 4096
    ds_read_b64_tr_b16 v[202:203], v236 offset:37376
    v_mfma_f32_16x16x32_bf16 v[12:15], a[212:215], v[212:215], v[12:15]
    v_mfma_f32_16x16x32_bf16 v[20:23], a[200:203], v[208:211], v[20:23]
    s_add_u32 m0, s67, 0
    s_add_u32 s63, s61, 1048576
    ds_read_b64_tr_b16 v[204:205], v236 offset:45056
    v_mfma_f32_16x16x32_bf16 v[20:23], a[216:219], v[212:215], v[20:23]
    buffer_load_dwordx4 v226, s[28:31], s63 offen offset:0 nt lds
    v_mfma_f32_16x16x32_bf16 v[28:31], a[204:207], v[208:211], v[28:31]
    ds_read_b64_tr_b16 v[206:207], v236 offset:45568
    v_mfma_f32_16x16x32_bf16 v[28:31], a[220:223], v[212:215], v[28:31]
    s_waitcnt lgkmcnt(4)
    v_mfma_f32_16x16x32_bf16 v[4:7], a[224:227], v[192:195], v[4:7]
    ds_read_b64_tr_b16 v[208:209], v236 offset:53248
    v_mfma_f32_16x16x32_bf16 v[4:7], a[240:243], v[196:199], v[4:7]
    v_mfma_f32_16x16x32_bf16 v[12:15], a[228:231], v[192:195], v[12:15]
    ds_read_b64_tr_b16 v[210:211], v236 offset:53760
    v_mfma_f32_16x16x32_bf16 v[12:15], a[244:247], v[196:199], v[12:15]
    v_mfma_f32_16x16x32_bf16 v[20:23], a[232:235], v[192:195], v[20:23]
    ds_read_b64_tr_b16 v[212:213], v236 offset:61440
    v_mfma_f32_16x16x32_bf16 v[20:23], a[248:251], v[196:199], v[20:23]
    buffer_load_dwordx4 v227, s[28:31], s63 offen offset:1024 nt lds
    v_mfma_f32_16x16x32_bf16 v[28:31], a[236:239], v[192:195], v[28:31]
    ds_read_b64_tr_b16 v[214:215], v236 offset:61952
    v_mfma_f32_16x16x32_bf16 v[28:31], a[252:255], v[196:199], v[28:31]
    s_waitcnt lgkmcnt(4)
    v_mfma_f32_16x16x32_bf16 v[32:35], a[192:195], v[200:203], v[32:35]
    ds_read_b64_tr_b16 v[192:193], v237 offset:36864
    v_mfma_f32_16x16x32_bf16 v[32:35], a[208:211], v[204:207], v[32:35]
    buffer_load_dwordx4 v238, s[28:31], s63 offen offset:2048 nt lds
    v_mfma_f32_16x16x32_bf16 v[40:43], a[196:199], v[200:203], v[40:43]
    ds_read_b64_tr_b16 v[194:195], v237 offset:37376
    v_cvt_pk_bf16_f32 v0, v0, v1
    v_mfma_f32_16x16x32_bf16 v[40:43], a[212:215], v[204:207], v[40:43]
    v_cvt_pk_bf16_f32 v1, v2, v3
    v_cvt_pk_bf16_f32 v2, v4, v5
    v_mfma_f32_16x16x32_bf16 v[48:51], a[200:203], v[200:203], v[48:51]
    ds_read_b64_tr_b16 v[196:197], v237 offset:45056
    v_cvt_pk_bf16_f32 v3, v6, v7
    v_mfma_f32_16x16x32_bf16 v[48:51], a[216:219], v[204:207], v[48:51]
    buffer_load_dwordx4 v239, s[28:31], s63 offen offset:3072 nt lds
    v_mfma_f32_16x16x32_bf16 v[56:59], a[204:207], v[200:203], v[56:59]
    ds_read_b64_tr_b16 v[198:199], v237 offset:45568
    v_permlane16_swap_b32 v0, v2
    v_mfma_f32_16x16x32_bf16 v[56:59], a[220:223], v[204:207], v[56:59]
    s_waitcnt lgkmcnt(4)
    v_permlane16_swap_b32 v1, v3
    v_cvt_pk_bf16_f32 v8, v8, v9
    v_mfma_f32_16x16x32_bf16 v[32:35], a[224:227], v[208:211], v[32:35]
    ds_read_b64_tr_b16 v[200:201], v237 offset:53248
    v_cvt_pk_bf16_f32 v9, v10, v11
    v_mfma_f32_16x16x32_bf16 v[32:35], a[240:243], v[212:215], v[32:35]
    buffer_load_dwordx4 a[96:99], v224, s[8:11], s68 offen offset:0 sc1
    v_mfma_f32_16x16x32_bf16 v[40:43], a[228:231], v[208:211], v[40:43]
    ds_read_b64_tr_b16 v[202:203], v237 offset:53760
    v_cvt_pk_bf16_f32 v10, v12, v13
    v_mfma_f32_16x16x32_bf16 v[40:43], a[244:247], v[212:215], v[40:43]
    v_cvt_pk_bf16_f32 v11, v14, v15
    v_mfma_f32_16x16x32_bf16 v[48:51], a[232:235], v[208:211], v[48:51]
    ds_read_b64_tr_b16 v[204:205], v237 offset:61440
    v_mfma_f32_16x16x32_bf16 v[48:51], a[248:251], v[212:215], v[48:51]
    s_waitcnt vmcnt(40)
    s_barrier
    v_permlane16_swap_b32 v8, v10
    v_mfma_f32_16x16x32_bf16 v[56:59], a[236:239], v[208:211], v[56:59]
    ds_read_b64_tr_b16 v[206:207], v237 offset:61952
    v_permlane16_swap_b32 v9, v11
    v_mfma_f32_16x16x32_bf16 v[56:59], a[252:255], v[212:215], v[56:59]
    s_waitcnt lgkmcnt(4)
    v_cvt_pk_bf16_f32 v16, v16, v17
    v_cvt_pk_bf16_f32 v17, v18, v19
    v_mfma_f32_16x16x32_bf16 v[36:39], a[192:195], v[192:195], v[36:39]
    ds_read_b64_tr_b16 v[208:209], v240 offset:0
    v_cvt_pk_bf16_f32 v18, v20, v21
    v_mfma_f32_16x16x32_bf16 v[36:39], a[208:211], v[196:199], v[36:39]
    buffer_load_dwordx4 a[100:103], v224, s[8:11], s68 offen offset:1024 sc1
    v_mfma_f32_16x16x32_bf16 v[44:47], a[196:199], v[192:195], v[44:47]
    ds_read_b64_tr_b16 v[210:211], v240 offset:1024
    v_cvt_pk_bf16_f32 v19, v22, v23
    v_mfma_f32_16x16x32_bf16 v[44:47], a[212:215], v[196:199], v[44:47]
    v_mfma_f32_16x16x32_bf16 v[52:55], a[200:203], v[192:195], v[52:55]
    s_add_u32 s3, s65, 16384
    ds_read_b64_tr_b16 v[212:213], v240 offset:8192
    v_permlane16_swap_b32 v16, v18
    v_mfma_f32_16x16x32_bf16 v[52:55], a[216:219], v[196:199], v[52:55]
    buffer_store_dwordx4 v[0:3], v224, s[8:11], s3 offen offset:2048 sc1
    v_mfma_f32_16x16x32_bf16 v[60:63], a[204:207], v[192:195], v[60:63]
    ds_read_b64_tr_b16 v[214:215], v240 offset:9216
    v_permlane16_swap_b32 v17, v19
    v_mfma_f32_16x16x32_bf16 v[60:63], a[220:223], v[196:199], v[60:63]
    s_waitcnt lgkmcnt(4)
    v_cvt_pk_bf16_f32 v24, v24, v25
    v_cvt_pk_bf16_f32 v25, v26, v27
    v_mfma_f32_16x16x32_bf16 v[36:39], a[224:227], v[200:203], v[36:39]
    ds_read_b64_tr_b16 v[192:193], v241 offset:0
    v_cvt_pk_bf16_f32 v26, v28, v29
    v_mfma_f32_16x16x32_bf16 v[36:39], a[240:243], v[204:207], v[36:39]
    v_cvt_pk_bf16_f32 v27, v30, v31
    v_mfma_f32_16x16x32_bf16 v[44:47], a[228:231], v[200:203], v[44:47]
    ds_read_b64_tr_b16 v[194:195], v241 offset:1024
    v_mfma_f32_16x16x32_bf16 v[44:47], a[244:247], v[204:207], v[44:47]
    v_permlane16_swap_b32 v24, v26
    v_permlane16_swap_b32 v25, v27
    v_mfma_f32_16x16x32_bf16 v[52:55], a[232:235], v[200:203], v[52:55]
    s_add_u32 s3, s65, 20480
    ds_read_b64_tr_b16 v[196:197], v241 offset:8192
    v_mfma_f32_16x16x32_bf16 v[52:55], a[248:251], v[204:207], v[52:55]
    buffer_store_dwordx4 v[8:11], v224, s[8:11], s3 offen offset:2048 sc1
    v_mfma_f32_16x16x32_bf16 v[60:63], a[236:239], v[200:203], v[60:63]
    ds_read_b64_tr_b16 v[198:199], v241 offset:9216
    v_mfma_f32_16x16x32_bf16 v[60:63], a[252:255], v[204:207], v[60:63]
    s_waitcnt vmcnt(28) lgkmcnt(4)
    v_mfma_f32_16x16x32_bf16 v[64:67], v[208:211], a[0:3], 0
    ds_read_b64_tr_b16 v[200:201], v242 offset:0
    v_mfma_f32_16x16x32_bf16 v[64:67], v[212:215], a[16:19], v[64:67]
    v_mfma_f32_16x16x32_bf16 v[68:71], v[208:211], a[4:7], 0
    ds_read_b64_tr_b16 v[202:203], v242 offset:1024
    v_cvt_pk_bf16_f32 v32, v32, v33
    v_mfma_f32_16x16x32_bf16 v[68:71], v[212:215], a[20:23], v[68:71]
    v_cvt_pk_bf16_f32 v33, v34, v35
    v_cvt_pk_bf16_f32 v34, v36, v37
    v_mfma_f32_16x16x32_bf16 v[128:131], v[208:211], a[8:11], 0
    s_add_u32 s3, s65, 24576
    ds_read_b64_tr_b16 v[204:205], v242 offset:8192
    v_cvt_pk_bf16_f32 v35, v38, v39
    v_mfma_f32_16x16x32_bf16 v[128:131], v[212:215], a[24:27], v[128:131]
    buffer_store_dwordx4 v[16:19], v224, s[8:11], s3 offen offset:2048 sc1
    v_mfma_f32_16x16x32_bf16 v[132:135], v[208:211], a[12:15], 0
    ds_read_b64_tr_b16 v[206:207], v242 offset:9216
    v_permlane16_swap_b32 v32, v34
    v_mfma_f32_16x16x32_bf16 v[132:135], v[212:215], a[28:31], v[132:135]
    s_waitcnt lgkmcnt(4)
    v_permlane16_swap_b32 v33, v35
    v_cvt_pk_bf16_f32 v40, v40, v41
    v_mfma_f32_16x16x32_bf16 v[72:75], v[192:195], a[0:3], 0
    ds_read_b64_tr_b16 v[208:209], v243 offset:0
    v_cvt_pk_bf16_f32 v41, v42, v43
    v_mfma_f32_16x16x32_bf16 v[72:75], v[196:199], a[16:19], v[72:75]
    v_cvt_pk_bf16_f32 v42, v44, v45
    v_cvt_pk_bf16_f32 v43, v46, v47
    v_mfma_f32_16x16x32_bf16 v[76:79], v[192:195], a[4:7], 0
    ds_read_b64_tr_b16 v[210:211], v243 offset:1024
    v_mfma_f32_16x16x32_bf16 v[76:79], v[196:199], a[20:23], v[76:79]
    v_permlane16_swap_b32 v40, v42
    v_permlane16_swap_b32 v41, v43
    v_mfma_f32_16x16x32_bf16 v[136:139], v[192:195], a[8:11], 0
    s_add_u32 s3, s65, 28672
    ds_read_b64_tr_b16 v[212:213], v243 offset:8192
    v_cvt_pk_bf16_f32 v48, v48, v49
    v_mfma_f32_16x16x32_bf16 v[136:139], v[196:199], a[24:27], v[136:139]
    buffer_store_dwordx4 v[24:27], v224, s[8:11], s3 offen offset:2048 sc1
    v_mfma_f32_16x16x32_bf16 v[140:143], v[192:195], a[12:15], 0
    ds_read_b64_tr_b16 v[214:215], v243 offset:9216
    v_cvt_pk_bf16_f32 v49, v50, v51
    v_mfma_f32_16x16x32_bf16 v[140:143], v[196:199], a[28:31], v[140:143]
    s_waitcnt lgkmcnt(4)
    v_cvt_pk_bf16_f32 v50, v52, v53
    v_cvt_pk_bf16_f32 v51, v54, v55
    v_mfma_f32_16x16x32_bf16 v[80:83], v[200:203], a[0:3], 0
    ds_read_b64_tr_b16 v[192:193], v244 offset:0
    v_mfma_f32_16x16x32_bf16 v[80:83], v[204:207], a[16:19], v[80:83]
    v_permlane16_swap_b32 v48, v50
    v_permlane16_swap_b32 v49, v51
    v_mfma_f32_16x16x32_bf16 v[84:87], v[200:203], a[4:7], 0
    ds_read_b64_tr_b16 v[194:195], v244 offset:1024
    v_cvt_pk_bf16_f32 v56, v56, v57
    v_mfma_f32_16x16x32_bf16 v[84:87], v[204:207], a[20:23], v[84:87]
    v_cvt_pk_bf16_f32 v57, v58, v59
    v_cvt_pk_bf16_f32 v58, v60, v61
    v_mfma_f32_16x16x32_bf16 v[144:147], v[200:203], a[8:11], 0
    s_add_u32 s3, s65, 16384
    ds_read_b64_tr_b16 v[196:197], v244 offset:8192
    v_cvt_pk_bf16_f32 v59, v62, v63
    v_mfma_f32_16x16x32_bf16 v[144:147], v[204:207], a[24:27], v[144:147]
    buffer_store_dwordx4 v[32:35], v224, s[8:11], s3 offen offset:3072 sc1
    v_mfma_f32_16x16x32_bf16 v[148:151], v[200:203], a[12:15], 0
    ds_read_b64_tr_b16 v[198:199], v244 offset:9216
    v_permlane16_swap_b32 v56, v58
    v_mfma_f32_16x16x32_bf16 v[148:151], v[204:207], a[28:31], v[148:151]
    s_waitcnt lgkmcnt(4)
    v_permlane16_swap_b32 v57, v59
    v_mfma_f32_16x16x32_bf16 v[88:91], v[208:211], a[0:3], 0
    ds_read_b64_tr_b16 v[200:201], v245 offset:0
    v_mfma_f32_16x16x32_bf16 v[88:91], v[212:215], a[16:19], v[88:91]
    v_mfma_f32_16x16x32_bf16 v[92:95], v[208:211], a[4:7], 0
    ds_read_b64_tr_b16 v[202:203], v245 offset:1024
    v_mfma_f32_16x16x32_bf16 v[92:95], v[212:215], a[20:23], v[92:95]
    v_mfma_f32_16x16x32_bf16 v[152:155], v[208:211], a[8:11], 0
    s_add_u32 s3, s65, 20480
    ds_read_b64_tr_b16 v[204:205], v245 offset:8192
    v_mfma_f32_16x16x32_bf16 v[152:155], v[212:215], a[24:27], v[152:155]
    buffer_store_dwordx4 v[40:43], v224, s[8:11], s3 offen offset:3072 sc1
    v_mfma_f32_16x16x32_bf16 v[156:159], v[208:211], a[12:15], 0
    ds_read_b64_tr_b16 v[206:207], v245 offset:9216
    v_mfma_f32_16x16x32_bf16 v[156:159], v[212:215], a[28:31], v[156:159]
    s_waitcnt lgkmcnt(4)
    v_mfma_f32_16x16x32_bf16 v[96:99], v[192:195], a[0:3], 0
    ds_read_b64_tr_b16 v[208:209], v246 offset:0
    v_mfma_f32_16x16x32_bf16 v[96:99], v[196:199], a[16:19], v[96:99]
    v_mfma_f32_16x16x32_bf16 v[100:103], v[192:195], a[4:7], 0
    ds_read_b64_tr_b16 v[210:211], v246 offset:1024
    v_mfma_f32_16x16x32_bf16 v[100:103], v[196:199], a[20:23], v[100:103]
    v_mfma_f32_16x16x32_bf16 v[160:163], v[192:195], a[8:11], 0
    s_add_u32 s3, s65, 24576
    ds_read_b64_tr_b16 v[212:213], v246 offset:8192
    v_mfma_f32_16x16x32_bf16 v[160:163], v[196:199], a[24:27], v[160:163]
    buffer_store_dwordx4 v[48:51], v224, s[8:11], s3 offen offset:3072 sc1
    v_mfma_f32_16x16x32_bf16 v[164:167], v[192:195], a[12:15], 0
    ds_read_b64_tr_b16 v[214:215], v246 offset:9216
    v_mfma_f32_16x16x32_bf16 v[164:167], v[196:199], a[28:31], v[164:167]
    s_waitcnt lgkmcnt(4)
    v_mfma_f32_16x16x32_bf16 v[104:107], v[200:203], a[0:3], 0
    ds_read_b64_tr_b16 v[192:193], v247 offset:0
    v_mfma_f32_16x16x32_bf16 v[104:107], v[204:207], a[16:19], v[104:107]
    v_mfma_f32_16x16x32_bf16 v[108:111], v[200:203], a[4:7], 0
    ds_read_b64_tr_b16 v[194:195], v247 offset:1024
    v_mfma_f32_16x16x32_bf16 v[108:111], v[204:207], a[20:23], v[108:111]
    v_mfma_f32_16x16x32_bf16 v[168:171], v[200:203], a[8:11], 0
    ds_read_b64_tr_b16 v[196:197], v247 offset:8192
    v_mfma_f32_16x16x32_bf16 v[168:171], v[204:207], a[24:27], v[168:171]
    s_barrier
    v_mfma_f32_16x16x32_bf16 v[172:175], v[200:203], a[12:15], 0
    ds_read_b64_tr_b16 v[198:199], v247 offset:9216
    v_mfma_f32_16x16x32_bf16 v[172:175], v[204:207], a[28:31], v[172:175]
    s_waitcnt lgkmcnt(4)
    v_mfma_f32_16x16x32_bf16 v[112:115], v[208:211], a[0:3], 0
    s_add_u32 s3, s65, 28672
    ds_read_b64_tr_b16 v[200:201], v240 offset:16384
    v_mfma_f32_16x16x32_bf16 v[112:115], v[212:215], a[16:19], v[112:115]
    buffer_store_dwordx4 v[56:59], v224, s[8:11], s3 offen offset:3072 sc1
    v_mfma_f32_16x16x32_bf16 v[116:119], v[208:211], a[4:7], 0
    ds_read_b64_tr_b16 v[202:203], v240 offset:17408
    v_mfma_f32_16x16x32_bf16 v[116:119], v[212:215], a[20:23], v[116:119]
    v_mfma_f32_16x16x32_bf16 v[176:179], v[208:211], a[8:11], 0
    ds_read_b64_tr_b16 v[204:205], v240 offset:24576
    v_mfma_f32_16x16x32_bf16 v[176:179], v[212:215], a[24:27], v[176:179]
    v_mfma_f32_16x16x32_bf16 v[180:183], v[208:211], a[12:15], 0
    ds_read_b64_tr_b16 v[206:207], v240 offset:25600
    v_mfma_f32_16x16x32_bf16 v[180:183], v[212:215], a[28:31], v[180:183]
    s_waitcnt lgkmcnt(4)
    v_add_u32 v240, 0xffff0000, v240
    v_mfma_f32_16x16x32_bf16 v[120:123], v[192:195], a[0:3], 0
    ds_read_b64_tr_b16 v[208:209], v241 offset:16384
    v_mfma_f32_16x16x32_bf16 v[120:123], v[196:199], a[16:19], v[120:123]
    buffer_load_dwordx4 a[112:115], v224, s[8:11], s68 offen offset:2048 sc1
    v_mfma_f32_16x16x32_bf16 v[124:127], v[192:195], a[4:7], 0
    ds_read_b64_tr_b16 v[210:211], v241 offset:17408
    v_mfma_f32_16x16x32_bf16 v[124:127], v[196:199], a[20:23], v[124:127]
    v_mfma_f32_16x16x32_bf16 v[184:187], v[192:195], a[8:11], 0
    ds_read_b64_tr_b16 v[212:213], v241 offset:24576
    v_mfma_f32_16x16x32_bf16 v[184:187], v[196:199], a[24:27], v[184:187]
    buffer_load_dwordx4 a[116:119], v224, s[8:11], s68 offen offset:3072 sc1
    v_mfma_f32_16x16x32_bf16 v[188:191], v[192:195], a[12:15], 0
    s_add_u32 s68, s68, 4096
    ds_read_b64_tr_b16 v[214:215], v241 offset:25600
    v_mfma_f32_16x16x32_bf16 v[188:191], v[196:199], a[28:31], v[188:191]
    s_waitcnt vmcnt(28) lgkmcnt(4)
    v_add_u32 v241, 0xffff0000, v241
    v_mfma_f32_16x16x32_bf16 v[64:67], v[200:203], a[32:35], v[64:67]
    ds_read_b64_tr_b16 v[192:193], v242 offset:16384
    v_mfma_f32_16x16x32_bf16 v[64:67], v[204:207], a[48:51], v[64:67]
    buffer_load_dwordx4 a[104:107], v224, s[8:11], s69 offen offset:0 sc1
    v_mfma_f32_16x16x32_bf16 v[68:71], v[200:203], a[36:39], v[68:71]
    ds_read_b64_tr_b16 v[194:195], v242 offset:17408
    v_mfma_f32_16x16x32_bf16 v[68:71], v[204:207], a[52:55], v[68:71]
    v_mfma_f32_16x16x32_bf16 v[128:131], v[200:203], a[40:43], v[128:131]
    ds_read_b64_tr_b16 v[196:197], v242 offset:24576
    v_mfma_f32_16x16x32_bf16 v[128:131], v[204:207], a[56:59], v[128:131]
    v_mfma_f32_16x16x32_bf16 v[132:135], v[200:203], a[44:47], v[132:135]
    ds_read_b64_tr_b16 v[198:199], v242 offset:25600
    v_mfma_f32_16x16x32_bf16 v[132:135], v[204:207], a[60:63], v[132:135]
    s_waitcnt lgkmcnt(4)
    v_add_u32 v242, 0xffff0000, v242
    v_mfma_f32_16x16x32_bf16 v[72:75], v[208:211], a[32:35], v[72:75]
    ds_read_b64_tr_b16 v[200:201], v243 offset:16384
    v_mfma_f32_16x16x32_bf16 v[72:75], v[212:215], a[48:51], v[72:75]
    buffer_load_dwordx4 a[108:111], v224, s[8:11], s69 offen offset:1024 sc1
    v_mfma_f32_16x16x32_bf16 v[76:79], v[208:211], a[36:39], v[76:79]
    ds_read_b64_tr_b16 v[202:203], v243 offset:17408
    v_mfma_f32_16x16x32_bf16 v[76:79], v[212:215], a[52:55], v[76:79]
    v_mfma_f32_16x16x32_bf16 v[136:139], v[208:211], a[40:43], v[136:139]
    ds_read_b64_tr_b16 v[204:205], v243 offset:24576
    v_mfma_f32_16x16x32_bf16 v[136:139], v[212:215], a[56:59], v[136:139]
    buffer_load_dwordx4 a[120:123], v224, s[8:11], s69 offen offset:2048 sc1
    v_mfma_f32_16x16x32_bf16 v[140:143], v[208:211], a[44:47], v[140:143]
    ds_read_b64_tr_b16 v[206:207], v243 offset:25600
    v_mfma_f32_16x16x32_bf16 v[140:143], v[212:215], a[60:63], v[140:143]
    s_waitcnt lgkmcnt(4)
    v_add_u32 v243, 0xffff0000, v243
    v_mfma_f32_16x16x32_bf16 v[80:83], v[192:195], a[32:35], v[80:83]
    ds_read_b64_tr_b16 v[208:209], v244 offset:16384
    v_mfma_f32_16x16x32_bf16 v[80:83], v[196:199], a[48:51], v[80:83]
    v_mfma_f32_16x16x32_bf16 v[84:87], v[192:195], a[36:39], v[84:87]
    ds_read_b64_tr_b16 v[210:211], v244 offset:17408
    v_mfma_f32_16x16x32_bf16 v[84:87], v[196:199], a[52:55], v[84:87]
    v_mfma_f32_16x16x32_bf16 v[144:147], v[192:195], a[40:43], v[144:147]
    ds_read_b64_tr_b16 v[212:213], v244 offset:24576
    v_mfma_f32_16x16x32_bf16 v[144:147], v[196:199], a[56:59], v[144:147]
    buffer_load_dwordx4 a[124:127], v224, s[8:11], s69 offen offset:3072 sc1
    v_mfma_f32_16x16x32_bf16 v[148:151], v[192:195], a[44:47], v[148:151]
    s_add_u32 s69, s69, 4096
    ds_read_b64_tr_b16 v[214:215], v244 offset:25600
    v_mfma_f32_16x16x32_bf16 v[148:151], v[196:199], a[60:63], v[148:151]
    s_waitcnt lgkmcnt(4)
    v_add_u32 v244, 0xffff0000, v244
    v_mfma_f32_16x16x32_bf16 v[88:91], v[200:203], a[32:35], v[88:91]
    s_add_u32 m0, s67, 16384
    s_add_u32 s63, s61, 1572864
    ds_read_b64_tr_b16 v[192:193], v245 offset:16384
    v_mfma_f32_16x16x32_bf16 v[88:91], v[204:207], a[48:51], v[88:91]
    buffer_load_dwordx4 v226, s[28:31], s63 offen offset:0 nt lds
    v_mfma_f32_16x16x32_bf16 v[92:95], v[200:203], a[36:39], v[92:95]
    ds_read_b64_tr_b16 v[194:195], v245 offset:17408
    v_mfma_f32_16x16x32_bf16 v[92:95], v[204:207], a[52:55], v[92:95]
    v_mfma_f32_16x16x32_bf16 v[152:155], v[200:203], a[40:43], v[152:155]
    ds_read_b64_tr_b16 v[196:197], v245 offset:24576
    v_mfma_f32_16x16x32_bf16 v[152:155], v[204:207], a[56:59], v[152:155]
    buffer_load_dwordx4 v227, s[28:31], s63 offen offset:1024 nt lds
    v_mfma_f32_16x16x32_bf16 v[156:159], v[200:203], a[44:47], v[156:159]
    ds_read_b64_tr_b16 v[198:199], v245 offset:25600
    v_mfma_f32_16x16x32_bf16 v[156:159], v[204:207], a[60:63], v[156:159]
    s_waitcnt lgkmcnt(4)
    v_add_u32 v245, 0xffff0000, v245
    v_mfma_f32_16x16x32_bf16 v[96:99], v[208:211], a[32:35], v[96:99]
    ds_read_b64_tr_b16 v[200:201], v246 offset:16384
    v_mfma_f32_16x16x32_bf16 v[96:99], v[212:215], a[48:51], v[96:99]
    buffer_load_dwordx4 v238, s[28:31], s63 offen offset:2048 nt lds
    v_mfma_f32_16x16x32_bf16 v[100:103], v[208:211], a[36:39], v[100:103]
    ds_read_b64_tr_b16 v[202:203], v246 offset:17408
    v_mfma_f32_16x16x32_bf16 v[100:103], v[212:215], a[52:55], v[100:103]
    v_mfma_f32_16x16x32_bf16 v[160:163], v[208:211], a[40:43], v[160:163]
    ds_read_b64_tr_b16 v[204:205], v246 offset:24576
    v_mfma_f32_16x16x32_bf16 v[160:163], v[212:215], a[56:59], v[160:163]
    buffer_load_dwordx4 v239, s[28:31], s63 offen offset:3072 nt lds
    v_mfma_f32_16x16x32_bf16 v[164:167], v[208:211], a[44:47], v[164:167]
    ds_read_b64_tr_b16 v[206:207], v246 offset:25600
    v_mfma_f32_16x16x32_bf16 v[164:167], v[212:215], a[60:63], v[164:167]
    s_waitcnt lgkmcnt(4)
    v_add_u32 v246, 0xffff0000, v246
    v_mfma_f32_16x16x32_bf16 v[104:107], v[192:195], a[32:35], v[104:107]
    ds_read_b64_tr_b16 v[208:209], v247 offset:16384
    v_mfma_f32_16x16x32_bf16 v[104:107], v[196:199], a[48:51], v[104:107]
    buffer_load_dwordx4 a[128:131], v224, s[8:11], s68 offen offset:0 sc1
    v_mfma_f32_16x16x32_bf16 v[108:111], v[192:195], a[36:39], v[108:111]
    ds_read_b64_tr_b16 v[210:211], v247 offset:17408
    v_mfma_f32_16x16x32_bf16 v[108:111], v[196:199], a[52:55], v[108:111]
    v_mfma_f32_16x16x32_bf16 v[168:171], v[192:195], a[40:43], v[168:171]
    ds_read_b64_tr_b16 v[212:213], v247 offset:24576
    v_mfma_f32_16x16x32_bf16 v[168:171], v[196:199], a[56:59], v[168:171]
    s_waitcnt vmcnt(21)
    s_barrier
    v_mfma_f32_16x16x32_bf16 v[172:175], v[192:195], a[44:47], v[172:175]
    ds_read_b64_tr_b16 v[214:215], v247 offset:25600
    v_mfma_f32_16x16x32_bf16 v[172:175], v[196:199], a[60:63], v[172:175]
    s_waitcnt lgkmcnt(4)
    v_add_u32 v247, 0xffff0000, v247
    v_mfma_f32_16x16x32_bf16 v[112:115], v[200:203], a[32:35], v[112:115]
    ds_read_b64_tr_b16 v[192:193], v240 offset:0
    v_mfma_f32_16x16x32_bf16 v[112:115], v[204:207], a[48:51], v[112:115]
    buffer_load_dwordx4 a[132:135], v224, s[8:11], s68 offen offset:1024 sc1
    v_mfma_f32_16x16x32_bf16 v[116:119], v[200:203], a[36:39], v[116:119]
    ds_read_b64_tr_b16 v[194:195], v240 offset:1024
    v_mfma_f32_16x16x32_bf16 v[116:119], v[204:207], a[52:55], v[116:119]
    v_mfma_f32_16x16x32_bf16 v[176:179], v[200:203], a[40:43], v[176:179]
    ds_read_b64_tr_b16 v[196:197], v240 offset:8192
    v_mfma_f32_16x16x32_bf16 v[176:179], v[204:207], a[56:59], v[176:179]
    buffer_load_dwordx4 a[144:147], v224, s[8:11], s68 offen offset:2048 sc1
    v_mfma_f32_16x16x32_bf16 v[180:183], v[200:203], a[44:47], v[180:183]
    ds_read_b64_tr_b16 v[198:199], v240 offset:9216
    v_mfma_f32_16x16x32_bf16 v[180:183], v[204:207], a[60:63], v[180:183]
    s_waitcnt lgkmcnt(4)
    v_mfma_f32_16x16x32_bf16 v[120:123], v[208:211], a[32:35], v[120:123]
    ds_read_b64_tr_b16 v[200:201], v241 offset:0
    v_mfma_f32_16x16x32_bf16 v[120:123], v[212:215], a[48:51], v[120:123]
    v_mfma_f32_16x16x32_bf16 v[124:127], v[208:211], a[36:39], v[124:127]
    ds_read_b64_tr_b16 v[202:203], v241 offset:1024
    v_mfma_f32_16x16x32_bf16 v[124:127], v[212:215], a[52:55], v[124:127]
    v_mfma_f32_16x16x32_bf16 v[184:187], v[208:211], a[40:43], v[184:187]
    ds_read_b64_tr_b16 v[204:205], v241 offset:8192
    v_mfma_f32_16x16x32_bf16 v[184:187], v[212:215], a[56:59], v[184:187]
    buffer_load_dwordx4 a[148:151], v224, s[8:11], s68 offen offset:3072 sc1
    v_mfma_f32_16x16x32_bf16 v[188:191], v[208:211], a[44:47], v[188:191]
    s_add_u32 s68, s68, 4096
    ds_read_b64_tr_b16 v[206:207], v241 offset:9216
    v_mfma_f32_16x16x32_bf16 v[188:191], v[212:215], a[60:63], v[188:191]
    s_waitcnt lgkmcnt(4)
    v_mfma_f32_16x16x32_bf16 v[64:67], v[192:195], a[64:67], v[64:67]
    ds_read_b64_tr_b16 v[208:209], v242 offset:0
    v_mfma_f32_16x16x32_bf16 v[64:67], v[196:199], a[80:83], v[64:67]
    buffer_load_dwordx4 a[136:139], v224, s[8:11], s69 offen offset:0 sc1
    v_mfma_f32_16x16x32_bf16 v[68:71], v[192:195], a[68:71], v[68:71]
    ds_read_b64_tr_b16 v[210:211], v242 offset:1024
    v_mfma_f32_16x16x32_bf16 v[68:71], v[196:199], a[84:87], v[68:71]
    v_mfma_f32_16x16x32_bf16 v[128:131], v[192:195], a[72:75], v[128:131]
    s_mov_b32 s88, s42
    s_and_b32 s89, s43, 0xffff
    ds_read_b64_tr_b16 v[212:213], v242 offset:8192
    v_mfma_f32_16x16x32_bf16 v[128:131], v[196:199], a[88:91], v[128:131]
    buffer_load_dwordx4 a[140:143], v224, s[8:11], s69 offen offset:1024 sc1
    v_mfma_f32_16x16x32_bf16 v[132:135], v[192:195], a[76:79], v[132:135]
    s_mov_b32 s90, 0x400000
    s_mov_b32 s91, 0x20000
    ds_read_b64_tr_b16 v[214:215], v242 offset:9216
    v_mfma_f32_16x16x32_bf16 v[132:135], v[196:199], a[92:95], v[132:135]
    s_waitcnt lgkmcnt(4)
    s_mov_b32 s56, s44
    s_and_b32 s57, s45, 0xffff
    v_mfma_f32_16x16x32_bf16 v[72:75], v[200:203], a[64:67], v[72:75]
    s_mov_b32 s82, s46
    s_and_b32 s83, s47, 0xffff
    ds_read_b64_tr_b16 v[192:193], v243 offset:0
    v_mfma_f32_16x16x32_bf16 v[72:75], v[204:207], a[80:83], v[72:75]
    s_and_b32 s53, s53, 0xffff
    s_lshl_b32 s97, s71, 13
    s_add_u32 s97, s97, 131072
    v_mfma_f32_16x16x32_bf16 v[76:79], v[200:203], a[68:71], v[76:79]
    s_lshl_b32 s96, s2, 2
    s_add_u32 s96, s96, 0x4e02800
    ds_read_b64_tr_b16 v[194:195], v243 offset:1024
    v_mfma_f32_16x16x32_bf16 v[76:79], v[204:207], a[84:87], v[76:79]
    s_lshl_b32 s87, s2, 14
    s_lshl_b32 s100, s71, 8
    s_add_u32 s87, s87, s100
    v_mfma_f32_16x16x32_bf16 v[136:139], v[200:203], a[72:75], v[136:139]
    s_mul_i32 s85, s71, 1088
    s_add_u32 s85, s85, s2
    ds_read_b64_tr_b16 v[196:197], v243 offset:8192
    v_mfma_f32_16x16x32_bf16 v[136:139], v[204:207], a[88:91], v[136:139]
    buffer_load_dwordx4 a[152:155], v224, s[8:11], s69 offen offset:2048 sc1
    v_mfma_f32_16x16x32_bf16 v[140:143], v[200:203], a[76:79], v[140:143]
    s_lshl_b32 s85, s85, 10
    s_add_u32 s85, s85, 0x3600000
    ds_read_b64_tr_b16 v[198:199], v243 offset:9216
    v_mfma_f32_16x16x32_bf16 v[140:143], v[204:207], a[92:95], v[140:143]
    s_waitcnt lgkmcnt(4)
    s_mul_i32 s86, s71, 452
    s_add_u32 s86, s86, s2
    v_mfma_f32_16x16x32_bf16 v[80:83], v[208:211], a[64:67], v[80:83]
    s_lshl_b32 s86, s86, 10
    s_add_u32 s86, s86, 0x4adc000
    ds_read_b64_tr_b16 v[200:201], v244 offset:0
    v_mfma_f32_16x16x32_bf16 v[80:83], v[212:215], a[80:83], v[80:83]
    buffer_load_dwordx4 a[156:159], v224, s[8:11], s69 offen offset:3072 sc1
    v_mfma_f32_16x16x32_bf16 v[84:87], v[208:211], a[68:71], v[84:87]
    s_add_u32 s69, s69, 4096
    ds_read_b64_tr_b16 v[202:203], v244 offset:1024
    v_mfma_f32_16x16x32_bf16 v[84:87], v[212:215], a[84:87], v[84:87]
    s_cmp_ge_u32 s2, 144
    s_cselect_b32 s86, s86, 0x7f000000
    s_and_b32 s100, s2, 7
    v_mfma_f32_16x16x32_bf16 v[144:147], v[208:211], a[72:75], v[144:147]
    s_lshr_b32 s101, s2, 3
    s_min_u32 s4, s74, 1
    ds_read_b64_tr_b16 v[204:205], v244 offset:8192
    v_mfma_f32_16x16x32_bf16 v[144:147], v[212:215], a[88:91], v[144:147]
    buffer_load_dwordx4 a[160:163], v224, s[8:11], s68 offen offset:0 sc1
    v_mfma_f32_16x16x32_bf16 v[148:151], v[208:211], a[76:79], v[148:151]
    s_lshl_b32 s4, s4, 2
    s_sub_u32 s101, s101, s4
    ds_read_b64_tr_b16 v[206:207], v244 offset:9216
    v_mfma_f32_16x16x32_bf16 v[148:151], v[212:215], a[92:95], v[148:151]
    s_waitcnt lgkmcnt(4)
    s_lshl_b32 s101, s101, 2
    s_add_u32 s101, s101, s71
    v_mfma_f32_16x16x32_bf16 v[88:91], v[192:195], a[64:67], v[88:91]
    s_mul_i32 s3, s101, 9363
    s_lshr_b32 s3, s3, 16
    ds_read_b64_tr_b16 v[208:209], v245 offset:0
    v_mfma_f32_16x16x32_bf16 v[88:91], v[196:199], a[80:83], v[88:91]
    s_mul_i32 s4, s3, 7
    s_sub_u32 s92, s101, s4
    s_mul_i32 s3, s3, 224
    v_mfma_f32_16x16x32_bf16 v[92:95], v[192:195], a[68:71], v[92:95]
    s_mul_i32 s4, s100, 12
    s_add_u32 s4, s4, s92
    ds_read_b64_tr_b16 v[210:211], v245 offset:1024
    v_mfma_f32_16x16x32_bf16 v[92:95], v[196:199], a[84:87], v[92:95]
    s_lshl_b32 s59, s92, 3
    s_add_u32 s59, s59, s100
    s_lshl_b32 s59, s59, 2
    v_mfma_f32_16x16x32_bf16 v[152:155], v[192:195], a[72:75], v[152:155]
    ds_read_b64_tr_b16 v[212:213], v245 offset:8192
    v_mfma_f32_16x16x32_bf16 v[152:155], v[196:199], a[88:91], v[152:155]
    buffer_load_dwordx4 a[164:167], v224, s[8:11], s68 offen offset:1024 sc1
    v_mfma_f32_16x16x32_bf16 v[156:159], v[192:195], a[76:79], v[156:159]
    ds_read_b64_tr_b16 v[214:215], v245 offset:9216
    v_mfma_f32_16x16x32_bf16 v[156:159], v[196:199], a[92:95], v[156:159]
    s_waitcnt lgkmcnt(4)
    v_mfma_f32_16x16x32_bf16 v[96:99], v[200:203], a[64:67], v[96:99]
    ds_read_b64_tr_b16 v[192:193], v246 offset:0
    v_mfma_f32_16x16x32_bf16 v[96:99], v[204:207], a[80:83], v[96:99]
    buffer_load_dwordx4 a[176:179], v224, s[8:11], s68 offen offset:2048 sc1
    v_mfma_f32_16x16x32_bf16 v[100:103], v[200:203], a[68:71], v[100:103]
    ds_read_b64_tr_b16 v[194:195], v246 offset:1024
    v_mfma_f32_16x16x32_bf16 v[100:103], v[204:207], a[84:87], v[100:103]
    s_cmp_lt_u32 s92, 3
    s_cselect_b32 s92, s4, s59
    s_cselect_b32 s93, 3, 1
    v_mfma_f32_16x16x32_bf16 v[160:163], v[200:203], a[72:75], v[160:163]
    s_add_u32 s92, s92, s3
    s_lshl_b32 s93, s93, 10
    ds_read_b64_tr_b16 v[196:197], v246 offset:8192
    v_mfma_f32_16x16x32_bf16 v[160:163], v[204:207], a[88:91], v[160:163]
    s_lshl_b32 s92, s92, 10
    s_add_u32 s92, s92, 0x3f00000
    s_lshl_b32 s94, s101, 10
    v_mfma_f32_16x16x32_bf16 v[164:167], v[200:203], a[76:79], v[164:167]
    s_lshr_b32 s3, s100, 2
    s_lshl_b32 s3, s3, 9
    ds_read_b64_tr_b16 v[198:199], v246 offset:9216
    v_mfma_f32_16x16x32_bf16 v[164:167], v[204:207], a[92:95], v[164:167]
    s_waitcnt lgkmcnt(4)
    s_and_b32 s4, s100, 3
    s_lshl_b32 s4, s4, 2
    v_mfma_f32_16x16x32_bf16 v[104:107], v[208:211], a[64:67], v[104:107]
    s_add_u32 s3, s3, s4
    s_add_u32 s94, s94, s3
    ds_read_b64_tr_b16 v[200:201], v247 offset:0
    v_mfma_f32_16x16x32_bf16 v[104:107], v[212:215], a[80:83], v[104:107]
    buffer_load_dwordx4 a[180:183], v224, s[8:11], s68 offen offset:3072 sc1
    v_mfma_f32_16x16x32_bf16 v[108:111], v[208:211], a[68:71], v[108:111]
    s_add_u32 s68, s68, 4096
    s_add_u32 s94, s94, 0x4280000
    ds_read_b64_tr_b16 v[202:203], v247 offset:1024
    v_mfma_f32_16x16x32_bf16 v[108:111], v[212:215], a[84:87], v[108:111]
    s_mul_i32 s59, s100, 229376
    s_lshl_b32 s101, s101, 5
    s_add_u32 s59, s59, s101
    v_mfma_f32_16x16x32_bf16 v[168:171], v[208:211], a[72:75], v[168:171]
    ds_read_b64_tr_b16 v[204:205], v247 offset:8192
    v_mfma_f32_16x16x32_bf16 v[168:171], v[212:215], a[88:91], v[168:171]
    s_waitcnt vmcnt(12)
    s_barrier
    v_mfma_f32_16x16x32_bf16 v[172:175], v[208:211], a[76:79], v[172:175]
    ds_read_b64_tr_b16 v[206:207], v247 offset:9216
    v_mfma_f32_16x16x32_bf16 v[172:175], v[212:215], a[92:95], v[172:175]
    s_waitcnt lgkmcnt(4)
    v_mfma_f32_16x16x32_bf16 v[112:115], v[192:195], a[64:67], v[112:115]
    ds_read_b64_tr_b16 v[208:209], v240 offset:16384
    v_mfma_f32_16x16x32_bf16 v[112:115], v[196:199], a[80:83], v[112:115]
    buffer_load_dwordx4 a[168:171], v224, s[8:11], s69 offen offset:0 sc1
    v_mfma_f32_16x16x32_bf16 v[116:119], v[192:195], a[68:71], v[116:119]
    s_bfe_u32 s49, s2, 0x10001
    s_mul_i32 s48, s49, 15
    ds_read_b64_tr_b16 v[210:211], v240 offset:17408
    v_mfma_f32_16x16x32_bf16 v[116:119], v[196:199], a[84:87], v[116:119]
    s_bfe_u32 s49, s2, 0x10002
    s_mul_i32 s49, s49, 7
    s_xor_b32 s48, s48, s49
    v_mfma_f32_16x16x32_bf16 v[176:179], v[192:195], a[72:75], v[176:179]
    s_lshr_b32 s49, s2, 7
    s_xor_b32 s48, s48, s49
    ds_read_b64_tr_b16 v[212:213], v240 offset:24576
    v_mfma_f32_16x16x32_bf16 v[176:179], v[196:199], a[88:91], v[176:179]
    buffer_store_dword v253, v255, s[8:11], s5 offen sc1
    v_mfma_f32_16x16x32_bf16 v[180:183], v[192:195], a[76:79], v[180:183]
    s_and_b32 s49, s2, 1
    s_lshl_b32 s49, s49, 1
    ds_read_b64_tr_b16 v[214:215], v240 offset:25600
    v_mfma_f32_16x16x32_bf16 v[180:183], v[196:199], a[92:95], v[180:183]
    s_waitcnt lgkmcnt(4)
    s_xor_b32 s48, s48, s49
    v_add_u32 v0, 0x18000, v240
    v_mfma_f32_16x16x32_bf16 v[120:123], v[200:203], a[64:67], v[120:123]
    s_lshl_b32 s48, s48, 2
    s_bfe_u32 s49, s2, 0x20005
    ds_read_b64_tr_b16 v[192:193], v241 offset:16384
    v_mfma_f32_16x16x32_bf16 v[120:123], v[204:207], a[80:83], v[120:123]
    buffer_load_dwordx4 a[172:175], v224, s[8:11], s69 offen offset:1024 sc1
    v_mfma_f32_16x16x32_bf16 v[124:127], v[200:203], a[68:71], v[124:127]
    s_add_u32 s48, s48, s49
    s_lshl_b32 s48, s48, 15
    ds_read_b64_tr_b16 v[194:195], v241 offset:17408
    v_mfma_f32_16x16x32_bf16 v[124:127], v[204:207], a[84:87], v[124:127]
    s_bfe_u32 s49, s2, 0x20003
    s_lshl_b32 s49, s49, 8
    s_add_u32 s48, s48, s49
    v_mfma_f32_16x16x32_bf16 v[184:187], v[200:203], a[72:75], v[184:187]
    s_lshl_b32 s49, s71, 6
    s_add_u32 s48, s48, s49
    ds_read_b64_tr_b16 v[196:197], v241 offset:24576
    v_mfma_f32_16x16x32_bf16 v[184:187], v[204:207], a[88:91], v[184:187]
    buffer_load_dwordx4 a[184:187], v224, s[8:11], s69 offen offset:2048 sc1
    v_mfma_f32_16x16x32_bf16 v[188:191], v[200:203], a[76:79], v[188:191]
    ds_read_b64_tr_b16 v[198:199], v241 offset:25600
    v_bfe_u32 v8, v224, 4, 4
    v_mfma_f32_16x16x32_bf16 v[188:191], v[204:207], a[92:95], v[188:191]
    s_waitcnt lgkmcnt(4)
    v_add_u32 v1, 0x18000, v241
    v_lshrrev_b32 v9, 8, v224
    v_mfma_f32_16x16x32_bf16 v[64:67], v[208:211], a[96:99], v[64:67]
    ds_read_b64_tr_b16 v[200:201], v242 offset:16384
    v_lshlrev_b32 v9, 4, v9
    v_mfma_f32_16x16x32_bf16 v[64:67], v[212:215], a[112:115], v[64:67]
    buffer_load_dwordx4 a[188:191], v224, s[8:11], s69 offen offset:3072 sc1
    v_mfma_f32_16x16x32_bf16 v[68:71], v[208:211], a[100:103], v[68:71]
    s_add_u32 s69, s69, 4096
    ds_read_b64_tr_b16 v[202:203], v242 offset:17408
    v_lshl_add_u32 v9, v8, 10, v9
    v_mfma_f32_16x16x32_bf16 v[68:71], v[212:215], a[116:119], v[68:71]
    s_movk_i32 s49, 0x4000
    v_add_u32 v249, s48, v9
    v_mfma_f32_16x16x32_bf16 v[128:131], v[208:211], a[104:107], v[128:131]
    ds_read_b64_tr_b16 v[204:205], v242 offset:24576
    v_mfma_f32_16x16x32_bf16 v[128:131], v[212:215], a[120:123], v[128:131]
    buffer_load_dwordx4 a[192:195], v224, s[8:11], s68 offen offset:0 sc1
    v_mfma_f32_16x16x32_bf16 v[132:135], v[208:211], a[108:111], v[132:135]
    ds_read_b64_tr_b16 v[206:207], v242 offset:25600
    v_mfma_f32_16x16x32_bf16 v[132:135], v[212:215], a[124:127], v[132:135]
    s_waitcnt lgkmcnt(4)
    v_add_u32 v2, 0x18000, v242
    v_mfma_f32_16x16x32_bf16 v[72:75], v[192:195], a[96:99], v[72:75]
    ds_read_b64_tr_b16 v[208:209], v243 offset:16384
    v_mfma_f32_16x16x32_bf16 v[72:75], v[196:199], a[112:115], v[72:75]
    buffer_load_dwordx4 a[196:199], v224, s[8:11], s68 offen offset:1024 sc1
    v_mfma_f32_16x16x32_bf16 v[76:79], v[192:195], a[100:103], v[76:79]
    ds_read_b64_tr_b16 v[210:211], v243 offset:17408
    v_mfma_f32_16x16x32_bf16 v[76:79], v[196:199], a[116:119], v[76:79]
    s_cmp_lg_u32 s74, 0
    s_cselect_b32 s59, s59, 0x7f000000
    s_cselect_b32 s92, s92, 0x7f000000
    v_mfma_f32_16x16x32_bf16 v[136:139], v[192:195], a[104:107], v[136:139]
    s_cmp_lg_u32 s74, 0
    s_cselect_b32 s94, s94, 0x7f000000
    ds_read_b64_tr_b16 v[212:213], v243 offset:24576
    v_mfma_f32_16x16x32_bf16 v[136:139], v[196:199], a[120:123], v[136:139]
    buffer_load_dwordx4 a[208:211], v224, s[8:11], s68 offen offset:2048 sc1
    v_mfma_f32_16x16x32_bf16 v[140:143], v[192:195], a[108:111], v[140:143]
    s_sub_u32 s101, s87, 2359296
    ds_read_b64_tr_b16 v[214:215], v243 offset:25600
    v_mfma_f32_16x16x32_bf16 v[140:143], v[196:199], a[124:127], v[140:143]
    s_waitcnt lgkmcnt(4)
    v_add_u32 v3, 0x18000, v243
    v_mfma_f32_16x16x32_bf16 v[80:83], v[200:203], a[96:99], v[80:83]
    s_cmp_ge_u32 s2, 144
    s_cselect_b32 s101, s101, 0x7f000000
    ds_read_b64_tr_b16 v[192:193], v244 offset:16384
    v_mfma_f32_16x16x32_bf16 v[80:83], v[204:207], a[112:115], v[80:83]
    v_lshrrev_b32 v232, 8, v224
    v_and_b32 v233, 0xf0, v224
    v_mfma_f32_16x16x32_bf16 v[84:87], v[200:203], a[100:103], v[84:87]
    ds_read_b64_tr_b16 v[194:195], v244 offset:17408
    v_lshl_add_u32 v248, v232, 10, v233
    v_mfma_f32_16x16x32_bf16 v[84:87], v[204:207], a[116:119], v[84:87]
    v_lshrrev_b32 v232, 5, v224
    v_mul_u32_u24 v232, 3584, v232
    v_mfma_f32_16x16x32_bf16 v[144:147], v[200:203], a[104:107], v[144:147]
    ds_read_b64_tr_b16 v[196:197], v244 offset:24576
    v_and_b32 v233, 16, v224
    v_mfma_f32_16x16x32_bf16 v[144:147], v[204:207], a[120:123], v[144:147]
    buffer_load_dwordx4 a[212:215], v224, s[8:11], s68 offen offset:3072 sc1
    v_mfma_f32_16x16x32_bf16 v[148:151], v[200:203], a[108:111], v[148:151]
    s_add_u32 s68, s68, 4096
    ds_read_b64_tr_b16 v[198:199], v244 offset:25600
    v_add_u32 v231, v232, v233
    v_mfma_f32_16x16x32_bf16 v[148:151], v[204:207], a[124:127], v[148:151]
    s_waitcnt lgkmcnt(4)
    v_add_u32 v4, 0x18000, v244
    v_bfe_u32 v232, v224, 6, 2
    v_mfma_f32_16x16x32_bf16 v[88:91], v[208:211], a[96:99], v[88:91]
    ds_read_b64_tr_b16 v[200:201], v245 offset:16384
    v_lshrrev_b32 v233, 9, v224
    v_mfma_f32_16x16x32_bf16 v[88:91], v[212:215], a[112:115], v[88:91]
    buffer_load_dwordx4 a[200:203], v224, s[8:11], s69 offen offset:0 sc1
    v_mfma_f32_16x16x32_bf16 v[92:95], v[208:211], a[100:103], v[92:95]
    ds_read_b64_tr_b16 v[202:203], v245 offset:17408
    v_lshl_add_u32 v250, v233, 2, v232
    v_mfma_f32_16x16x32_bf16 v[92:95], v[212:215], a[116:119], v[92:95]
    v_lshlrev_b32 v250, 8, v250
    v_lshl_add_u32 v251, v233, 2, v232
    v_mfma_f32_16x16x32_bf16 v[152:155], v[208:211], a[104:107], v[152:155]
    ds_read_b64_tr_b16 v[204:205], v245 offset:24576
    v_lshlrev_b32 v251, 5, v251
    v_mfma_f32_16x16x32_bf16 v[152:155], v[212:215], a[120:123], v[152:155]
    v_bfe_u32 v232, v224, 8, 1
    v_lshl_add_u32 v250, v232, 5, v250
    v_mfma_f32_16x16x32_bf16 v[156:159], v[208:211], a[108:111], v[156:159]
    ds_read_b64_tr_b16 v[206:207], v245 offset:25600
    v_lshl_add_u32 v251, v232, 11, v251
    v_mfma_f32_16x16x32_bf16 v[156:159], v[212:215], a[124:127], v[156:159]
    s_waitcnt lgkmcnt(4)
    v_add_u32 v5, 0x18000, v245
    v_bfe_u32 v232, v224, 4, 2
    v_mfma_f32_16x16x32_bf16 v[96:99], v[192:195], a[96:99], v[96:99]
    ds_read_b64_tr_b16 v[208:209], v246 offset:16384
    v_lshl_add_u32 v250, v232, 3, v250
    v_mfma_f32_16x16x32_bf16 v[96:99], v[196:199], a[112:115], v[96:99]
    buffer_load_dwordx4 a[204:207], v224, s[8:11], s69 offen offset:1024 sc1
    v_mfma_f32_16x16x32_bf16 v[100:103], v[192:195], a[100:103], v[100:103]
    ds_read_b64_tr_b16 v[210:211], v246 offset:17408
    v_lshl_add_u32 v251, v232, 3, v251
    v_mfma_f32_16x16x32_bf16 v[100:103], v[196:199], a[116:119], v[100:103]
    v_add_u32 v250, s97, v250
    v_add_u32 v251, s97, v251
    v_mfma_f32_16x16x32_bf16 v[160:163], v[192:195], a[104:107], v[160:163]
    ds_read_b64_tr_b16 v[212:213], v246 offset:24576
    v_mfma_f32_16x16x32_bf16 v[160:163], v[196:199], a[120:123], v[160:163]
    buffer_load_dwordx4 a[216:219], v224, s[8:11], s69 offen offset:2048 sc1
    v_mfma_f32_16x16x32_bf16 v[164:167], v[192:195], a[108:111], v[164:167]
    ds_read_b64_tr_b16 v[214:215], v246 offset:25600
    v_mfma_f32_16x16x32_bf16 v[164:167], v[196:199], a[124:127], v[164:167]
    s_waitcnt lgkmcnt(4)
    v_add_u32 v6, 0x18000, v246
    v_mfma_f32_16x16x32_bf16 v[104:107], v[200:203], a[96:99], v[104:107]
    ds_read_b64_tr_b16 v[192:193], v247 offset:16384
    v_mfma_f32_16x16x32_bf16 v[104:107], v[204:207], a[112:115], v[104:107]
    buffer_load_dwordx4 a[220:223], v224, s[8:11], s69 offen offset:3072 sc1
    v_mfma_f32_16x16x32_bf16 v[108:111], v[200:203], a[100:103], v[108:111]
    s_add_u32 s69, s69, 4096
    ds_read_b64_tr_b16 v[194:195], v247 offset:17408
    v_mfma_f32_16x16x32_bf16 v[108:111], v[204:207], a[116:119], v[108:111]
    v_mfma_f32_16x16x32_bf16 v[168:171], v[200:203], a[104:107], v[168:171]
    ds_read_b64_tr_b16 v[196:197], v247 offset:24576
    v_mfma_f32_16x16x32_bf16 v[168:171], v[204:207], a[120:123], v[168:171]
    s_barrier
    v_mfma_f32_16x16x32_bf16 v[172:175], v[200:203], a[108:111], v[172:175]
    ds_read_b64_tr_b16 v[198:199], v247 offset:25600
    v_mfma_f32_16x16x32_bf16 v[172:175], v[204:207], a[124:127], v[172:175]
    s_waitcnt lgkmcnt(4)
    v_add_u32 v7, 0x18000, v247
    v_mfma_f32_16x16x32_bf16 v[112:115], v[208:211], a[96:99], v[112:115]
    ds_read_b64_tr_b16 v[200:201], v0 offset:32768
    v_mfma_f32_16x16x32_bf16 v[112:115], v[212:215], a[112:115], v[112:115]
    buffer_load_dwordx4 a[224:227], v224, s[8:11], s68 offen offset:0 sc1
    v_mfma_f32_16x16x32_bf16 v[116:119], v[208:211], a[100:103], v[116:119]
    ds_read_b64_tr_b16 v[202:203], v0 offset:33792
    v_mfma_f32_16x16x32_bf16 v[116:119], v[212:215], a[116:119], v[116:119]
    v_mfma_f32_16x16x32_bf16 v[176:179], v[208:211], a[104:107], v[176:179]
    ds_read_b64_tr_b16 v[204:205], v0 offset:40960
    v_mfma_f32_16x16x32_bf16 v[176:179], v[212:215], a[120:123], v[176:179]
    buffer_load_dwordx4 a[228:231], v224, s[8:11], s68 offen offset:1024 sc1
    v_mfma_f32_16x16x32_bf16 v[180:183], v[208:211], a[108:111], v[180:183]
    ds_read_b64_tr_b16 v[206:207], v0 offset:41984
    v_mfma_f32_16x16x32_bf16 v[180:183], v[212:215], a[124:127], v[180:183]
    s_waitcnt lgkmcnt(4)
    v_mfma_f32_16x16x32_bf16 v[120:123], v[192:195], a[96:99], v[120:123]
    ds_read_b64_tr_b16 v[208:209], v1 offset:32768
    v_mfma_f32_16x16x32_bf16 v[120:123], v[196:199], a[112:115], v[120:123]
    buffer_load_dwordx4 a[240:243], v224, s[8:11], s68 offen offset:2048 sc1
    v_mfma_f32_16x16x32_bf16 v[124:127], v[192:195], a[100:103], v[124:127]
    ds_read_b64_tr_b16 v[210:211], v1 offset:33792
    v_mfma_f32_16x16x32_bf16 v[124:127], v[196:199], a[116:119], v[124:127]
    v_mfma_f32_16x16x32_bf16 v[184:187], v[192:195], a[104:107], v[184:187]
    ds_read_b64_tr_b16 v[212:213], v1 offset:40960
    v_mfma_f32_16x16x32_bf16 v[184:187], v[196:199], a[120:123], v[184:187]
    v_mfma_f32_16x16x32_bf16 v[188:191], v[192:195], a[108:111], v[188:191]
    ds_read_b64_tr_b16 v[214:215], v1 offset:41984
    v_mfma_f32_16x16x32_bf16 v[188:191], v[196:199], a[124:127], v[188:191]
    s_waitcnt vmcnt(20) lgkmcnt(4)
    v_mfma_f32_16x16x32_bf16 v[64:67], v[200:203], a[128:131], v[64:67]
    ds_read_b64_tr_b16 v[192:193], v2 offset:32768
    v_mfma_f32_16x16x32_bf16 v[64:67], v[204:207], a[144:147], v[64:67]
    buffer_load_dwordx4 a[244:247], v224, s[8:11], s68 offen offset:3072 sc1
    v_mfma_f32_16x16x32_bf16 v[68:71], v[200:203], a[132:135], v[68:71]
    s_add_u32 s68, s68, 4096
    ds_read_b64_tr_b16 v[194:195], v2 offset:33792
    v_mfma_f32_16x16x32_bf16 v[68:71], v[204:207], a[148:151], v[68:71]
    v_mfma_f32_16x16x32_bf16 v[128:131], v[200:203], a[136:139], v[128:131]
    ds_read_b64_tr_b16 v[196:197], v2 offset:40960
    v_mfma_f32_16x16x32_bf16 v[128:131], v[204:207], a[152:155], v[128:131]
    buffer_load_dwordx4 a[232:235], v224, s[8:11], s69 offen offset:0 sc1
    v_mfma_f32_16x16x32_bf16 v[132:135], v[200:203], a[140:143], v[132:135]
    ds_read_b64_tr_b16 v[198:199], v2 offset:41984
    v_mfma_f32_16x16x32_bf16 v[132:135], v[204:207], a[156:159], v[132:135]
    s_waitcnt lgkmcnt(4)
    v_mfma_f32_16x16x32_bf16 v[72:75], v[208:211], a[128:131], v[72:75]
    ds_read_b64_tr_b16 v[200:201], v3 offset:32768
    v_mfma_f32_16x16x32_bf16 v[72:75], v[212:215], a[144:147], v[72:75]
    v_mfma_f32_16x16x32_bf16 v[76:79], v[208:211], a[132:135], v[76:79]
    ds_read_b64_tr_b16 v[202:203], v3 offset:33792
    v_mfma_f32_16x16x32_bf16 v[76:79], v[212:215], a[148:151], v[76:79]
    v_mfma_f32_16x16x32_bf16 v[136:139], v[208:211], a[136:139], v[136:139]
    ds_read_b64_tr_b16 v[204:205], v3 offset:40960
    v_mfma_f32_16x16x32_bf16 v[136:139], v[212:215], a[152:155], v[136:139]
    buffer_load_dwordx4 a[236:239], v224, s[8:11], s69 offen offset:1024 sc1
    v_mfma_f32_16x16x32_bf16 v[140:143], v[208:211], a[140:143], v[140:143]
    ds_read_b64_tr_b16 v[206:207], v3 offset:41984
    v_mfma_f32_16x16x32_bf16 v[140:143], v[212:215], a[156:159], v[140:143]
    s_waitcnt lgkmcnt(4)
    v_mfma_f32_16x16x32_bf16 v[80:83], v[192:195], a[128:131], v[80:83]
    ds_read_b64_tr_b16 v[208:209], v4 offset:32768
    v_mfma_f32_16x16x32_bf16 v[80:83], v[196:199], a[144:147], v[80:83]
    buffer_load_dwordx4 a[248:251], v224, s[8:11], s69 offen offset:2048 sc1
    v_mfma_f32_16x16x32_bf16 v[84:87], v[192:195], a[132:135], v[84:87]
    ds_read_b64_tr_b16 v[210:211], v4 offset:33792
    v_mfma_f32_16x16x32_bf16 v[84:87], v[196:199], a[148:151], v[84:87]
    v_mfma_f32_16x16x32_bf16 v[144:147], v[192:195], a[136:139], v[144:147]
    ds_read_b64_tr_b16 v[212:213], v4 offset:40960
    v_mfma_f32_16x16x32_bf16 v[144:147], v[196:199], a[152:155], v[144:147]
    buffer_load_dwordx4 a[252:255], v224, s[8:11], s69 offen offset:3072 sc1
    v_mfma_f32_16x16x32_bf16 v[148:151], v[192:195], a[140:143], v[148:151]
    s_add_u32 s69, s69, 4096
    ds_read_b64_tr_b16 v[214:215], v4 offset:41984
    v_mfma_f32_16x16x32_bf16 v[148:151], v[196:199], a[156:159], v[148:151]
    s_waitcnt lgkmcnt(4)
    v_mfma_f32_16x16x32_bf16 v[88:91], v[200:203], a[128:131], v[88:91]
    ds_read_b64_tr_b16 v[192:193], v5 offset:32768
    v_mfma_f32_16x16x32_bf16 v[88:91], v[204:207], a[144:147], v[88:91]
    v_mfma_f32_16x16x32_bf16 v[92:95], v[200:203], a[132:135], v[92:95]
    ds_read_b64_tr_b16 v[194:195], v5 offset:33792
    v_mfma_f32_16x16x32_bf16 v[92:95], v[204:207], a[148:151], v[92:95]
    v_mfma_f32_16x16x32_bf16 v[152:155], v[200:203], a[136:139], v[152:155]
    ds_read_b64_tr_b16 v[196:197], v5 offset:40960
    v_mfma_f32_16x16x32_bf16 v[152:155], v[204:207], a[152:155], v[152:155]
    v_mfma_f32_16x16x32_bf16 v[156:159], v[200:203], a[140:143], v[156:159]
    ds_read_b64_tr_b16 v[198:199], v5 offset:41984
    v_mfma_f32_16x16x32_bf16 v[156:159], v[204:207], a[156:159], v[156:159]
    s_waitcnt lgkmcnt(4)
    v_mfma_f32_16x16x32_bf16 v[96:99], v[208:211], a[128:131], v[96:99]
    ds_read_b64_tr_b16 v[200:201], v6 offset:32768
    v_mfma_f32_16x16x32_bf16 v[96:99], v[212:215], a[144:147], v[96:99]
    v_mfma_f32_16x16x32_bf16 v[100:103], v[208:211], a[132:135], v[100:103]
    ds_read_b64_tr_b16 v[202:203], v6 offset:33792
    v_mfma_f32_16x16x32_bf16 v[100:103], v[212:215], a[148:151], v[100:103]
    v_mfma_f32_16x16x32_bf16 v[160:163], v[208:211], a[136:139], v[160:163]
    ds_read_b64_tr_b16 v[204:205], v6 offset:40960
    v_mfma_f32_16x16x32_bf16 v[160:163], v[212:215], a[152:155], v[160:163]
    v_mfma_f32_16x16x32_bf16 v[164:167], v[208:211], a[140:143], v[164:167]
    ds_read_b64_tr_b16 v[206:207], v6 offset:41984
    v_mfma_f32_16x16x32_bf16 v[164:167], v[212:215], a[156:159], v[164:167]
    s_waitcnt lgkmcnt(4)
    v_mfma_f32_16x16x32_bf16 v[104:107], v[192:195], a[128:131], v[104:107]
    ds_read_b64_tr_b16 v[208:209], v7 offset:32768
    v_mfma_f32_16x16x32_bf16 v[104:107], v[196:199], a[144:147], v[104:107]
    buffer_load_dword v218, v220, s[8:11], s6 offen sc1
    v_mfma_f32_16x16x32_bf16 v[108:111], v[192:195], a[132:135], v[108:111]
    ds_read_b64_tr_b16 v[210:211], v7 offset:33792
    v_mfma_f32_16x16x32_bf16 v[108:111], v[196:199], a[148:151], v[108:111]
    v_mfma_f32_16x16x32_bf16 v[168:171], v[192:195], a[136:139], v[168:171]
    ds_read_b64_tr_b16 v[212:213], v7 offset:40960
    v_mfma_f32_16x16x32_bf16 v[168:171], v[196:199], a[152:155], v[168:171]
    s_barrier
    v_mfma_f32_16x16x32_bf16 v[172:175], v[192:195], a[140:143], v[172:175]
    ds_read_b64_tr_b16 v[214:215], v7 offset:41984
    v_mfma_f32_16x16x32_bf16 v[172:175], v[196:199], a[156:159], v[172:175]
    s_waitcnt lgkmcnt(4)
    v_mfma_f32_16x16x32_bf16 v[112:115], v[200:203], a[128:131], v[112:115]
    ds_read_b64_tr_b16 v[192:193], v0 offset:49152
    v_mfma_f32_16x16x32_bf16 v[112:115], v[204:207], a[144:147], v[112:115]
    buffer_load_dwordx4 v[240:243], v249, s[32:35], 0 offen
    v_mfma_f32_16x16x32_bf16 v[116:119], v[200:203], a[132:135], v[116:119]
    ds_read_b64_tr_b16 v[194:195], v0 offset:50176
    v_cmp_gt_i32 s[16:17], 0, v222
    v_mfma_f32_16x16x32_bf16 v[116:119], v[204:207], a[148:151], v[116:119]
    v_cmp_gt_i32 s[18:19], 1, v222
    v_cmp_gt_i32 s[20:21], 2, v222
    v_mfma_f32_16x16x32_bf16 v[176:179], v[200:203], a[136:139], v[176:179]
    ds_read_b64_tr_b16 v[196:197], v0 offset:57344
    v_cmp_gt_i32 s[22:23], 3, v222
    v_mfma_f32_16x16x32_bf16 v[176:179], v[204:207], a[152:155], v[176:179]
    buffer_load_dwordx4 v[244:247], v249, s[32:35], s49 offen
    v_mfma_f32_16x16x32_bf16 v[180:183], v[200:203], a[140:143], v[180:183]
    ds_read_b64_tr_b16 v[198:199], v0 offset:58368
    v_cmp_gt_i32 s[24:25], 4, v222
    v_mfma_f32_16x16x32_bf16 v[180:183], v[204:207], a[156:159], v[180:183]
    s_waitcnt lgkmcnt(4)
    v_cmp_gt_i32 s[26:27], 5, v222
    v_cmp_gt_i32 s[28:29], 6, v222
    v_mfma_f32_16x16x32_bf16 v[120:123], v[208:211], a[128:131], v[120:123]
    ds_read_b64_tr_b16 v[200:201], v1 offset:49152
    v_cmp_gt_i32 s[30:31], 7, v222
    v_mfma_f32_16x16x32_bf16 v[120:123], v[212:215], a[144:147], v[120:123]
    v_cmp_gt_i32 s[36:37], 18, v222
    v_cmp_gt_i32 s[38:39], 19, v222
    v_mfma_f32_16x16x32_bf16 v[124:127], v[208:211], a[132:135], v[124:127]
    ds_read_b64_tr_b16 v[202:203], v1 offset:50176
    v_cmp_gt_i32 s[40:41], 20, v222
    v_mfma_f32_16x16x32_bf16 v[124:127], v[212:215], a[148:151], v[124:127]
    v_cmp_gt_i32 s[42:43], 21, v222
    v_cmp_gt_i32 s[44:45], 22, v222
    v_mfma_f32_16x16x32_bf16 v[184:187], v[208:211], a[136:139], v[184:187]
    ds_read_b64_tr_b16 v[204:205], v1 offset:57344
    v_cmp_gt_i32 s[46:47], 23, v222
    v_mfma_f32_16x16x32_bf16 v[184:187], v[212:215], a[152:155], v[184:187]
    v_cmp_gt_i32 s[32:33], 16, v222
    v_cmp_gt_i32 s[34:35], 17, v222
    v_mfma_f32_16x16x32_bf16 v[188:191], v[208:211], a[140:143], v[188:191]
    ds_read_b64_tr_b16 v[206:207], v1 offset:58368
    v_mfma_f32_16x16x32_bf16 v[188:191], v[212:215], a[156:159], v[188:191]
    s_waitcnt vmcnt(19) lgkmcnt(4)
    v_mfma_f32_16x16x32_bf16 v[64:67], v[192:195], a[160:163], v[64:67]
    ds_read_b64_tr_b16 v[208:209], v2 offset:49152
    v_mfma_f32_16x16x32_bf16 v[64:67], v[196:199], a[176:179], v[64:67]
    v_mfma_f32_16x16x32_bf16 v[68:71], v[192:195], a[164:167], v[68:71]
    ds_read_b64_tr_b16 v[210:211], v2 offset:50176
    v_mfma_f32_16x16x32_bf16 v[68:71], v[196:199], a[180:183], v[68:71]
    v_mfma_f32_16x16x32_bf16 v[128:131], v[192:195], a[168:171], v[128:131]
    ds_read_b64_tr_b16 v[212:213], v2 offset:57344
    v_mfma_f32_16x16x32_bf16 v[128:131], v[196:199], a[184:187], v[128:131]
    v_mfma_f32_16x16x32_bf16 v[132:135], v[192:195], a[172:175], v[132:135]
    ds_read_b64_tr_b16 v[214:215], v2 offset:58368
    v_mfma_f32_16x16x32_bf16 v[132:135], v[196:199], a[188:191], v[132:135]
    s_waitcnt lgkmcnt(4)
    v_mfma_f32_16x16x32_bf16 v[72:75], v[200:203], a[160:163], v[72:75]
    ds_read_b64_tr_b16 v[192:193], v3 offset:49152
    v_mfma_f32_16x16x32_bf16 v[72:75], v[204:207], a[176:179], v[72:75]
    v_mfma_f32_16x16x32_bf16 v[76:79], v[200:203], a[164:167], v[76:79]
    ds_read_b64_tr_b16 v[194:195], v3 offset:50176
    v_mfma_f32_16x16x32_bf16 v[76:79], v[204:207], a[180:183], v[76:79]
    v_mfma_f32_16x16x32_bf16 v[136:139], v[200:203], a[168:171], v[136:139]
    ds_read_b64_tr_b16 v[196:197], v3 offset:57344
    v_mfma_f32_16x16x32_bf16 v[136:139], v[204:207], a[184:187], v[136:139]
    v_mfma_f32_16x16x32_bf16 v[140:143], v[200:203], a[172:175], v[140:143]
    ds_read_b64_tr_b16 v[198:199], v3 offset:58368
    v_mfma_f32_16x16x32_bf16 v[140:143], v[204:207], a[188:191], v[140:143]
    s_waitcnt lgkmcnt(4)
    v_mfma_f32_16x16x32_bf16 v[80:83], v[208:211], a[160:163], v[80:83]
    ds_read_b64_tr_b16 v[200:201], v4 offset:49152
    v_mfma_f32_16x16x32_bf16 v[80:83], v[212:215], a[176:179], v[80:83]
    v_mfma_f32_16x16x32_bf16 v[84:87], v[208:211], a[164:167], v[84:87]
    ds_read_b64_tr_b16 v[202:203], v4 offset:50176
    v_mfma_f32_16x16x32_bf16 v[84:87], v[212:215], a[180:183], v[84:87]
    s_waitcnt vmcnt(2)
    v_cmp_ne_u32 vcc, s73, v218
    s_nop 1
    s_cbranch_vccnz L_poll2_sequential_preLN__compressed_kv_cla__geglu_ffn__prompt_kernel
L_poll2_sequential_preLN__compressed_kv_cla__geglu_ffn__prompt_kernel_ok:
    v_mfma_f32_16x16x32_bf16 v[144:147], v[208:211], a[168:171], v[144:147]
    s_add_u32 m0, s55, 0
    s_add_u32 s63, s54, 0
    ds_read_b64_tr_b16 v[204:205], v4 offset:57344
    v_mfma_f32_16x16x32_bf16 v[144:147], v[212:215], a[184:187], v[144:147]
    buffer_load_dwordx4 v224, s[12:15], s63 offen offset:0 sc1 lds
    v_mfma_f32_16x16x32_bf16 v[148:151], v[208:211], a[172:175], v[148:151]
    ds_read_b64_tr_b16 v[206:207], v4 offset:58368
    v_mov_b32 v229, 0xff800000
    v_mfma_f32_16x16x32_bf16 v[148:151], v[212:215], a[188:191], v[148:151]
    s_waitcnt lgkmcnt(4)
    v_mov_b32 v228, v224
    v_add_u32 v227, 0x10000, v224
    v_mfma_f32_16x16x32_bf16 v[88:91], v[192:195], a[160:163], v[88:91]
    ds_read_b64_tr_b16 v[208:209], v5 offset:49152
    v_mov_b32 v225, 0
    v_mfma_f32_16x16x32_bf16 v[88:91], v[196:199], a[176:179], v[88:91]
    buffer_load_dwordx4 v224, s[12:15], s63 offen offset:1024 sc1 lds
    v_mfma_f32_16x16x32_bf16 v[92:95], v[192:195], a[164:167], v[92:95]
    s_lshl_b32 s70, s74, 1
    ds_read_b64_tr_b16 v[210:211], v5 offset:50176
    v_mov_b32 v226, 0
    v_mfma_f32_16x16x32_bf16 v[92:95], v[196:199], a[180:183], v[92:95]
    s_sub_u32 s3, 26, s70
    s_add_u32 s67, s70, 2
    s_mov_b32 s50, s70
    v_mfma_f32_16x16x32_bf16 v[152:155], v[192:195], a[168:171], v[152:155]
    s_sub_u32 s6, s3, 2
    s_mov_b32 s61, 0
    ds_read_b64_tr_b16 v[212:213], v5 offset:57344
    v_mfma_f32_16x16x32_bf16 v[152:155], v[196:199], a[184:187], v[152:155]
    buffer_load_dwordx4 v224, s[12:15], s63 offen offset:2048 sc1 lds
    v_mfma_f32_16x16x32_bf16 v[156:159], v[192:195], a[172:175], v[156:159]
    s_mov_b32 s72, 0x7f000000
    ds_read_b64_tr_b16 v[214:215], v5 offset:58368
    v_mfma_f32_16x16x32_bf16 v[156:159], v[196:199], a[188:191], v[156:159]
    s_waitcnt lgkmcnt(4)
    s_cmp_eq_u32 s74, 0
    s_cselect_b32 s7, s71, 9
    v_mfma_f32_16x16x32_bf16 v[96:99], v[200:203], a[160:163], v[96:99]
    s_lshl_b32 s68, s74, 2
    s_add_u32 s80, s68, s71
    ds_read_b64_tr_b16 v[192:193], v6 offset:49152
    v_mfma_f32_16x16x32_bf16 v[96:99], v[204:207], a[176:179], v[96:99]
    buffer_load_dwordx4 v224, s[12:15], s63 offen offset:3072 sc1 lds
    v_mfma_f32_16x16x32_bf16 v[100:103], v[200:203], a[164:167], v[100:103]
    s_sub_u32 s68, 60, s68
    s_add_u32 s81, s68, s71
    ds_read_b64_tr_b16 v[194:195], v6 offset:50176
    v_mfma_f32_16x16x32_bf16 v[100:103], v[204:207], a[180:183], v[100:103]
    s_lshr_b32 s70, s74, 2
    s_mul_i32 s64, s70, 7
    s_xor_b32 s64, s64, s74
    v_mfma_f32_16x16x32_bf16 v[160:163], v[200:203], a[168:171], v[160:163]
    s_add_u32 m0, s55, 4096
    s_add_u32 s63, s54, 4096
    ds_read_b64_tr_b16 v[196:197], v6 offset:57344
    v_mfma_f32_16x16x32_bf16 v[160:163], v[204:207], a[184:187], v[160:163]
    buffer_load_dwordx4 v224, s[12:15], s63 offen offset:0 sc1 lds
    v_mfma_f32_16x16x32_bf16 v[164:167], v[200:203], a[172:175], v[164:167]
    s_lshl_b32 s64, s64, 2
    s_add_u32 s64, s64, s71
    ds_read_b64_tr_b16 v[198:199], v6 offset:58368
    v_mfma_f32_16x16x32_bf16 v[164:167], v[204:207], a[188:191], v[164:167]
    s_waitcnt lgkmcnt(4)
    s_lshl_b32 s64, s64, 1
    s_add_u32 s64, s64, s70
    v_mfma_f32_16x16x32_bf16 v[104:107], v[208:211], a[160:163], v[104:107]
    s_lshl_b32 s70, s75, 13
    s_add_u32 s70, s70, 0x2500000
    ds_read_b64_tr_b16 v[200:201], v7 offset:49152
    v_mfma_f32_16x16x32_bf16 v[104:107], v[212:215], a[176:179], v[104:107]
    buffer_load_dwordx4 v224, s[12:15], s63 offen offset:1024 sc1 lds
    v_mfma_f32_16x16x32_bf16 v[108:111], v[208:211], a[164:167], v[108:111]
    s_mul_i32 s64, s64, 557056
    s_add_u32 s64, s64, s70
    ds_read_b64_tr_b16 v[202:203], v7 offset:50176
    v_mfma_f32_16x16x32_bf16 v[108:111], v[212:215], a[180:183], v[108:111]
    s_add_u32 s65, s64, 278528
    v_mfma_f32_16x16x32_bf16 v[168:171], v[208:211], a[168:171], v[168:171]
    s_and_b32 s68, s2, 7
    s_lshr_b32 s69, s2, 3
    ds_read_b64_tr_b16 v[204:205], v7 offset:57344
    v_mfma_f32_16x16x32_bf16 v[168:171], v[212:215], a[184:187], v[168:171]
    s_barrier
    s_lshl_b32 s68, s68, 2
    v_mfma_f32_16x16x32_bf16 v[172:175], v[208:211], a[172:175], v[172:175]
    s_lshr_b32 s70, s69, 3
    s_add_u32 s68, s68, s70
    ds_read_b64_tr_b16 v[206:207], v7 offset:58368
    v_mfma_f32_16x16x32_bf16 v[172:175], v[212:215], a[188:191], v[172:175]
    s_waitcnt lgkmcnt(4)
    s_and_b32 s69, s69, 7
    s_bfe_u32 s51, s2, 0x20003
    v_mfma_f32_16x16x32_bf16 v[112:115], v[192:195], a[160:163], v[112:115]
    s_lshl_b32 s51, s51, 2
    s_add_u32 s51, s51, s71
    ds_read_b64_tr_b16 v[208:209], v0 offset:0
    v_mfma_f32_16x16x32_bf16 v[112:115], v[196:199], a[176:179], v[112:115]
    buffer_load_dwordx4 v224, s[12:15], s63 offen offset:2048 sc1 lds
    v_mfma_f32_16x16x32_bf16 v[116:119], v[192:195], a[164:167], v[116:119]
    s_mul_i32 s51, s51, 278528
    s_bfe_u32 s70, s2, 0x20001
    ds_read_b64_tr_b16 v[210:211], v0 offset:1024
    v_mfma_f32_16x16x32_bf16 v[116:119], v[196:199], a[180:183], v[116:119]
    s_lshl_b32 s70, s70, 16
    s_add_u32 s51, s51, s70
    s_add_u32 s62, s51, 0x3600000
    v_mfma_f32_16x16x32_bf16 v[176:179], v[192:195], a[168:171], v[176:179]
    s_bfe_u32 s51, s2, 0x20001
    ds_read_b64_tr_b16 v[212:213], v0 offset:8192
    v_add_u32 v252, 4096, v224
    v_mfma_f32_16x16x32_bf16 v[176:179], v[196:199], a[184:187], v[176:179]
    buffer_load_dwordx4 v224, s[12:15], s63 offen offset:3072 sc1 lds
    v_mfma_f32_16x16x32_bf16 v[180:183], v[192:195], a[172:175], v[180:183]
    s_add_u32 s54, s54, 33792
    s_add_u32 s55, s55, 32768
    ds_read_b64_tr_b16 v[214:215], v0 offset:9216
    v_mfma_f32_16x16x32_bf16 v[180:183], v[196:199], a[188:191], v[180:183]
    s_waitcnt lgkmcnt(4)
    s_lshl_b32 s51, s51, 2
    s_lshr_b32 s70, s2, 6
    v_mfma_f32_16x16x32_bf16 v[120:123], v[200:203], a[160:163], v[120:123]
    s_add_u32 m0, s55, 0
    s_add_u32 s63, s54, 0
    ds_read_b64_tr_b16 v[192:193], v0 offset:16384
    v_mfma_f32_16x16x32_bf16 v[120:123], v[204:207], a[176:179], v[120:123]
    buffer_load_dwordx4 v224, s[12:15], s63 offen offset:0 sc1 lds
    v_mfma_f32_16x16x32_bf16 v[124:127], v[200:203], a[164:167], v[124:127]
    s_add_u32 s51, s51, s70
    s_mul_i32 s51, s51, 229376
    ds_read_b64_tr_b16 v[194:195], v0 offset:17408
    v_mfma_f32_16x16x32_bf16 v[124:127], v[204:207], a[180:183], v[124:127]
    s_lshl_b32 s70, s71, 13
    s_add_u32 s51, s51, s70
    s_add_u32 s60, s51, 0x3f10000
    v_mfma_f32_16x16x32_bf16 v[184:187], v[200:203], a[168:171], v[184:187]
    s_add_u32 s51, s97, 4096
    ds_read_b64_tr_b16 v[196:197], v0 offset:24576
    v_mfma_f32_16x16x32_bf16 v[184:187], v[204:207], a[184:187], v[184:187]
    buffer_load_dwordx4 v224, s[12:15], s63 offen offset:1024 sc1 lds
    v_mfma_f32_16x16x32_bf16 v[188:191], v[200:203], a[172:175], v[188:191]
    ds_read_b64_tr_b16 v[198:199], v0 offset:25600
    v_mfma_f32_16x16x32_bf16 v[188:191], v[204:207], a[188:191], v[188:191]
    s_waitcnt lgkmcnt(4)
    v_mfma_f32_16x16x32_bf16 v[64:67], v[208:211], a[192:195], v[64:67]
    ds_read_b64_tr_b16 v[200:201], v1 offset:0
    v_mfma_f32_16x16x32_bf16 v[64:67], v[212:215], a[208:211], v[64:67]
    buffer_load_dwordx4 v224, s[12:15], s63 offen offset:2048 sc1 lds
    v_mfma_f32_16x16x32_bf16 v[68:71], v[208:211], a[196:199], v[68:71]
    ds_read_b64_tr_b16 v[202:203], v1 offset:1024
    v_mfma_f32_16x16x32_bf16 v[68:71], v[212:215], a[212:215], v[68:71]
    v_mfma_f32_16x16x32_bf16 v[128:131], v[208:211], a[200:203], v[128:131]
    ds_read_b64_tr_b16 v[204:205], v1 offset:8192
    v_mfma_f32_16x16x32_bf16 v[128:131], v[212:215], a[216:219], v[128:131]
    buffer_load_dwordx4 v224, s[12:15], s63 offen offset:3072 sc1 lds
    v_mfma_f32_16x16x32_bf16 v[132:135], v[208:211], a[204:207], v[132:135]
    ds_read_b64_tr_b16 v[206:207], v1 offset:9216
    v_mfma_f32_16x16x32_bf16 v[132:135], v[212:215], a[220:223], v[132:135]
    s_waitcnt lgkmcnt(4)
    v_mfma_f32_16x16x32_bf16 v[64:67], v[192:195], a[224:227], v[64:67]
    s_add_u32 m0, s55, 4096
    s_add_u32 s63, s54, 4096
    ds_read_b64_tr_b16 v[208:209], v1 offset:16384
    v_mfma_f32_16x16x32_bf16 v[64:67], v[196:199], a[240:243], v[64:67]
    buffer_load_dwordx4 v224, s[12:15], s63 offen offset:0 sc1 lds
    v_mfma_f32_16x16x32_bf16 v[68:71], v[192:195], a[228:231], v[68:71]
    ds_read_b64_tr_b16 v[210:211], v1 offset:17408
    v_mfma_f32_16x16x32_bf16 v[68:71], v[196:199], a[244:247], v[68:71]
    v_mfma_f32_16x16x32_bf16 v[128:131], v[192:195], a[232:235], v[128:131]
    ds_read_b64_tr_b16 v[212:213], v1 offset:24576
    v_mfma_f32_16x16x32_bf16 v[128:131], v[196:199], a[248:251], v[128:131]
    v_mfma_f32_16x16x32_bf16 v[132:135], v[192:195], a[236:239], v[132:135]
    ds_read_b64_tr_b16 v[214:215], v1 offset:25600
    v_mfma_f32_16x16x32_bf16 v[132:135], v[196:199], a[252:255], v[132:135]
    s_waitcnt lgkmcnt(4)
    v_mfma_f32_16x16x32_bf16 v[72:75], v[200:203], a[192:195], v[72:75]
    ds_read_b64_tr_b16 v[192:193], v2 offset:0
    v_mfma_f32_16x16x32_bf16 v[72:75], v[204:207], a[208:211], v[72:75]
    buffer_load_dwordx4 v224, s[12:15], s63 offen offset:1024 sc1 lds
    v_mfma_f32_16x16x32_bf16 v[76:79], v[200:203], a[196:199], v[76:79]
    ds_read_b64_tr_b16 v[194:195], v2 offset:1024
    v_cvt_pk_bf16_f32 v232, v64, v65
    v_mfma_f32_16x16x32_bf16 v[76:79], v[204:207], a[212:215], v[76:79]
    v_cvt_pk_bf16_f32 v233, v66, v67
    v_cvt_pk_bf16_f32 v234, v68, v69
    v_mfma_f32_16x16x32_bf16 v[136:139], v[200:203], a[200:203], v[136:139]
    ds_read_b64_tr_b16 v[196:197], v2 offset:8192
    v_cvt_pk_bf16_f32 v235, v70, v71
    v_mfma_f32_16x16x32_bf16 v[136:139], v[204:207], a[216:219], v[136:139]
    buffer_load_dwordx4 v224, s[12:15], s63 offen offset:2048 sc1 lds
    v_mfma_f32_16x16x32_bf16 v[140:143], v[200:203], a[204:207], v[140:143]
    ds_read_b64_tr_b16 v[198:199], v2 offset:9216
    v_cvt_pk_bf16_f32 v236, v128, v129
    v_mfma_f32_16x16x32_bf16 v[140:143], v[204:207], a[220:223], v[140:143]
    s_waitcnt lgkmcnt(4)
    v_cvt_pk_bf16_f32 v237, v130, v131
    v_cvt_pk_bf16_f32 v238, v132, v133
    v_mfma_f32_16x16x32_bf16 v[72:75], v[208:211], a[224:227], v[72:75]
    ds_read_b64_tr_b16 v[200:201], v2 offset:16384
    v_cvt_pk_bf16_f32 v239, v134, v135
    v_mfma_f32_16x16x32_bf16 v[72:75], v[212:215], a[240:243], v[72:75]
    buffer_load_dwordx4 v224, s[12:15], s63 offen offset:3072 sc1 lds
    v_mfma_f32_16x16x32_bf16 v[76:79], v[208:211], a[228:231], v[76:79]
    s_add_u32 s54, s54, 33792
    s_add_u32 s55, s55, 32768
    ds_read_b64_tr_b16 v[202:203], v2 offset:17408
    v_mfma_f32_16x16x32_bf16 v[76:79], v[212:215], a[244:247], v[76:79]
    v_permlane16_swap_b32 v232, v234
    v_permlane16_swap_b32 v233, v235
    v_mfma_f32_16x16x32_bf16 v[136:139], v[208:211], a[232:235], v[136:139]
    s_add_u32 m0, s55, 0
    s_add_u32 s63, s54, 0
    ds_read_b64_tr_b16 v[204:205], v2 offset:24576
    v_mfma_f32_16x16x32_bf16 v[136:139], v[212:215], a[248:251], v[136:139]
    buffer_load_dwordx4 v224, s[12:15], s63 offen offset:0 sc1 lds
    v_mfma_f32_16x16x32_bf16 v[140:143], v[208:211], a[236:239], v[140:143]
    ds_read_b64_tr_b16 v[206:207], v2 offset:25600
    v_permlane16_swap_b32 v236, v238
    v_mfma_f32_16x16x32_bf16 v[140:143], v[212:215], a[252:255], v[140:143]
    s_waitcnt lgkmcnt(4)
    v_permlane16_swap_b32 v237, v239
    v_accvgpr_write_b32 a0, v232
    v_mfma_f32_16x16x32_bf16 v[80:83], v[192:195], a[192:195], v[80:83]
    ds_read_b64_tr_b16 v[208:209], v3 offset:0
    v_accvgpr_write_b32 a1, v233
    v_mfma_f32_16x16x32_bf16 v[80:83], v[196:199], a[208:211], v[80:83]
    v_accvgpr_write_b32 a2, v234
    v_accvgpr_write_b32 a3, v235
    v_mfma_f32_16x16x32_bf16 v[84:87], v[192:195], a[196:199], v[84:87]
    ds_read_b64_tr_b16 v[210:211], v3 offset:1024
    v_accvgpr_write_b32 a32, v236
    v_mfma_f32_16x16x32_bf16 v[84:87], v[196:199], a[212:215], v[84:87]
    v_accvgpr_write_b32 a33, v237
    v_accvgpr_write_b32 a34, v238
    v_mfma_f32_16x16x32_bf16 v[144:147], v[192:195], a[200:203], v[144:147]
    ds_read_b64_tr_b16 v[212:213], v3 offset:8192
    v_accvgpr_write_b32 a35, v239
    v_mfma_f32_16x16x32_bf16 v[144:147], v[196:199], a[216:219], v[144:147]
    buffer_load_dwordx4 v224, s[12:15], s63 offen offset:1024 sc1 lds
    v_mfma_f32_16x16x32_bf16 v[148:151], v[192:195], a[204:207], v[148:151]
    ds_read_b64_tr_b16 v[214:215], v3 offset:9216
    v_cvt_pk_bf16_f32 v232, v72, v73
    v_mfma_f32_16x16x32_bf16 v[148:151], v[196:199], a[220:223], v[148:151]
    s_waitcnt lgkmcnt(4)
    v_cvt_pk_bf16_f32 v233, v74, v75
    v_cvt_pk_bf16_f32 v234, v76, v77
    v_mfma_f32_16x16x32_bf16 v[80:83], v[200:203], a[224:227], v[80:83]
    ds_read_b64_tr_b16 v[192:193], v3 offset:16384
    v_cvt_pk_bf16_f32 v235, v78, v79
    v_mfma_f32_16x16x32_bf16 v[80:83], v[204:207], a[240:243], v[80:83]
    buffer_load_dwordx4 v224, s[12:15], s63 offen offset:2048 sc1 lds
    v_mfma_f32_16x16x32_bf16 v[84:87], v[200:203], a[228:231], v[84:87]
    ds_read_b64_tr_b16 v[194:195], v3 offset:17408
    v_cvt_pk_bf16_f32 v236, v136, v137
    v_mfma_f32_16x16x32_bf16 v[84:87], v[204:207], a[244:247], v[84:87]
    v_cvt_pk_bf16_f32 v237, v138, v139
    v_cvt_pk_bf16_f32 v238, v140, v141
    v_mfma_f32_16x16x32_bf16 v[144:147], v[200:203], a[232:235], v[144:147]
    ds_read_b64_tr_b16 v[196:197], v3 offset:24576
    v_cvt_pk_bf16_f32 v239, v142, v143
    v_mfma_f32_16x16x32_bf16 v[144:147], v[204:207], a[248:251], v[144:147]
    buffer_load_dwordx4 v224, s[12:15], s63 offen offset:3072 sc1 lds
    v_mfma_f32_16x16x32_bf16 v[148:151], v[200:203], a[236:239], v[148:151]
    ds_read_b64_tr_b16 v[198:199], v3 offset:25600
    v_permlane16_swap_b32 v232, v234
    v_mfma_f32_16x16x32_bf16 v[148:151], v[204:207], a[252:255], v[148:151]
    s_waitcnt lgkmcnt(4)
    v_permlane16_swap_b32 v233, v235
    v_mfma_f32_16x16x32_bf16 v[88:91], v[208:211], a[192:195], v[88:91]
    s_add_u32 m0, s55, 4096
    s_add_u32 s63, s54, 4096
    ds_read_b64_tr_b16 v[200:201], v4 offset:0
    v_mfma_f32_16x16x32_bf16 v[88:91], v[212:215], a[208:211], v[88:91]
    buffer_load_dwordx4 v224, s[12:15], s63 offen offset:0 sc1 lds
    v_mfma_f32_16x16x32_bf16 v[92:95], v[208:211], a[196:199], v[92:95]
    ds_read_b64_tr_b16 v[202:203], v4 offset:1024
    v_permlane16_swap_b32 v236, v238
    v_mfma_f32_16x16x32_bf16 v[92:95], v[212:215], a[212:215], v[92:95]
    v_permlane16_swap_b32 v237, v239
    v_accvgpr_write_b32 a4, v232
    v_mfma_f32_16x16x32_bf16 v[152:155], v[208:211], a[200:203], v[152:155]
    ds_read_b64_tr_b16 v[204:205], v4 offset:8192
    v_accvgpr_write_b32 a5, v233
    v_mfma_f32_16x16x32_bf16 v[152:155], v[212:215], a[216:219], v[152:155]
    v_accvgpr_write_b32 a6, v234
    v_accvgpr_write_b32 a7, v235
    v_mfma_f32_16x16x32_bf16 v[156:159], v[208:211], a[204:207], v[156:159]
    ds_read_b64_tr_b16 v[206:207], v4 offset:9216
    v_accvgpr_write_b32 a36, v236
    v_mfma_f32_16x16x32_bf16 v[156:159], v[212:215], a[220:223], v[156:159]
    s_waitcnt lgkmcnt(4)
    v_accvgpr_write_b32 a37, v237
    v_accvgpr_write_b32 a38, v238
    v_mfma_f32_16x16x32_bf16 v[88:91], v[192:195], a[224:227], v[88:91]
    ds_read_b64_tr_b16 v[208:209], v4 offset:16384
    v_accvgpr_write_b32 a39, v239
    v_mfma_f32_16x16x32_bf16 v[88:91], v[196:199], a[240:243], v[88:91]
    buffer_load_dwordx4 v224, s[12:15], s63 offen offset:1024 sc1 lds
    v_mfma_f32_16x16x32_bf16 v[92:95], v[192:195], a[228:231], v[92:95]
    ds_read_b64_tr_b16 v[210:211], v4 offset:17408
    v_cvt_pk_bf16_f32 v232, v80, v81
    v_mfma_f32_16x16x32_bf16 v[92:95], v[196:199], a[244:247], v[92:95]
    v_cvt_pk_bf16_f32 v233, v82, v83
    v_cvt_pk_bf16_f32 v234, v84, v85
    v_mfma_f32_16x16x32_bf16 v[152:155], v[192:195], a[232:235], v[152:155]
    ds_read_b64_tr_b16 v[212:213], v4 offset:24576
    v_cvt_pk_bf16_f32 v235, v86, v87
    v_mfma_f32_16x16x32_bf16 v[152:155], v[196:199], a[248:251], v[152:155]
    buffer_load_dwordx4 v224, s[12:15], s63 offen offset:2048 sc1 lds
    v_mfma_f32_16x16x32_bf16 v[156:159], v[192:195], a[236:239], v[156:159]
    ds_read_b64_tr_b16 v[214:215], v4 offset:25600
    v_cvt_pk_bf16_f32 v236, v144, v145
    v_mfma_f32_16x16x32_bf16 v[156:159], v[196:199], a[252:255], v[156:159]
    s_waitcnt lgkmcnt(4)
    v_cvt_pk_bf16_f32 v237, v146, v147
    v_cvt_pk_bf16_f32 v238, v148, v149
    v_mfma_f32_16x16x32_bf16 v[96:99], v[200:203], a[192:195], v[96:99]
    ds_read_b64_tr_b16 v[192:193], v5 offset:0
    v_cvt_pk_bf16_f32 v239, v150, v151
    v_mfma_f32_16x16x32_bf16 v[96:99], v[204:207], a[208:211], v[96:99]
    buffer_load_dwordx4 v224, s[12:15], s63 offen offset:3072 sc1 lds
    v_mfma_f32_16x16x32_bf16 v[100:103], v[200:203], a[196:199], v[100:103]
    ds_read_b64_tr_b16 v[194:195], v5 offset:1024
    v_permlane16_swap_b32 v232, v234
    v_mfma_f32_16x16x32_bf16 v[100:103], v[204:207], a[212:215], v[100:103]
    v_permlane16_swap_b32 v233, v235
    v_mfma_f32_16x16x32_bf16 v[160:163], v[200:203], a[200:203], v[160:163]
    ds_read_b64_tr_b16 v[196:197], v5 offset:8192
    v_permlane16_swap_b32 v236, v238
    v_mfma_f32_16x16x32_bf16 v[160:163], v[204:207], a[216:219], v[160:163]
    v_permlane16_swap_b32 v237, v239
    v_accvgpr_write_b32 a8, v232
    v_mfma_f32_16x16x32_bf16 v[164:167], v[200:203], a[204:207], v[164:167]
    ds_read_b64_tr_b16 v[198:199], v5 offset:9216
    v_accvgpr_write_b32 a9, v233
    v_mfma_f32_16x16x32_bf16 v[164:167], v[204:207], a[220:223], v[164:167]
    s_waitcnt lgkmcnt(4)
    v_accvgpr_write_b32 a10, v234
    v_accvgpr_write_b32 a11, v235
    v_mfma_f32_16x16x32_bf16 v[96:99], v[208:211], a[224:227], v[96:99]
    ds_read_b64_tr_b16 v[200:201], v5 offset:16384
    v_accvgpr_write_b32 a40, v236
    v_mfma_f32_16x16x32_bf16 v[96:99], v[212:215], a[240:243], v[96:99]
    v_accvgpr_write_b32 a41, v237
    v_accvgpr_write_b32 a42, v238
    v_mfma_f32_16x16x32_bf16 v[100:103], v[208:211], a[228:231], v[100:103]
    ds_read_b64_tr_b16 v[202:203], v5 offset:17408
    v_accvgpr_write_b32 a43, v239
    v_mfma_f32_16x16x32_bf16 v[100:103], v[212:215], a[244:247], v[100:103]
    v_cvt_pk_bf16_f32 v232, v88, v89
    v_cvt_pk_bf16_f32 v233, v90, v91
    v_mfma_f32_16x16x32_bf16 v[160:163], v[208:211], a[232:235], v[160:163]
    ds_read_b64_tr_b16 v[204:205], v5 offset:24576
    v_cvt_pk_bf16_f32 v234, v92, v93
    v_mfma_f32_16x16x32_bf16 v[160:163], v[212:215], a[248:251], v[160:163]
    v_cvt_pk_bf16_f32 v235, v94, v95
    v_cvt_pk_bf16_f32 v236, v152, v153
    v_mfma_f32_16x16x32_bf16 v[164:167], v[208:211], a[236:239], v[164:167]
    ds_read_b64_tr_b16 v[206:207], v5 offset:25600
    v_cvt_pk_bf16_f32 v237, v154, v155
    v_mfma_f32_16x16x32_bf16 v[164:167], v[212:215], a[252:255], v[164:167]
    s_waitcnt lgkmcnt(4)
    v_cvt_pk_bf16_f32 v238, v156, v157
    v_cvt_pk_bf16_f32 v239, v158, v159
    v_mfma_f32_16x16x32_bf16 v[104:107], v[192:195], a[192:195], v[104:107]
    ds_read_b64_tr_b16 v[208:209], v6 offset:0
    v_permlane16_swap_b32 v232, v234
    v_mfma_f32_16x16x32_bf16 v[104:107], v[196:199], a[208:211], v[104:107]
    v_permlane16_swap_b32 v233, v235
    v_mfma_f32_16x16x32_bf16 v[108:111], v[192:195], a[196:199], v[108:111]
    ds_read_b64_tr_b16 v[210:211], v6 offset:1024
    v_permlane16_swap_b32 v236, v238
    v_mfma_f32_16x16x32_bf16 v[108:111], v[196:199], a[212:215], v[108:111]
    v_permlane16_swap_b32 v237, v239
    v_accvgpr_write_b32 a12, v232
    v_mfma_f32_16x16x32_bf16 v[168:171], v[192:195], a[200:203], v[168:171]
    ds_read_b64_tr_b16 v[212:213], v6 offset:8192
    v_accvgpr_write_b32 a13, v233
    v_mfma_f32_16x16x32_bf16 v[168:171], v[196:199], a[216:219], v[168:171]
    v_accvgpr_write_b32 a14, v234
    v_accvgpr_write_b32 a15, v235
    v_mfma_f32_16x16x32_bf16 v[172:175], v[192:195], a[204:207], v[172:175]
    ds_read_b64_tr_b16 v[214:215], v6 offset:9216
    v_accvgpr_write_b32 a44, v236
    v_mfma_f32_16x16x32_bf16 v[172:175], v[196:199], a[220:223], v[172:175]
    s_waitcnt lgkmcnt(4)
    v_accvgpr_write_b32 a45, v237
    v_accvgpr_write_b32 a46, v238
    v_mfma_f32_16x16x32_bf16 v[104:107], v[200:203], a[224:227], v[104:107]
    ds_read_b64_tr_b16 v[192:193], v6 offset:16384
    v_accvgpr_write_b32 a47, v239
    v_mfma_f32_16x16x32_bf16 v[104:107], v[204:207], a[240:243], v[104:107]
    v_cvt_pk_bf16_f32 v232, v96, v97
    v_cvt_pk_bf16_f32 v233, v98, v99
    v_mfma_f32_16x16x32_bf16 v[108:111], v[200:203], a[228:231], v[108:111]
    ds_read_b64_tr_b16 v[194:195], v6 offset:17408
    v_cvt_pk_bf16_f32 v234, v100, v101
    v_mfma_f32_16x16x32_bf16 v[108:111], v[204:207], a[244:247], v[108:111]
    v_cvt_pk_bf16_f32 v235, v102, v103
    v_cvt_pk_bf16_f32 v236, v160, v161
    v_mfma_f32_16x16x32_bf16 v[168:171], v[200:203], a[232:235], v[168:171]
    ds_read_b64_tr_b16 v[196:197], v6 offset:24576
    v_cvt_pk_bf16_f32 v237, v162, v163
    v_mfma_f32_16x16x32_bf16 v[168:171], v[204:207], a[248:251], v[168:171]
    v_cvt_pk_bf16_f32 v238, v164, v165
    v_cvt_pk_bf16_f32 v239, v166, v167
    v_mfma_f32_16x16x32_bf16 v[172:175], v[200:203], a[236:239], v[172:175]
    ds_read_b64_tr_b16 v[198:199], v6 offset:25600
    v_permlane16_swap_b32 v232, v234
    v_mfma_f32_16x16x32_bf16 v[172:175], v[204:207], a[252:255], v[172:175]
    s_waitcnt lgkmcnt(4)
    v_permlane16_swap_b32 v233, v235
    v_mfma_f32_16x16x32_bf16 v[112:115], v[208:211], a[192:195], v[112:115]
    ds_read_b64_tr_b16 v[200:201], v7 offset:0
    v_permlane16_swap_b32 v236, v238
    v_mfma_f32_16x16x32_bf16 v[112:115], v[212:215], a[208:211], v[112:115]
    v_permlane16_swap_b32 v237, v239
    v_accvgpr_write_b32 a16, v232
    v_mfma_f32_16x16x32_bf16 v[116:119], v[208:211], a[196:199], v[116:119]
    ds_read_b64_tr_b16 v[202:203], v7 offset:1024
    v_accvgpr_write_b32 a17, v233
    v_mfma_f32_16x16x32_bf16 v[116:119], v[212:215], a[212:215], v[116:119]
    v_accvgpr_write_b32 a18, v234
    v_accvgpr_write_b32 a19, v235
    v_mfma_f32_16x16x32_bf16 v[176:179], v[208:211], a[200:203], v[176:179]
    ds_read_b64_tr_b16 v[204:205], v7 offset:8192
    v_accvgpr_write_b32 a48, v236
    v_mfma_f32_16x16x32_bf16 v[176:179], v[212:215], a[216:219], v[176:179]
    v_accvgpr_write_b32 a49, v237
    v_accvgpr_write_b32 a50, v238
    v_mfma_f32_16x16x32_bf16 v[180:183], v[208:211], a[204:207], v[180:183]
    ds_read_b64_tr_b16 v[206:207], v7 offset:9216
    v_accvgpr_write_b32 a51, v239
    v_mfma_f32_16x16x32_bf16 v[180:183], v[212:215], a[220:223], v[180:183]
    s_waitcnt lgkmcnt(4)
    v_cvt_pk_bf16_f32 v232, v104, v105
    v_cvt_pk_bf16_f32 v233, v106, v107
    v_mfma_f32_16x16x32_bf16 v[112:115], v[192:195], a[224:227], v[112:115]
    ds_read_b64_tr_b16 v[208:209], v7 offset:16384
    v_cvt_pk_bf16_f32 v234, v108, v109
    v_mfma_f32_16x16x32_bf16 v[112:115], v[196:199], a[240:243], v[112:115]
    v_cvt_pk_bf16_f32 v235, v110, v111
    v_cvt_pk_bf16_f32 v236, v168, v169
    v_mfma_f32_16x16x32_bf16 v[116:119], v[192:195], a[228:231], v[116:119]
    ds_read_b64_tr_b16 v[210:211], v7 offset:17408
    v_cvt_pk_bf16_f32 v237, v170, v171
    v_mfma_f32_16x16x32_bf16 v[116:119], v[196:199], a[244:247], v[116:119]
    v_cvt_pk_bf16_f32 v238, v172, v173
    v_cvt_pk_bf16_f32 v239, v174, v175
    v_mfma_f32_16x16x32_bf16 v[176:179], v[192:195], a[232:235], v[176:179]
    ds_read_b64_tr_b16 v[212:213], v7 offset:24576
    v_permlane16_swap_b32 v232, v234
    v_mfma_f32_16x16x32_bf16 v[176:179], v[196:199], a[248:251], v[176:179]
    s_waitcnt vmcnt(16)
    s_barrier
    v_permlane16_swap_b32 v233, v235
    v_mfma_f32_16x16x32_bf16 v[180:183], v[192:195], a[236:239], v[180:183]
    ds_read_b64_tr_b16 v[214:215], v7 offset:25600
    v_permlane16_swap_b32 v236, v238
    v_mfma_f32_16x16x32_bf16 v[180:183], v[196:199], a[252:255], v[180:183]
    s_waitcnt lgkmcnt(4)
    v_permlane16_swap_b32 v237, v239
    v_accvgpr_write_b32 a20, v232
    v_mfma_f32_16x16x32_bf16 v[120:123], v[200:203], a[192:195], v[120:123]
    ds_read_b128 a[64:67], v228 offset:0
    v_accvgpr_write_b32 a21, v233
    v_mfma_f32_16x16x32_bf16 v[120:123], v[204:207], a[208:211], v[120:123]
    v_accvgpr_write_b32 a22, v234
    v_accvgpr_write_b32 a23, v235
    v_mfma_f32_16x16x32_bf16 v[124:127], v[200:203], a[196:199], v[124:127]
    ds_read_b128 a[68:71], v228 offset:1024
    v_accvgpr_write_b32 a52, v236
    v_mfma_f32_16x16x32_bf16 v[124:127], v[204:207], a[212:215], v[124:127]
    v_accvgpr_write_b32 a53, v237
    v_accvgpr_write_b32 a54, v238
    v_mfma_f32_16x16x32_bf16 v[184:187], v[200:203], a[200:203], v[184:187]
    ds_read_b128 a[72:75], v228 offset:2048
    v_accvgpr_write_b32 a55, v239
    v_mfma_f32_16x16x32_bf16 v[184:187], v[204:207], a[216:219], v[184:187]
    v_mfma_f32_16x16x32_bf16 v[188:191], v[200:203], a[204:207], v[188:191]
    ds_read_b128 a[76:79], v228 offset:3072
    v_mfma_f32_16x16x32_bf16 v[188:191], v[204:207], a[220:223], v[188:191]
    s_waitcnt lgkmcnt(4)
    v_mfma_f32_16x16x32_bf16 v[120:123], v[208:211], a[224:227], v[120:123]
    ds_read_b128 a[80:83], v228 offset:4096
    v_mfma_f32_16x16x32_bf16 v[120:123], v[212:215], a[240:243], v[120:123]
    v_mfma_f32_16x16x32_bf16 v[124:127], v[208:211], a[228:231], v[124:127]
    ds_read_b128 a[84:87], v228 offset:5120
    v_mfma_f32_16x16x32_bf16 v[124:127], v[212:215], a[244:247], v[124:127]
    v_mfma_f32_16x16x32_bf16 v[184:187], v[208:211], a[232:235], v[184:187]
    ds_read_b128 a[88:91], v228 offset:6144
    v_mfma_f32_16x16x32_bf16 v[184:187], v[212:215], a[248:251], v[184:187]
    v_mfma_f32_16x16x32_bf16 v[188:191], v[208:211], a[236:239], v[188:191]
    ds_read_b128 a[92:95], v228 offset:7168
    v_mfma_f32_16x16x32_bf16 v[188:191], v[212:215], a[252:255], v[188:191]
    s_waitcnt lgkmcnt(7)
    v_mfma_f32_32x32x16_bf16 v[0:15], a[64:67], a[0:3], 0
    s_mov_b32 m0, s97
    s_nop 0
    buffer_load_dwordx4 v248, s[88:91], s87 offen offset:0 nt lds
    v_cvt_pk_bf16_f32 v232, v112, v113
    v_cvt_pk_bf16_f32 v233, v114, v115
    v_cvt_pk_bf16_f32 v234, v116, v117
    v_cvt_pk_bf16_f32 v235, v118, v119
    v_mfma_f32_32x32x16_bf16 v[32:47], a[64:67], a[32:35], 0
    ds_read_b128 a[64:67], v228 offset:8192
    v_cvt_pk_bf16_f32 v236, v176, v177
    v_cvt_pk_bf16_f32 v237, v178, v179
    v_cvt_pk_bf16_f32 v238, v180, v181
    v_cvt_pk_bf16_f32 v239, v182, v183
    v_permlane16_swap_b32 v232, v234
    s_waitcnt lgkmcnt(7)
    v_mfma_f32_32x32x16_bf16 v[0:15], a[68:71], a[4:7], v[0:15]
    s_add_u32 s87, s87, 3072
    buffer_load_dwordx4 v248, s[88:91], s87 offen offset:1024 nt lds
    v_permlane16_swap_b32 v233, v235
    v_permlane16_swap_b32 v236, v238
    v_permlane16_swap_b32 v237, v239
    v_accvgpr_write_b32 a24, v232
    v_mfma_f32_32x32x16_bf16 v[32:47], a[68:71], a[36:39], v[32:47]
    ds_read_b128 a[68:71], v228 offset:9216
    v_accvgpr_write_b32 a25, v233
    v_accvgpr_write_b32 a26, v234
    v_accvgpr_write_b32 a27, v235
    v_accvgpr_write_b32 a56, v236
    v_accvgpr_write_b32 a57, v237
    s_waitcnt lgkmcnt(7)
    v_mfma_f32_32x32x16_bf16 v[0:15], a[72:75], a[8:11], v[0:15]
    s_add_u32 s87, s87, 3072
    buffer_load_dwordx4 v248, s[88:91], s87 offen offset:2048 nt lds
    v_accvgpr_write_b32 a58, v238
    v_accvgpr_write_b32 a59, v239
    v_cvt_pk_bf16_f32 v232, v120, v121
    v_cvt_pk_bf16_f32 v233, v122, v123
    v_mfma_f32_32x32x16_bf16 v[32:47], a[72:75], a[40:43], v[32:47]
    ds_read_b128 a[72:75], v228 offset:10240
    v_cvt_pk_bf16_f32 v234, v124, v125
    v_cvt_pk_bf16_f32 v235, v126, v127
    v_cvt_pk_bf16_f32 v236, v184, v185
    v_cvt_pk_bf16_f32 v237, v186, v187
    v_cvt_pk_bf16_f32 v238, v188, v189
    s_waitcnt lgkmcnt(7)
    v_mfma_f32_32x32x16_bf16 v[0:15], a[76:79], a[12:15], v[0:15]
    s_add_u32 s87, s87, 3072
    buffer_load_dwordx4 v248, s[88:91], s87 offen offset:3072 nt lds
    v_cvt_pk_bf16_f32 v239, v190, v191
    v_permlane16_swap_b32 v232, v234
    v_permlane16_swap_b32 v233, v235
    v_permlane16_swap_b32 v236, v238
    v_mfma_f32_32x32x16_bf16 v[32:47], a[76:79], a[44:47], v[32:47]
    ds_read_b128 a[76:79], v228 offset:11264
    v_permlane16_swap_b32 v237, v239
    v_accvgpr_write_b32 a28, v232
    v_accvgpr_write_b32 a29, v233
    v_accvgpr_write_b32 a30, v234
    v_accvgpr_write_b32 a31, v235
    s_waitcnt lgkmcnt(7)
    v_mfma_f32_32x32x16_bf16 v[0:15], a[80:83], a[16:19], v[0:15]
    s_mov_b32 s88, s56
    s_mov_b32 s89, s57
    s_mov_b32 s90, 0x1c0000
    s_add_u32 m0, s97, 4096
    s_mov_b32 s87, s59
    buffer_load_dwordx4 v231, s[88:91], s87 offen offset:0  lds
    v_accvgpr_write_b32 a60, v236
    v_accvgpr_write_b32 a61, v237
    v_accvgpr_write_b32 a62, v238
    v_accvgpr_write_b32 a63, v239
    v_mfma_f32_32x32x16_bf16 v[32:47], a[80:83], a[48:51], v[32:47]
    ds_read_b128 a[80:83], v228 offset:12288
    s_waitcnt lgkmcnt(7)
    v_mfma_f32_32x32x16_bf16 v[0:15], a[84:87], a[20:23], v[0:15]
    s_add_u32 s87, s87, 113664
    buffer_load_dwordx4 v231, s[88:91], s87 offen offset:1024  lds
    v_mfma_f32_32x32x16_bf16 v[32:47], a[84:87], a[52:55], v[32:47]
    ds_read_b128 a[84:87], v228 offset:13312
    s_nop 0
    s_waitcnt lgkmcnt(7)
    v_mfma_f32_32x32x16_bf16 v[0:15], a[88:91], a[24:27], v[0:15]
    s_mov_b32 s88, s82
    s_mov_b32 s89, s83
    s_add_u32 m0, s97, 6144
    s_mov_b32 s87, s59
    buffer_load_dwordx4 v231, s[88:91], s87 offen offset:0  lds
    v_mfma_f32_32x32x16_bf16 v[32:47], a[88:91], a[56:59], v[32:47]
    s_nop 0
    s_waitcnt lgkmcnt(6)
    v_mfma_f32_32x32x16_bf16 v[0:15], a[92:95], a[28:31], v[0:15]
    s_add_u32 s87, s87, 113664
    buffer_load_dwordx4 v231, s[88:91], s87 offen offset:1024  lds
    v_mfma_f32_32x32x16_bf16 v[32:47], a[92:95], a[60:63], v[32:47]
    v_and_b32 v16, 0x1ff, v224
    buffer_load_dword a200, v16, s[8:11], s94 offen sc1
    s_nop 7
    s_nop 3
    s_cmp_lg_u32 s7, 0
    s_cbranch_scc1 L_nofix0_sequential_preLN__compressed_kv_cla__geglu_ffn__prompt_kernel
    v_cndmask_b32 v0, v0, v229, s[16:17]
    v_cndmask_b32 v1, v1, v229, s[18:19]
    v_cndmask_b32 v2, v2, v229, s[20:21]
    v_cndmask_b32 v3, v3, v229, s[22:23]
    v_cndmask_b32 v4, v4, v229, s[24:25]
    v_cndmask_b32 v5, v5, v229, s[26:27]
    v_cndmask_b32 v6, v6, v229, s[28:29]
    v_cndmask_b32 v7, v7, v229, s[30:31]
    v_cndmask_b32 v8, v8, v229, s[32:33]
    v_cndmask_b32 v9, v9, v229, s[34:35]
    v_cndmask_b32 v10, v10, v229, s[36:37]
    v_cndmask_b32 v11, v11, v229, s[38:39]
    v_cndmask_b32 v12, v12, v229, s[40:41]
    v_cndmask_b32 v13, v13, v229, s[42:43]
    v_cndmask_b32 v14, v14, v229, s[44:45]
    v_cndmask_b32 v15, v15, v229, s[46:47]
L_nofix0_sequential_preLN__compressed_kv_cla__geglu_ffn__prompt_kernel:
    s_cmp_le_u32 s7, 1
    s_cselect_b64 s[48:49], -1, 0
    s_cmp_lt_u32 s7, 1
    s_cselect_b64 s[4:5], -1, 0
    v_max3_f32 v230, v0, v1, v2
    v_max3_f32 v232, v3, v4, v5
    v_max3_f32 v231, v32, v33, v34
    v_max3_f32 v233, v35, v36, v37
    v_max3_f32 v230, v230, v6, v7
    v_max3_f32 v232, v232, v8, v9
    v_max3_f32 v231, v231, v38, v39
    v_max3_f32 v233, v233, v40, v41
    v_max3_f32 v230, v230, v10, v11
    v_max3_f32 v232, v232, v12, v13
    v_max3_f32 v231, v231, v42, v43
    v_max3_f32 v233, v233, v44, v45
    v_max3_f32 v230, v230, v14, v15
    v_max3_f32 v231, v231, v46, v47
    v_max_f32 v230, v230, v232
    v_max_f32 v231, v231, v233
    v_mov_b32 v232, v230
    v_mov_b32 v233, v231
    s_nop 0
    v_permlane32_swap_b32 v232, v230
    v_permlane32_swap_b32 v233, v231
    v_max_f32 v230, v230, v232
    v_max_f32 v231, v231, v233
    v_sub_f32 v232, 0, v230
    v_sub_f32 v234, 0, v231
    v_sub_f32 v233, 0, v230
    v_sub_f32 v235, 0, v231
    v_pk_add_f32 v[0:1], v[0:1], v[232:233]
    v_pk_add_f32 v[2:3], v[2:3], v[232:233]
    v_pk_add_f32 v[4:5], v[4:5], v[232:233]
    v_pk_add_f32 v[6:7], v[6:7], v[232:233]
    v_pk_add_f32 v[8:9], v[8:9], v[232:233]
    v_pk_add_f32 v[10:11], v[10:11], v[232:233]
    v_pk_add_f32 v[12:13], v[12:13], v[232:233]
    v_pk_add_f32 v[14:15], v[14:15], v[232:233]
    v_pk_add_f32 v[32:33], v[32:33], v[234:235]
    v_pk_add_f32 v[34:35], v[34:35], v[234:235]
    v_pk_add_f32 v[36:37], v[36:37], v[234:235]
    v_pk_add_f32 v[38:39], v[38:39], v[234:235]
    v_pk_add_f32 v[40:41], v[40:41], v[234:235]
    v_pk_add_f32 v[42:43], v[42:43], v[234:235]
    v_pk_add_f32 v[44:45], v[44:45], v[234:235]
    v_pk_add_f32 v[46:47], v[46:47], v[234:235]
    v_mov_b64 v[208:209], v[234:235]
    v_mov_b64 v[210:211], v[234:235]
    v_mov_b64 v[212:213], v[234:235]
    v_mov_b64 v[214:215], v[234:235]
    v_mov_b64 v[216:217], v[234:235]
    v_mov_b64 v[218:219], v[234:235]
    v_mov_b64 v[220:221], v[234:235]
    v_mov_b64 v[222:223], v[234:235]
    v_mov_b32 v235, v232
    v_cndmask_b32 v232, v235, v229, s[48:49]
    v_cndmask_b32 v233, v235, v229, s[4:5]
    v_cndmask_b32 v192, v233, v232, s[16:17]
    v_cndmask_b32 v193, v233, v232, s[18:19]
    v_cndmask_b32 v194, v233, v232, s[20:21]
    v_cndmask_b32 v195, v233, v232, s[22:23]
    v_cndmask_b32 v196, v233, v232, s[24:25]
    v_cndmask_b32 v197, v233, v232, s[26:27]
    v_cndmask_b32 v198, v233, v232, s[28:29]
    v_cndmask_b32 v199, v233, v232, s[30:31]
    v_cndmask_b32 v200, v233, v232, s[32:33]
    v_cndmask_b32 v201, v233, v232, s[34:35]
    v_cndmask_b32 v202, v233, v232, s[36:37]
    v_cndmask_b32 v203, v233, v232, s[38:39]
    v_cndmask_b32 v204, v233, v232, s[40:41]
    v_cndmask_b32 v205, v233, v232, s[42:43]
    v_cndmask_b32 v206, v233, v232, s[44:45]
    v_cndmask_b32 v207, v233, v232, s[46:47]
    v_exp_f32 v0, v0
    v_exp_f32 v32, v32
    v_exp_f32 v1, v1
    v_exp_f32 v33, v33
    v_add_f32 v225, v225, v0
    v_add_f32 v226, v226, v32
    v_exp_f32 v2, v2
    v_exp_f32 v34, v34
    v_add_f32 v225, v225, v1
    v_add_f32 v226, v226, v33
    v_cvt_pk_bf16_f32 v0, v0, v1
    v_cvt_pk_bf16_f32 v32, v32, v33
    v_exp_f32 v3, v3
    v_exp_f32 v35, v35
    v_add_f32 v225, v225, v2
    v_add_f32 v226, v226, v34
    v_exp_f32 v4, v4
    v_exp_f32 v36, v36
    v_add_f32 v225, v225, v3
    v_add_f32 v226, v226, v35
    v_cvt_pk_bf16_f32 v1, v2, v3
    v_cvt_pk_bf16_f32 v33, v34, v35
    v_exp_f32 v5, v5
    v_exp_f32 v37, v37
    v_add_f32 v225, v225, v4
    v_add_f32 v226, v226, v36
    s_waitcnt lgkmcnt(5)
    v_mfma_f32_32x32x16_bf16 v[16:31], a[64:67], a[0:3], v[192:207]
    v_exp_f32 v6, v6
    v_exp_f32 v38, v38
    v_add_f32 v225, v225, v5
    v_add_f32 v226, v226, v37
    v_mfma_f32_32x32x16_bf16 v[48:63], a[64:67], a[32:35], v[208:223]
    s_waitcnt lgkmcnt(4)
    s_waitcnt vmcnt(17)
    s_barrier
    ds_read_b128 a[88:91], v228 offset:14336
    v_cvt_pk_bf16_f32 v2, v4, v5
    v_mfma_f32_32x32x16_bf16 v[16:31], a[68:71], a[4:7], v[16:31]
    v_cvt_pk_bf16_f32 v34, v36, v37
    v_exp_f32 v7, v7
    v_exp_f32 v39, v39
    v_add_f32 v225, v225, v6
    v_mfma_f32_32x32x16_bf16 v[48:63], a[68:71], a[36:39], v[48:63]
    s_waitcnt lgkmcnt(4)
    ds_read_b128 a[92:95], v228 offset:15360
    v_add_f32 v226, v226, v38
    v_exp_f32 v8, v8
    v_exp_f32 v40, v40
    v_mfma_f32_32x32x16_bf16 v[16:31], a[72:75], a[8:11], v[16:31]
    s_add_u32 m0, s55, 32768
    s_add_u32 s63, s54, 33792
    v_add_f32 v225, v225, v7
    v_add_f32 v226, v226, v39
    v_cvt_pk_bf16_f32 v3, v6, v7
    v_cvt_pk_bf16_f32 v35, v38, v39
    v_mfma_f32_32x32x16_bf16 v[48:63], a[72:75], a[40:43], v[48:63]
    s_waitcnt lgkmcnt(4)
    ds_read_b128 a[64:67], v228 offset:16384
    v_exp_f32 v9, v9
    v_exp_f32 v41, v41
    v_add_f32 v225, v225, v8
    v_mfma_f32_32x32x16_bf16 v[16:31], a[76:79], a[12:15], v[16:31]
    buffer_load_dwordx4 v224, s[12:15], s63 offen offset:0 sc1 lds
    v_add_f32 v226, v226, v40
    v_exp_f32 v10, v10
    v_mfma_f32_32x32x16_bf16 v[48:63], a[76:79], a[44:47], v[48:63]
    s_waitcnt lgkmcnt(4)
    ds_read_b128 a[68:71], v228 offset:17408
    v_exp_f32 v42, v42
    v_add_f32 v225, v225, v9
    v_add_f32 v226, v226, v41
    v_cvt_pk_bf16_f32 v8, v8, v9
    v_mfma_f32_32x32x16_bf16 v[16:31], a[80:83], a[16:19], v[16:31]
    s_cmp_le_u32 s7, 2
    v_cvt_pk_bf16_f32 v40, v40, v41
    v_exp_f32 v11, v11
    v_exp_f32 v43, v43
    v_add_f32 v225, v225, v10
    v_mfma_f32_32x32x16_bf16 v[48:63], a[80:83], a[48:51], v[48:63]
    s_waitcnt lgkmcnt(4)
    ds_read_b128 a[72:75], v228 offset:18432
    v_add_f32 v226, v226, v42
    v_exp_f32 v12, v12
    v_exp_f32 v44, v44
    v_mfma_f32_32x32x16_bf16 v[16:31], a[84:87], a[20:23], v[16:31]
    s_cselect_b64 s[48:49], -1, 0
    v_add_f32 v225, v225, v11
    v_add_f32 v226, v226, v43
    v_cvt_pk_bf16_f32 v9, v10, v11
    v_cvt_pk_bf16_f32 v41, v42, v43
    v_exp_f32 v13, v13
    v_mfma_f32_32x32x16_bf16 v[48:63], a[84:87], a[52:55], v[48:63]
    s_waitcnt lgkmcnt(4)
    ds_read_b128 a[76:79], v228 offset:19456
    v_exp_f32 v45, v45
    v_add_f32 v225, v225, v12
    v_add_f32 v226, v226, v44
    v_mfma_f32_32x32x16_bf16 v[16:31], a[88:91], a[24:27], v[16:31]
    s_cmp_lt_u32 s7, 2
    buffer_load_dwordx4 v224, s[12:15], s63 offen offset:1024 sc1 lds
    v_exp_f32 v14, v14
    v_exp_f32 v46, v46
    v_mfma_f32_32x32x16_bf16 v[48:63], a[88:91], a[56:59], v[48:63]
    s_waitcnt lgkmcnt(4)
    ds_read_b128 a[80:83], v228 offset:20480
    v_add_f32 v225, v225, v13
    v_add_f32 v226, v226, v45
    v_cvt_pk_bf16_f32 v10, v12, v13
    v_cvt_pk_bf16_f32 v42, v44, v45
    v_mfma_f32_32x32x16_bf16 v[16:31], a[92:95], a[28:31], v[16:31]
    s_cselect_b64 s[4:5], -1, 0
    v_exp_f32 v15, v15
    v_exp_f32 v47, v47
    v_add_f32 v225, v225, v14
    v_add_f32 v226, v226, v46
    v_mfma_f32_32x32x16_bf16 v[48:63], a[92:95], a[60:63], v[48:63]
    s_waitcnt lgkmcnt(4)
    ds_read_b128 a[84:87], v228 offset:21504
    v_add_f32 v225, v225, v15
    v_add_f32 v226, v226, v47
    v_cvt_pk_bf16_f32 v11, v14, v15
    v_cvt_pk_bf16_f32 v43, v46, v47
    v_mfma_f32_32x32x16_bf16 v[64:79], a[64:67], v[0:3], 0
    v_cndmask_b32 v232, v235, v229, s[48:49]
    v_cndmask_b32 v233, v235, v229, s[4:5]
    v_cndmask_b32 v192, v233, v232, s[16:17]
    v_cndmask_b32 v193, v233, v232, s[18:19]
    v_cndmask_b32 v194, v233, v232, s[20:21]
    v_cndmask_b32 v195, v233, v232, s[22:23]
    v_mfma_f32_32x32x16_bf16 v[128:143], a[64:67], v[32:35], 0
    s_waitcnt lgkmcnt(4)
    ds_read_b128 a[88:91], v228 offset:22528
    v_cndmask_b32 v196, v233, v232, s[24:25]
    v_cndmask_b32 v197, v233, v232, s[26:27]
    v_cndmask_b32 v198, v233, v232, s[28:29]
    v_cndmask_b32 v199, v233, v232, s[30:31]
    v_cndmask_b32 v200, v233, v232, s[32:33]
    v_mfma_f32_32x32x16_bf16 v[80:95], a[68:71], v[0:3], 0
    s_waitcnt vmcnt(7)
    ds_read_b64_tr_b16 a[128:129], v250 offset:0
    v_exp_f32 v16, v16
    v_exp_f32 v48, v48
    v_cndmask_b32 v201, v233, v232, s[34:35]
    v_mfma_f32_32x32x16_bf16 v[144:159], a[68:71], v[32:35], 0
    s_waitcnt lgkmcnt(5)
    ds_read_b128 a[92:95], v228 offset:23552
    ds_read_b64_tr_b16 a[130:131], v250 offset:2048
    v_exp_f32 v17, v17
    v_exp_f32 v49, v49
    v_mfma_f32_32x32x16_bf16 v[96:111], a[72:75], v[0:3], 0
    ds_read_b64_tr_b16 a[132:133], v250 offset:64
    v_add_f32 v225, v225, v16
    v_add_f32 v226, v226, v48
    v_exp_f32 v18, v18
    v_cndmask_b32 v202, v233, v232, s[36:37]
    v_mfma_f32_32x32x16_bf16 v[160:175], a[72:75], v[32:35], 0
    s_waitcnt lgkmcnt(7)
    ds_read_b128 a[64:67], v228 offset:32768
    ds_read_b64_tr_b16 a[134:135], v250 offset:2112
    v_exp_f32 v50, v50
    v_add_f32 v225, v225, v17
    v_add_f32 v226, v226, v49
    v_mfma_f32_32x32x16_bf16 v[112:127], a[76:79], v[0:3], 0
    ds_read_b64_tr_b16 a[136:137], v250 offset:128
    s_waitcnt lgkmcnt(4)
    buffer_store_dwordx4 a[128:131], v224, s[8:11], s85 offen sc1
    s_add_u32 s85, s85, 278528
    v_cvt_pk_bf16_f32 v16, v16, v17
    v_mfma_f32_32x32x16_bf16 v[176:191], a[76:79], v[32:35], 0
    ds_read_b128 a[68:71], v228 offset:33792
    ds_read_b64_tr_b16 a[138:139], v250 offset:2176
    v_cvt_pk_bf16_f32 v48, v48, v49
    v_exp_f32 v19, v19
    v_cndmask_b32 v203, v233, v232, s[38:39]
    v_mfma_f32_32x32x16_bf16 v[64:79], a[80:83], v[8:11], v[64:79]
    buffer_load_dwordx4 v224, s[12:15], s63 offen offset:2048 sc1 lds
    ds_read_b64_tr_b16 a[140:141], v250 offset:192
    v_exp_f32 v51, v51
    v_add_f32 v225, v225, v18
    v_mfma_f32_32x32x16_bf16 v[128:143], a[80:83], v[40:43], v[128:143]
    ds_read_b128 a[72:75], v228 offset:34816
    ds_read_b64_tr_b16 a[142:143], v250 offset:2240
    s_waitcnt lgkmcnt(6)
    buffer_store_dwordx4 a[132:135], v224, s[8:11], s85 offen sc1
    s_add_u32 s85, s85, 278528
    v_mfma_f32_32x32x16_bf16 v[80:95], a[84:87], v[8:11], v[80:95]
    v_add_f32 v226, v226, v50
    v_exp_f32 v20, v20
    v_exp_f32 v52, v52
    v_add_f32 v225, v225, v19
    v_mfma_f32_32x32x16_bf16 v[144:159], a[84:87], v[40:43], v[144:159]
    ds_read_b128 a[76:79], v228 offset:35840
    s_waitcnt lgkmcnt(4)
    buffer_store_dwordx4 a[136:139], v224, s[8:11], s85 offen sc1
    s_add_u32 s85, s85, 278528
    v_add_f32 v226, v226, v51
    v_mfma_f32_32x32x16_bf16 v[96:111], a[88:91], v[8:11], v[96:111]
    buffer_load_dwordx4 v224, s[12:15], s63 offen offset:3072 sc1 lds
    v_cvt_pk_bf16_f32 v17, v18, v19
    v_cvt_pk_bf16_f32 v49, v50, v51
    v_exp_f32 v21, v21
    v_mfma_f32_32x32x16_bf16 v[160:175], a[88:91], v[40:43], v[160:175]
    ds_read_b128 a[80:83], v228 offset:36864
    v_exp_f32 v53, v53
    v_add_f32 v225, v225, v20
    v_add_f32 v226, v226, v52
    v_cndmask_b32 v204, v233, v232, s[40:41]
    v_mfma_f32_32x32x16_bf16 v[112:127], a[92:95], v[8:11], v[112:127]
    s_waitcnt lgkmcnt(2)
    buffer_store_dwordx4 a[140:143], v224, s[8:11], s85 offen sc1
    v_cndmask_b32 v205, v233, v232, s[42:43]
    v_cndmask_b32 v206, v233, v232, s[44:45]
    v_cndmask_b32 v207, v233, v232, s[46:47]
    v_mfma_f32_32x32x16_bf16 v[176:191], a[92:95], v[40:43], v[176:191]
    ds_read_b128 a[84:87], v228 offset:37888
    v_mfma_f32_32x32x16_bf16 v[0:15], a[64:67], a[0:3], v[192:207]
    s_add_u32 m0, s55, 36864
    s_add_u32 s63, s54, 37888
    v_exp_f32 v22, v22
    v_exp_f32 v54, v54
    v_add_f32 v225, v225, v21
    v_mfma_f32_32x32x16_bf16 v[32:47], a[64:67], a[32:35], v[208:223]
    ds_read_b128 a[88:91], v228 offset:38912
    v_add_f32 v226, v226, v53
    v_cvt_pk_bf16_f32 v18, v20, v21
    v_cvt_pk_bf16_f32 v50, v52, v53
    v_exp_f32 v23, v23
    v_mfma_f32_32x32x16_bf16 v[0:15], a[68:71], a[4:7], v[0:15]
    buffer_load_dwordx4 v224, s[12:15], s63 offen offset:0 sc1 lds
    v_exp_f32 v55, v55
    v_add_f32 v225, v225, v22
    v_add_f32 v226, v226, v54
    v_mfma_f32_32x32x16_bf16 v[32:47], a[68:71], a[36:39], v[32:47]
    ds_read_b128 a[92:95], v228 offset:39936
    v_exp_f32 v24, v24
    v_exp_f32 v56, v56
    v_add_f32 v225, v225, v23
    v_mfma_f32_32x32x16_bf16 v[0:15], a[72:75], a[8:11], v[0:15]
    s_waitcnt vmcnt(10)
    s_mov_b32 s88, s52
    s_mov_b32 s89, s53
    ds_read_b64_tr_b16 a[144:145], v251 offset:4096
    v_add_f32 v226, v226, v55
    v_cvt_pk_bf16_f32 v19, v22, v23
    v_cvt_pk_bf16_f32 v51, v54, v55
    v_mfma_f32_32x32x16_bf16 v[32:47], a[72:75], a[40:43], v[32:47]
    s_waitcnt lgkmcnt(5)
    ds_read_b128 a[64:67], v228 offset:24576
    ds_read_b64_tr_b16 a[146:147], v251 offset:4352
    v_exp_f32 v25, v25
    v_exp_f32 v57, v57
    v_mfma_f32_32x32x16_bf16 v[0:15], a[76:79], a[12:15], v[0:15]
    ds_read_b64_tr_b16 a[148:149], v251 offset:4608
    v_add_f32 v225, v225, v24
    v_add_f32 v226, v226, v56
    v_exp_f32 v26, v26
    v_mfma_f32_32x32x16_bf16 v[32:47], a[76:79], a[44:47], v[32:47]
    s_waitcnt lgkmcnt(7)
    ds_read_b128 a[68:71], v228 offset:25600
    ds_read_b64_tr_b16 a[150:151], v251 offset:4864
    v_exp_f32 v58, v58
    v_add_f32 v225, v225, v25
    v_add_f32 v226, v226, v57
    v_mfma_f32_32x32x16_bf16 v[0:15], a[80:83], a[16:19], v[0:15]
    s_cmp_le_u32 s7, 3
    buffer_load_dwordx4 v224, s[12:15], s63 offen offset:1024 sc1 lds
    ds_read_b64_tr_b16 a[152:153], v251 offset:5120
    v_cvt_pk_bf16_f32 v24, v24, v25
    v_cvt_pk_bf16_f32 v56, v56, v57
    v_mfma_f32_32x32x16_bf16 v[32:47], a[80:83], a[48:51], v[32:47]
    s_waitcnt lgkmcnt(9)
    ds_read_b128 a[72:75], v228 offset:26624
    ds_read_b64_tr_b16 a[154:155], v251 offset:5376
    v_exp_f32 v27, v27
    v_exp_f32 v59, v59
    v_mfma_f32_32x32x16_bf16 v[0:15], a[84:87], a[20:23], v[0:15]
    s_cselect_b64 s[48:49], -1, 0
    ds_read_b64_tr_b16 a[156:157], v251 offset:5632
    v_add_f32 v225, v225, v26
    v_add_f32 v226, v226, v58
    v_exp_f32 v28, v28
    v_mfma_f32_32x32x16_bf16 v[32:47], a[84:87], a[52:55], v[32:47]
    s_waitcnt lgkmcnt(11)
    ds_read_b128 a[76:79], v228 offset:27648
    ds_read_b64_tr_b16 a[158:159], v251 offset:5888
    s_waitcnt lgkmcnt(9)
    buffer_store_dwordx4 a[144:147], v224, s[8:11], s92 offen sc1
    s_add_u32 s92, s92, s93
    v_mfma_f32_32x32x16_bf16 v[0:15], a[88:91], a[24:27], v[0:15]
    s_cmp_lt_u32 s7, 3
    v_exp_f32 v60, v60
    v_add_f32 v225, v225, v27
    v_add_f32 v226, v226, v59
    v_cvt_pk_bf16_f32 v25, v26, v27
    v_cvt_pk_bf16_f32 v57, v58, v59
    v_mfma_f32_32x32x16_bf16 v[32:47], a[88:91], a[56:59], v[32:47]
    ds_read_b128 a[80:83], v228 offset:28672
    v_exp_f32 v29, v29
    v_exp_f32 v61, v61
    v_add_f32 v225, v225, v28
    v_mfma_f32_32x32x16_bf16 v[0:15], a[92:95], a[28:31], v[0:15]
    s_cselect_b64 s[4:5], -1, 0
    buffer_load_dwordx4 v224, s[12:15], s63 offen offset:2048 sc1 lds
    v_add_f32 v226, v226, v60
    v_exp_f32 v30, v30
    v_mfma_f32_32x32x16_bf16 v[32:47], a[92:95], a[60:63], v[32:47]
    ds_read_b128 a[84:87], v228 offset:29696
    v_exp_f32 v62, v62
    v_add_f32 v225, v225, v29
    v_add_f32 v226, v226, v61
    v_cvt_pk_bf16_f32 v26, v28, v29
    v_mfma_f32_32x32x16_bf16 v[64:79], a[64:67], v[16:19], v[64:79]
    v_mov_b32 v236, 0x3f803f80
    v_cvt_pk_bf16_f32 v58, v60, v61
    v_exp_f32 v31, v31
    v_exp_f32 v63, v63
    v_mfma_f32_32x32x16_bf16 v[128:143], a[64:67], v[48:51], v[128:143]
    s_waitcnt lgkmcnt(9)
    ds_read_b128 a[88:91], v228 offset:30720
    v_add_f32 v225, v225, v30
    v_add_f32 v226, v226, v62
    v_add_f32 v225, v225, v31
    v_add_f32 v226, v226, v63
    v_cvt_pk_bf16_f32 v27, v30, v31
    v_mfma_f32_32x32x16_bf16 v[80:95], a[68:71], v[16:19], v[80:95]
    s_waitcnt lgkmcnt(9)
    buffer_store_dwordx4 a[148:151], v224, s[8:11], s92 offen sc1
    s_add_u32 s92, s92, s93
    v_mov_b32 v237, 0x3f803f80
    v_cvt_pk_bf16_f32 v59, v62, v63
    v_cndmask_b32 v232, v235, v229, s[48:49]
    v_mfma_f32_32x32x16_bf16 v[144:159], a[68:71], v[48:51], v[144:159]
    s_waitcnt lgkmcnt(7)
    ds_read_b128 a[92:95], v228 offset:31744
    v_exp_f32 v0, v0
    v_exp_f32 v32, v32
    v_cndmask_b32 v233, v235, v229, s[4:5]
    v_mfma_f32_32x32x16_bf16 v[96:111], a[72:75], v[16:19], v[96:111]
    s_and_b32 s52, s2, 7
    v_mov_b32 v238, 0x3f803f80
    v_exp_f32 v1, v1
    v_exp_f32 v33, v33
    v_add_f32 v225, v225, v0
    v_mfma_f32_32x32x16_bf16 v[160:175], a[72:75], v[48:51], v[160:175]
    s_waitcnt lgkmcnt(5)
    ds_read_b128 a[64:67], v228 offset:40960
    v_add_f32 v226, v226, v32
    v_exp_f32 v2, v2
    v_exp_f32 v34, v34
    v_mfma_f32_32x32x16_bf16 v[112:127], a[76:79], v[16:19], v[112:127]
    s_lshl_b32 s52, s52, 5
    buffer_load_dwordx4 v224, s[12:15], s63 offen offset:3072 sc1 lds
    v_mov_b32 v239, 0x3f803f80
    v_add_f32 v225, v225, v1
    v_add_f32 v226, v226, v33
    v_cvt_pk_bf16_f32 v0, v0, v1
    v_mfma_f32_32x32x16_bf16 v[176:191], a[76:79], v[48:51], v[176:191]
    s_waitcnt lgkmcnt(4)
    ds_read_b128 a[68:71], v228 offset:41984
    v_cvt_pk_bf16_f32 v32, v32, v33
    v_exp_f32 v3, v3
    v_exp_f32 v35, v35
    v_mfma_f32_32x32x16_bf16 v[64:79], a[80:83], v[24:27], v[64:79]
    s_add_u32 s54, s54, 67584
    s_mov_b32 m0, s97
    s_mov_b32 s87, s101
    buffer_load_dwordx4 v248, s[88:91], s87 offen offset:0 nt lds
    v_add_f32 v225, v225, v2
    v_add_f32 v226, v226, v34
    v_mfma_f32_32x32x16_bf16 v[128:143], a[80:83], v[56:59], v[128:143]
    s_waitcnt lgkmcnt(4)
    ds_read_b128 a[72:75], v228 offset:43008
    v_exp_f32 v4, v4
    v_exp_f32 v36, v36
    v_add_f32 v225, v225, v3
    v_mfma_f32_32x32x16_bf16 v[80:95], a[84:87], v[24:27], v[80:95]
    s_xor_b32 s55, s55, 0x10000
    s_add_u32 s87, s87, 3072
    buffer_load_dwordx4 v248, s[88:91], s87 offen offset:1024 nt lds
    v_add_f32 v226, v226, v35
    v_cvt_pk_bf16_f32 v1, v2, v3
    v_cvt_pk_bf16_f32 v33, v34, v35
    v_cndmask_b32 v192, v233, v232, s[16:17]
    v_mfma_f32_32x32x16_bf16 v[144:159], a[84:87], v[56:59], v[144:159]
    s_waitcnt lgkmcnt(4)
    ds_read_b128 a[76:79], v228 offset:44032
    v_exp_f32 v5, v5
    v_exp_f32 v37, v37
    v_add_f32 v225, v225, v4
    v_cndmask_b32 v193, v233, v232, s[18:19]
    v_mfma_f32_32x32x16_bf16 v[96:111], a[88:91], v[24:27], v[96:111]
    s_add_u32 s87, s87, 3072
    buffer_load_dwordx4 v248, s[88:91], s87 offen offset:2048 nt lds
    v_add_f32 v226, v226, v36
    v_cndmask_b32 v194, v233, v232, s[20:21]
    v_cndmask_b32 v195, v233, v232, s[22:23]
    v_cndmask_b32 v196, v233, v232, s[24:25]
    v_cndmask_b32 v197, v233, v232, s[26:27]
    v_mfma_f32_32x32x16_bf16 v[160:175], a[88:91], v[56:59], v[160:175]
    s_waitcnt lgkmcnt(4)
    ds_read_b128 a[80:83], v228 offset:45056
    s_add_u32 s87, s87, 3072
    buffer_load_dwordx4 v248, s[88:91], s87 offen offset:3072 nt lds
    v_cndmask_b32 v198, v233, v232, s[28:29]
    v_cndmask_b32 v199, v233, v232, s[30:31]
    v_cndmask_b32 v200, v233, v232, s[32:33]
    v_mfma_f32_32x32x16_bf16 v[112:127], a[92:95], v[24:27], v[112:127]
    s_lshr_b32 s53, s2, 3
    v_cndmask_b32 v201, v233, v232, s[34:35]
    v_cndmask_b32 v202, v233, v232, s[36:37]
    v_cndmask_b32 v203, v233, v232, s[38:39]
    v_cndmask_b32 v204, v233, v232, s[40:41]
    v_cndmask_b32 v205, v233, v232, s[42:43]
    v_cndmask_b32 v206, v233, v232, s[44:45]
    v_cndmask_b32 v207, v233, v232, s[46:47]
    v_mfma_f32_32x32x16_bf16 v[176:191], a[92:95], v[56:59], v[176:191]
    s_waitcnt lgkmcnt(4)
    s_barrier
    ds_read_b128 a[84:87], v228 offset:46080
    v_mfma_f32_32x32x16_bf16 v[16:31], a[64:67], a[0:3], v[192:207]
    v_mfma_f32_32x32x16_bf16 a[160:175], v[236:239], a[144:147], 0
    v_exp_f32 v6, v6
    v_exp_f32 v38, v38
    v_add_f32 v225, v225, v5
    v_mfma_f32_32x32x16_bf16 v[48:63], a[64:67], a[32:35], v[208:223]
    s_waitcnt lgkmcnt(4)
    ds_read_b128 a[88:91], v228 offset:47104
    v_add_f32 v226, v226, v37
    v_cvt_pk_bf16_f32 v2, v4, v5
    v_cvt_pk_bf16_f32 v34, v36, v37
    v_exp_f32 v7, v7
    v_mfma_f32_32x32x16_bf16 v[16:31], a[68:71], a[4:7], v[16:31]
    s_mov_b32 m0, s55
    v_mfma_f32_32x32x16_bf16 a[160:175], v[236:239], a[148:151], a[160:175]
    v_exp_f32 v39, v39
    v_add_f32 v225, v225, v6
    v_add_f32 v226, v226, v38
    v_mfma_f32_32x32x16_bf16 v[48:63], a[68:71], a[36:39], v[48:63]
    s_waitcnt lgkmcnt(4)
    ds_read_b128 a[92:95], v228 offset:48128
    v_exp_f32 v8, v8
    v_exp_f32 v40, v40
    v_add_f32 v225, v225, v7
    v_mfma_f32_32x32x16_bf16 v[16:31], a[72:75], a[8:11], v[16:31]
    buffer_load_dwordx4 v224, s[12:15], s54 offen offset:0 sc1 lds
    v_mfma_f32_32x32x16_bf16 a[160:175], v[236:239], a[152:155], a[160:175]
    v_add_f32 v226, v226, v39
    v_cvt_pk_bf16_f32 v3, v6, v7
    v_mfma_f32_32x32x16_bf16 v[48:63], a[72:75], a[40:43], v[48:63]
    s_waitcnt lgkmcnt(4)
    ds_read_b128 a[64:67], v228 offset:49152
    v_cvt_pk_bf16_f32 v35, v38, v39
    v_exp_f32 v9, v9
    v_exp_f32 v41, v41
    v_mfma_f32_32x32x16_bf16 v[16:31], a[76:79], a[12:15], v[16:31]
    v_mfma_f32_32x32x16_bf16 a[160:175], v[236:239], a[156:159], a[160:175]
    v_add_f32 v225, v225, v8
    v_add_f32 v226, v226, v40
    v_exp_f32 v10, v10
    v_mfma_f32_32x32x16_bf16 v[48:63], a[76:79], a[44:47], v[48:63]
    s_waitcnt lgkmcnt(4)
    ds_read_b128 a[68:71], v228 offset:50176
    buffer_store_dwordx4 a[152:155], v224, s[8:11], s92 offen sc1
    s_add_u32 s92, s92, s93
    v_mfma_f32_32x32x16_bf16 v[16:31], a[80:83], a[16:19], v[16:31]
    s_add_u32 s52, s52, s53
    v_exp_f32 v42, v42
    v_add_f32 v225, v225, v9
    v_add_f32 v226, v226, v41
    v_cvt_pk_bf16_f32 v8, v8, v9
    v_cvt_pk_bf16_f32 v40, v40, v41
    v_mfma_f32_32x32x16_bf16 v[48:63], a[80:83], a[48:51], v[48:63]
    s_waitcnt lgkmcnt(4)
    ds_read_b128 a[72:75], v228 offset:51200
    v_exp_f32 v11, v11
    v_exp_f32 v43, v43
    v_add_f32 v225, v225, v10
    v_mfma_f32_32x32x16_bf16 v[16:31], a[84:87], a[20:23], v[16:31]
    s_lshl_b32 s52, s52, 2
    buffer_load_dwordx4 v224, s[12:15], s54 offen offset:1024 sc1 lds
    v_add_f32 v226, v226, v42
    v_exp_f32 v12, v12
    v_mfma_f32_32x32x16_bf16 v[48:63], a[84:87], a[52:55], v[48:63]
    s_waitcnt lgkmcnt(4)
    ds_read_b128 a[76:79], v228 offset:52224
    v_accvgpr_read_b32 v232, a160
    v_exp_f32 v44, v44
    v_add_f32 v225, v225, v11
    v_add_f32 v226, v226, v43
    v_mfma_f32_32x32x16_bf16 v[16:31], a[88:91], a[24:27], v[16:31]
    s_add_u32 s52, s52, s71
    v_cvt_pk_bf16_f32 v233, v232, v232
    v_cvt_pk_bf16_f32 v9, v10, v11
    v_cvt_pk_bf16_f32 v41, v42, v43
    v_exp_f32 v13, v13
    v_mfma_f32_32x32x16_bf16 v[48:63], a[88:91], a[56:59], v[48:63]
    s_waitcnt lgkmcnt(4)
    ds_read_b128 a[80:83], v228 offset:53248
    v_lshlrev_b32 v233, 16, v233
    v_exp_f32 v45, v45
    v_add_f32 v225, v225, v12
    v_add_f32 v226, v226, v44
    v_mfma_f32_32x32x16_bf16 v[16:31], a[92:95], a[28:31], v[16:31]
    s_lshl_b32 s52, s52, 13
    v_exp_f32 v14, v14
    v_exp_f32 v46, v46
    v_add_f32 v225, v225, v13
    v_add_f32 v226, v226, v45
    v_mfma_f32_32x32x16_bf16 v[48:63], a[92:95], a[60:63], v[48:63]
    s_waitcnt lgkmcnt(4)
    ds_read_b128 a[84:87], v228 offset:54272
    v_sub_f32 v233, v232, v233
    v_cvt_pk_bf16_f32 v10, v12, v13
    v_cvt_pk_bf16_f32 v42, v44, v45
    v_exp_f32 v15, v15
    v_mfma_f32_32x32x16_bf16 v[64:79], a[64:67], v[0:3], v[64:79]
    buffer_store_dwordx4 a[156:159], v224, s[8:11], s92 offen sc1
    v_exp_f32 v47, v47
    v_add_f32 v225, v225, v14
    v_add_f32 v226, v226, v46
    v_mfma_f32_32x32x16_bf16 v[128:143], a[64:67], v[32:35], v[128:143]
    s_waitcnt lgkmcnt(4)
    ds_read_b128 a[88:91], v228 offset:55296
    v_cvt_pk_bf16_f32 v232, v232, v233
    v_add_f32 v225, v225, v15
    v_add_f32 v226, v226, v47
    v_cvt_pk_bf16_f32 v11, v14, v15
    v_cvt_pk_bf16_f32 v43, v46, v47
    v_mfma_f32_32x32x16_bf16 v[80:95], a[68:71], v[0:3], v[80:95]
    s_add_u32 s52, s52, 0x5000000
    v_and_b32 v233, 0x1ff, v224
    v_exp_f32 v16, v16
    v_exp_f32 v48, v48
    v_mfma_f32_32x32x16_bf16 v[144:159], a[68:71], v[32:35], v[144:159]
    s_waitcnt lgkmcnt(4)
    ds_read_b128 a[92:95], v228 offset:56320
    v_exp_f32 v17, v17
    v_exp_f32 v49, v49
    v_mfma_f32_32x32x16_bf16 v[96:111], a[72:75], v[0:3], v[96:111]
    v_add_f32 v225, v225, v16
    v_add_f32 v226, v226, v48
    v_exp_f32 v18, v18
    v_mfma_f32_32x32x16_bf16 v[160:175], a[72:75], v[32:35], v[160:175]
    s_waitcnt lgkmcnt(4)
    ds_read_b128 a[64:67], v227 offset:0
    v_exp_f32 v50, v50
    v_add_f32 v225, v225, v17
    v_add_f32 v226, v226, v49
    v_mfma_f32_32x32x16_bf16 v[112:127], a[76:79], v[0:3], v[112:127]
    buffer_load_dwordx4 v224, s[12:15], s54 offen offset:2048 sc1 lds
    v_cvt_pk_bf16_f32 v16, v16, v17
    v_cvt_pk_bf16_f32 v48, v48, v49
    v_mfma_f32_32x32x16_bf16 v[176:191], a[76:79], v[32:35], v[176:191]
    s_waitcnt lgkmcnt(4)
    ds_read_b128 a[68:71], v227 offset:1024
    v_exp_f32 v19, v19
    v_exp_f32 v51, v51
    v_mfma_f32_32x32x16_bf16 v[64:79], a[80:83], v[8:11], v[64:79]
    buffer_store_dword v232, v233, s[8:11], s94 offen sc1
    v_add_f32 v225, v225, v18
    v_add_f32 v226, v226, v50
    v_mfma_f32_32x32x16_bf16 v[128:143], a[80:83], v[40:43], v[128:143]
    s_waitcnt lgkmcnt(4)
    s_mov_b32 s61, 2
    ds_read_b128 a[72:75], v227 offset:2048
    v_exp_f32 v20, v20
    v_mfma_f32_32x32x16_bf16 v[80:95], a[84:87], v[8:11], v[80:95]
    buffer_load_dwordx4 v224, s[12:15], s54 offen offset:3072 sc1 lds
    v_exp_f32 v52, v52
    v_add_f32 v225, v225, v19
    v_mfma_f32_32x32x16_bf16 v[144:159], a[84:87], v[40:43], v[144:159]
    s_waitcnt lgkmcnt(4)
    ds_read_b128 a[76:79], v227 offset:3072
    v_add_f32 v226, v226, v51
    v_cvt_pk_bf16_f32 v17, v18, v19
    v_cvt_pk_bf16_f32 v49, v50, v51
    v_mfma_f32_32x32x16_bf16 v[96:111], a[88:91], v[8:11], v[96:111]
    ds_read_b128 a[84:87], v227 offset:5120
    v_xor_b32 v228, 0x10000, v228
    v_exp_f32 v21, v21
    v_mfma_f32_32x32x16_bf16 v[160:175], a[88:91], v[40:43], v[160:175]
    s_waitcnt lgkmcnt(5)
    ds_read_b128 a[80:83], v227 offset:4096
    v_exp_f32 v53, v53
    v_add_f32 v225, v225, v20
    v_add_f32 v226, v226, v52
    v_mfma_f32_32x32x16_bf16 v[112:127], a[92:95], v[8:11], v[112:127]
    v_xor_b32 v227, 0x10000, v227
    v_mfma_f32_32x32x16_bf16 v[176:191], a[92:95], v[40:43], v[176:191]
    s_waitcnt lgkmcnt(5)
    s_cmp_eq_u32 s74, 0
    s_cbranch_scc1 L_dA_sequential_preLN__compressed_kv_cla__geglu_ffn__prompt_kernel
    s_cmp_eq_u32 s74, 1
    s_cbranch_scc1 L_Q_sequential_preLN__compressed_kv_cla__geglu_ffn__prompt_kernel
.p2align 4
L_dual_sequential_preLN__compressed_kv_cla__geglu_ffn__prompt_kernel:
    v_mfma_f32_32x32x16_bf16 v[0:15], a[64:67], a[0:3], v[192:207]
    s_add_u32 m0, s55, 4096
    s_add_u32 s63, s54, 4096
    v_exp_f32 v22, v22
    v_exp_f32 v54, v54
    v_add_f32 v225, v225, v21
    v_mfma_f32_32x32x16_bf16 v[32:47], a[64:67], a[32:35], v[208:223]
    s_waitcnt lgkmcnt(4)
    ds_read_b128 a[88:91], v228 offset:6144
    v_add_f32 v226, v226, v53
    v_cvt_pk_bf16_f32 v18, v20, v21
    v_cvt_pk_bf16_f32 v50, v52, v53
    v_exp_f32 v23, v23
    v_mfma_f32_32x32x16_bf16 v[0:15], a[68:71], a[4:7], v[0:15]
    buffer_load_dwordx4 v224, s[12:15], s63 offen offset:0 sc1 lds
    v_exp_f32 v55, v55
    v_add_f32 v225, v225, v22
    v_add_f32 v226, v226, v54
    v_mfma_f32_32x32x16_bf16 v[32:47], a[68:71], a[36:39], v[32:47]
    s_waitcnt lgkmcnt(4)
    ds_read_b128 a[92:95], v228 offset:7168
    v_exp_f32 v24, v24
    v_exp_f32 v56, v56
    v_add_f32 v225, v225, v23
    v_mfma_f32_32x32x16_bf16 v[0:15], a[72:75], a[8:11], v[0:15]
    v_add_f32 v226, v226, v55
    v_cvt_pk_bf16_f32 v19, v22, v23
    v_cvt_pk_bf16_f32 v51, v54, v55
    v_exp_f32 v25, v25
    v_mfma_f32_32x32x16_bf16 v[32:47], a[72:75], a[40:43], v[32:47]
    s_waitcnt lgkmcnt(4)
    ds_read_b128 a[64:67], v227 offset:57344
    v_exp_f32 v57, v57
    v_add_f32 v225, v225, v24
    v_add_f32 v226, v226, v56
    v_mfma_f32_32x32x16_bf16 v[0:15], a[76:79], a[12:15], v[0:15]
    v_exp_f32 v26, v26
    v_exp_f32 v58, v58
    v_add_f32 v225, v225, v25
    v_add_f32 v226, v226, v57
    v_mfma_f32_32x32x16_bf16 v[32:47], a[76:79], a[44:47], v[32:47]
    s_waitcnt lgkmcnt(3)
    ds_read_b128 a[68:71], v227 offset:58368
    v_cvt_pk_bf16_f32 v24, v24, v25
    v_cvt_pk_bf16_f32 v56, v56, v57
    v_exp_f32 v27, v27
    v_mfma_f32_32x32x16_bf16 v[0:15], a[80:83], a[16:19], v[0:15]
    buffer_load_dwordx4 v224, s[12:15], s63 offen offset:1024 sc1 lds
    v_exp_f32 v59, v59
    v_add_f32 v225, v225, v26
    v_add_f32 v226, v226, v58
    v_mfma_f32_32x32x16_bf16 v[32:47], a[80:83], a[48:51], v[32:47]
    ds_read_b128 a[72:75], v227 offset:59392
    v_exp_f32 v28, v28
    v_exp_f32 v60, v60
    v_add_f32 v225, v225, v27
    v_mfma_f32_32x32x16_bf16 v[0:15], a[84:87], a[20:23], v[0:15]
    v_add_f32 v226, v226, v59
    v_cvt_pk_bf16_f32 v25, v26, v27
    v_cvt_pk_bf16_f32 v57, v58, v59
    v_exp_f32 v29, v29
    v_mfma_f32_32x32x16_bf16 v[32:47], a[84:87], a[52:55], v[32:47]
    s_waitcnt lgkmcnt(4)
    ds_read_b128 a[76:79], v227 offset:60416
    v_exp_f32 v61, v61
    v_add_f32 v225, v225, v28
    v_add_f32 v226, v226, v60
    v_mfma_f32_32x32x16_bf16 v[0:15], a[88:91], a[24:27], v[0:15]
    v_exp_f32 v30, v30
    v_exp_f32 v62, v62
    v_add_f32 v225, v225, v29
    v_add_f32 v226, v226, v61
    v_mfma_f32_32x32x16_bf16 v[32:47], a[88:91], a[56:59], v[32:47]
    s_waitcnt lgkmcnt(4)
    ds_read_b128 a[80:83], v227 offset:61440
    v_cvt_pk_bf16_f32 v26, v28, v29
    v_cvt_pk_bf16_f32 v58, v60, v61
    v_exp_f32 v31, v31
    v_mfma_f32_32x32x16_bf16 v[0:15], a[92:95], a[28:31], v[0:15]
    buffer_load_dwordx4 v224, s[12:15], s63 offen offset:2048 sc1 lds
    v_exp_f32 v63, v63
    v_add_f32 v225, v225, v30
    v_add_f32 v226, v226, v62
    v_mfma_f32_32x32x16_bf16 v[32:47], a[92:95], a[60:63], v[32:47]
    s_waitcnt lgkmcnt(4)
    ds_read_b128 a[84:87], v227 offset:62464
    v_add_f32 v225, v225, v31
    v_add_f32 v226, v226, v63
    v_cvt_pk_bf16_f32 v27, v30, v31
    v_cvt_pk_bf16_f32 v59, v62, v63
    v_mfma_f32_32x32x16_bf16 v[64:79], a[64:67], v[16:19], v[64:79]
    v_mfma_f32_32x32x16_bf16 v[128:143], a[64:67], v[48:51], v[128:143]
    s_waitcnt lgkmcnt(4)
    ds_read_b128 a[88:91], v227 offset:63488
    v_mfma_f32_32x32x16_bf16 v[80:95], a[68:71], v[16:19], v[80:95]
    v_exp_f32 v0, v0
    v_exp_f32 v32, v32
    v_mfma_f32_32x32x16_bf16 v[144:159], a[68:71], v[48:51], v[144:159]
    s_waitcnt lgkmcnt(4)
    ds_read_b128 a[92:95], v227 offset:64512
    v_exp_f32 v1, v1
    v_mfma_f32_32x32x16_bf16 v[96:111], a[72:75], v[16:19], v[96:111]
    v_exp_f32 v33, v33
    v_add_f32 v225, v225, v0
    v_add_f32 v226, v226, v32
    v_mfma_f32_32x32x16_bf16 v[160:175], a[72:75], v[48:51], v[160:175]
    s_waitcnt lgkmcnt(4)
    ds_read_b128 a[64:67], v228 offset:8192
    v_exp_f32 v2, v2
    v_mfma_f32_32x32x16_bf16 v[112:127], a[76:79], v[16:19], v[112:127]
    buffer_load_dwordx4 v224, s[12:15], s63 offen offset:3072 sc1 lds
    v_exp_f32 v34, v34
    v_mfma_f32_32x32x16_bf16 v[176:191], a[76:79], v[48:51], v[176:191]
    s_waitcnt lgkmcnt(4)
    ds_read_b128 a[68:71], v228 offset:9216
    v_add_f32 v225, v225, v1
    v_add_f32 v226, v226, v33
    v_cvt_pk_bf16_f32 v0, v0, v1
    v_mfma_f32_32x32x16_bf16 v[64:79], a[80:83], v[24:27], v[64:79]
    v_cvt_pk_bf16_f32 v32, v32, v33
    v_exp_f32 v3, v3
    v_mfma_f32_32x32x16_bf16 v[128:143], a[80:83], v[56:59], v[128:143]
    s_waitcnt lgkmcnt(4)
    ds_read_b128 a[72:75], v228 offset:10240
    v_exp_f32 v35, v35
    v_add_f32 v225, v225, v2
    v_mfma_f32_32x32x16_bf16 v[80:95], a[84:87], v[24:27], v[80:95]
    v_add_f32 v226, v226, v34
    v_exp_f32 v4, v4
    v_mfma_f32_32x32x16_bf16 v[144:159], a[84:87], v[56:59], v[144:159]
    s_waitcnt lgkmcnt(4)
    ds_read_b128 a[76:79], v228 offset:11264
    v_exp_f32 v36, v36
    v_add_f32 v225, v225, v3
    v_mfma_f32_32x32x16_bf16 v[96:111], a[88:91], v[24:27], v[96:111]
    v_add_f32 v226, v226, v35
    v_cvt_pk_bf16_f32 v1, v2, v3
    v_cvt_pk_bf16_f32 v33, v34, v35
    v_mfma_f32_32x32x16_bf16 v[160:175], a[88:91], v[56:59], v[160:175]
    s_waitcnt lgkmcnt(4)
    ds_read_b128 a[80:83], v228 offset:12288
    v_exp_f32 v5, v5
    v_mfma_f32_32x32x16_bf16 v[112:127], a[92:95], v[24:27], v[112:127]
    v_exp_f32 v37, v37
    v_add_f32 v225, v225, v4
    v_add_f32 v226, v226, v36
    v_mfma_f32_32x32x16_bf16 v[176:191], a[92:95], v[56:59], v[176:191]
    s_waitcnt lgkmcnt(4)
    s_waitcnt vmcnt(9)
    s_barrier
    ds_read_b128 a[84:87], v228 offset:13312
    v_mfma_f32_32x32x16_bf16 v[16:31], a[64:67], a[0:3], v[192:207]
    v_exp_f32 v6, v6
    v_exp_f32 v38, v38
    v_add_f32 v225, v225, v5
    v_add_f32 v226, v226, v37
    v_mfma_f32_32x32x16_bf16 v[48:63], a[64:67], a[32:35], v[208:223]
    s_waitcnt lgkmcnt(4)
    ds_read_b128 a[88:91], v228 offset:14336
    v_cvt_pk_bf16_f32 v2, v4, v5
    v_cvt_pk_bf16_f32 v34, v36, v37
    v_exp_f32 v7, v7
    v_mfma_f32_32x32x16_bf16 v[16:31], a[68:71], a[4:7], v[16:31]
    s_add_u32 m0, s55, 32768
    s_add_u32 s63, s54, 33792
    v_exp_f32 v39, v39
    v_add_f32 v225, v225, v6
    v_add_f32 v226, v226, v38
    v_mfma_f32_32x32x16_bf16 v[48:63], a[68:71], a[36:39], v[48:63]
    s_waitcnt lgkmcnt(4)
    ds_read_b128 a[92:95], v228 offset:15360
    v_exp_f32 v8, v8
    v_exp_f32 v40, v40
    v_add_f32 v225, v225, v7
    v_mfma_f32_32x32x16_bf16 v[16:31], a[72:75], a[8:11], v[16:31]
    buffer_load_dwordx4 v224, s[12:15], s63 offen offset:0 sc1 lds
    v_add_f32 v226, v226, v39
    v_cvt_pk_bf16_f32 v3, v6, v7
    v_cvt_pk_bf16_f32 v35, v38, v39
    v_mfma_f32_32x32x16_bf16 v[48:63], a[72:75], a[40:43], v[48:63]
    s_waitcnt lgkmcnt(4)
    ds_read_b128 a[64:67], v228 offset:16384
    v_exp_f32 v9, v9
    v_exp_f32 v41, v41
    v_add_f32 v225, v225, v8
    v_mfma_f32_32x32x16_bf16 v[16:31], a[76:79], a[12:15], v[16:31]
    v_add_f32 v226, v226, v40
    v_exp_f32 v10, v10
    v_exp_f32 v42, v42
    v_add_f32 v225, v225, v9
    v_mfma_f32_32x32x16_bf16 v[48:63], a[76:79], a[44:47], v[48:63]
    s_waitcnt lgkmcnt(4)
    ds_read_b128 a[68:71], v228 offset:17408
    v_add_f32 v226, v226, v41
    v_cvt_pk_bf16_f32 v8, v8, v9
    v_cvt_pk_bf16_f32 v40, v40, v41
    v_exp_f32 v11, v11
    v_mfma_f32_32x32x16_bf16 v[16:31], a[80:83], a[16:19], v[16:31]
    v_exp_f32 v43, v43
    v_add_f32 v225, v225, v10
    v_add_f32 v226, v226, v42
    v_exp_f32 v12, v12
    v_mfma_f32_32x32x16_bf16 v[48:63], a[80:83], a[48:51], v[48:63]
    s_waitcnt lgkmcnt(4)
    ds_read_b128 a[72:75], v228 offset:18432
    v_exp_f32 v44, v44
    v_add_f32 v225, v225, v11
    v_add_f32 v226, v226, v43
    v_cvt_pk_bf16_f32 v9, v10, v11
    v_mfma_f32_32x32x16_bf16 v[16:31], a[84:87], a[20:23], v[16:31]
    buffer_load_dwordx4 v224, s[12:15], s63 offen offset:1024 sc1 lds
    v_cvt_pk_bf16_f32 v41, v42, v43
    v_exp_f32 v13, v13
    v_mfma_f32_32x32x16_bf16 v[48:63], a[84:87], a[52:55], v[48:63]
    s_waitcnt lgkmcnt(4)
    ds_read_b128 a[76:79], v228 offset:19456
    v_exp_f32 v45, v45
    v_add_f32 v225, v225, v12
    v_add_f32 v226, v226, v44
    v_mfma_f32_32x32x16_bf16 v[16:31], a[88:91], a[24:27], v[16:31]
    v_exp_f32 v14, v14
    v_exp_f32 v46, v46
    v_add_f32 v225, v225, v13
    v_add_f32 v226, v226, v45
    v_mfma_f32_32x32x16_bf16 v[48:63], a[88:91], a[56:59], v[48:63]
    s_waitcnt lgkmcnt(4)
    ds_read_b128 a[80:83], v228 offset:20480
    v_cvt_pk_bf16_f32 v10, v12, v13
    v_cvt_pk_bf16_f32 v42, v44, v45
    v_exp_f32 v15, v15
    v_mfma_f32_32x32x16_bf16 v[16:31], a[92:95], a[28:31], v[16:31]
    v_exp_f32 v47, v47
    v_add_f32 v225, v225, v14
    v_add_f32 v226, v226, v46
    v_add_f32 v225, v225, v15
    v_add_f32 v226, v226, v47
    v_mfma_f32_32x32x16_bf16 v[48:63], a[92:95], a[60:63], v[48:63]
    s_waitcnt lgkmcnt(4)
    ds_read_b128 a[84:87], v228 offset:21504
    v_cvt_pk_bf16_f32 v11, v14, v15
    v_cvt_pk_bf16_f32 v43, v46, v47
    v_mfma_f32_32x32x16_bf16 v[64:79], a[64:67], v[0:3], v[64:79]
    v_mfma_f32_32x32x16_bf16 v[128:143], a[64:67], v[32:35], v[128:143]
    s_waitcnt lgkmcnt(4)
    ds_read_b128 a[88:91], v228 offset:22528
    v_mfma_f32_32x32x16_bf16 v[80:95], a[68:71], v[0:3], v[80:95]
    v_exp_f32 v16, v16
    v_exp_f32 v48, v48
    v_mfma_f32_32x32x16_bf16 v[144:159], a[68:71], v[32:35], v[144:159]
    s_waitcnt lgkmcnt(4)
    ds_read_b128 a[92:95], v228 offset:23552
    v_exp_f32 v17, v17
    v_exp_f32 v49, v49
    v_mfma_f32_32x32x16_bf16 v[96:111], a[72:75], v[0:3], v[96:111]
    v_add_f32 v225, v225, v16
    v_add_f32 v226, v226, v48
    v_exp_f32 v18, v18
    v_mfma_f32_32x32x16_bf16 v[160:175], a[72:75], v[32:35], v[160:175]
    s_waitcnt lgkmcnt(4)
    ds_read_b128 a[64:67], v228 offset:32768
    v_exp_f32 v50, v50
    v_add_f32 v225, v225, v17
    v_add_f32 v226, v226, v49
    v_mfma_f32_32x32x16_bf16 v[112:127], a[76:79], v[0:3], v[112:127]
    buffer_load_dwordx4 v224, s[12:15], s63 offen offset:2048 sc1 lds
    v_cvt_pk_bf16_f32 v16, v16, v17
    v_cvt_pk_bf16_f32 v48, v48, v49
    v_mfma_f32_32x32x16_bf16 v[176:191], a[76:79], v[32:35], v[176:191]
    s_waitcnt lgkmcnt(4)
    ds_read_b128 a[68:71], v228 offset:33792
    v_exp_f32 v19, v19
    v_exp_f32 v51, v51
    v_mfma_f32_32x32x16_bf16 v[64:79], a[80:83], v[8:11], v[64:79]
    v_add_f32 v225, v225, v18
    v_add_f32 v226, v226, v50
    v_exp_f32 v20, v20
    v_mfma_f32_32x32x16_bf16 v[128:143], a[80:83], v[40:43], v[128:143]
    s_waitcnt lgkmcnt(4)
    ds_read_b128 a[72:75], v228 offset:34816
    v_exp_f32 v52, v52
    v_add_f32 v225, v225, v19
    v_add_f32 v226, v226, v51
    v_mfma_f32_32x32x16_bf16 v[80:95], a[84:87], v[8:11], v[80:95]
    buffer_load_dwordx4 v224, s[12:15], s63 offen offset:3072 sc1 lds
    v_cvt_pk_bf16_f32 v17, v18, v19
    v_cvt_pk_bf16_f32 v49, v50, v51
    v_mfma_f32_32x32x16_bf16 v[144:159], a[84:87], v[40:43], v[144:159]
    s_waitcnt lgkmcnt(4)
    ds_read_b128 a[76:79], v228 offset:35840
    v_exp_f32 v21, v21
    v_exp_f32 v53, v53
    v_mfma_f32_32x32x16_bf16 v[96:111], a[88:91], v[8:11], v[96:111]
    v_add_f32 v225, v225, v20
    v_add_f32 v226, v226, v52
    v_mfma_f32_32x32x16_bf16 v[160:175], a[88:91], v[40:43], v[160:175]
    s_waitcnt lgkmcnt(4)
    ds_read_b128 a[80:83], v228 offset:36864
    v_mfma_f32_32x32x16_bf16 v[112:127], a[92:95], v[8:11], v[112:127]
    v_mfma_f32_32x32x16_bf16 v[176:191], a[92:95], v[40:43], v[176:191]
    s_waitcnt lgkmcnt(4)
    ds_read_b128 a[84:87], v228 offset:37888
    v_mfma_f32_32x32x16_bf16 v[0:15], a[64:67], a[0:3], v[192:207]
    s_add_u32 m0, s55, 36864
    s_add_u32 s63, s54, 37888
    v_exp_f32 v22, v22
    v_exp_f32 v54, v54
    v_add_f32 v225, v225, v21
    v_mfma_f32_32x32x16_bf16 v[32:47], a[64:67], a[32:35], v[208:223]
    s_waitcnt lgkmcnt(4)
    ds_read_b128 a[88:91], v228 offset:38912
    v_add_f32 v226, v226, v53
    v_cvt_pk_bf16_f32 v18, v20, v21
    v_cvt_pk_bf16_f32 v50, v52, v53
    v_exp_f32 v23, v23
    v_mfma_f32_32x32x16_bf16 v[0:15], a[68:71], a[4:7], v[0:15]
    buffer_load_dwordx4 v224, s[12:15], s63 offen offset:0 sc1 lds
    v_exp_f32 v55, v55
    v_add_f32 v225, v225, v22
    v_add_f32 v226, v226, v54
    v_mfma_f32_32x32x16_bf16 v[32:47], a[68:71], a[36:39], v[32:47]
    s_waitcnt lgkmcnt(4)
    ds_read_b128 a[92:95], v228 offset:39936
    v_exp_f32 v24, v24
    v_exp_f32 v56, v56
    v_add_f32 v225, v225, v23
    v_mfma_f32_32x32x16_bf16 v[0:15], a[72:75], a[8:11], v[0:15]
    v_add_f32 v226, v226, v55
    v_cvt_pk_bf16_f32 v19, v22, v23
    v_cvt_pk_bf16_f32 v51, v54, v55
    v_exp_f32 v25, v25
    v_mfma_f32_32x32x16_bf16 v[32:47], a[72:75], a[40:43], v[32:47]
    s_waitcnt lgkmcnt(4)
    ds_read_b128 a[64:67], v228 offset:24576
    v_exp_f32 v57, v57
    v_add_f32 v225, v225, v24
    v_add_f32 v226, v226, v56
    v_mfma_f32_32x32x16_bf16 v[0:15], a[76:79], a[12:15], v[0:15]
    v_exp_f32 v26, v26
    v_exp_f32 v58, v58
    v_add_f32 v225, v225, v25
    v_add_f32 v226, v226, v57
    v_mfma_f32_32x32x16_bf16 v[32:47], a[76:79], a[44:47], v[32:47]
    s_waitcnt lgkmcnt(4)
    ds_read_b128 a[68:71], v228 offset:25600
    v_cvt_pk_bf16_f32 v24, v24, v25
    v_cvt_pk_bf16_f32 v56, v56, v57
    v_exp_f32 v27, v27
    v_mfma_f32_32x32x16_bf16 v[0:15], a[80:83], a[16:19], v[0:15]
    buffer_load_dwordx4 v224, s[12:15], s63 offen offset:1024 sc1 lds
    v_exp_f32 v59, v59
    v_add_f32 v225, v225, v26
    v_add_f32 v226, v226, v58
    v_mfma_f32_32x32x16_bf16 v[32:47], a[80:83], a[48:51], v[32:47]
    s_waitcnt lgkmcnt(4)
    ds_read_b128 a[72:75], v228 offset:26624
    v_exp_f32 v28, v28
    v_exp_f32 v60, v60
    v_add_f32 v225, v225, v27
    v_mfma_f32_32x32x16_bf16 v[0:15], a[84:87], a[20:23], v[0:15]
    v_add_f32 v226, v226, v59
    v_cvt_pk_bf16_f32 v25, v26, v27
    v_cvt_pk_bf16_f32 v57, v58, v59
    v_exp_f32 v29, v29
    v_mfma_f32_32x32x16_bf16 v[32:47], a[84:87], a[52:55], v[32:47]
    s_waitcnt lgkmcnt(4)
    ds_read_b128 a[76:79], v228 offset:27648
    v_exp_f32 v61, v61
    v_add_f32 v225, v225, v28
    v_add_f32 v226, v226, v60
    v_mfma_f32_32x32x16_bf16 v[0:15], a[88:91], a[24:27], v[0:15]
    v_exp_f32 v30, v30
    v_exp_f32 v62, v62
    v_add_f32 v225, v225, v29
    v_add_f32 v226, v226, v61
    v_mfma_f32_32x32x16_bf16 v[32:47], a[88:91], a[56:59], v[32:47]
    s_waitcnt lgkmcnt(4)
    ds_read_b128 a[80:83], v228 offset:28672
    v_cvt_pk_bf16_f32 v26, v28, v29
    v_cvt_pk_bf16_f32 v58, v60, v61
    v_exp_f32 v31, v31
    v_mfma_f32_32x32x16_bf16 v[0:15], a[92:95], a[28:31], v[0:15]
    buffer_load_dwordx4 v224, s[12:15], s63 offen offset:2048 sc1 lds
    v_exp_f32 v63, v63
    v_add_f32 v225, v225, v30
    v_add_f32 v226, v226, v62
    v_mfma_f32_32x32x16_bf16 v[32:47], a[92:95], a[60:63], v[32:47]
    s_waitcnt lgkmcnt(4)
    ds_read_b128 a[84:87], v228 offset:29696
    v_add_f32 v225, v225, v31
    v_add_f32 v226, v226, v63
    v_cvt_pk_bf16_f32 v27, v30, v31
    v_cvt_pk_bf16_f32 v59, v62, v63
    v_mfma_f32_32x32x16_bf16 v[64:79], a[64:67], v[16:19], v[64:79]
    v_mfma_f32_32x32x16_bf16 v[128:143], a[64:67], v[48:51], v[128:143]
    s_waitcnt lgkmcnt(4)
    ds_read_b128 a[88:91], v228 offset:30720
    v_mfma_f32_32x32x16_bf16 v[80:95], a[68:71], v[16:19], v[80:95]
    v_exp_f32 v0, v0
    v_exp_f32 v32, v32
    v_mfma_f32_32x32x16_bf16 v[144:159], a[68:71], v[48:51], v[144:159]
    s_waitcnt lgkmcnt(4)
    ds_read_b128 a[92:95], v228 offset:31744
    v_exp_f32 v1, v1
    v_mfma_f32_32x32x16_bf16 v[96:111], a[72:75], v[16:19], v[96:111]
    v_exp_f32 v33, v33
    v_add_f32 v225, v225, v0
    v_add_f32 v226, v226, v32
    v_mfma_f32_32x32x16_bf16 v[160:175], a[72:75], v[48:51], v[160:175]
    s_waitcnt lgkmcnt(4)
    ds_read_b128 a[64:67], v228 offset:40960
    v_exp_f32 v2, v2
    v_mfma_f32_32x32x16_bf16 v[112:127], a[76:79], v[16:19], v[112:127]
    buffer_load_dwordx4 v224, s[12:15], s63 offen offset:3072 sc1 lds
    v_exp_f32 v34, v34
    v_mfma_f32_32x32x16_bf16 v[176:191], a[76:79], v[48:51], v[176:191]
    s_waitcnt lgkmcnt(4)
    ds_read_b128 a[68:71], v228 offset:41984
    v_add_f32 v225, v225, v1
    v_add_f32 v226, v226, v33
    v_cvt_pk_bf16_f32 v0, v0, v1
    v_mfma_f32_32x32x16_bf16 v[64:79], a[80:83], v[24:27], v[64:79]
    s_add_u32 s54, s54, 67584
    v_cvt_pk_bf16_f32 v32, v32, v33
    v_exp_f32 v3, v3
    v_mfma_f32_32x32x16_bf16 v[128:143], a[80:83], v[56:59], v[128:143]
    s_waitcnt lgkmcnt(4)
    ds_read_b128 a[72:75], v228 offset:43008
    v_exp_f32 v35, v35
    v_add_f32 v225, v225, v2
    v_mfma_f32_32x32x16_bf16 v[80:95], a[84:87], v[24:27], v[80:95]
    s_xor_b32 s55, s55, 0x10000
    v_add_f32 v226, v226, v34
    v_exp_f32 v4, v4
    v_mfma_f32_32x32x16_bf16 v[144:159], a[84:87], v[56:59], v[144:159]
    s_waitcnt lgkmcnt(4)
    ds_read_b128 a[76:79], v228 offset:44032
    v_exp_f32 v36, v36
    v_add_f32 v225, v225, v3
    v_mfma_f32_32x32x16_bf16 v[96:111], a[88:91], v[24:27], v[96:111]
    v_add_f32 v226, v226, v35
    v_cvt_pk_bf16_f32 v1, v2, v3
    v_cvt_pk_bf16_f32 v33, v34, v35
    v_mfma_f32_32x32x16_bf16 v[160:175], a[88:91], v[56:59], v[160:175]
    s_waitcnt lgkmcnt(4)
    ds_read_b128 a[80:83], v228 offset:45056
    v_exp_f32 v5, v5
    v_mfma_f32_32x32x16_bf16 v[112:127], a[92:95], v[24:27], v[112:127]
    v_exp_f32 v37, v37
    v_add_f32 v225, v225, v4
    v_add_f32 v226, v226, v36
    v_mfma_f32_32x32x16_bf16 v[176:191], a[92:95], v[56:59], v[176:191]
    s_waitcnt lgkmcnt(4)
    s_waitcnt vmcnt(8)
    s_barrier
    ds_read_b128 a[84:87], v228 offset:46080
    v_mfma_f32_32x32x16_bf16 v[16:31], a[64:67], a[0:3], v[192:207]
    buffer_store_dword v253, v255, s[8:11], s96 offen sc1
    v_exp_f32 v6, v6
    v_exp_f32 v38, v38
    v_mfma_f32_32x32x16_bf16 v[48:63], a[64:67], a[32:35], v[208:223]
    s_waitcnt lgkmcnt(4)
    s_mov_b32 s96, 0x7f000000
    ds_read_b128 a[88:91], v228 offset:47104
    v_add_f32 v225, v225, v5
    v_add_f32 v226, v226, v37
    v_cvt_pk_bf16_f32 v2, v4, v5
    v_cvt_pk_bf16_f32 v34, v36, v37
    v_mfma_f32_32x32x16_bf16 v[16:31], a[68:71], a[4:7], v[16:31]
    s_mov_b32 m0, s55
    v_exp_f32 v7, v7
    v_exp_f32 v39, v39
    v_add_f32 v225, v225, v6
    v_add_f32 v226, v226, v38
    v_mfma_f32_32x32x16_bf16 v[48:63], a[68:71], a[36:39], v[48:63]
    s_waitcnt lgkmcnt(4)
    ds_read_b128 a[92:95], v228 offset:48128
    v_exp_f32 v8, v8
    v_exp_f32 v40, v40
    v_add_f32 v225, v225, v7
    v_mfma_f32_32x32x16_bf16 v[16:31], a[72:75], a[8:11], v[16:31]
    buffer_load_dwordx4 v224, s[12:15], s54 offen offset:0 sc1 lds
    v_add_f32 v226, v226, v39
    v_cvt_pk_bf16_f32 v3, v6, v7
    v_cvt_pk_bf16_f32 v35, v38, v39
    v_mfma_f32_32x32x16_bf16 v[48:63], a[72:75], a[40:43], v[48:63]
    s_waitcnt lgkmcnt(4)
    ds_read_b128 a[64:67], v228 offset:49152
    v_exp_f32 v9, v9
    v_exp_f32 v41, v41
    v_add_f32 v225, v225, v8
    v_mfma_f32_32x32x16_bf16 v[16:31], a[76:79], a[12:15], v[16:31]
    v_add_f32 v226, v226, v40
    v_exp_f32 v10, v10
    v_exp_f32 v42, v42
    v_add_f32 v225, v225, v9
    v_mfma_f32_32x32x16_bf16 v[48:63], a[76:79], a[44:47], v[48:63]
    s_waitcnt lgkmcnt(4)
    ds_read_b128 a[68:71], v228 offset:50176
    v_add_f32 v226, v226, v41
    v_cvt_pk_bf16_f32 v8, v8, v9
    v_cvt_pk_bf16_f32 v40, v40, v41
    v_exp_f32 v11, v11
    v_mfma_f32_32x32x16_bf16 v[16:31], a[80:83], a[16:19], v[16:31]
    v_exp_f32 v43, v43
    v_add_f32 v225, v225, v10
    v_add_f32 v226, v226, v42
    v_exp_f32 v12, v12
    v_mfma_f32_32x32x16_bf16 v[48:63], a[80:83], a[48:51], v[48:63]
    s_waitcnt lgkmcnt(4)
    ds_read_b128 a[72:75], v228 offset:51200
    v_exp_f32 v44, v44
    v_add_f32 v225, v225, v11
    v_add_f32 v226, v226, v43
    v_cvt_pk_bf16_f32 v9, v10, v11
    v_mfma_f32_32x32x16_bf16 v[16:31], a[84:87], a[20:23], v[16:31]
    buffer_load_dwordx4 v224, s[12:15], s54 offen offset:1024 sc1 lds
    v_cvt_pk_bf16_f32 v41, v42, v43
    v_exp_f32 v13, v13
    v_mfma_f32_32x32x16_bf16 v[48:63], a[84:87], a[52:55], v[48:63]
    s_waitcnt lgkmcnt(4)
    ds_read_b128 a[76:79], v228 offset:52224
    v_exp_f32 v45, v45
    v_add_f32 v225, v225, v12
    v_add_f32 v226, v226, v44
    v_mfma_f32_32x32x16_bf16 v[16:31], a[88:91], a[24:27], v[16:31]
    v_exp_f32 v14, v14
    v_exp_f32 v46, v46
    v_add_f32 v225, v225, v13
    v_add_f32 v226, v226, v45
    v_mfma_f32_32x32x16_bf16 v[48:63], a[88:91], a[56:59], v[48:63]
    s_waitcnt lgkmcnt(4)
    ds_read_b128 a[80:83], v228 offset:53248
    v_cvt_pk_bf16_f32 v10, v12, v13
    v_cvt_pk_bf16_f32 v42, v44, v45
    v_exp_f32 v15, v15
    v_mfma_f32_32x32x16_bf16 v[16:31], a[92:95], a[28:31], v[16:31]
    v_exp_f32 v47, v47
    v_add_f32 v225, v225, v14
    v_add_f32 v226, v226, v46
    v_add_f32 v225, v225, v15
    v_add_f32 v226, v226, v47
    v_mfma_f32_32x32x16_bf16 v[48:63], a[92:95], a[60:63], v[48:63]
    s_waitcnt lgkmcnt(4)
    ds_read_b128 a[84:87], v228 offset:54272
    v_cvt_pk_bf16_f32 v11, v14, v15
    v_cvt_pk_bf16_f32 v43, v46, v47
    v_mfma_f32_32x32x16_bf16 v[64:79], a[64:67], v[0:3], v[64:79]
    v_mfma_f32_32x32x16_bf16 v[128:143], a[64:67], v[32:35], v[128:143]
    s_waitcnt lgkmcnt(4)
    ds_read_b128 a[88:91], v228 offset:55296
    v_mfma_f32_32x32x16_bf16 v[80:95], a[68:71], v[0:3], v[80:95]
    v_exp_f32 v16, v16
    v_exp_f32 v48, v48
    v_mfma_f32_32x32x16_bf16 v[144:159], a[68:71], v[32:35], v[144:159]
    s_waitcnt lgkmcnt(4)
    ds_read_b128 a[92:95], v228 offset:56320
    v_exp_f32 v17, v17
    v_exp_f32 v49, v49
    v_mfma_f32_32x32x16_bf16 v[96:111], a[72:75], v[0:3], v[96:111]
    v_add_f32 v225, v225, v16
    v_add_f32 v226, v226, v48
    v_exp_f32 v18, v18
    v_mfma_f32_32x32x16_bf16 v[160:175], a[72:75], v[32:35], v[160:175]
    s_waitcnt lgkmcnt(4)
    ds_read_b128 a[64:67], v227 offset:0
    v_exp_f32 v50, v50
    v_add_f32 v225, v225, v17
    v_add_f32 v226, v226, v49
    v_mfma_f32_32x32x16_bf16 v[112:127], a[76:79], v[0:3], v[112:127]
    buffer_load_dwordx4 v224, s[12:15], s54 offen offset:2048 sc1 lds
    v_cvt_pk_bf16_f32 v16, v16, v17
    v_cvt_pk_bf16_f32 v48, v48, v49
    v_mfma_f32_32x32x16_bf16 v[176:191], a[76:79], v[32:35], v[176:191]
    s_waitcnt lgkmcnt(4)
    ds_read_b128 a[68:71], v227 offset:1024
    v_exp_f32 v19, v19
    v_exp_f32 v51, v51
    v_mfma_f32_32x32x16_bf16 v[64:79], a[80:83], v[8:11], v[64:79]
    v_add_f32 v225, v225, v18
    v_add_f32 v226, v226, v50
    v_exp_f32 v20, v20
    v_mfma_f32_32x32x16_bf16 v[128:143], a[80:83], v[40:43], v[128:143]
    s_waitcnt lgkmcnt(4)
    ds_read_b128 a[72:75], v227 offset:2048
    v_exp_f32 v52, v52
    v_add_f32 v225, v225, v19
    v_add_f32 v226, v226, v51
    v_mfma_f32_32x32x16_bf16 v[80:95], a[84:87], v[8:11], v[80:95]
    buffer_load_dwordx4 v224, s[12:15], s54 offen offset:3072 sc1 lds
    v_cvt_pk_bf16_f32 v17, v18, v19
    v_cvt_pk_bf16_f32 v49, v50, v51
    v_mfma_f32_32x32x16_bf16 v[144:159], a[84:87], v[40:43], v[144:159]
    s_waitcnt lgkmcnt(4)
    ds_read_b128 a[76:79], v227 offset:3072
    v_exp_f32 v21, v21
    v_exp_f32 v53, v53
    v_mfma_f32_32x32x16_bf16 v[96:111], a[88:91], v[8:11], v[96:111]
    s_add_u32 s61, s61, 2
    ds_read_b128 a[84:87], v227 offset:5120
    v_xor_b32 v228, 0x10000, v228
    v_add_f32 v225, v225, v20
    v_add_f32 v226, v226, v52
    v_mfma_f32_32x32x16_bf16 v[160:175], a[88:91], v[40:43], v[160:175]
    s_waitcnt lgkmcnt(5)
    ds_read_b128 a[80:83], v227 offset:4096
    v_mfma_f32_32x32x16_bf16 v[112:127], a[92:95], v[8:11], v[112:127]
    s_cmp_lt_u32 s61, s50
    v_xor_b32 v227, 0x10000, v227
    v_mfma_f32_32x32x16_bf16 v[176:191], a[92:95], v[40:43], v[176:191]
    s_waitcnt lgkmcnt(5)
    s_cbranch_scc1 L_dual_sequential_preLN__compressed_kv_cla__geglu_ffn__prompt_kernel
L_Q_sequential_preLN__compressed_kv_cla__geglu_ffn__prompt_kernel:
    s_cmp_lg_u32 s71, 0
    s_cbranch_scc1 L_Q0_sequential_preLN__compressed_kv_cla__geglu_ffn__prompt_kernel
    v_cndmask_b32 v192, v192, v229, s[16:17]
    v_cndmask_b32 v193, v193, v229, s[18:19]
    v_cndmask_b32 v194, v194, v229, s[20:21]
    v_cndmask_b32 v195, v195, v229, s[22:23]
    v_cndmask_b32 v196, v196, v229, s[24:25]
    v_cndmask_b32 v197, v197, v229, s[26:27]
    v_cndmask_b32 v198, v198, v229, s[28:29]
    v_cndmask_b32 v199, v199, v229, s[30:31]
    v_cndmask_b32 v200, v200, v229, s[32:33]
    v_cndmask_b32 v201, v201, v229, s[34:35]
    v_cndmask_b32 v202, v202, v229, s[36:37]
    v_cndmask_b32 v203, v203, v229, s[38:39]
    v_cndmask_b32 v204, v204, v229, s[40:41]
    v_cndmask_b32 v205, v205, v229, s[42:43]
    v_cndmask_b32 v206, v206, v229, s[44:45]
    v_cndmask_b32 v207, v207, v229, s[46:47]
    s_nop 1
L_Q0_sequential_preLN__compressed_kv_cla__geglu_ffn__prompt_kernel:
    v_mfma_f32_32x32x16_bf16 v[0:15], a[64:67], a[0:3], v[192:207]
    s_add_u32 m0, s55, 4096
    s_add_u32 s63, s54, 4096
    v_accvgpr_write_b32 a96, -1
    v_exp_f32 v22, v22
    v_exp_f32 v54, v54
    v_mfma_f32_32x32x16_bf16 v[32:47], a[64:67], a[32:35], v[208:223]
    s_waitcnt lgkmcnt(4)
    s_cmp_ge_u32 s74, 6
    s_cselect_b32 s72, 0x4e02800, s72
    ds_read_b128 a[88:91], v228 offset:6144
    v_accvgpr_write_b32 a97, -1
    v_add_f32 v225, v225, v21
    v_add_f32 v226, v226, v53
    v_mfma_f32_32x32x16_bf16 v[0:15], a[68:71], a[4:7], v[0:15]
    buffer_load_dwordx4 v224, s[12:15], s63 offen offset:0 sc1 lds
    v_accvgpr_write_b32 a98, -1
    v_cvt_pk_bf16_f32 v18, v20, v21
    v_cvt_pk_bf16_f32 v50, v52, v53
    v_mfma_f32_32x32x16_bf16 v[32:47], a[68:71], a[36:39], v[32:47]
    s_waitcnt lgkmcnt(4)
    ds_read_b128 a[92:95], v228 offset:7168
    v_accvgpr_write_b32 a99, -1
    v_exp_f32 v23, v23
    v_exp_f32 v55, v55
    v_mfma_f32_32x32x16_bf16 v[0:15], a[72:75], a[8:11], v[0:15]
    buffer_load_dwordx4 v[236:239], v224, s[8:11], s72 offen sc1
    v_add_f32 v225, v225, v22
    v_add_f32 v226, v226, v54
    v_exp_f32 v24, v24
    v_mfma_f32_32x32x16_bf16 v[32:47], a[72:75], a[40:43], v[32:47]
    s_waitcnt lgkmcnt(4)
    ds_read_b128 a[64:67], v227 offset:57344
    buffer_store_dwordx4 a[96:99], v224, s[8:11], s52 offen offset:0 sc1
    v_exp_f32 v56, v56
    v_add_f32 v225, v225, v23
    v_mfma_f32_32x32x16_bf16 v[0:15], a[76:79], a[12:15], v[0:15]
    s_waitcnt vmcnt(10)
    ds_read_b64_tr_b16 a[240:241], v250 offset:0
    v_add_f32 v226, v226, v55
    v_cvt_pk_bf16_f32 v19, v22, v23
    v_cvt_pk_bf16_f32 v51, v54, v55
    v_exp_f32 v25, v25
    v_mfma_f32_32x32x16_bf16 v[32:47], a[76:79], a[44:47], v[32:47]
    s_waitcnt lgkmcnt(4)
    ds_read_b128 a[68:71], v227 offset:58368
    v_exp_f32 v57, v57
    v_add_f32 v225, v225, v24
    v_add_f32 v226, v226, v56
    v_mfma_f32_32x32x16_bf16 v[0:15], a[80:83], a[16:19], v[0:15]
    s_cmp_le_u32 s71, 1
    buffer_load_dwordx4 v224, s[12:15], s63 offen offset:1024 sc1 lds
    ds_read_b64_tr_b16 a[242:243], v250 offset:2048
    v_exp_f32 v26, v26
    v_mfma_f32_32x32x16_bf16 v[32:47], a[80:83], a[48:51], v[32:47]
    ds_read_b128 a[72:75], v227 offset:59392
    v_exp_f32 v58, v58
    v_add_f32 v225, v225, v25
    v_add_f32 v226, v226, v57
    v_cvt_pk_bf16_f32 v24, v24, v25
    v_mfma_f32_32x32x16_bf16 v[0:15], a[84:87], a[20:23], v[0:15]
    s_cselect_b64 s[48:49], -1, 0
    ds_read_b64_tr_b16 a[244:245], v250 offset:64
    v_cvt_pk_bf16_f32 v56, v56, v57
    v_exp_f32 v27, v27
    v_exp_f32 v59, v59
    v_mfma_f32_32x32x16_bf16 v[32:47], a[84:87], a[52:55], v[32:47]
    s_waitcnt lgkmcnt(7)
    ds_read_b128 a[76:79], v227 offset:60416
    buffer_store_dwordx4 a[96:99], v224, s[8:11], s52 offen offset:1024 sc1
    v_add_f32 v225, v225, v26
    v_add_f32 v226, v226, v58
    v_mfma_f32_32x32x16_bf16 v[0:15], a[88:91], a[24:27], v[0:15]
    s_cmp_lt_u32 s71, 1
    ds_read_b64_tr_b16 a[246:247], v250 offset:2112
    v_exp_f32 v28, v28
    v_exp_f32 v60, v60
    v_add_f32 v225, v225, v27
    v_mfma_f32_32x32x16_bf16 v[32:47], a[88:91], a[56:59], v[32:47]
    s_waitcnt lgkmcnt(8)
    ds_read_b128 a[80:83], v227 offset:61440
    v_add_f32 v226, v226, v59
    v_cvt_pk_bf16_f32 v25, v26, v27
    v_cvt_pk_bf16_f32 v57, v58, v59
    v_exp_f32 v29, v29
    v_mfma_f32_32x32x16_bf16 v[0:15], a[92:95], a[28:31], v[0:15]
    s_cselect_b64 s[4:5], -1, 0
    buffer_load_dwordx4 v224, s[12:15], s63 offen offset:2048 sc1 lds
    ds_read_b64_tr_b16 a[248:249], v250 offset:128
    v_exp_f32 v61, v61
    v_add_f32 v225, v225, v28
    v_mfma_f32_32x32x16_bf16 v[32:47], a[92:95], a[60:63], v[32:47]
    s_waitcnt lgkmcnt(9)
    ds_read_b128 a[84:87], v227 offset:62464
    v_add_f32 v226, v226, v60
    v_exp_f32 v30, v30
    v_exp_f32 v62, v62
    v_mfma_f32_32x32x16_bf16 v[64:79], a[64:67], v[16:19], v[64:79]
    ds_read_b64_tr_b16 a[250:251], v250 offset:2176
    s_waitcnt lgkmcnt(8)
    buffer_store_dwordx4 a[240:243], v224, s[8:11], s86 offen sc1
    s_add_u32 s86, s86, 115712
    v_add_f32 v225, v225, v29
    v_mfma_f32_32x32x16_bf16 v[128:143], a[64:67], v[48:51], v[128:143]
    ds_read_b128 a[88:91], v227 offset:63488
    v_add_f32 v226, v226, v61
    v_cvt_pk_bf16_f32 v26, v28, v29
    v_cvt_pk_bf16_f32 v58, v60, v61
    v_exp_f32 v31, v31
    v_mfma_f32_32x32x16_bf16 v[80:95], a[68:71], v[16:19], v[80:95]
    s_cmp_ge_u32 s74, 7
    s_cselect_b32 s92, s62, 0x7f000000
    ds_read_b64_tr_b16 a[252:253], v250 offset:192
    v_exp_f32 v63, v63
    v_add_f32 v225, v225, v30
    v_add_f32 v226, v226, v62
    v_mfma_f32_32x32x16_bf16 v[144:159], a[68:71], v[48:51], v[144:159]
    s_waitcnt lgkmcnt(9)
    ds_read_b128 a[92:95], v227 offset:64512
    buffer_store_dwordx4 a[96:99], v224, s[8:11], s52 offen offset:2048 sc1
    v_add_f32 v225, v225, v31
    v_add_f32 v226, v226, v63
    v_cvt_pk_bf16_f32 v27, v30, v31
    v_mfma_f32_32x32x16_bf16 v[96:111], a[72:75], v[16:19], v[96:111]
    ds_read_b64_tr_b16 a[254:255], v250 offset:2240
    v_cvt_pk_bf16_f32 v59, v62, v63
    v_exp_f32 v0, v0
    v_exp_f32 v32, v32
    v_mfma_f32_32x32x16_bf16 v[160:175], a[72:75], v[48:51], v[160:175]
    s_waitcnt lgkmcnt(9)
    ds_read_b128 a[64:67], v228 offset:8192
    v_exp_f32 v1, v1
    v_exp_f32 v33, v33
    v_add_f32 v225, v225, v0
    v_mfma_f32_32x32x16_bf16 v[112:127], a[76:79], v[16:19], v[112:127]
    buffer_load_dwordx4 v224, s[12:15], s63 offen offset:3072 sc1 lds
    v_add_f32 v226, v226, v32
    v_exp_f32 v2, v2
    v_cndmask_b32 v232, v235, v229, s[48:49]
    v_cndmask_b32 v233, v235, v229, s[4:5]
    v_mfma_f32_32x32x16_bf16 v[176:191], a[76:79], v[48:51], v[176:191]
    s_waitcnt lgkmcnt(8)
    ds_read_b128 a[68:71], v228 offset:9216
    v_exp_f32 v34, v34
    v_add_f32 v225, v225, v1
    v_add_f32 v226, v226, v33
    v_cvt_pk_bf16_f32 v0, v0, v1
    v_cndmask_b32 v192, v233, v232, s[16:17]
    v_mfma_f32_32x32x16_bf16 v[64:79], a[80:83], v[24:27], v[64:79]
    s_cmp_ge_u32 s74, 6
    s_cselect_b64 s[94:95], -1, 0
    v_cvt_pk_bf16_f32 v32, v32, v33
    v_exp_f32 v3, v3
    v_exp_f32 v35, v35
    v_cndmask_b32 v193, v233, v232, s[18:19]
    v_mfma_f32_32x32x16_bf16 v[128:143], a[80:83], v[56:59], v[128:143]
    s_waitcnt lgkmcnt(7)
    ds_read_b128 a[72:75], v228 offset:10240
    v_add_f32 v225, v225, v2
    v_add_f32 v226, v226, v34
    v_exp_f32 v4, v4
    v_cndmask_b32 v194, v233, v232, s[20:21]
    v_cndmask_b32 v195, v233, v232, s[22:23]
    v_mfma_f32_32x32x16_bf16 v[80:95], a[84:87], v[24:27], v[80:95]
    buffer_store_dwordx4 a[244:247], v224, s[8:11], s86 offen sc1
    s_add_u32 s86, s86, 115712
    v_exp_f32 v36, v36
    v_add_f32 v225, v225, v3
    v_cndmask_b32 v196, v233, v232, s[24:25]
    v_mfma_f32_32x32x16_bf16 v[144:159], a[84:87], v[56:59], v[144:159]
    s_waitcnt lgkmcnt(6)
    ds_read_b128 a[76:79], v228 offset:11264
    v_add_f32 v226, v226, v35
    v_cvt_pk_bf16_f32 v1, v2, v3
    v_cvt_pk_bf16_f32 v33, v34, v35
    v_exp_f32 v5, v5
    v_cndmask_b32 v197, v233, v232, s[26:27]
    v_mfma_f32_32x32x16_bf16 v[96:111], a[88:91], v[24:27], v[96:111]
    s_waitcnt vmcnt(8)
    v_bitop3_b32 v236, v236, v237, s73 bitop3:0x7e
    v_bitop3_b32 v238, v238, v239, s73 bitop3:0x7e
    v_exp_f32 v37, v37
    v_add_f32 v225, v225, v4
    v_add_f32 v226, v226, v36
    v_cndmask_b32 v198, v233, v232, s[28:29]
    v_mfma_f32_32x32x16_bf16 v[160:175], a[88:91], v[56:59], v[160:175]
    s_waitcnt lgkmcnt(5)
    ds_read_b128 a[80:83], v228 offset:12288
    buffer_store_dwordx4 a[96:99], v224, s[8:11], s52 offen offset:3072 sc1
    v_cndmask_b32 v199, v233, v232, s[30:31]
    v_cndmask_b32 v200, v233, v232, s[32:33]
    v_cndmask_b32 v201, v233, v232, s[34:35]
    v_cndmask_b32 v202, v233, v232, s[36:37]
    v_mfma_f32_32x32x16_bf16 v[112:127], a[92:95], v[24:27], v[112:127]
    v_or_b32 v236, v236, v238
    v_cmp_ne_u32 vcc, 0, v236
    v_cndmask_b32 v203, v233, v232, s[38:39]
    v_cndmask_b32 v204, v233, v232, s[40:41]
    v_cndmask_b32 v205, v233, v232, s[42:43]
    v_cndmask_b32 v206, v233, v232, s[44:45]
    v_cndmask_b32 v207, v233, v232, s[46:47]
    v_mfma_f32_32x32x16_bf16 v[176:191], a[92:95], v[56:59], v[176:191]
    s_waitcnt lgkmcnt(4)
    s_barrier
    ds_read_b128 a[84:87], v228 offset:13312
    v_mfma_f32_32x32x16_bf16 v[16:31], a[64:67], a[0:3], v[192:207]
    s_and_b64 vcc, vcc, s[94:95]
    v_exp_f32 v6, v6
    v_exp_f32 v38, v38
    v_add_f32 v225, v225, v5
    v_add_f32 v226, v226, v37
    v_mfma_f32_32x32x16_bf16 v[48:63], a[64:67], a[32:35], v[208:223]
    s_waitcnt lgkmcnt(4)
    s_cbranch_vccnz L_poll4_sequential_preLN__compressed_kv_cla__geglu_ffn__prompt_kernel
L_poll4_sequential_preLN__compressed_kv_cla__geglu_ffn__prompt_kernel_ok:
    ds_read_b128 a[88:91], v228 offset:14336
    v_cvt_pk_bf16_f32 v2, v4, v5
    v_cvt_pk_bf16_f32 v34, v36, v37
    v_exp_f32 v7, v7
    v_mfma_f32_32x32x16_bf16 v[16:31], a[68:71], a[4:7], v[16:31]
    s_add_u32 m0, s55, 32768
    s_add_u32 s63, s54, 33792
    v_exp_f32 v39, v39
    v_add_f32 v225, v225, v6
    v_add_f32 v226, v226, v38
    v_mfma_f32_32x32x16_bf16 v[48:63], a[68:71], a[36:39], v[48:63]
    s_waitcnt lgkmcnt(4)
    ds_read_b128 a[92:95], v228 offset:15360
    buffer_load_dwordx4 a[128:131], v224, s[8:11], s92 offen offset:0 sc1
    v_exp_f32 v8, v8
    v_mfma_f32_32x32x16_bf16 v[16:31], a[72:75], a[8:11], v[16:31]
    s_cmp_le_u32 s71, 2
    buffer_load_dwordx4 v224, s[12:15], s63 offen offset:0 sc1 lds
    v_exp_f32 v40, v40
    v_add_f32 v225, v225, v7
    v_add_f32 v226, v226, v39
    v_mfma_f32_32x32x16_bf16 v[48:63], a[72:75], a[40:43], v[48:63]
    s_waitcnt lgkmcnt(4)
    ds_read_b128 a[64:67], v228 offset:16384
    v_cvt_pk_bf16_f32 v3, v6, v7
    v_cvt_pk_bf16_f32 v35, v38, v39
    v_exp_f32 v9, v9
    v_mfma_f32_32x32x16_bf16 v[16:31], a[76:79], a[12:15], v[16:31]
    s_cselect_b64 s[48:49], -1, 0
    buffer_load_dwordx4 a[132:135], v224, s[8:11], s92 offen offset:1024 sc1
    v_exp_f32 v41, v41
    v_add_f32 v225, v225, v8
    v_add_f32 v226, v226, v40
    v_mfma_f32_32x32x16_bf16 v[48:63], a[76:79], a[44:47], v[48:63]
    s_waitcnt lgkmcnt(4)
    ds_read_b128 a[68:71], v228 offset:17408
    v_exp_f32 v10, v10
    v_exp_f32 v42, v42
    v_add_f32 v225, v225, v9
    v_mfma_f32_32x32x16_bf16 v[16:31], a[80:83], a[16:19], v[16:31]
    buffer_store_dwordx4 a[248:251], v224, s[8:11], s86 offen sc1
    s_add_u32 s86, s86, 115712
    v_add_f32 v226, v226, v41
    v_cvt_pk_bf16_f32 v8, v8, v9
    v_cvt_pk_bf16_f32 v40, v40, v41
    v_mfma_f32_32x32x16_bf16 v[48:63], a[80:83], a[48:51], v[48:63]
    s_waitcnt lgkmcnt(4)
    ds_read_b128 a[72:75], v228 offset:18432
    v_exp_f32 v11, v11
    v_exp_f32 v43, v43
    v_add_f32 v225, v225, v10
    v_mfma_f32_32x32x16_bf16 v[16:31], a[84:87], a[20:23], v[16:31]
    s_cmp_lt_u32 s71, 2
    buffer_load_dwordx4 v224, s[12:15], s63 offen offset:1024 sc1 lds
    v_add_f32 v226, v226, v42
    v_exp_f32 v12, v12
    v_mfma_f32_32x32x16_bf16 v[48:63], a[84:87], a[52:55], v[48:63]
    s_waitcnt lgkmcnt(4)
    ds_read_b128 a[76:79], v228 offset:19456
    v_exp_f32 v44, v44
    v_add_f32 v225, v225, v11
    v_add_f32 v226, v226, v43
    v_cvt_pk_bf16_f32 v9, v10, v11
    v_mfma_f32_32x32x16_bf16 v[16:31], a[88:91], a[24:27], v[16:31]
    s_cselect_b64 s[4:5], -1, 0
    buffer_load_dwordx4 a[136:139], v224, s[8:11], s92 offen offset:2048 sc1
    v_cvt_pk_bf16_f32 v41, v42, v43
    v_exp_f32 v13, v13
    v_mfma_f32_32x32x16_bf16 v[48:63], a[88:91], a[56:59], v[48:63]
    s_waitcnt lgkmcnt(4)
    ds_read_b128 a[80:83], v228 offset:20480
    v_exp_f32 v45, v45
    v_add_f32 v225, v225, v12
    v_add_f32 v226, v226, v44
    v_mfma_f32_32x32x16_bf16 v[16:31], a[92:95], a[28:31], v[16:31]
    buffer_store_dwordx4 a[252:255], v224, s[8:11], s86 offen sc1
    v_exp_f32 v14, v14
    v_exp_f32 v46, v46
    v_mfma_f32_32x32x16_bf16 v[48:63], a[92:95], a[60:63], v[48:63]
    s_waitcnt lgkmcnt(4)
    ds_read_b128 a[84:87], v228 offset:21504
    v_add_f32 v225, v225, v13
    v_add_f32 v226, v226, v45
    v_cvt_pk_bf16_f32 v10, v12, v13
    v_cvt_pk_bf16_f32 v42, v44, v45
    v_mfma_f32_32x32x16_bf16 v[64:79], a[64:67], v[0:3], v[64:79]
    buffer_load_dwordx4 a[140:143], v224, s[8:11], s92 offen offset:3072 sc1
    v_exp_f32 v15, v15
    v_exp_f32 v47, v47
    v_mfma_f32_32x32x16_bf16 v[128:143], a[64:67], v[32:35], v[128:143]
    s_waitcnt lgkmcnt(4)
    ds_read_b128 a[88:91], v228 offset:22528
    v_add_f32 v225, v225, v14
    v_add_f32 v226, v226, v46
    v_add_f32 v225, v225, v15
    v_add_f32 v226, v226, v47
    v_cvt_pk_bf16_f32 v11, v14, v15
    v_mfma_f32_32x32x16_bf16 v[80:95], a[68:71], v[0:3], v[80:95]
    buffer_load_dwordx4 a[144:147], v252, s[8:11], s92 offen offset:0 sc1
    v_cvt_pk_bf16_f32 v43, v46, v47
    v_exp_f32 v16, v16
    v_cndmask_b32 v232, v235, v229, s[48:49]
    v_mfma_f32_32x32x16_bf16 v[144:159], a[68:71], v[32:35], v[144:159]
    s_waitcnt lgkmcnt(4)
    ds_read_b128 a[92:95], v228 offset:23552
    v_exp_f32 v48, v48
    v_exp_f32 v17, v17
    v_cndmask_b32 v233, v235, v229, s[4:5]
    v_mfma_f32_32x32x16_bf16 v[96:111], a[72:75], v[0:3], v[96:111]
    buffer_load_dwordx4 a[148:151], v252, s[8:11], s92 offen offset:1024 sc1
    v_exp_f32 v49, v49
    v_add_f32 v225, v225, v16
    v_cndmask_b32 v192, v233, v232, s[16:17]
    v_mfma_f32_32x32x16_bf16 v[160:175], a[72:75], v[32:35], v[160:175]
    s_waitcnt lgkmcnt(4)
    ds_read_b128 a[64:67], v228 offset:32768
    v_add_f32 v226, v226, v48
    v_exp_f32 v18, v18
    v_cndmask_b32 v193, v233, v232, s[18:19]
    v_cndmask_b32 v194, v233, v232, s[20:21]
    v_mfma_f32_32x32x16_bf16 v[112:127], a[76:79], v[0:3], v[112:127]
    buffer_load_dwordx4 v224, s[12:15], s63 offen offset:2048 sc1 lds
    v_exp_f32 v50, v50
    v_add_f32 v225, v225, v17
    v_cndmask_b32 v195, v233, v232, s[22:23]
    v_mfma_f32_32x32x16_bf16 v[176:191], a[76:79], v[32:35], v[176:191]
    s_waitcnt lgkmcnt(4)
    ds_read_b128 a[68:71], v228 offset:33792
    v_add_f32 v226, v226, v49
    v_cvt_pk_bf16_f32 v16, v16, v17
    v_cvt_pk_bf16_f32 v48, v48, v49
    v_cndmask_b32 v196, v233, v232, s[24:25]
    v_cndmask_b32 v197, v233, v232, s[26:27]
    v_mfma_f32_32x32x16_bf16 v[64:79], a[80:83], v[8:11], v[64:79]
    buffer_load_dwordx4 a[152:155], v252, s[8:11], s92 offen offset:2048 sc1
    v_exp_f32 v19, v19
    v_cndmask_b32 v198, v233, v232, s[28:29]
    v_cndmask_b32 v199, v233, v232, s[30:31]
    v_mfma_f32_32x32x16_bf16 v[128:143], a[80:83], v[40:43], v[128:143]
    s_waitcnt lgkmcnt(4)
    ds_read_b128 a[72:75], v228 offset:34816
    v_exp_f32 v51, v51
    v_add_f32 v225, v225, v18
    v_add_f32 v226, v226, v50
    v_cndmask_b32 v200, v233, v232, s[32:33]
    v_mfma_f32_32x32x16_bf16 v[80:95], a[84:87], v[8:11], v[80:95]
    buffer_load_dwordx4 v224, s[12:15], s63 offen offset:3072 sc1 lds
    v_exp_f32 v20, v20
    v_cndmask_b32 v201, v233, v232, s[34:35]
    v_cndmask_b32 v202, v233, v232, s[36:37]
    v_mfma_f32_32x32x16_bf16 v[144:159], a[84:87], v[40:43], v[144:159]
    s_waitcnt lgkmcnt(4)
    ds_read_b128 a[76:79], v228 offset:35840
    v_exp_f32 v52, v52
    v_add_f32 v225, v225, v19
    v_add_f32 v226, v226, v51
    v_cndmask_b32 v203, v233, v232, s[38:39]
    v_mfma_f32_32x32x16_bf16 v[96:111], a[88:91], v[8:11], v[96:111]
    buffer_load_dwordx4 a[156:159], v252, s[8:11], s92 offen offset:3072 sc1
    s_add_u32 s92, s92, 8192
    v_cvt_pk_bf16_f32 v17, v18, v19
    v_cvt_pk_bf16_f32 v49, v50, v51
    v_cndmask_b32 v204, v233, v232, s[40:41]
    v_mfma_f32_32x32x16_bf16 v[160:175], a[88:91], v[40:43], v[160:175]
    s_waitcnt lgkmcnt(4)
    ds_read_b128 a[80:83], v228 offset:36864
    v_exp_f32 v21, v21
    v_exp_f32 v53, v53
    v_cndmask_b32 v205, v233, v232, s[42:43]
    v_mfma_f32_32x32x16_bf16 v[112:127], a[92:95], v[8:11], v[112:127]
    buffer_load_dwordx4 a[160:163], v224, s[8:11], s92 offen offset:0 sc1
    v_add_f32 v225, v225, v20
    v_add_f32 v226, v226, v52
    v_cndmask_b32 v206, v233, v232, s[44:45]
    v_cndmask_b32 v207, v233, v232, s[46:47]
    v_mfma_f32_32x32x16_bf16 v[176:191], a[92:95], v[40:43], v[176:191]
    s_waitcnt lgkmcnt(4)
    ds_read_b128 a[84:87], v228 offset:37888
    v_mfma_f32_32x32x16_bf16 v[0:15], a[64:67], a[0:3], v[192:207]
    s_add_u32 m0, s55, 36864
    s_add_u32 s63, s54, 37888
    buffer_load_dwordx4 a[164:167], v224, s[8:11], s92 offen offset:1024 sc1
    v_exp_f32 v22, v22
    v_mfma_f32_32x32x16_bf16 v[32:47], a[64:67], a[32:35], v[208:223]
    s_waitcnt lgkmcnt(4)
    ds_read_b128 a[88:91], v228 offset:38912
    v_exp_f32 v54, v54
    v_add_f32 v225, v225, v21
    v_add_f32 v226, v226, v53
    v_cvt_pk_bf16_f32 v18, v20, v21
    v_mfma_f32_32x32x16_bf16 v[0:15], a[68:71], a[4:7], v[0:15]
    buffer_load_dwordx4 v224, s[12:15], s63 offen offset:0 sc1 lds
    v_cvt_pk_bf16_f32 v50, v52, v53
    v_exp_f32 v23, v23
    v_mfma_f32_32x32x16_bf16 v[32:47], a[68:71], a[36:39], v[32:47]
    s_waitcnt lgkmcnt(4)
    ds_read_b128 a[92:95], v228 offset:39936
    v_exp_f32 v55, v55
    v_add_f32 v225, v225, v22
    v_add_f32 v226, v226, v54
    v_mfma_f32_32x32x16_bf16 v[0:15], a[72:75], a[8:11], v[0:15]
    buffer_load_dwordx4 a[168:171], v224, s[8:11], s92 offen offset:2048 sc1
    v_exp_f32 v24, v24
    v_exp_f32 v56, v56
    v_mfma_f32_32x32x16_bf16 v[32:47], a[72:75], a[40:43], v[32:47]
    s_waitcnt lgkmcnt(4)
    ds_read_b128 a[64:67], v228 offset:24576
    v_add_f32 v225, v225, v23
    v_add_f32 v226, v226, v55
    v_cvt_pk_bf16_f32 v19, v22, v23
    v_cvt_pk_bf16_f32 v51, v54, v55
    v_mfma_f32_32x32x16_bf16 v[0:15], a[76:79], a[12:15], v[0:15]
    buffer_load_dwordx4 a[172:175], v224, s[8:11], s92 offen offset:3072 sc1
    v_exp_f32 v25, v25
    v_exp_f32 v57, v57
    v_mfma_f32_32x32x16_bf16 v[32:47], a[76:79], a[44:47], v[32:47]
    s_waitcnt lgkmcnt(4)
    ds_read_b128 a[68:71], v228 offset:25600
    v_add_f32 v225, v225, v24
    v_add_f32 v226, v226, v56
    v_exp_f32 v26, v26
    v_mfma_f32_32x32x16_bf16 v[0:15], a[80:83], a[16:19], v[0:15]
    s_cmp_le_u32 s71, 3
    buffer_load_dwordx4 v224, s[12:15], s63 offen offset:1024 sc1 lds
    v_exp_f32 v58, v58
    v_add_f32 v225, v225, v25
    v_add_f32 v226, v226, v57
    v_mfma_f32_32x32x16_bf16 v[32:47], a[80:83], a[48:51], v[32:47]
    s_waitcnt lgkmcnt(4)
    ds_read_b128 a[72:75], v228 offset:26624
    v_cvt_pk_bf16_f32 v24, v24, v25
    v_cvt_pk_bf16_f32 v56, v56, v57
    v_exp_f32 v27, v27
    v_mfma_f32_32x32x16_bf16 v[0:15], a[84:87], a[20:23], v[0:15]
    s_cselect_b64 s[48:49], -1, 0
    buffer_load_dwordx4 a[176:179], v252, s[8:11], s92 offen offset:0 sc1
    v_exp_f32 v59, v59
    v_add_f32 v225, v225, v26
    v_add_f32 v226, v226, v58
    v_mfma_f32_32x32x16_bf16 v[32:47], a[84:87], a[52:55], v[32:47]
    s_waitcnt lgkmcnt(4)
    ds_read_b128 a[76:79], v228 offset:27648
    v_exp_f32 v28, v28
    v_exp_f32 v60, v60
    v_add_f32 v225, v225, v27
    v_mfma_f32_32x32x16_bf16 v[0:15], a[88:91], a[24:27], v[0:15]
    s_cmp_lt_u32 s71, 3
    buffer_load_dwordx4 a[180:183], v252, s[8:11], s92 offen offset:1024 sc1
    v_add_f32 v226, v226, v59
    v_cvt_pk_bf16_f32 v25, v26, v27
    v_cvt_pk_bf16_f32 v57, v58, v59
    v_mfma_f32_32x32x16_bf16 v[32:47], a[88:91], a[56:59], v[32:47]
    s_waitcnt lgkmcnt(4)
    ds_read_b128 a[80:83], v228 offset:28672
    v_exp_f32 v29, v29
    v_exp_f32 v61, v61
    v_add_f32 v225, v225, v28
    v_mfma_f32_32x32x16_bf16 v[0:15], a[92:95], a[28:31], v[0:15]
    s_cselect_b64 s[4:5], -1, 0
    buffer_load_dwordx4 v224, s[12:15], s63 offen offset:2048 sc1 lds
    v_add_f32 v226, v226, v60
    v_exp_f32 v30, v30
    v_mfma_f32_32x32x16_bf16 v[32:47], a[92:95], a[60:63], v[32:47]
    s_waitcnt lgkmcnt(4)
    ds_read_b128 a[84:87], v228 offset:29696
    v_exp_f32 v62, v62
    v_add_f32 v225, v225, v29
    v_add_f32 v226, v226, v61
    v_cvt_pk_bf16_f32 v26, v28, v29
    v_mfma_f32_32x32x16_bf16 v[64:79], a[64:67], v[16:19], v[64:79]
    buffer_load_dwordx4 a[184:187], v252, s[8:11], s92 offen offset:2048 sc1
    v_cvt_pk_bf16_f32 v58, v60, v61
    v_exp_f32 v31, v31
    v_cndmask_b32 v232, v235, v229, s[48:49]
    v_mfma_f32_32x32x16_bf16 v[128:143], a[64:67], v[48:51], v[128:143]
    s_waitcnt lgkmcnt(4)
    ds_read_b128 a[88:91], v228 offset:30720
    v_exp_f32 v63, v63
    v_add_f32 v225, v225, v30
    v_add_f32 v226, v226, v62
    v_add_f32 v225, v225, v31
    v_mfma_f32_32x32x16_bf16 v[80:95], a[68:71], v[16:19], v[80:95]
    buffer_load_dwordx4 a[188:191], v252, s[8:11], s92 offen offset:3072 sc1
    s_add_u32 s92, s92, 8192
    v_add_f32 v226, v226, v63
    v_cvt_pk_bf16_f32 v27, v30, v31
    v_cvt_pk_bf16_f32 v59, v62, v63
    v_mfma_f32_32x32x16_bf16 v[144:159], a[68:71], v[48:51], v[144:159]
    s_waitcnt lgkmcnt(4)
    ds_read_b128 a[92:95], v228 offset:31744
    v_exp_f32 v0, v0
    v_exp_f32 v32, v32
    v_cndmask_b32 v233, v235, v229, s[4:5]
    v_mfma_f32_32x32x16_bf16 v[96:111], a[72:75], v[16:19], v[96:111]
    buffer_load_dwordx4 a[192:195], v224, s[8:11], s92 offen offset:0 sc1
    v_exp_f32 v1, v1
    v_exp_f32 v33, v33
    v_mfma_f32_32x32x16_bf16 v[160:175], a[72:75], v[48:51], v[160:175]
    s_waitcnt lgkmcnt(4)
    ds_read_b128 a[64:67], v228 offset:40960
    v_add_f32 v225, v225, v0
    v_add_f32 v226, v226, v32
    v_exp_f32 v2, v2
    v_cndmask_b32 v192, v233, v232, s[16:17]
    v_mfma_f32_32x32x16_bf16 v[112:127], a[76:79], v[16:19], v[112:127]
    buffer_load_dwordx4 v224, s[12:15], s63 offen offset:3072 sc1 lds
    v_exp_f32 v34, v34
    v_add_f32 v225, v225, v1
    v_add_f32 v226, v226, v33
    v_mfma_f32_32x32x16_bf16 v[176:191], a[76:79], v[48:51], v[176:191]
    s_waitcnt lgkmcnt(4)
    ds_read_b128 a[68:71], v228 offset:41984
    v_cvt_pk_bf16_f32 v0, v0, v1
    v_cvt_pk_bf16_f32 v32, v32, v33
    v_exp_f32 v3, v3
    v_cndmask_b32 v193, v233, v232, s[18:19]
    v_mfma_f32_32x32x16_bf16 v[64:79], a[80:83], v[24:27], v[64:79]
    s_add_u32 s54, s54, 67584
    buffer_load_dwordx4 a[196:199], v224, s[8:11], s92 offen offset:1024 sc1
    v_exp_f32 v35, v35
    v_add_f32 v225, v225, v2
    v_add_f32 v226, v226, v34
    v_mfma_f32_32x32x16_bf16 v[128:143], a[80:83], v[56:59], v[128:143]
    s_waitcnt lgkmcnt(4)
    ds_read_b128 a[72:75], v228 offset:43008
    v_exp_f32 v4, v4
    v_exp_f32 v36, v36
    v_add_f32 v225, v225, v3
    v_mfma_f32_32x32x16_bf16 v[80:95], a[84:87], v[24:27], v[80:95]
    s_xor_b32 s55, s55, 0x10000
    buffer_load_dwordx4 a[200:203], v224, s[8:11], s92 offen offset:2048 sc1
    v_add_f32 v226, v226, v35
    v_cvt_pk_bf16_f32 v1, v2, v3
    v_cvt_pk_bf16_f32 v33, v34, v35
    v_cndmask_b32 v194, v233, v232, s[20:21]
    v_mfma_f32_32x32x16_bf16 v[144:159], a[84:87], v[56:59], v[144:159]
    s_waitcnt lgkmcnt(4)
    ds_read_b128 a[76:79], v228 offset:44032
    v_exp_f32 v5, v5
    v_exp_f32 v37, v37
    v_add_f32 v225, v225, v4
    v_mfma_f32_32x32x16_bf16 v[96:111], a[88:91], v[24:27], v[96:111]
    buffer_load_dwordx4 a[204:207], v224, s[8:11], s92 offen offset:3072 sc1
    v_add_f32 v226, v226, v36
    v_cndmask_b32 v195, v233, v232, s[22:23]
    v_cndmask_b32 v196, v233, v232, s[24:25]
    v_cndmask_b32 v197, v233, v232, s[26:27]
    v_mfma_f32_32x32x16_bf16 v[160:175], a[88:91], v[56:59], v[160:175]
    s_waitcnt lgkmcnt(4)
    ds_read_b128 a[80:83], v228 offset:45056
    v_cndmask_b32 v198, v233, v232, s[28:29]
    v_cndmask_b32 v199, v233, v232, s[30:31]
    v_cndmask_b32 v200, v233, v232, s[32:33]
    v_cndmask_b32 v201, v233, v232, s[34:35]
    v_cndmask_b32 v202, v233, v232, s[36:37]
    v_mfma_f32_32x32x16_bf16 v[112:127], a[92:95], v[24:27], v[112:127]
    buffer_load_dwordx4 a[208:211], v252, s[8:11], s92 offen offset:0 sc1
    v_cndmask_b32 v203, v233, v232, s[38:39]
    v_cndmask_b32 v204, v233, v232, s[40:41]
    v_cndmask_b32 v205, v233, v232, s[42:43]
    v_cndmask_b32 v206, v233, v232, s[44:45]
    v_cndmask_b32 v207, v233, v232, s[46:47]
    v_mfma_f32_32x32x16_bf16 v[176:191], a[92:95], v[56:59], v[176:191]
    s_waitcnt lgkmcnt(4)
    s_waitcnt vmcnt(33)
    s_barrier
    ds_read_b128 a[84:87], v228 offset:46080
    v_mfma_f32_32x32x16_bf16 v[16:31], a[64:67], a[0:3], v[192:207]
    buffer_store_dword v253, v255, s[8:11], s96 offen sc1
    buffer_store_dwordx4 a[96:99], v252, s[8:11], s52 offen offset:0 sc1
    v_exp_f32 v6, v6
    v_mfma_f32_32x32x16_bf16 v[48:63], a[64:67], a[32:35], v[208:223]
    s_waitcnt lgkmcnt(4)
    s_mov_b32 s96, 0x7f000000
    ds_read_b128 a[88:91], v228 offset:47104
    v_exp_f32 v38, v38
    v_add_f32 v225, v225, v5
    v_add_f32 v226, v226, v37
    v_mfma_f32_32x32x16_bf16 v[16:31], a[68:71], a[4:7], v[16:31]
    s_mov_b32 m0, s55
    buffer_load_dwordx4 a[212:215], v252, s[8:11], s92 offen offset:1024 sc1
    v_cvt_pk_bf16_f32 v2, v4, v5
    v_cvt_pk_bf16_f32 v34, v36, v37
    v_exp_f32 v7, v7
    v_mfma_f32_32x32x16_bf16 v[48:63], a[68:71], a[36:39], v[48:63]
    s_waitcnt lgkmcnt(4)
    ds_read_b128 a[92:95], v228 offset:48128
    v_exp_f32 v39, v39
    v_add_f32 v225, v225, v6
    v_add_f32 v226, v226, v38
    v_mfma_f32_32x32x16_bf16 v[16:31], a[72:75], a[8:11], v[16:31]
    buffer_load_dwordx4 v224, s[12:15], s54 offen offset:0 sc1 lds
    v_exp_f32 v8, v8
    v_exp_f32 v40, v40
    v_mfma_f32_32x32x16_bf16 v[48:63], a[72:75], a[40:43], v[48:63]
    s_waitcnt lgkmcnt(4)
    ds_read_b128 a[64:67], v228 offset:49152
    v_add_f32 v225, v225, v7
    v_add_f32 v226, v226, v39
    v_cvt_pk_bf16_f32 v3, v6, v7
    v_cvt_pk_bf16_f32 v35, v38, v39
    v_mfma_f32_32x32x16_bf16 v[16:31], a[76:79], a[12:15], v[16:31]
    buffer_load_dwordx4 a[216:219], v252, s[8:11], s92 offen offset:2048 sc1
    v_exp_f32 v9, v9
    v_exp_f32 v41, v41
    v_mfma_f32_32x32x16_bf16 v[48:63], a[76:79], a[44:47], v[48:63]
    s_waitcnt lgkmcnt(4)
    ds_read_b128 a[68:71], v228 offset:50176
    v_add_f32 v225, v225, v8
    v_add_f32 v226, v226, v40
    v_exp_f32 v10, v10
    v_mfma_f32_32x32x16_bf16 v[16:31], a[80:83], a[16:19], v[16:31]
    buffer_load_dwordx4 a[220:223], v252, s[8:11], s92 offen offset:3072 sc1
    s_add_u32 s92, s92, 8192
    v_exp_f32 v42, v42
    v_add_f32 v225, v225, v9
    v_mfma_f32_32x32x16_bf16 v[48:63], a[80:83], a[48:51], v[48:63]
    s_waitcnt lgkmcnt(4)
    ds_read_b128 a[72:75], v228 offset:51200
    v_add_f32 v226, v226, v41
    v_cvt_pk_bf16_f32 v8, v8, v9
    v_cvt_pk_bf16_f32 v40, v40, v41
    v_exp_f32 v11, v11
    v_mfma_f32_32x32x16_bf16 v[16:31], a[84:87], a[20:23], v[16:31]
    buffer_load_dwordx4 v224, s[12:15], s54 offen offset:1024 sc1 lds
    v_exp_f32 v43, v43
    v_add_f32 v225, v225, v10
    v_add_f32 v226, v226, v42
    v_mfma_f32_32x32x16_bf16 v[48:63], a[84:87], a[52:55], v[48:63]
    s_waitcnt lgkmcnt(4)
    ds_read_b128 a[76:79], v228 offset:52224
    v_exp_f32 v12, v12
    v_exp_f32 v44, v44
    v_add_f32 v225, v225, v11
    v_mfma_f32_32x32x16_bf16 v[16:31], a[88:91], a[24:27], v[16:31]
    buffer_load_dwordx4 a[224:227], v224, s[8:11], s92 offen offset:0 sc1
    v_add_f32 v226, v226, v43
    v_cvt_pk_bf16_f32 v9, v10, v11
    v_cvt_pk_bf16_f32 v41, v42, v43
    v_mfma_f32_32x32x16_bf16 v[48:63], a[88:91], a[56:59], v[48:63]
    s_waitcnt lgkmcnt(4)
    ds_read_b128 a[80:83], v228 offset:53248
    v_exp_f32 v13, v13
    v_exp_f32 v45, v45
    v_add_f32 v225, v225, v12
    v_mfma_f32_32x32x16_bf16 v[16:31], a[92:95], a[28:31], v[16:31]
    buffer_load_dwordx4 a[228:231], v224, s[8:11], s92 offen offset:1024 sc1
    v_add_f32 v226, v226, v44
    v_exp_f32 v14, v14
    v_mfma_f32_32x32x16_bf16 v[48:63], a[92:95], a[60:63], v[48:63]
    s_waitcnt lgkmcnt(4)
    ds_read_b128 a[84:87], v228 offset:54272
    v_exp_f32 v46, v46
    v_add_f32 v225, v225, v13
    v_add_f32 v226, v226, v45
    v_cvt_pk_bf16_f32 v10, v12, v13
    v_mfma_f32_32x32x16_bf16 v[64:79], a[64:67], v[0:3], v[64:79]
    buffer_load_dwordx4 a[232:235], v224, s[8:11], s92 offen offset:2048 sc1
    v_cvt_pk_bf16_f32 v42, v44, v45
    v_exp_f32 v15, v15
    v_mfma_f32_32x32x16_bf16 v[128:143], a[64:67], v[32:35], v[128:143]
    s_waitcnt lgkmcnt(4)
    ds_read_b128 a[88:91], v228 offset:55296
    v_exp_f32 v47, v47
    v_add_f32 v225, v225, v14
    v_add_f32 v226, v226, v46
    v_add_f32 v225, v225, v15
    v_mfma_f32_32x32x16_bf16 v[80:95], a[68:71], v[0:3], v[80:95]
    buffer_store_dwordx4 a[96:99], v252, s[8:11], s52 offen offset:1024 sc1
    buffer_load_dwordx4 a[236:239], v224, s[8:11], s92 offen offset:3072 sc1
    v_add_f32 v226, v226, v47
    v_cvt_pk_bf16_f32 v11, v14, v15
    v_mfma_f32_32x32x16_bf16 v[144:159], a[68:71], v[32:35], v[144:159]
    s_waitcnt lgkmcnt(4)
    ds_read_b128 a[92:95], v228 offset:56320
    v_cvt_pk_bf16_f32 v43, v46, v47
    v_exp_f32 v16, v16
    v_exp_f32 v48, v48
    v_mfma_f32_32x32x16_bf16 v[96:111], a[72:75], v[0:3], v[96:111]
    buffer_load_dwordx4 a[240:243], v252, s[8:11], s92 offen offset:0 sc1
    v_exp_f32 v17, v17
    v_exp_f32 v49, v49
    v_mfma_f32_32x32x16_bf16 v[160:175], a[72:75], v[32:35], v[160:175]
    s_waitcnt lgkmcnt(4)
    ds_read_b128 a[64:67], v227 offset:0
    v_add_f32 v225, v225, v16
    v_add_f32 v226, v226, v48
    v_exp_f32 v18, v18
    v_mfma_f32_32x32x16_bf16 v[112:127], a[76:79], v[0:3], v[112:127]
    buffer_load_dwordx4 v224, s[12:15], s54 offen offset:2048 sc1 lds
    v_exp_f32 v50, v50
    v_add_f32 v225, v225, v17
    v_add_f32 v226, v226, v49
    v_mfma_f32_32x32x16_bf16 v[176:191], a[76:79], v[32:35], v[176:191]
    s_waitcnt lgkmcnt(4)
    ds_read_b128 a[68:71], v227 offset:1024
    v_cvt_pk_bf16_f32 v16, v16, v17
    v_cvt_pk_bf16_f32 v48, v48, v49
    v_exp_f32 v19, v19
    v_mfma_f32_32x32x16_bf16 v[64:79], a[80:83], v[8:11], v[64:79]
    buffer_load_dwordx4 a[244:247], v252, s[8:11], s92 offen offset:1024 sc1
    v_exp_f32 v51, v51
    v_add_f32 v225, v225, v18
    v_add_f32 v226, v226, v50
    v_mfma_f32_32x32x16_bf16 v[128:143], a[80:83], v[40:43], v[128:143]
    s_waitcnt lgkmcnt(4)
    ds_read_b128 a[72:75], v227 offset:2048
    v_exp_f32 v20, v20
    v_exp_f32 v52, v52
    v_add_f32 v225, v225, v19
    v_mfma_f32_32x32x16_bf16 v[80:95], a[84:87], v[8:11], v[80:95]
    s_add_u32 s61, s61, 2
    buffer_load_dwordx4 v224, s[12:15], s54 offen offset:3072 sc1 lds
    v_add_f32 v226, v226, v51
    v_cvt_pk_bf16_f32 v17, v18, v19
    v_cvt_pk_bf16_f32 v49, v50, v51
    v_mfma_f32_32x32x16_bf16 v[144:159], a[84:87], v[40:43], v[144:159]
    s_waitcnt lgkmcnt(4)
    ds_read_b128 a[76:79], v227 offset:3072
    v_exp_f32 v21, v21
    v_exp_f32 v53, v53
    v_add_f32 v225, v225, v20
    v_mfma_f32_32x32x16_bf16 v[96:111], a[88:91], v[8:11], v[96:111]
    ds_read_b128 a[84:87], v227 offset:5120
    buffer_load_dwordx4 a[248:251], v252, s[8:11], s92 offen offset:2048 sc1
    v_xor_b32 v228, 0x10000, v228
    v_add_f32 v226, v226, v52
    v_mfma_f32_32x32x16_bf16 v[160:175], a[88:91], v[40:43], v[160:175]
    s_waitcnt lgkmcnt(5)
    ds_read_b128 a[80:83], v227 offset:4096
    v_mfma_f32_32x32x16_bf16 v[112:127], a[92:95], v[8:11], v[112:127]
    buffer_load_dwordx4 a[252:255], v252, s[8:11], s92 offen offset:3072 sc1
    s_add_u32 s92, s92, 8192
    v_xor_b32 v227, 0x10000, v227
    v_mfma_f32_32x32x16_bf16 v[176:191], a[92:95], v[40:43], v[176:191]
    s_waitcnt lgkmcnt(5)
    s_cmp_eq_u32 s74, 7
    s_cselect_b32 s62, s92, s62
L_dA_sequential_preLN__compressed_kv_cla__geglu_ffn__prompt_kernel:
    v_add_u32 v234, 0x8000, v227
    ds_read_b128 a[96:99], v234 offset:24576
    ds_read_b128 a[100:103], v234 offset:25600
    ds_read_b128 a[104:107], v234 offset:26624
    ds_read_b128 a[108:111], v234 offset:27648
    ds_read_b128 a[112:115], v234 offset:28672
    ds_read_b128 a[116:119], v234 offset:29696
    ds_read_b128 a[120:123], v234 offset:30720
    ds_read_b128 a[124:127], v234 offset:31744
    v_exp_f32 v22, v22
    v_add_f32 v225, v225, v21
    v_cvt_pk_bf16_f32 v18, v20, v21
    v_exp_f32 v23, v23
    v_add_f32 v225, v225, v22
    v_exp_f32 v24, v24
    v_add_f32 v225, v225, v23
    v_cvt_pk_bf16_f32 v19, v22, v23
    s_nop 0
    s_waitcnt lgkmcnt(7)
    v_mfma_f32_32x32x16_bf16 v[64:79], a[96:99], v[16:19], v[64:79]
    v_exp_f32 v25, v25
    v_add_f32 v225, v225, v24
    v_exp_f32 v26, v26
    v_add_f32 v225, v225, v25
    v_cvt_pk_bf16_f32 v24, v24, v25
    s_waitcnt lgkmcnt(6)
    v_mfma_f32_32x32x16_bf16 v[80:95], a[100:103], v[16:19], v[80:95]
    v_exp_f32 v27, v27
    v_add_f32 v225, v225, v26
    v_exp_f32 v28, v28
    v_add_f32 v225, v225, v27
    v_cvt_pk_bf16_f32 v25, v26, v27
    s_waitcnt lgkmcnt(5)
    v_mfma_f32_32x32x16_bf16 v[96:111], a[104:107], v[16:19], v[96:111]
    v_exp_f32 v29, v29
    v_add_f32 v225, v225, v28
    v_exp_f32 v30, v30
    v_add_f32 v225, v225, v29
    v_cvt_pk_bf16_f32 v26, v28, v29
    s_waitcnt lgkmcnt(4)
    v_mfma_f32_32x32x16_bf16 v[112:127], a[108:111], v[16:19], v[112:127]
    v_exp_f32 v31, v31
    v_add_f32 v225, v225, v30
    s_nop 0
    v_add_f32 v225, v225, v31
    v_cvt_pk_bf16_f32 v27, v30, v31
    s_nop 1
    s_waitcnt lgkmcnt(3)
    v_mfma_f32_32x32x16_bf16 v[64:79], a[112:115], v[24:27], v[64:79]
    v_mov_b32 v232, v225
    s_nop 1
    v_permlane32_swap_b32 v232, v225
    s_lshr_b32 s57, s74, 2
    s_mul_i32 s59, s57, 7
    s_xor_b32 s59, s59, s74
    s_lshl_b32 s59, s59, 2
    s_add_u32 s59, s59, s71
    s_lshl_b32 s59, s59, 1
    s_add_u32 s59, s59, s57
    s_lshl_b32 s59, s59, 5
    s_add_u32 s59, s59, s75
    s_lshl_b32 s59, s59, 7
    s_waitcnt lgkmcnt(2)
    v_mfma_f32_32x32x16_bf16 v[80:95], a[116:119], v[24:27], v[80:95]
    v_add_f32 v225, v225, v232
    v_rcp_f32 v232, v225
    v_cmp_nge_f32 vcc, 0x53800000, v225
    s_add_u32 s59, s59, 0x4ea0000
    v_and_b32 v250, 0x200, v224
    v_lshrrev_b32 v251, 2, v224
    s_cmp_eq_u32 s74, 7
    v_lshl_add_u32 v251, v250, 21, v251
    s_cselect_b32 s57, s59, 0x7f000000
    s_and_b32 s53, s2, 1
    s_lshl_b32 s53, s53, 3
    s_add_u32 s53, s53, s74
    s_bfe_u32 s70, s2, 0x20001
    s_waitcnt lgkmcnt(1)
    v_mfma_f32_32x32x16_bf16 v[96:111], a[120:123], v[24:27], v[96:111]
    s_lshl_b32 s56, s53, 3
    s_add_u32 s56, s56, s70
    s_lshl_b32 s56, s56, 10
    s_add_u32 s56, s56, 0x4ea0000
    s_lshl_b32 s87, s70, 4
    s_add_u32 s87, s87, s71
    s_lshl_b32 s87, s87, 12
    s_mul_i32 s86, s53, 1114112
    s_add_u32 s87, s87, s86
    s_add_u32 s87, s87, 0x2500000
    s_waitcnt lgkmcnt(0)
    v_mfma_f32_32x32x16_bf16 v[112:127], a[124:127], v[24:27], v[112:127]
    v_lshlrev_b32 v250, 3, v224
    s_and_b32 s86, s74, 1
    v_and_b32 v250, 0x380, v250
    s_lshl_b32 s86, s86, 16
    s_cmp_eq_u32 s70, 0
    s_cselect_b32 s53, 4096, 0
    s_cselect_b32 s48, 557056, 0
    s_add_u32 s53, s53, s56
    s_add_u32 s48, s48, s87
L_finA_sequential_preLN__compressed_kv_cla__geglu_ffn__prompt_kernel:
    s_cbranch_vccnz L_redoA_sequential_preLN__compressed_kv_cla__geglu_ffn__prompt_kernel
L_redoneA_sequential_preLN__compressed_kv_cla__geglu_ffn__prompt_kernel:
    v_pk_mul_f32 v[64:65], v[64:65], v[232:233] op_sel_hi:[1,0]
    v_pk_mul_f32 v[66:67], v[66:67], v[232:233] op_sel_hi:[1,0]
    v_pk_mul_f32 v[68:69], v[68:69], v[232:233] op_sel_hi:[1,0]
    v_pk_mul_f32 v[70:71], v[70:71], v[232:233] op_sel_hi:[1,0]
    v_cvt_pk_bf16_f32 v64, v64, v65
    v_cvt_pk_bf16_f32 v65, v66, v67
    v_cvt_pk_bf16_f32 v66, v68, v69
    v_cvt_pk_bf16_f32 v67, v70, v71
    buffer_store_dwordx4 v[64:67], v224, s[8:11], s64 offen offset:0 sc1
    v_pk_mul_f32 v[72:73], v[72:73], v[232:233] op_sel_hi:[1,0]
    v_pk_mul_f32 v[74:75], v[74:75], v[232:233] op_sel_hi:[1,0]
    v_pk_mul_f32 v[76:77], v[76:77], v[232:233] op_sel_hi:[1,0]
    v_pk_mul_f32 v[78:79], v[78:79], v[232:233] op_sel_hi:[1,0]
    v_cvt_pk_bf16_f32 v72, v72, v73
    v_cvt_pk_bf16_f32 v73, v74, v75
    v_cvt_pk_bf16_f32 v74, v76, v77
    v_cvt_pk_bf16_f32 v75, v78, v79
    buffer_store_dwordx4 v[72:75], v224, s[8:11], s64 offen offset:1024 sc1
    v_pk_mul_f32 v[80:81], v[80:81], v[232:233] op_sel_hi:[1,0]
    v_pk_mul_f32 v[82:83], v[82:83], v[232:233] op_sel_hi:[1,0]
    v_pk_mul_f32 v[84:85], v[84:85], v[232:233] op_sel_hi:[1,0]
    v_pk_mul_f32 v[86:87], v[86:87], v[232:233] op_sel_hi:[1,0]
    v_cvt_pk_bf16_f32 v80, v80, v81
    v_cvt_pk_bf16_f32 v81, v82, v83
    v_cvt_pk_bf16_f32 v82, v84, v85
    v_cvt_pk_bf16_f32 v83, v86, v87
    buffer_store_dwordx4 v[80:83], v224, s[8:11], s64 offen offset:2048 sc1
    v_pk_mul_f32 v[88:89], v[88:89], v[232:233] op_sel_hi:[1,0]
    v_pk_mul_f32 v[90:91], v[90:91], v[232:233] op_sel_hi:[1,0]
    v_pk_mul_f32 v[92:93], v[92:93], v[232:233] op_sel_hi:[1,0]
    v_pk_mul_f32 v[94:95], v[94:95], v[232:233] op_sel_hi:[1,0]
    v_cvt_pk_bf16_f32 v88, v88, v89
    v_cvt_pk_bf16_f32 v89, v90, v91
    v_cvt_pk_bf16_f32 v90, v92, v93
    v_cvt_pk_bf16_f32 v91, v94, v95
    buffer_store_dwordx4 v[88:91], v224, s[8:11], s64 offen offset:3072 sc1
    v_pk_mul_f32 v[96:97], v[96:97], v[232:233] op_sel_hi:[1,0]
    v_pk_mul_f32 v[98:99], v[98:99], v[232:233] op_sel_hi:[1,0]
    v_pk_mul_f32 v[100:101], v[100:101], v[232:233] op_sel_hi:[1,0]
    v_pk_mul_f32 v[102:103], v[102:103], v[232:233] op_sel_hi:[1,0]
    v_cvt_pk_bf16_f32 v96, v96, v97
    v_cvt_pk_bf16_f32 v97, v98, v99
    v_cvt_pk_bf16_f32 v98, v100, v101
    v_cvt_pk_bf16_f32 v99, v102, v103
    s_add_u32 s64, s64, 4096
    buffer_store_dwordx4 v[96:99], v224, s[8:11], s64 offen offset:0 sc1
    v_pk_mul_f32 v[104:105], v[104:105], v[232:233] op_sel_hi:[1,0]
    v_pk_mul_f32 v[106:107], v[106:107], v[232:233] op_sel_hi:[1,0]
    v_pk_mul_f32 v[108:109], v[108:109], v[232:233] op_sel_hi:[1,0]
    v_pk_mul_f32 v[110:111], v[110:111], v[232:233] op_sel_hi:[1,0]
    v_cvt_pk_bf16_f32 v104, v104, v105
    v_cvt_pk_bf16_f32 v105, v106, v107
    v_cvt_pk_bf16_f32 v106, v108, v109
    v_cvt_pk_bf16_f32 v107, v110, v111
    buffer_store_dwordx4 v[104:107], v224, s[8:11], s64 offen offset:1024 sc1
    v_pk_mul_f32 v[112:113], v[112:113], v[232:233] op_sel_hi:[1,0]
    v_pk_mul_f32 v[114:115], v[114:115], v[232:233] op_sel_hi:[1,0]
    v_pk_mul_f32 v[116:117], v[116:117], v[232:233] op_sel_hi:[1,0]
    v_pk_mul_f32 v[118:119], v[118:119], v[232:233] op_sel_hi:[1,0]
    v_cvt_pk_bf16_f32 v112, v112, v113
    v_cvt_pk_bf16_f32 v113, v114, v115
    v_cvt_pk_bf16_f32 v114, v116, v117
    v_cvt_pk_bf16_f32 v115, v118, v119
    buffer_store_dwordx4 v[112:115], v224, s[8:11], s64 offen offset:2048 sc1
    v_pk_mul_f32 v[120:121], v[120:121], v[232:233] op_sel_hi:[1,0]
    v_pk_mul_f32 v[122:123], v[122:123], v[232:233] op_sel_hi:[1,0]
    v_pk_mul_f32 v[124:125], v[124:125], v[232:233] op_sel_hi:[1,0]
    v_pk_mul_f32 v[126:127], v[126:127], v[232:233] op_sel_hi:[1,0]
    v_cvt_pk_bf16_f32 v120, v120, v121
    v_cvt_pk_bf16_f32 v121, v122, v123
    v_cvt_pk_bf16_f32 v122, v124, v125
    v_cvt_pk_bf16_f32 v123, v126, v127
    buffer_store_dwordx4 v[120:123], v224, s[8:11], s64 offen offset:3072 sc1
    s_cmp_eq_u32 s74, 7
    s_waitcnt vmcnt(19)
    s_cbranch_scc1 L_S1x_sequential_preLN__compressed_kv_cla__geglu_ffn__prompt_kernel
    s_cmp_eq_u32 s74, 6
    s_cbranch_scc1 L_R_sequential_preLN__compressed_kv_cla__geglu_ffn__prompt_kernel
    s_cmp_eq_u32 s74, 0
    s_cbranch_scc1 L_mk0_sequential_preLN__compressed_kv_cla__geglu_ffn__prompt_kernel
.p2align 4
L_single_sequential_preLN__compressed_kv_cla__geglu_ffn__prompt_kernel:
    v_mfma_f32_32x32x16_bf16 v[32:47], a[64:67], a[32:35], v[208:223]
    s_add_u32 m0, s55, 4096
    s_add_u32 s63, s54, 4096
    ds_read_b128 a[88:91], v228 offset:6144
    v_exp_f32 v54, v54
    v_add_f32 v226, v226, v53
    v_cvt_pk_bf16_f32 v50, v52, v53
    v_mfma_f32_32x32x16_bf16 v[32:47], a[68:71], a[36:39], v[32:47]
    s_waitcnt lgkmcnt(3)
    ds_read_b128 a[92:95], v228 offset:7168
    buffer_load_dwordx4 v224, s[12:15], s63 offen offset:0 sc1 lds
    v_exp_f32 v55, v55
    v_add_f32 v226, v226, v54
    v_mfma_f32_32x32x16_bf16 v[32:47], a[72:75], a[40:43], v[32:47]
    ds_read_b128 a[64:67], v227 offset:57344
    v_exp_f32 v56, v56
    v_add_f32 v226, v226, v55
    v_cvt_pk_bf16_f32 v51, v54, v55
    v_mfma_f32_32x32x16_bf16 v[32:47], a[76:79], a[44:47], v[32:47]
    s_waitcnt lgkmcnt(3)
    ds_read_b128 a[68:71], v227 offset:58368
    buffer_load_dwordx4 v224, s[12:15], s63 offen offset:1024 sc1 lds
    v_exp_f32 v57, v57
    v_add_f32 v226, v226, v56
    v_mfma_f32_32x32x16_bf16 v[32:47], a[80:83], a[48:51], v[32:47]
    ds_read_b128 a[72:75], v227 offset:59392
    v_exp_f32 v58, v58
    v_add_f32 v226, v226, v57
    v_cvt_pk_bf16_f32 v56, v56, v57
    v_mfma_f32_32x32x16_bf16 v[32:47], a[84:87], a[52:55], v[32:47]
    s_waitcnt lgkmcnt(3)
    ds_read_b128 a[76:79], v227 offset:60416
    buffer_load_dwordx4 v224, s[12:15], s63 offen offset:2048 sc1 lds
    v_exp_f32 v59, v59
    v_add_f32 v226, v226, v58
    v_mfma_f32_32x32x16_bf16 v[32:47], a[88:91], a[56:59], v[32:47]
    ds_read_b128 a[80:83], v227 offset:61440
    v_exp_f32 v60, v60
    v_add_f32 v226, v226, v59
    v_cvt_pk_bf16_f32 v57, v58, v59
    v_mfma_f32_32x32x16_bf16 v[32:47], a[92:95], a[60:63], v[32:47]
    s_waitcnt lgkmcnt(3)
    ds_read_b128 a[84:87], v227 offset:62464
    buffer_load_dwordx4 v224, s[12:15], s63 offen offset:3072 sc1 lds
    v_exp_f32 v61, v61
    v_add_f32 v226, v226, v60
    v_mfma_f32_32x32x16_bf16 v[128:143], a[64:67], v[48:51], v[128:143]
    ds_read_b128 a[88:91], v227 offset:63488
    v_exp_f32 v62, v62
    v_add_f32 v226, v226, v61
    v_cvt_pk_bf16_f32 v58, v60, v61
    v_mfma_f32_32x32x16_bf16 v[144:159], a[68:71], v[48:51], v[144:159]
    s_waitcnt lgkmcnt(3)
    ds_read_b128 a[92:95], v227 offset:64512
    v_exp_f32 v63, v63
    v_add_f32 v226, v226, v62
    v_exp_f32 v32, v32
    v_mfma_f32_32x32x16_bf16 v[160:175], a[72:75], v[48:51], v[160:175]
    ds_read_b128 a[64:67], v228 offset:8192
    v_add_f32 v226, v226, v63
    v_cvt_pk_bf16_f32 v59, v62, v63
    v_exp_f32 v33, v33
    v_add_f32 v226, v226, v32
    v_mfma_f32_32x32x16_bf16 v[176:191], a[76:79], v[48:51], v[176:191]
    s_waitcnt lgkmcnt(3)
    ds_read_b128 a[68:71], v228 offset:9216
    v_exp_f32 v34, v34
    v_add_f32 v226, v226, v33
    v_cvt_pk_bf16_f32 v32, v32, v33
    v_mfma_f32_32x32x16_bf16 v[128:143], a[80:83], v[56:59], v[128:143]
    ds_read_b128 a[72:75], v228 offset:10240
    v_exp_f32 v35, v35
    v_add_f32 v226, v226, v34
    v_mfma_f32_32x32x16_bf16 v[144:159], a[84:87], v[56:59], v[144:159]
    s_waitcnt lgkmcnt(3)
    ds_read_b128 a[76:79], v228 offset:11264
    v_exp_f32 v36, v36
    v_add_f32 v226, v226, v35
    v_cvt_pk_bf16_f32 v33, v34, v35
    v_mfma_f32_32x32x16_bf16 v[160:175], a[88:91], v[56:59], v[160:175]
    s_cmp_eq_u32 s61, s67
    ds_read_b128 a[80:83], v228 offset:12288
    v_exp_f32 v37, v37
    v_add_f32 v226, v226, v36
    v_mfma_f32_32x32x16_bf16 v[176:191], a[92:95], v[56:59], v[176:191]
    s_waitcnt lgkmcnt(3)
    s_cbranch_scc1 L_spbs_sequential_preLN__compressed_kv_cla__geglu_ffn__prompt_kernel
    s_waitcnt vmcnt(10)
L_spbs_sequential_preLN__compressed_kv_cla__geglu_ffn__prompt_kernel:
    s_barrier
    ds_read_b128 a[84:87], v228 offset:13312
    v_mfma_f32_32x32x16_bf16 v[48:63], a[64:67], a[32:35], v[208:223]
    s_add_u32 m0, s55, 32768
    s_add_u32 s63, s54, 33792
    ds_read_b128 a[88:91], v228 offset:14336
    v_exp_f32 v38, v38
    v_add_f32 v226, v226, v37
    v_cvt_pk_bf16_f32 v34, v36, v37
    v_mfma_f32_32x32x16_bf16 v[48:63], a[68:71], a[36:39], v[48:63]
    s_waitcnt lgkmcnt(3)
    ds_read_b128 a[92:95], v228 offset:15360
    buffer_load_dwordx4 v224, s[12:15], s63 offen offset:0 sc1 lds
    v_exp_f32 v39, v39
    v_add_f32 v226, v226, v38
    v_mfma_f32_32x32x16_bf16 v[48:63], a[72:75], a[40:43], v[48:63]
    ds_read_b128 a[64:67], v228 offset:16384
    v_exp_f32 v40, v40
    v_add_f32 v226, v226, v39
    v_cvt_pk_bf16_f32 v35, v38, v39
    v_mfma_f32_32x32x16_bf16 v[48:63], a[76:79], a[44:47], v[48:63]
    s_waitcnt lgkmcnt(3)
    ds_read_b128 a[68:71], v228 offset:17408
    buffer_load_dwordx4 v224, s[12:15], s63 offen offset:1024 sc1 lds
    v_exp_f32 v41, v41
    v_add_f32 v226, v226, v40
    v_mfma_f32_32x32x16_bf16 v[48:63], a[80:83], a[48:51], v[48:63]
    ds_read_b128 a[72:75], v228 offset:18432
    v_exp_f32 v42, v42
    v_add_f32 v226, v226, v41
    v_cvt_pk_bf16_f32 v40, v40, v41
    v_mfma_f32_32x32x16_bf16 v[48:63], a[84:87], a[52:55], v[48:63]
    s_waitcnt lgkmcnt(3)
    ds_read_b128 a[76:79], v228 offset:19456
    buffer_load_dwordx4 v224, s[12:15], s63 offen offset:2048 sc1 lds
    v_exp_f32 v43, v43
    v_add_f32 v226, v226, v42
    v_mfma_f32_32x32x16_bf16 v[48:63], a[88:91], a[56:59], v[48:63]
    ds_read_b128 a[80:83], v228 offset:20480
    v_exp_f32 v44, v44
    v_add_f32 v226, v226, v43
    v_cvt_pk_bf16_f32 v41, v42, v43
    v_mfma_f32_32x32x16_bf16 v[48:63], a[92:95], a[60:63], v[48:63]
    s_waitcnt lgkmcnt(3)
    ds_read_b128 a[84:87], v228 offset:21504
    buffer_load_dwordx4 v224, s[12:15], s63 offen offset:3072 sc1 lds
    v_exp_f32 v45, v45
    v_add_f32 v226, v226, v44
    v_mfma_f32_32x32x16_bf16 v[128:143], a[64:67], v[32:35], v[128:143]
    ds_read_b128 a[88:91], v228 offset:22528
    v_exp_f32 v46, v46
    v_add_f32 v226, v226, v45
    v_cvt_pk_bf16_f32 v42, v44, v45
    v_mfma_f32_32x32x16_bf16 v[144:159], a[68:71], v[32:35], v[144:159]
    s_waitcnt lgkmcnt(3)
    ds_read_b128 a[92:95], v228 offset:23552
    v_exp_f32 v47, v47
    v_add_f32 v226, v226, v46
    v_exp_f32 v48, v48
    v_mfma_f32_32x32x16_bf16 v[160:175], a[72:75], v[32:35], v[160:175]
    ds_read_b128 a[64:67], v228 offset:32768
    v_add_f32 v226, v226, v47
    v_cvt_pk_bf16_f32 v43, v46, v47
    v_exp_f32 v49, v49
    v_add_f32 v226, v226, v48
    v_mfma_f32_32x32x16_bf16 v[176:191], a[76:79], v[32:35], v[176:191]
    s_waitcnt lgkmcnt(3)
    ds_read_b128 a[68:71], v228 offset:33792
    v_exp_f32 v50, v50
    v_add_f32 v226, v226, v49
    v_cvt_pk_bf16_f32 v48, v48, v49
    v_mfma_f32_32x32x16_bf16 v[128:143], a[80:83], v[40:43], v[128:143]
    ds_read_b128 a[72:75], v228 offset:34816
    v_exp_f32 v51, v51
    v_add_f32 v226, v226, v50
    v_mfma_f32_32x32x16_bf16 v[144:159], a[84:87], v[40:43], v[144:159]
    s_waitcnt lgkmcnt(3)
    ds_read_b128 a[76:79], v228 offset:35840
    v_exp_f32 v52, v52
    v_add_f32 v226, v226, v51
    v_cvt_pk_bf16_f32 v49, v50, v51
    v_mfma_f32_32x32x16_bf16 v[160:175], a[88:91], v[40:43], v[160:175]
    ds_read_b128 a[80:83], v228 offset:36864
    v_exp_f32 v53, v53
    v_add_f32 v226, v226, v52
    v_mfma_f32_32x32x16_bf16 v[176:191], a[92:95], v[40:43], v[176:191]
    s_waitcnt lgkmcnt(3)
    ds_read_b128 a[84:87], v228 offset:37888
    v_mfma_f32_32x32x16_bf16 v[32:47], a[64:67], a[32:35], v[208:223]
    s_add_u32 m0, s55, 36864
    s_add_u32 s63, s54, 37888
    ds_read_b128 a[88:91], v228 offset:38912
    v_exp_f32 v54, v54
    v_add_f32 v226, v226, v53
    v_cvt_pk_bf16_f32 v50, v52, v53
    v_mfma_f32_32x32x16_bf16 v[32:47], a[68:71], a[36:39], v[32:47]
    s_waitcnt lgkmcnt(3)
    ds_read_b128 a[92:95], v228 offset:39936
    buffer_load_dwordx4 v224, s[12:15], s63 offen offset:0 sc1 lds
    v_exp_f32 v55, v55
    v_add_f32 v226, v226, v54
    v_mfma_f32_32x32x16_bf16 v[32:47], a[72:75], a[40:43], v[32:47]
    ds_read_b128 a[64:67], v228 offset:24576
    v_exp_f32 v56, v56
    v_add_f32 v226, v226, v55
    v_cvt_pk_bf16_f32 v51, v54, v55
    v_mfma_f32_32x32x16_bf16 v[32:47], a[76:79], a[44:47], v[32:47]
    s_waitcnt lgkmcnt(3)
    ds_read_b128 a[68:71], v228 offset:25600
    buffer_load_dwordx4 v224, s[12:15], s63 offen offset:1024 sc1 lds
    v_exp_f32 v57, v57
    v_add_f32 v226, v226, v56
    v_mfma_f32_32x32x16_bf16 v[32:47], a[80:83], a[48:51], v[32:47]
    ds_read_b128 a[72:75], v228 offset:26624
    v_exp_f32 v58, v58
    v_add_f32 v226, v226, v57
    v_cvt_pk_bf16_f32 v56, v56, v57
    v_mfma_f32_32x32x16_bf16 v[32:47], a[84:87], a[52:55], v[32:47]
    s_waitcnt lgkmcnt(3)
    ds_read_b128 a[76:79], v228 offset:27648
    buffer_load_dwordx4 v224, s[12:15], s63 offen offset:2048 sc1 lds
    v_exp_f32 v59, v59
    v_add_f32 v226, v226, v58
    v_mfma_f32_32x32x16_bf16 v[32:47], a[88:91], a[56:59], v[32:47]
    ds_read_b128 a[80:83], v228 offset:28672
    v_exp_f32 v60, v60
    v_add_f32 v226, v226, v59
    v_cvt_pk_bf16_f32 v57, v58, v59
    v_mfma_f32_32x32x16_bf16 v[32:47], a[92:95], a[60:63], v[32:47]
    s_waitcnt lgkmcnt(3)
    ds_read_b128 a[84:87], v228 offset:29696
    buffer_load_dwordx4 v224, s[12:15], s63 offen offset:3072 sc1 lds
    v_exp_f32 v61, v61
    v_add_f32 v226, v226, v60
    v_mfma_f32_32x32x16_bf16 v[128:143], a[64:67], v[48:51], v[128:143]
    s_cmp_eq_u32 s61, s6
    s_cselect_b32 s72, 0x4e02800, s72
    ds_read_b128 a[88:91], v228 offset:30720
    v_exp_f32 v62, v62
    v_add_f32 v226, v226, v61
    v_cvt_pk_bf16_f32 v58, v60, v61
    v_mfma_f32_32x32x16_bf16 v[144:159], a[68:71], v[48:51], v[144:159]
    s_waitcnt lgkmcnt(3)
    ds_read_b128 a[92:95], v228 offset:31744
    v_exp_f32 v63, v63
    v_add_f32 v226, v226, v62
    v_exp_f32 v32, v32
    v_mfma_f32_32x32x16_bf16 v[160:175], a[72:75], v[48:51], v[160:175]
    s_add_u32 s54, s54, 67584
    ds_read_b128 a[64:67], v228 offset:40960
    v_add_f32 v226, v226, v63
    v_cvt_pk_bf16_f32 v59, v62, v63
    v_exp_f32 v33, v33
    v_add_f32 v226, v226, v32
    v_mfma_f32_32x32x16_bf16 v[176:191], a[76:79], v[48:51], v[176:191]
    s_waitcnt lgkmcnt(3)
    ds_read_b128 a[68:71], v228 offset:41984
    v_exp_f32 v34, v34
    v_add_f32 v226, v226, v33
    v_cvt_pk_bf16_f32 v32, v32, v33
    v_mfma_f32_32x32x16_bf16 v[128:143], a[80:83], v[56:59], v[128:143]
    ds_read_b128 a[72:75], v228 offset:43008
    buffer_load_dwordx4 v[236:239], v224, s[8:11], s72 offen sc1
    v_exp_f32 v35, v35
    v_add_f32 v226, v226, v34
    v_mfma_f32_32x32x16_bf16 v[144:159], a[84:87], v[56:59], v[144:159]
    s_waitcnt lgkmcnt(3)
    ds_read_b128 a[76:79], v228 offset:44032
    v_exp_f32 v36, v36
    v_add_f32 v226, v226, v35
    v_cvt_pk_bf16_f32 v33, v34, v35
    v_mfma_f32_32x32x16_bf16 v[160:175], a[88:91], v[56:59], v[160:175]
    s_xor_b32 s55, s55, 0x10000
    ds_read_b128 a[80:83], v228 offset:45056
    v_exp_f32 v37, v37
    v_add_f32 v226, v226, v36
    v_mfma_f32_32x32x16_bf16 v[176:191], a[92:95], v[56:59], v[176:191]
    s_waitcnt lgkmcnt(3)
    ds_read_b128 a[84:87], v228 offset:46080
    s_waitcnt vmcnt(9)
    s_barrier
    buffer_store_dword v253, v255, s[8:11], s96 offen sc1
    v_mfma_f32_32x32x16_bf16 v[48:63], a[64:67], a[32:35], v[208:223]
    s_mov_b32 m0, s55
    ds_read_b128 a[88:91], v228 offset:47104
    v_exp_f32 v38, v38
    v_add_f32 v226, v226, v37
    v_cvt_pk_bf16_f32 v34, v36, v37
    v_mfma_f32_32x32x16_bf16 v[48:63], a[68:71], a[36:39], v[48:63]
    s_waitcnt lgkmcnt(3)
    ds_read_b128 a[92:95], v228 offset:48128
    buffer_load_dwordx4 v224, s[12:15], s54 offen offset:0 sc1 lds
    v_exp_f32 v39, v39
    v_add_f32 v226, v226, v38
    v_mfma_f32_32x32x16_bf16 v[48:63], a[72:75], a[40:43], v[48:63]
    s_mov_b32 s96, 0x7f000000
    ds_read_b128 a[64:67], v228 offset:49152
    v_exp_f32 v40, v40
    v_add_f32 v226, v226, v39
    v_cvt_pk_bf16_f32 v35, v38, v39
    v_mfma_f32_32x32x16_bf16 v[48:63], a[76:79], a[44:47], v[48:63]
    s_waitcnt lgkmcnt(3)
    ds_read_b128 a[68:71], v228 offset:50176
    buffer_load_dwordx4 v224, s[12:15], s54 offen offset:1024 sc1 lds
    v_exp_f32 v41, v41
    v_add_f32 v226, v226, v40
    v_mfma_f32_32x32x16_bf16 v[48:63], a[80:83], a[48:51], v[48:63]
    ds_read_b128 a[72:75], v228 offset:51200
    v_exp_f32 v42, v42
    v_add_f32 v226, v226, v41
    v_cvt_pk_bf16_f32 v40, v40, v41
    v_mfma_f32_32x32x16_bf16 v[48:63], a[84:87], a[52:55], v[48:63]
    s_waitcnt lgkmcnt(3)
    ds_read_b128 a[76:79], v228 offset:52224
    buffer_load_dwordx4 v224, s[12:15], s54 offen offset:2048 sc1 lds
    v_exp_f32 v43, v43
    v_add_f32 v226, v226, v42
    v_mfma_f32_32x32x16_bf16 v[48:63], a[88:91], a[56:59], v[48:63]
    ds_read_b128 a[80:83], v228 offset:53248
    v_exp_f32 v44, v44
    v_add_f32 v226, v226, v43
    v_cvt_pk_bf16_f32 v41, v42, v43
    v_mfma_f32_32x32x16_bf16 v[48:63], a[92:95], a[60:63], v[48:63]
    s_waitcnt lgkmcnt(3)
    ds_read_b128 a[84:87], v228 offset:54272
    buffer_load_dwordx4 v224, s[12:15], s54 offen offset:3072 sc1 lds
    v_exp_f32 v45, v45
    v_add_f32 v226, v226, v44
    v_mfma_f32_32x32x16_bf16 v[128:143], a[64:67], v[32:35], v[128:143]
    ds_read_b128 a[88:91], v228 offset:55296
    v_exp_f32 v46, v46
    v_add_f32 v226, v226, v45
    v_cvt_pk_bf16_f32 v42, v44, v45
    v_mfma_f32_32x32x16_bf16 v[144:159], a[68:71], v[32:35], v[144:159]
    s_waitcnt lgkmcnt(3)
    ds_read_b128 a[92:95], v228 offset:56320
    v_exp_f32 v47, v47
    v_add_f32 v226, v226, v46
    v_exp_f32 v48, v48
    v_mfma_f32_32x32x16_bf16 v[160:175], a[72:75], v[32:35], v[160:175]
    ds_read_b128 a[64:67], v227 offset:0
    v_add_f32 v226, v226, v47
    v_cvt_pk_bf16_f32 v43, v46, v47
    v_exp_f32 v49, v49
    v_add_f32 v226, v226, v48
    v_mfma_f32_32x32x16_bf16 v[176:191], a[76:79], v[32:35], v[176:191]
    s_waitcnt lgkmcnt(3)
    ds_read_b128 a[68:71], v227 offset:1024
    v_exp_f32 v50, v50
    v_add_f32 v226, v226, v49
    v_cvt_pk_bf16_f32 v48, v48, v49
    v_mfma_f32_32x32x16_bf16 v[128:143], a[80:83], v[40:43], v[128:143]
    s_add_u32 s61, s61, 2
    ds_read_b128 a[72:75], v227 offset:2048
    v_xor_b32 v228, 0x10000, v228
    v_exp_f32 v51, v51
    v_add_f32 v226, v226, v50
    v_mfma_f32_32x32x16_bf16 v[144:159], a[84:87], v[40:43], v[144:159]
    s_waitcnt lgkmcnt(3)
    ds_read_b128 a[76:79], v227 offset:3072
    v_exp_f32 v52, v52
    v_add_f32 v226, v226, v51
    v_cvt_pk_bf16_f32 v49, v50, v51
    v_mfma_f32_32x32x16_bf16 v[160:175], a[88:91], v[40:43], v[160:175]
    s_cmp_lt_u32 s61, s3
    ds_read_b128 a[80:83], v227 offset:4096
    ds_read_b128 a[84:87], v227 offset:5120
    v_xor_b32 v227, 0x10000, v227
    v_exp_f32 v53, v53
    v_add_f32 v226, v226, v52
    v_mfma_f32_32x32x16_bf16 v[176:191], a[92:95], v[40:43], v[176:191]
    s_waitcnt lgkmcnt(4)
    s_cbranch_scc1 L_single_sequential_preLN__compressed_kv_cla__geglu_ffn__prompt_kernel
L_R_sequential_preLN__compressed_kv_cla__geglu_ffn__prompt_kernel:
    v_mfma_f32_32x32x16_bf16 v[32:47], a[64:67], a[32:35], v[208:223]
    s_add_u32 m0, s55, 4096
    s_add_u32 s63, s54, 4096
    s_cmp_ge_u32 s74, 6
    s_cselect_b64 s[94:95], 0, -1
    ds_read_b128 a[88:91], v228 offset:6144
    v_exp_f32 v54, v54
    v_add_f32 v226, v226, v53
    v_cvt_pk_bf16_f32 v50, v52, v53
    v_mfma_f32_32x32x16_bf16 v[32:47], a[68:71], a[36:39], v[32:47]
    s_waitcnt lgkmcnt(3)
    s_cbranch_scc1 L_R1_sequential_preLN__compressed_kv_cla__geglu_ffn__prompt_kernel
    s_waitcnt vmcnt(5)
L_R1_sequential_preLN__compressed_kv_cla__geglu_ffn__prompt_kernel:
    ds_read_b128 a[92:95], v228 offset:7168
    buffer_load_dwordx4 v224, s[12:15], s63 offen offset:0 sc1 lds
    v_exp_f32 v55, v55
    v_add_f32 v226, v226, v54
    v_mfma_f32_32x32x16_bf16 v[32:47], a[72:75], a[40:43], v[32:47]
    ds_read_b128 a[64:67], v227 offset:57344
    v_bitop3_b32 v236, v236, v237, s73 bitop3:0x7e
    v_exp_f32 v56, v56
    v_add_f32 v226, v226, v55
    v_cvt_pk_bf16_f32 v51, v54, v55
    v_mfma_f32_32x32x16_bf16 v[32:47], a[76:79], a[44:47], v[32:47]
    s_waitcnt lgkmcnt(3)
    ds_read_b128 a[68:71], v227 offset:58368
    buffer_load_dwordx4 v224, s[12:15], s63 offen offset:1024 sc1 lds
    v_exp_f32 v57, v57
    v_add_f32 v226, v226, v56
    v_mfma_f32_32x32x16_bf16 v[32:47], a[80:83], a[48:51], v[32:47]
    ds_read_b128 a[72:75], v227 offset:59392
    v_bitop3_b32 v238, v238, v239, s73 bitop3:0x7e
    v_exp_f32 v58, v58
    v_add_f32 v226, v226, v57
    v_cvt_pk_bf16_f32 v56, v56, v57
    v_mfma_f32_32x32x16_bf16 v[32:47], a[84:87], a[52:55], v[32:47]
    s_waitcnt lgkmcnt(3)
    ds_read_b128 a[76:79], v227 offset:60416
    buffer_load_dwordx4 v224, s[12:15], s63 offen offset:2048 sc1 lds
    v_exp_f32 v59, v59
    v_add_f32 v226, v226, v58
    v_mfma_f32_32x32x16_bf16 v[32:47], a[88:91], a[56:59], v[32:47]
    ds_read_b128 a[80:83], v227 offset:61440
    v_or_b32 v236, v236, v238
    v_exp_f32 v60, v60
    v_add_f32 v226, v226, v59
    v_cvt_pk_bf16_f32 v57, v58, v59
    v_mfma_f32_32x32x16_bf16 v[32:47], a[92:95], a[60:63], v[32:47]
    s_waitcnt lgkmcnt(3)
    ds_read_b128 a[84:87], v227 offset:62464
    buffer_load_dwordx4 v224, s[12:15], s63 offen offset:3072 sc1 lds
    v_exp_f32 v61, v61
    v_add_f32 v226, v226, v60
    v_mfma_f32_32x32x16_bf16 v[128:143], a[64:67], v[48:51], v[128:143]
    ds_read_b128 a[88:91], v227 offset:63488
    v_cmp_ne_u32 vcc, 0, v236
    v_exp_f32 v62, v62
    v_add_f32 v226, v226, v61
    v_cvt_pk_bf16_f32 v58, v60, v61
    v_mfma_f32_32x32x16_bf16 v[144:159], a[68:71], v[48:51], v[144:159]
    s_waitcnt lgkmcnt(3)
    s_and_b64 vcc, vcc, s[94:95]
    ds_read_b128 a[92:95], v227 offset:64512
    v_exp_f32 v63, v63
    v_add_f32 v226, v226, v62
    v_exp_f32 v32, v32
    v_mfma_f32_32x32x16_bf16 v[160:175], a[72:75], v[48:51], v[160:175]
    s_cbranch_vccnz L_poll3_sequential_preLN__compressed_kv_cla__geglu_ffn__prompt_kernel
L_poll3_sequential_preLN__compressed_kv_cla__geglu_ffn__prompt_kernel_ok:
    ds_read_b128 a[64:67], v228 offset:8192
    v_add_f32 v226, v226, v63
    v_cvt_pk_bf16_f32 v59, v62, v63
    v_exp_f32 v33, v33
    v_add_f32 v226, v226, v32
    v_mfma_f32_32x32x16_bf16 v[176:191], a[76:79], v[48:51], v[176:191]
    s_waitcnt lgkmcnt(3)
    ds_read_b128 a[68:71], v228 offset:9216
    v_exp_f32 v34, v34
    v_add_f32 v226, v226, v33
    v_cvt_pk_bf16_f32 v32, v32, v33
    v_mfma_f32_32x32x16_bf16 v[128:143], a[80:83], v[56:59], v[128:143]
    ds_read_b128 a[72:75], v228 offset:10240
    buffer_load_dwordx4 a[128:131], v224, s[8:11], s62 offen offset:0 sc1
    v_exp_f32 v35, v35
    v_add_f32 v226, v226, v34
    v_mfma_f32_32x32x16_bf16 v[144:159], a[84:87], v[56:59], v[144:159]
    s_waitcnt lgkmcnt(3)
    ds_read_b128 a[76:79], v228 offset:11264
    v_exp_f32 v36, v36
    v_add_f32 v226, v226, v35
    v_cvt_pk_bf16_f32 v33, v34, v35
    v_mfma_f32_32x32x16_bf16 v[160:175], a[88:91], v[56:59], v[160:175]
    ds_read_b128 a[80:83], v228 offset:12288
    buffer_load_dwordx4 a[132:135], v224, s[8:11], s62 offen offset:1024 sc1
    v_exp_f32 v37, v37
    v_add_f32 v226, v226, v36
    v_mfma_f32_32x32x16_bf16 v[176:191], a[92:95], v[56:59], v[176:191]
    s_waitcnt lgkmcnt(3)
    s_barrier
    ds_read_b128 a[84:87], v228 offset:13312
    buffer_load_dwordx4 a[136:139], v224, s[8:11], s62 offen offset:2048 sc1
    v_mfma_f32_32x32x16_bf16 v[48:63], a[64:67], a[32:35], v[208:223]
    s_add_u32 m0, s55, 32768
    s_add_u32 s63, s54, 33792
    ds_read_b128 a[88:91], v228 offset:14336
    v_exp_f32 v38, v38
    v_add_f32 v226, v226, v37
    v_cvt_pk_bf16_f32 v34, v36, v37
    v_mfma_f32_32x32x16_bf16 v[48:63], a[68:71], a[36:39], v[48:63]
    s_waitcnt lgkmcnt(3)
    ds_read_b128 a[92:95], v228 offset:15360
    buffer_load_dwordx4 v224, s[12:15], s63 offen offset:0 sc1 lds
    v_exp_f32 v39, v39
    v_add_f32 v226, v226, v38
    v_mfma_f32_32x32x16_bf16 v[48:63], a[72:75], a[40:43], v[48:63]
    ds_read_b128 a[64:67], v228 offset:16384
    v_exp_f32 v40, v40
    v_add_f32 v226, v226, v39
    v_cvt_pk_bf16_f32 v35, v38, v39
    v_mfma_f32_32x32x16_bf16 v[48:63], a[76:79], a[44:47], v[48:63]
    s_waitcnt lgkmcnt(3)
    ds_read_b128 a[68:71], v228 offset:17408
    buffer_load_dwordx4 v224, s[12:15], s63 offen offset:1024 sc1 lds
    v_exp_f32 v41, v41
    v_add_f32 v226, v226, v40
    v_mfma_f32_32x32x16_bf16 v[48:63], a[80:83], a[48:51], v[48:63]
    ds_read_b128 a[72:75], v228 offset:18432
    v_exp_f32 v42, v42
    v_add_f32 v226, v226, v41
    v_cvt_pk_bf16_f32 v40, v40, v41
    v_mfma_f32_32x32x16_bf16 v[48:63], a[84:87], a[52:55], v[48:63]
    s_waitcnt lgkmcnt(3)
    ds_read_b128 a[76:79], v228 offset:19456
    buffer_load_dwordx4 v224, s[12:15], s63 offen offset:2048 sc1 lds
    v_exp_f32 v43, v43
    v_add_f32 v226, v226, v42
    v_mfma_f32_32x32x16_bf16 v[48:63], a[88:91], a[56:59], v[48:63]
    ds_read_b128 a[80:83], v228 offset:20480
    v_exp_f32 v44, v44
    v_add_f32 v226, v226, v43
    v_cvt_pk_bf16_f32 v41, v42, v43
    v_mfma_f32_32x32x16_bf16 v[48:63], a[92:95], a[60:63], v[48:63]
    s_waitcnt lgkmcnt(3)
    ds_read_b128 a[84:87], v228 offset:21504
    buffer_load_dwordx4 v224, s[12:15], s63 offen offset:3072 sc1 lds
    v_exp_f32 v45, v45
    v_add_f32 v226, v226, v44
    v_mfma_f32_32x32x16_bf16 v[128:143], a[64:67], v[32:35], v[128:143]
    ds_read_b128 a[88:91], v228 offset:22528
    v_exp_f32 v46, v46
    v_add_f32 v226, v226, v45
    v_cvt_pk_bf16_f32 v42, v44, v45
    v_mfma_f32_32x32x16_bf16 v[144:159], a[68:71], v[32:35], v[144:159]
    s_waitcnt lgkmcnt(3)
    ds_read_b128 a[92:95], v228 offset:23552
    v_exp_f32 v47, v47
    v_add_f32 v226, v226, v46
    v_exp_f32 v48, v48
    v_mfma_f32_32x32x16_bf16 v[160:175], a[72:75], v[32:35], v[160:175]
    ds_read_b128 a[64:67], v228 offset:32768
    v_add_f32 v226, v226, v47
    v_cvt_pk_bf16_f32 v43, v46, v47
    v_exp_f32 v49, v49
    v_add_f32 v226, v226, v48
    v_mfma_f32_32x32x16_bf16 v[176:191], a[76:79], v[32:35], v[176:191]
    s_waitcnt lgkmcnt(3)
    ds_read_b128 a[68:71], v228 offset:33792
    v_exp_f32 v50, v50
    v_add_f32 v226, v226, v49
    v_cvt_pk_bf16_f32 v48, v48, v49
    v_mfma_f32_32x32x16_bf16 v[128:143], a[80:83], v[40:43], v[128:143]
    ds_read_b128 a[72:75], v228 offset:34816
    buffer_load_dwordx4 a[140:143], v224, s[8:11], s62 offen offset:3072 sc1
    v_exp_f32 v51, v51
    v_add_f32 v226, v226, v50
    v_mfma_f32_32x32x16_bf16 v[144:159], a[84:87], v[40:43], v[144:159]
    s_waitcnt lgkmcnt(3)
    ds_read_b128 a[76:79], v228 offset:35840
    v_exp_f32 v52, v52
    v_add_f32 v226, v226, v51
    v_cvt_pk_bf16_f32 v49, v50, v51
    v_mfma_f32_32x32x16_bf16 v[160:175], a[88:91], v[40:43], v[160:175]
    ds_read_b128 a[80:83], v228 offset:36864
    buffer_load_dwordx4 a[144:147], v252, s[8:11], s62 offen offset:0 sc1
    v_exp_f32 v53, v53
    v_add_f32 v226, v226, v52
    v_mfma_f32_32x32x16_bf16 v[176:191], a[92:95], v[40:43], v[176:191]
    s_waitcnt lgkmcnt(3)
    ds_read_b128 a[84:87], v228 offset:37888
    buffer_load_dwordx4 a[148:151], v252, s[8:11], s62 offen offset:1024 sc1
    v_mfma_f32_32x32x16_bf16 v[32:47], a[64:67], a[32:35], v[208:223]
    s_add_u32 m0, s55, 36864
    s_add_u32 s63, s54, 37888
    ds_read_b128 a[88:91], v228 offset:38912
    v_exp_f32 v54, v54
    v_add_f32 v226, v226, v53
    v_cvt_pk_bf16_f32 v50, v52, v53
    v_mfma_f32_32x32x16_bf16 v[32:47], a[68:71], a[36:39], v[32:47]
    s_waitcnt lgkmcnt(3)
    ds_read_b128 a[92:95], v228 offset:39936
    buffer_load_dwordx4 v224, s[12:15], s63 offen offset:0 sc1 lds
    v_exp_f32 v55, v55
    v_add_f32 v226, v226, v54
    v_mfma_f32_32x32x16_bf16 v[32:47], a[72:75], a[40:43], v[32:47]
    ds_read_b128 a[64:67], v228 offset:24576
    v_exp_f32 v56, v56
    v_add_f32 v226, v226, v55
    v_cvt_pk_bf16_f32 v51, v54, v55
    v_mfma_f32_32x32x16_bf16 v[32:47], a[76:79], a[44:47], v[32:47]
    s_waitcnt lgkmcnt(3)
    ds_read_b128 a[68:71], v228 offset:25600
    buffer_load_dwordx4 v224, s[12:15], s63 offen offset:1024 sc1 lds
    v_exp_f32 v57, v57
    v_add_f32 v226, v226, v56
    v_mfma_f32_32x32x16_bf16 v[32:47], a[80:83], a[48:51], v[32:47]
    ds_read_b128 a[72:75], v228 offset:26624
    v_exp_f32 v58, v58
    v_add_f32 v226, v226, v57
    v_cvt_pk_bf16_f32 v56, v56, v57
    v_mfma_f32_32x32x16_bf16 v[32:47], a[84:87], a[52:55], v[32:47]
    s_waitcnt lgkmcnt(3)
    ds_read_b128 a[76:79], v228 offset:27648
    buffer_load_dwordx4 v224, s[12:15], s63 offen offset:2048 sc1 lds
    v_exp_f32 v59, v59
    v_add_f32 v226, v226, v58
    v_mfma_f32_32x32x16_bf16 v[32:47], a[88:91], a[56:59], v[32:47]
    ds_read_b128 a[80:83], v228 offset:28672
    v_exp_f32 v60, v60
    v_add_f32 v226, v226, v59
    v_cvt_pk_bf16_f32 v57, v58, v59
    v_mfma_f32_32x32x16_bf16 v[32:47], a[92:95], a[60:63], v[32:47]
    s_waitcnt lgkmcnt(3)
    ds_read_b128 a[84:87], v228 offset:29696
    buffer_load_dwordx4 v224, s[12:15], s63 offen offset:3072 sc1 lds
    v_exp_f32 v61, v61
    v_add_f32 v226, v226, v60
    v_mfma_f32_32x32x16_bf16 v[128:143], a[64:67], v[48:51], v[128:143]
    ds_read_b128 a[88:91], v228 offset:30720
    v_exp_f32 v62, v62
    v_add_f32 v226, v226, v61
    v_cvt_pk_bf16_f32 v58, v60, v61
    v_mfma_f32_32x32x16_bf16 v[144:159], a[68:71], v[48:51], v[144:159]
    s_waitcnt lgkmcnt(3)
    ds_read_b128 a[92:95], v228 offset:31744
    v_exp_f32 v63, v63
    v_add_f32 v226, v226, v62
    v_exp_f32 v32, v32
    v_mfma_f32_32x32x16_bf16 v[160:175], a[72:75], v[48:51], v[160:175]
    s_add_u32 s54, s54, 67584
    ds_read_b128 a[64:67], v228 offset:40960
    v_add_f32 v226, v226, v63
    v_cvt_pk_bf16_f32 v59, v62, v63
    v_exp_f32 v33, v33
    v_add_f32 v226, v226, v32
    v_mfma_f32_32x32x16_bf16 v[176:191], a[76:79], v[48:51], v[176:191]
    s_waitcnt lgkmcnt(3)
    ds_read_b128 a[68:71], v228 offset:41984
    buffer_load_dwordx4 a[152:155], v252, s[8:11], s62 offen offset:2048 sc1
    v_exp_f32 v34, v34
    v_add_f32 v226, v226, v33
    v_cvt_pk_bf16_f32 v32, v32, v33
    v_mfma_f32_32x32x16_bf16 v[128:143], a[80:83], v[56:59], v[128:143]
    ds_read_b128 a[72:75], v228 offset:43008
    buffer_load_dwordx4 a[156:159], v252, s[8:11], s62 offen offset:3072 sc1
    s_add_u32 s62, s62, 8192
    v_exp_f32 v35, v35
    v_add_f32 v226, v226, v34
    v_mfma_f32_32x32x16_bf16 v[144:159], a[84:87], v[56:59], v[144:159]
    s_waitcnt lgkmcnt(3)
    ds_read_b128 a[76:79], v228 offset:44032
    v_exp_f32 v36, v36
    v_add_f32 v226, v226, v35
    v_cvt_pk_bf16_f32 v33, v34, v35
    v_mfma_f32_32x32x16_bf16 v[160:175], a[88:91], v[56:59], v[160:175]
    s_xor_b32 s55, s55, 0x10000
    ds_read_b128 a[80:83], v228 offset:45056
    buffer_load_dwordx4 a[160:163], v224, s[8:11], s62 offen offset:0 sc1
    v_exp_f32 v37, v37
    v_add_f32 v226, v226, v36
    v_mfma_f32_32x32x16_bf16 v[176:191], a[92:95], v[56:59], v[176:191]
    s_waitcnt lgkmcnt(3)
    s_waitcnt vmcnt(17)
    s_barrier
    ds_read_b128 a[84:87], v228 offset:46080
    buffer_load_dwordx4 a[164:167], v224, s[8:11], s62 offen offset:1024 sc1
    v_mfma_f32_32x32x16_bf16 v[48:63], a[64:67], a[32:35], v[208:223]
    s_mov_b32 m0, s55
    ds_read_b128 a[88:91], v228 offset:47104
    v_exp_f32 v38, v38
    v_add_f32 v226, v226, v37
    v_cvt_pk_bf16_f32 v34, v36, v37
    v_mfma_f32_32x32x16_bf16 v[48:63], a[68:71], a[36:39], v[48:63]
    s_waitcnt lgkmcnt(3)
    ds_read_b128 a[92:95], v228 offset:48128
    buffer_load_dwordx4 v224, s[12:15], s54 offen offset:0 sc1 lds
    v_exp_f32 v39, v39
    v_add_f32 v226, v226, v38
    v_mfma_f32_32x32x16_bf16 v[48:63], a[72:75], a[40:43], v[48:63]
    ds_read_b128 a[64:67], v228 offset:49152
    v_exp_f32 v40, v40
    v_add_f32 v226, v226, v39
    v_cvt_pk_bf16_f32 v35, v38, v39
    v_mfma_f32_32x32x16_bf16 v[48:63], a[76:79], a[44:47], v[48:63]
    s_waitcnt lgkmcnt(3)
    ds_read_b128 a[68:71], v228 offset:50176
    buffer_load_dwordx4 v224, s[12:15], s54 offen offset:1024 sc1 lds
    v_exp_f32 v41, v41
    v_add_f32 v226, v226, v40
    v_mfma_f32_32x32x16_bf16 v[48:63], a[80:83], a[48:51], v[48:63]
    ds_read_b128 a[72:75], v228 offset:51200
    v_exp_f32 v42, v42
    v_add_f32 v226, v226, v41
    v_cvt_pk_bf16_f32 v40, v40, v41
    v_mfma_f32_32x32x16_bf16 v[48:63], a[84:87], a[52:55], v[48:63]
    s_waitcnt lgkmcnt(3)
    ds_read_b128 a[76:79], v228 offset:52224
    buffer_load_dwordx4 v224, s[12:15], s54 offen offset:2048 sc1 lds
    v_exp_f32 v43, v43
    v_add_f32 v226, v226, v42
    v_mfma_f32_32x32x16_bf16 v[48:63], a[88:91], a[56:59], v[48:63]
    ds_read_b128 a[80:83], v228 offset:53248
    v_exp_f32 v44, v44
    v_add_f32 v226, v226, v43
    v_cvt_pk_bf16_f32 v41, v42, v43
    v_mfma_f32_32x32x16_bf16 v[48:63], a[92:95], a[60:63], v[48:63]
    s_waitcnt lgkmcnt(3)
    ds_read_b128 a[84:87], v228 offset:54272
    buffer_load_dwordx4 v224, s[12:15], s54 offen offset:3072 sc1 lds
    v_exp_f32 v45, v45
    v_add_f32 v226, v226, v44
    v_mfma_f32_32x32x16_bf16 v[128:143], a[64:67], v[32:35], v[128:143]
    ds_read_b128 a[88:91], v228 offset:55296
    buffer_load_dwordx4 a[168:171], v224, s[8:11], s62 offen offset:2048 sc1
    v_exp_f32 v46, v46
    v_add_f32 v226, v226, v45
    v_cvt_pk_bf16_f32 v42, v44, v45
    v_mfma_f32_32x32x16_bf16 v[144:159], a[68:71], v[32:35], v[144:159]
    s_waitcnt lgkmcnt(3)
    ds_read_b128 a[92:95], v228 offset:56320
    v_exp_f32 v47, v47
    v_add_f32 v226, v226, v46
    v_exp_f32 v48, v48
    v_mfma_f32_32x32x16_bf16 v[160:175], a[72:75], v[32:35], v[160:175]
    ds_read_b128 a[64:67], v227 offset:0
    v_add_f32 v226, v226, v47
    v_cvt_pk_bf16_f32 v43, v46, v47
    v_exp_f32 v49, v49
    v_add_f32 v226, v226, v48
    v_mfma_f32_32x32x16_bf16 v[176:191], a[76:79], v[32:35], v[176:191]
    s_waitcnt lgkmcnt(3)
    ds_read_b128 a[68:71], v227 offset:1024
    buffer_load_dwordx4 a[172:175], v224, s[8:11], s62 offen offset:3072 sc1
    v_exp_f32 v50, v50
    v_add_f32 v226, v226, v49
    v_cvt_pk_bf16_f32 v48, v48, v49
    v_mfma_f32_32x32x16_bf16 v[128:143], a[80:83], v[40:43], v[128:143]
    ds_read_b128 a[72:75], v227 offset:2048
    buffer_load_dwordx4 a[176:179], v252, s[8:11], s62 offen offset:0 sc1
    v_xor_b32 v228, 0x10000, v228
    v_exp_f32 v51, v51
    v_add_f32 v226, v226, v50
    v_mfma_f32_32x32x16_bf16 v[144:159], a[84:87], v[40:43], v[144:159]
    s_waitcnt lgkmcnt(3)
    ds_read_b128 a[76:79], v227 offset:3072
    buffer_store_dword v253, v251, s[8:11], s59 offen sc1
    v_exp_f32 v52, v52
    v_add_f32 v226, v226, v51
    v_cvt_pk_bf16_f32 v49, v50, v51
    v_mfma_f32_32x32x16_bf16 v[160:175], a[88:91], v[40:43], v[160:175]
    ds_read_b128 a[80:83], v227 offset:4096
    ds_read_b128 a[84:87], v227 offset:5120
    v_xor_b32 v227, 0x10000, v227
    v_exp_f32 v53, v53
    v_add_f32 v226, v226, v52
    v_mfma_f32_32x32x16_bf16 v[176:191], a[92:95], v[40:43], v[176:191]
    s_waitcnt lgkmcnt(4)
    buffer_load_dwordx4 a[180:183], v252, s[8:11], s62 offen offset:1024 sc1
L_P_sequential_preLN__compressed_kv_cla__geglu_ffn__prompt_kernel:
    v_mfma_f32_32x32x16_bf16 v[32:47], a[64:67], a[32:35], v[208:223]
    s_add_u32 m0, s55, 4096
    s_add_u32 s63, s54, 4096
    ds_read_b128 a[88:91], v228 offset:6144
    v_exp_f32 v54, v54
    v_add_f32 v226, v226, v53
    v_cvt_pk_bf16_f32 v50, v52, v53
    v_mfma_f32_32x32x16_bf16 v[32:47], a[68:71], a[36:39], v[32:47]
    s_waitcnt lgkmcnt(3)
    ds_read_b128 a[92:95], v228 offset:7168
    buffer_load_dwordx4 v224, s[12:15], s63 offen offset:0 sc1 lds
    v_exp_f32 v55, v55
    v_add_f32 v226, v226, v54
    v_mfma_f32_32x32x16_bf16 v[32:47], a[72:75], a[40:43], v[32:47]
    ds_read_b128 a[64:67], v227 offset:57344
    v_exp_f32 v56, v56
    v_add_f32 v226, v226, v55
    v_cvt_pk_bf16_f32 v51, v54, v55
    v_mfma_f32_32x32x16_bf16 v[32:47], a[76:79], a[44:47], v[32:47]
    s_waitcnt lgkmcnt(3)
    ds_read_b128 a[68:71], v227 offset:58368
    buffer_load_dwordx4 v224, s[12:15], s63 offen offset:1024 sc1 lds
    v_exp_f32 v57, v57
    v_add_f32 v226, v226, v56
    v_mfma_f32_32x32x16_bf16 v[32:47], a[80:83], a[48:51], v[32:47]
    ds_read_b128 a[72:75], v227 offset:59392
    v_exp_f32 v58, v58
    v_add_f32 v226, v226, v57
    v_cvt_pk_bf16_f32 v56, v56, v57
    v_mfma_f32_32x32x16_bf16 v[32:47], a[84:87], a[52:55], v[32:47]
    s_waitcnt lgkmcnt(3)
    ds_read_b128 a[76:79], v227 offset:60416
    buffer_load_dwordx4 v224, s[12:15], s63 offen offset:2048 sc1 lds
    v_exp_f32 v59, v59
    v_add_f32 v226, v226, v58
    v_mfma_f32_32x32x16_bf16 v[32:47], a[88:91], a[56:59], v[32:47]
    ds_read_b128 a[80:83], v227 offset:61440
    v_exp_f32 v60, v60
    v_add_f32 v226, v226, v59
    v_cvt_pk_bf16_f32 v57, v58, v59
    v_mfma_f32_32x32x16_bf16 v[32:47], a[92:95], a[60:63], v[32:47]
    s_waitcnt lgkmcnt(3)
    ds_read_b128 a[84:87], v227 offset:62464
    buffer_load_dwordx4 v224, s[12:15], s63 offen offset:3072 sc1 lds
    v_exp_f32 v61, v61
    v_add_f32 v226, v226, v60
    v_mfma_f32_32x32x16_bf16 v[128:143], a[64:67], v[48:51], v[128:143]
    ds_read_b128 a[88:91], v227 offset:63488
    v_exp_f32 v62, v62
    v_add_f32 v226, v226, v61
    v_cvt_pk_bf16_f32 v58, v60, v61
    v_mfma_f32_32x32x16_bf16 v[144:159], a[68:71], v[48:51], v[144:159]
    s_waitcnt lgkmcnt(3)
    ds_read_b128 a[92:95], v227 offset:64512
    v_exp_f32 v63, v63
    v_add_f32 v226, v226, v62
    v_exp_f32 v32, v32
    v_mfma_f32_32x32x16_bf16 v[160:175], a[72:75], v[48:51], v[160:175]
    ds_read_b128 a[64:67], v228 offset:8192
    v_add_f32 v226, v226, v63
    v_cvt_pk_bf16_f32 v59, v62, v63
    v_exp_f32 v33, v33
    v_add_f32 v226, v226, v32
    v_mfma_f32_32x32x16_bf16 v[176:191], a[76:79], v[48:51], v[176:191]
    s_waitcnt lgkmcnt(3)
    ds_read_b128 a[68:71], v228 offset:9216
    v_exp_f32 v34, v34
    v_add_f32 v226, v226, v33
    v_cvt_pk_bf16_f32 v32, v32, v33
    v_mfma_f32_32x32x16_bf16 v[128:143], a[80:83], v[56:59], v[128:143]
    ds_read_b128 a[72:75], v228 offset:10240
    buffer_load_dwordx4 a[184:187], v252, s[8:11], s62 offen offset:2048 sc1
    v_exp_f32 v35, v35
    v_add_f32 v226, v226, v34
    v_mfma_f32_32x32x16_bf16 v[144:159], a[84:87], v[56:59], v[144:159]
    s_waitcnt lgkmcnt(3)
    ds_read_b128 a[76:79], v228 offset:11264
    v_exp_f32 v36, v36
    v_add_f32 v226, v226, v35
    v_cvt_pk_bf16_f32 v33, v34, v35
    v_mfma_f32_32x32x16_bf16 v[160:175], a[88:91], v[56:59], v[160:175]
    ds_read_b128 a[80:83], v228 offset:12288
    buffer_load_dwordx4 a[188:191], v252, s[8:11], s62 offen offset:3072 sc1
    s_add_u32 s62, s62, 8192
    v_exp_f32 v37, v37
    v_add_f32 v226, v226, v36
    v_mfma_f32_32x32x16_bf16 v[176:191], a[92:95], v[56:59], v[176:191]
    s_waitcnt lgkmcnt(3)
    s_waitcnt vmcnt(19)
    s_barrier
    ds_read_b128 a[84:87], v228 offset:13312
    buffer_load_dwordx4 a[192:195], v224, s[8:11], s62 offen offset:0 sc1
    v_mfma_f32_32x32x16_bf16 v[48:63], a[64:67], a[32:35], v[208:223]
    s_add_u32 m0, s55, 32768
    s_add_u32 s63, s54, 33792
    ds_read_b128 a[88:91], v228 offset:14336
    v_exp_f32 v38, v38
    v_add_f32 v226, v226, v37
    v_cvt_pk_bf16_f32 v34, v36, v37
    v_mfma_f32_32x32x16_bf16 v[48:63], a[68:71], a[36:39], v[48:63]
    s_waitcnt lgkmcnt(3)
    ds_read_b128 a[92:95], v228 offset:15360
    buffer_load_dwordx4 v224, s[12:15], s63 offen offset:0 sc1 lds
    v_exp_f32 v39, v39
    v_add_f32 v226, v226, v38
    v_mfma_f32_32x32x16_bf16 v[48:63], a[72:75], a[40:43], v[48:63]
    ds_read_b128 a[64:67], v228 offset:16384
    v_exp_f32 v40, v40
    v_add_f32 v226, v226, v39
    v_cvt_pk_bf16_f32 v35, v38, v39
    v_mfma_f32_32x32x16_bf16 v[48:63], a[76:79], a[44:47], v[48:63]
    s_waitcnt lgkmcnt(3)
    ds_read_b128 a[68:71], v228 offset:17408
    buffer_load_dwordx4 v224, s[12:15], s63 offen offset:1024 sc1 lds
    v_exp_f32 v41, v41
    v_add_f32 v226, v226, v40
    v_mfma_f32_32x32x16_bf16 v[48:63], a[80:83], a[48:51], v[48:63]
    ds_read_b128 a[72:75], v228 offset:18432
    v_exp_f32 v42, v42
    v_add_f32 v226, v226, v41
    v_cvt_pk_bf16_f32 v40, v40, v41
    v_mfma_f32_32x32x16_bf16 v[48:63], a[84:87], a[52:55], v[48:63]
    s_waitcnt lgkmcnt(3)
    ds_read_b128 a[76:79], v228 offset:19456
    buffer_load_dwordx4 v224, s[12:15], s63 offen offset:2048 sc1 lds
    v_exp_f32 v43, v43
    v_add_f32 v226, v226, v42
    v_mfma_f32_32x32x16_bf16 v[48:63], a[88:91], a[56:59], v[48:63]
    ds_read_b128 a[80:83], v228 offset:20480
    v_exp_f32 v44, v44
    v_add_f32 v226, v226, v43
    v_cvt_pk_bf16_f32 v41, v42, v43
    v_mfma_f32_32x32x16_bf16 v[48:63], a[92:95], a[60:63], v[48:63]
    s_waitcnt lgkmcnt(3)
    ds_read_b128 a[84:87], v228 offset:21504
    buffer_load_dwordx4 v224, s[12:15], s63 offen offset:3072 sc1 lds
    v_exp_f32 v45, v45
    v_add_f32 v226, v226, v44
    v_mfma_f32_32x32x16_bf16 v[128:143], a[64:67], v[32:35], v[128:143]
    ds_read_b128 a[88:91], v228 offset:22528
    v_exp_f32 v46, v46
    v_add_f32 v226, v226, v45
    v_cvt_pk_bf16_f32 v42, v44, v45
    v_mfma_f32_32x32x16_bf16 v[144:159], a[68:71], v[32:35], v[144:159]
    s_waitcnt lgkmcnt(3)
    ds_read_b128 a[92:95], v228 offset:23552
    v_exp_f32 v47, v47
    v_add_f32 v226, v226, v46
    v_exp_f32 v48, v48
    v_mfma_f32_32x32x16_bf16 v[160:175], a[72:75], v[32:35], v[160:175]
    ds_read_b128 a[64:67], v228 offset:32768
    v_add_f32 v226, v226, v47
    v_cvt_pk_bf16_f32 v43, v46, v47
    v_exp_f32 v49, v49
    v_add_f32 v226, v226, v48
    v_mfma_f32_32x32x16_bf16 v[176:191], a[76:79], v[32:35], v[176:191]
    s_waitcnt lgkmcnt(3)
    ds_read_b128 a[68:71], v228 offset:33792
    v_exp_f32 v50, v50
    v_add_f32 v226, v226, v49
    v_cvt_pk_bf16_f32 v48, v48, v49
    v_mfma_f32_32x32x16_bf16 v[128:143], a[80:83], v[40:43], v[128:143]
    ds_read_b128 a[72:75], v228 offset:34816
    buffer_load_dwordx4 a[196:199], v224, s[8:11], s62 offen offset:1024 sc1
    v_exp_f32 v51, v51
    v_add_f32 v226, v226, v50
    v_mfma_f32_32x32x16_bf16 v[144:159], a[84:87], v[40:43], v[144:159]
    s_waitcnt lgkmcnt(3)
    ds_read_b128 a[76:79], v228 offset:35840
    v_exp_f32 v52, v52
    v_add_f32 v226, v226, v51
    v_cvt_pk_bf16_f32 v49, v50, v51
    v_mfma_f32_32x32x16_bf16 v[160:175], a[88:91], v[40:43], v[160:175]
    ds_read_b128 a[80:83], v228 offset:36864
    buffer_load_dwordx4 a[200:203], v224, s[8:11], s62 offen offset:2048 sc1
    v_exp_f32 v53, v53
    v_add_f32 v226, v226, v52
    v_mfma_f32_32x32x16_bf16 v[176:191], a[92:95], v[40:43], v[176:191]
    s_waitcnt lgkmcnt(3)
    ds_read_b128 a[84:87], v228 offset:37888
    buffer_load_dwordx4 a[204:207], v224, s[8:11], s62 offen offset:3072 sc1
    v_mfma_f32_32x32x16_bf16 v[32:47], a[64:67], a[32:35], v[208:223]
    s_add_u32 m0, s55, 36864
    s_add_u32 s63, s54, 37888
    ds_read_b128 a[88:91], v228 offset:38912
    v_exp_f32 v54, v54
    v_add_f32 v226, v226, v53
    v_cvt_pk_bf16_f32 v50, v52, v53
    v_mfma_f32_32x32x16_bf16 v[32:47], a[68:71], a[36:39], v[32:47]
    s_waitcnt lgkmcnt(3)
    ds_read_b128 a[92:95], v228 offset:39936
    buffer_load_dwordx4 v224, s[12:15], s63 offen offset:0 sc1 lds
    v_exp_f32 v55, v55
    v_add_f32 v226, v226, v54
    v_mfma_f32_32x32x16_bf16 v[32:47], a[72:75], a[40:43], v[32:47]
    ds_read_b128 a[64:67], v228 offset:24576
    v_exp_f32 v56, v56
    v_add_f32 v226, v226, v55
    v_cvt_pk_bf16_f32 v51, v54, v55
    v_mfma_f32_32x32x16_bf16 v[32:47], a[76:79], a[44:47], v[32:47]
    s_waitcnt lgkmcnt(3)
    ds_read_b128 a[68:71], v228 offset:25600
    buffer_load_dwordx4 v224, s[12:15], s63 offen offset:1024 sc1 lds
    v_exp_f32 v57, v57
    v_add_f32 v226, v226, v56
    v_mfma_f32_32x32x16_bf16 v[32:47], a[80:83], a[48:51], v[32:47]
    ds_read_b128 a[72:75], v228 offset:26624
    v_exp_f32 v58, v58
    v_add_f32 v226, v226, v57
    v_cvt_pk_bf16_f32 v56, v56, v57
    v_mfma_f32_32x32x16_bf16 v[32:47], a[84:87], a[52:55], v[32:47]
    s_waitcnt lgkmcnt(3)
    ds_read_b128 a[76:79], v228 offset:27648
    buffer_load_dwordx4 v224, s[12:15], s63 offen offset:2048 sc1 lds
    v_exp_f32 v59, v59
    v_add_f32 v226, v226, v58
    v_mfma_f32_32x32x16_bf16 v[32:47], a[88:91], a[56:59], v[32:47]
    ds_read_b128 a[80:83], v228 offset:28672
    v_exp_f32 v60, v60
    v_add_f32 v226, v226, v59
    v_cvt_pk_bf16_f32 v57, v58, v59
    v_mfma_f32_32x32x16_bf16 v[32:47], a[92:95], a[60:63], v[32:47]
    s_waitcnt lgkmcnt(3)
    ds_read_b128 a[84:87], v228 offset:29696
    buffer_load_dwordx4 v224, s[12:15], s63 offen offset:3072 sc1 lds
    v_exp_f32 v61, v61
    v_add_f32 v226, v226, v60
    v_mfma_f32_32x32x16_bf16 v[128:143], a[64:67], v[48:51], v[128:143]
    ds_read_b128 a[88:91], v228 offset:30720
    v_exp_f32 v62, v62
    v_add_f32 v226, v226, v61
    v_cvt_pk_bf16_f32 v58, v60, v61
    v_mfma_f32_32x32x16_bf16 v[144:159], a[68:71], v[48:51], v[144:159]
    s_waitcnt lgkmcnt(3)
    ds_read_b128 a[92:95], v228 offset:31744
    v_exp_f32 v63, v63
    v_add_f32 v226, v226, v62
    v_exp_f32 v32, v32
    v_mfma_f32_32x32x16_bf16 v[160:175], a[72:75], v[48:51], v[160:175]
    ds_read_b128 a[64:67], v228 offset:40960
    v_add_f32 v226, v226, v63
    v_cvt_pk_bf16_f32 v59, v62, v63
    v_exp_f32 v33, v33
    v_add_f32 v226, v226, v32
    v_mfma_f32_32x32x16_bf16 v[176:191], a[76:79], v[48:51], v[176:191]
    s_waitcnt lgkmcnt(3)
    ds_read_b128 a[68:71], v228 offset:41984
    buffer_load_dwordx4 a[208:211], v252, s[8:11], s62 offen offset:0 sc1
    v_exp_f32 v34, v34
    v_add_f32 v226, v226, v33
    v_cvt_pk_bf16_f32 v32, v32, v33
    v_mfma_f32_32x32x16_bf16 v[128:143], a[80:83], v[56:59], v[128:143]
    ds_read_b128 a[72:75], v228 offset:43008
    buffer_load_dwordx4 a[212:215], v252, s[8:11], s62 offen offset:1024 sc1
    v_exp_f32 v35, v35
    v_add_f32 v226, v226, v34
    v_mfma_f32_32x32x16_bf16 v[144:159], a[84:87], v[56:59], v[144:159]
    s_waitcnt lgkmcnt(3)
    ds_read_b128 a[76:79], v228 offset:44032
    v_exp_f32 v36, v36
    v_add_f32 v226, v226, v35
    v_cvt_pk_bf16_f32 v33, v34, v35
    v_mfma_f32_32x32x16_bf16 v[160:175], a[88:91], v[56:59], v[160:175]
    ds_read_b128 a[80:83], v228 offset:45056
    buffer_load_dwordx4 a[216:219], v252, s[8:11], s62 offen offset:2048 sc1
    v_exp_f32 v37, v37
    v_add_f32 v226, v226, v36
    v_mfma_f32_32x32x16_bf16 v[176:191], a[92:95], v[56:59], v[176:191]
    s_waitcnt lgkmcnt(3)
    s_waitcnt vmcnt(17)
    s_barrier
    ds_read_b128 a[84:87], v228 offset:46080
    buffer_load_dwordx4 a[220:223], v252, s[8:11], s62 offen offset:3072 sc1
    s_add_u32 s62, s62, 8192
    v_mfma_f32_32x32x16_bf16 v[48:63], a[64:67], a[32:35], v[208:223]
    ds_read_b128 a[88:91], v228 offset:47104
    v_exp_f32 v38, v38
    v_add_f32 v226, v226, v37
    v_cvt_pk_bf16_f32 v34, v36, v37
    v_mfma_f32_32x32x16_bf16 v[48:63], a[68:71], a[36:39], v[48:63]
    s_waitcnt lgkmcnt(3)
    ds_read_b128 a[92:95], v228 offset:48128
    buffer_load_dwordx4 a[224:227], v224, s[8:11], s62 offen offset:0 sc1
    v_exp_f32 v39, v39
    v_add_f32 v226, v226, v38
    v_mfma_f32_32x32x16_bf16 v[48:63], a[72:75], a[40:43], v[48:63]
    ds_read_b128 a[64:67], v228 offset:49152
    v_exp_f32 v40, v40
    v_add_f32 v226, v226, v39
    v_cvt_pk_bf16_f32 v35, v38, v39
    v_mfma_f32_32x32x16_bf16 v[48:63], a[76:79], a[44:47], v[48:63]
    s_waitcnt lgkmcnt(3)
    ds_read_b128 a[68:71], v228 offset:50176
    buffer_load_dwordx4 a[228:231], v224, s[8:11], s62 offen offset:1024 sc1
    v_exp_f32 v41, v41
    v_add_f32 v226, v226, v40
    v_mfma_f32_32x32x16_bf16 v[48:63], a[80:83], a[48:51], v[48:63]
    ds_read_b128 a[72:75], v228 offset:51200
    v_exp_f32 v42, v42
    v_add_f32 v226, v226, v41
    v_cvt_pk_bf16_f32 v40, v40, v41
    v_mfma_f32_32x32x16_bf16 v[48:63], a[84:87], a[52:55], v[48:63]
    s_waitcnt lgkmcnt(3)
    ds_read_b128 a[76:79], v228 offset:52224
    buffer_load_dwordx4 a[232:235], v224, s[8:11], s62 offen offset:2048 sc1
    v_exp_f32 v43, v43
    v_add_f32 v226, v226, v42
    v_mfma_f32_32x32x16_bf16 v[48:63], a[88:91], a[56:59], v[48:63]
    ds_read_b128 a[80:83], v228 offset:53248
    v_exp_f32 v44, v44
    v_add_f32 v226, v226, v43
    v_cvt_pk_bf16_f32 v41, v42, v43
    v_mfma_f32_32x32x16_bf16 v[48:63], a[92:95], a[60:63], v[48:63]
    s_waitcnt lgkmcnt(3)
    ds_read_b128 a[84:87], v228 offset:54272
    buffer_load_dwordx4 a[236:239], v224, s[8:11], s62 offen offset:3072 sc1
    v_exp_f32 v45, v45
    v_add_f32 v226, v226, v44
    v_mfma_f32_32x32x16_bf16 v[128:143], a[64:67], v[32:35], v[128:143]
    ds_read_b128 a[88:91], v228 offset:55296
    buffer_load_dwordx4 a[240:243], v252, s[8:11], s62 offen offset:0 sc1
    v_exp_f32 v46, v46
    v_add_f32 v226, v226, v45
    v_cvt_pk_bf16_f32 v42, v44, v45
    v_mfma_f32_32x32x16_bf16 v[144:159], a[68:71], v[32:35], v[144:159]
    s_waitcnt lgkmcnt(3)
    ds_read_b128 a[92:95], v228 offset:56320
    buffer_load_dword v236, v250, s[8:11], s53 offen sc1
    v_exp_f32 v47, v47
    v_add_f32 v226, v226, v46
    v_exp_f32 v48, v48
    v_mfma_f32_32x32x16_bf16 v[160:175], a[72:75], v[32:35], v[160:175]
    ds_read_b128 a[64:67], v227 offset:0
    v_add_f32 v226, v226, v47
    v_cvt_pk_bf16_f32 v43, v46, v47
    v_exp_f32 v49, v49
    v_add_f32 v226, v226, v48
    v_mfma_f32_32x32x16_bf16 v[176:191], a[76:79], v[32:35], v[176:191]
    s_waitcnt lgkmcnt(3)
    ds_read_b128 a[68:71], v227 offset:1024
    buffer_load_dwordx4 a[244:247], v252, s[8:11], s62 offen offset:1024 sc1
    v_exp_f32 v50, v50
    v_add_f32 v226, v226, v49
    v_cvt_pk_bf16_f32 v48, v48, v49
    v_mfma_f32_32x32x16_bf16 v[128:143], a[80:83], v[40:43], v[128:143]
    ds_read_b128 a[72:75], v227 offset:2048
    buffer_load_dwordx4 a[248:251], v252, s[8:11], s62 offen offset:2048 sc1
    v_xor_b32 v228, 0x10000, v228
    v_exp_f32 v51, v51
    v_add_f32 v226, v226, v50
    v_mfma_f32_32x32x16_bf16 v[144:159], a[84:87], v[40:43], v[144:159]
    s_waitcnt lgkmcnt(3)
    ds_read_b128 a[76:79], v227 offset:3072
    v_exp_f32 v52, v52
    v_add_f32 v226, v226, v51
    v_cvt_pk_bf16_f32 v49, v50, v51
    v_mfma_f32_32x32x16_bf16 v[160:175], a[88:91], v[40:43], v[160:175]
    ds_read_b128 a[80:83], v227 offset:4096
    ds_read_b128 a[84:87], v227 offset:5120
    v_xor_b32 v227, 0x10000, v227
    v_exp_f32 v53, v53
    v_add_f32 v226, v226, v52
    v_mfma_f32_32x32x16_bf16 v[176:191], a[92:95], v[40:43], v[176:191]
    s_waitcnt lgkmcnt(4)
    buffer_load_dwordx4 a[252:255], v252, s[8:11], s62 offen offset:3072 sc1
    s_add_u32 s62, s62, 8192
L_S1_sequential_preLN__compressed_kv_cla__geglu_ffn__prompt_kernel:
    v_mfma_f32_32x32x16_bf16 v[32:47], a[64:67], a[32:35], v[208:223]
    s_cmp_eq_u32 s71, 0
    s_mov_b32 m0, s97
    ds_read_b128 a[88:91], v228 offset:6144
    v_exp_f32 v54, v54
    v_add_f32 v226, v226, v53
    v_cvt_pk_bf16_f32 v50, v52, v53
    v_mfma_f32_32x32x16_bf16 v[32:47], a[68:71], a[36:39], v[32:47]
    s_waitcnt lgkmcnt(3)
    ds_read_b128 a[92:95], v228 offset:7168
    buffer_load_dwordx4 v224, s[8:11], s60 offen offset:0 sc1 lds
    v_exp_f32 v55, v55
    v_add_f32 v226, v226, v54
    v_mfma_f32_32x32x16_bf16 v[32:47], a[72:75], a[40:43], v[32:47]
    s_cselect_b64 s[84:85], s[16:17], 0
    ds_read_b128 a[64:67], v227 offset:57344
    v_exp_f32 v56, v56
    v_add_f32 v226, v226, v55
    v_cvt_pk_bf16_f32 v51, v54, v55
    v_mfma_f32_32x32x16_bf16 v[32:47], a[76:79], a[44:47], v[32:47]
    s_waitcnt lgkmcnt(3)
    ds_read_b128 a[68:71], v227 offset:58368
    buffer_load_dwordx4 v224, s[8:11], s60 offen offset:1024 sc1 lds
    v_exp_f32 v57, v57
    v_add_f32 v226, v226, v56
    v_mfma_f32_32x32x16_bf16 v[32:47], a[80:83], a[48:51], v[32:47]
    s_cselect_b64 s[88:89], s[18:19], 0
    ds_read_b128 a[72:75], v227 offset:59392
    v_exp_f32 v58, v58
    v_add_f32 v226, v226, v57
    v_cvt_pk_bf16_f32 v56, v56, v57
    v_mfma_f32_32x32x16_bf16 v[32:47], a[84:87], a[52:55], v[32:47]
    s_waitcnt lgkmcnt(3)
    ds_read_b128 a[76:79], v227 offset:60416
    buffer_load_dwordx4 v224, s[8:11], s60 offen offset:2048 sc1 lds
    v_exp_f32 v59, v59
    v_add_f32 v226, v226, v58
    v_mfma_f32_32x32x16_bf16 v[32:47], a[88:91], a[56:59], v[32:47]
    s_cselect_b64 s[90:91], s[20:21], 0
    ds_read_b128 a[80:83], v227 offset:61440
    v_exp_f32 v60, v60
    v_add_f32 v226, v226, v59
    v_cvt_pk_bf16_f32 v57, v58, v59
    v_mfma_f32_32x32x16_bf16 v[32:47], a[92:95], a[60:63], v[32:47]
    s_waitcnt lgkmcnt(3)
    ds_read_b128 a[84:87], v227 offset:62464
    buffer_load_dwordx4 v224, s[8:11], s60 offen offset:3072 sc1 lds
    v_exp_f32 v61, v61
    v_add_f32 v226, v226, v60
    v_mfma_f32_32x32x16_bf16 v[128:143], a[64:67], v[48:51], v[128:143]
    s_cselect_b64 s[92:93], s[22:23], 0
    ds_read_b128 a[88:91], v227 offset:63488
    v_exp_f32 v62, v62
    v_add_f32 v226, v226, v61
    v_cvt_pk_bf16_f32 v58, v60, v61
    v_mfma_f32_32x32x16_bf16 v[144:159], a[68:71], v[48:51], v[144:159]
    s_waitcnt lgkmcnt(3)
    s_mov_b32 m0, s51
    ds_read_b128 a[92:95], v227 offset:64512
    v_exp_f32 v63, v63
    v_add_f32 v226, v226, v62
    v_cndmask_b32 v32, v32, v229, s[84:85]
    v_exp_f32 v32, v32
    v_mfma_f32_32x32x16_bf16 v[160:175], a[72:75], v[48:51], v[160:175]
    s_cselect_b64 s[94:95], s[24:25], 0
    ds_read_b128 a[64:67], v228 offset:8192
    v_add_f32 v226, v226, v63
    v_cvt_pk_bf16_f32 v59, v62, v63
    v_cndmask_b32 v33, v33, v229, s[88:89]
    v_exp_f32 v33, v33
    v_add_f32 v226, v226, v32
    v_mfma_f32_32x32x16_bf16 v[176:191], a[76:79], v[48:51], v[176:191]
    s_waitcnt lgkmcnt(3)
    ds_read_b128 a[68:71], v228 offset:9216
    buffer_load_dwordx4 v252, s[8:11], s60 offen offset:0 sc1 lds
    v_cndmask_b32 v34, v34, v229, s[90:91]
    v_exp_f32 v34, v34
    v_add_f32 v226, v226, v33
    v_cvt_pk_bf16_f32 v32, v32, v33
    v_mfma_f32_32x32x16_bf16 v[128:143], a[80:83], v[56:59], v[128:143]
    s_cselect_b64 s[100:101], s[26:27], 0
    ds_read_b128 a[72:75], v228 offset:10240
    buffer_load_dwordx4 v252, s[8:11], s60 offen offset:1024 sc1 lds
    v_cndmask_b32 v35, v35, v229, s[92:93]
    v_exp_f32 v35, v35
    v_add_f32 v226, v226, v34
    v_mfma_f32_32x32x16_bf16 v[144:159], a[84:87], v[56:59], v[144:159]
    s_waitcnt lgkmcnt(3)
    ds_read_b128 a[76:79], v228 offset:11264
    buffer_load_dwordx4 v252, s[8:11], s60 offen offset:2048 sc1 lds
    v_cndmask_b32 v36, v36, v229, s[94:95]
    v_exp_f32 v36, v36
    v_add_f32 v226, v226, v35
    v_cvt_pk_bf16_f32 v33, v34, v35
    v_mfma_f32_32x32x16_bf16 v[160:175], a[88:91], v[56:59], v[160:175]
    ds_read_b128 a[80:83], v228 offset:12288
    buffer_load_dwordx4 v252, s[8:11], s60 offen offset:3072 sc1 lds
    v_cndmask_b32 v37, v37, v229, s[100:101]
    v_exp_f32 v37, v37
    v_add_f32 v226, v226, v36
    v_mov_b32 v234, v228
    v_mfma_f32_32x32x16_bf16 v[176:191], a[92:95], v[56:59], v[176:191]
    s_waitcnt lgkmcnt(3)
    s_waitcnt vmcnt(21)
    s_barrier
    s_cmp_eq_u32 s71, 0
    ds_read_b128 a[84:87], v228 offset:13312
    s_cbranch_scc1 L_dB0_sequential_preLN__compressed_kv_cla__geglu_ffn__prompt_kernel
    v_mfma_f32_32x32x16_bf16 v[48:63], a[64:67], a[32:35], v[208:223]
    s_cmp_eq_u32 s71, 1
    ds_read_b128 a[88:91], v228 offset:14336
    v_exp_f32 v38, v38
    v_add_f32 v226, v226, v37
    v_cvt_pk_bf16_f32 v34, v36, v37
    v_mfma_f32_32x32x16_bf16 v[48:63], a[68:71], a[36:39], v[48:63]
    s_waitcnt lgkmcnt(3)
    ds_read_b128 a[92:95], v228 offset:15360
    buffer_load_dwordx4 a[0:3], v224, s[8:11], s62 offen offset:0 sc1
    v_exp_f32 v39, v39
    v_add_f32 v226, v226, v38
    v_mfma_f32_32x32x16_bf16 v[48:63], a[72:75], a[40:43], v[48:63]
    s_cselect_b64 s[84:85], s[16:17], 0
    ds_read_b128 a[64:67], v228 offset:16384
    v_exp_f32 v40, v40
    v_add_f32 v226, v226, v39
    v_cvt_pk_bf16_f32 v35, v38, v39
    v_mfma_f32_32x32x16_bf16 v[48:63], a[76:79], a[44:47], v[48:63]
    s_waitcnt lgkmcnt(3)
    ds_read_b128 a[68:71], v228 offset:17408
    buffer_load_dwordx4 a[4:7], v224, s[8:11], s62 offen offset:1024 sc1
    v_exp_f32 v41, v41
    v_add_f32 v226, v226, v40
    v_mfma_f32_32x32x16_bf16 v[48:63], a[80:83], a[48:51], v[48:63]
    s_cselect_b64 s[88:89], s[18:19], 0
    ds_read_b128 a[72:75], v228 offset:18432
    v_exp_f32 v42, v42
    v_add_f32 v226, v226, v41
    v_cvt_pk_bf16_f32 v40, v40, v41
    v_mfma_f32_32x32x16_bf16 v[48:63], a[84:87], a[52:55], v[48:63]
    s_waitcnt lgkmcnt(3)
    ds_read_b128 a[76:79], v228 offset:19456
    buffer_load_dwordx4 a[8:11], v224, s[8:11], s62 offen offset:2048 sc1
    v_exp_f32 v43, v43
    v_add_f32 v226, v226, v42
    v_mfma_f32_32x32x16_bf16 v[48:63], a[88:91], a[56:59], v[48:63]
    s_cselect_b64 s[90:91], s[20:21], 0
    ds_read_b128 a[80:83], v228 offset:20480
    v_exp_f32 v44, v44
    v_add_f32 v226, v226, v43
    v_cvt_pk_bf16_f32 v41, v42, v43
    v_mfma_f32_32x32x16_bf16 v[48:63], a[92:95], a[60:63], v[48:63]
    s_waitcnt lgkmcnt(3)
    ds_read_b128 a[84:87], v228 offset:21504
    buffer_load_dwordx4 a[12:15], v224, s[8:11], s62 offen offset:3072 sc1
    v_exp_f32 v45, v45
    v_add_f32 v226, v226, v44
    v_mfma_f32_32x32x16_bf16 v[128:143], a[64:67], v[32:35], v[128:143]
    s_cselect_b64 s[92:93], s[22:23], 0
    ds_read_b128 a[88:91], v228 offset:22528
    v_exp_f32 v46, v46
    v_add_f32 v226, v226, v45
    v_cvt_pk_bf16_f32 v42, v44, v45
    v_mfma_f32_32x32x16_bf16 v[144:159], a[68:71], v[32:35], v[144:159]
    s_waitcnt lgkmcnt(3)
    ds_read_b128 a[92:95], v228 offset:23552
    v_exp_f32 v47, v47
    v_add_f32 v226, v226, v46
    v_cndmask_b32 v48, v48, v229, s[84:85]
    v_exp_f32 v48, v48
    v_mfma_f32_32x32x16_bf16 v[160:175], a[72:75], v[32:35], v[160:175]
    s_cselect_b64 s[94:95], s[24:25], 0
    ds_read_b128 a[64:67], v228 offset:32768
    v_add_f32 v226, v226, v47
    v_cvt_pk_bf16_f32 v43, v46, v47
    v_cndmask_b32 v49, v49, v229, s[88:89]
    v_exp_f32 v49, v49
    v_add_f32 v226, v226, v48
    v_mfma_f32_32x32x16_bf16 v[176:191], a[76:79], v[32:35], v[176:191]
    s_waitcnt lgkmcnt(3)
    ds_read_b128 a[68:71], v228 offset:33792
    buffer_load_dwordx4 a[16:19], v252, s[8:11], s62 offen offset:0 sc1
    v_cndmask_b32 v50, v50, v229, s[90:91]
    v_exp_f32 v50, v50
    v_add_f32 v226, v226, v49
    v_cvt_pk_bf16_f32 v48, v48, v49
    v_mfma_f32_32x32x16_bf16 v[128:143], a[80:83], v[40:43], v[128:143]
    s_cselect_b64 s[100:101], s[26:27], 0
    ds_read_b128 a[72:75], v228 offset:34816
    buffer_load_dwordx4 a[20:23], v252, s[8:11], s62 offen offset:1024 sc1
    v_cndmask_b32 v51, v51, v229, s[92:93]
    v_exp_f32 v51, v51
    v_add_f32 v226, v226, v50
    v_mfma_f32_32x32x16_bf16 v[144:159], a[84:87], v[40:43], v[144:159]
    s_waitcnt lgkmcnt(3)
    ds_read_b128 a[76:79], v228 offset:35840
    buffer_load_dwordx4 a[24:27], v252, s[8:11], s62 offen offset:2048 sc1
    v_cndmask_b32 v52, v52, v229, s[94:95]
    v_exp_f32 v52, v52
    v_add_f32 v226, v226, v51
    v_cvt_pk_bf16_f32 v49, v50, v51
    v_mfma_f32_32x32x16_bf16 v[160:175], a[88:91], v[40:43], v[160:175]
    ds_read_b128 a[80:83], v228 offset:36864
    buffer_load_dwordx4 a[28:31], v252, s[8:11], s62 offen offset:3072 sc1
    s_add_u32 s62, s62, 8192
    v_cndmask_b32 v53, v53, v229, s[100:101]
    v_exp_f32 v53, v53
    v_add_f32 v226, v226, v52
    v_mfma_f32_32x32x16_bf16 v[176:191], a[92:95], v[40:43], v[176:191]
    s_waitcnt lgkmcnt(3)
    s_cmp_eq_u32 s71, 1
    ds_read_b128 a[84:87], v228 offset:37888
    s_cbranch_scc1 L_dB1_sequential_preLN__compressed_kv_cla__geglu_ffn__prompt_kernel
    v_mfma_f32_32x32x16_bf16 v[32:47], a[64:67], a[32:35], v[208:223]
    s_cmp_eq_u32 s71, 2
    ds_read_b128 a[88:91], v228 offset:38912
    v_exp_f32 v54, v54
    v_add_f32 v226, v226, v53
    v_cvt_pk_bf16_f32 v50, v52, v53
    v_mfma_f32_32x32x16_bf16 v[32:47], a[68:71], a[36:39], v[32:47]
    s_waitcnt lgkmcnt(3)
    ds_read_b128 a[92:95], v228 offset:39936
    v_exp_f32 v55, v55
    v_add_f32 v226, v226, v54
    v_mfma_f32_32x32x16_bf16 v[32:47], a[72:75], a[40:43], v[32:47]
    s_cselect_b64 s[84:85], s[16:17], 0
    ds_read_b128 a[64:67], v228 offset:24576
    v_exp_f32 v56, v56
    v_add_f32 v226, v226, v55
    v_cvt_pk_bf16_f32 v51, v54, v55
    v_mfma_f32_32x32x16_bf16 v[32:47], a[76:79], a[44:47], v[32:47]
    s_waitcnt lgkmcnt(3)
    ds_read_b128 a[68:71], v228 offset:25600
    v_exp_f32 v57, v57
    v_add_f32 v226, v226, v56
    v_mfma_f32_32x32x16_bf16 v[32:47], a[80:83], a[48:51], v[32:47]
    s_cselect_b64 s[88:89], s[18:19], 0
    ds_read_b128 a[72:75], v228 offset:26624
    v_exp_f32 v58, v58
    v_add_f32 v226, v226, v57
    v_cvt_pk_bf16_f32 v56, v56, v57
    v_mfma_f32_32x32x16_bf16 v[32:47], a[84:87], a[52:55], v[32:47]
    s_waitcnt lgkmcnt(3)
    ds_read_b128 a[76:79], v228 offset:27648
    v_exp_f32 v59, v59
    v_add_f32 v226, v226, v58
    v_mfma_f32_32x32x16_bf16 v[32:47], a[88:91], a[56:59], v[32:47]
    s_cselect_b64 s[90:91], s[20:21], 0
    ds_read_b128 a[80:83], v228 offset:28672
    v_exp_f32 v60, v60
    v_add_f32 v226, v226, v59
    v_cvt_pk_bf16_f32 v57, v58, v59
    v_mfma_f32_32x32x16_bf16 v[32:47], a[92:95], a[60:63], v[32:47]
    s_waitcnt lgkmcnt(3)
    ds_read_b128 a[84:87], v228 offset:29696
    v_exp_f32 v61, v61
    v_add_f32 v226, v226, v60
    v_mfma_f32_32x32x16_bf16 v[128:143], a[64:67], v[48:51], v[128:143]
    s_cselect_b64 s[92:93], s[22:23], 0
    ds_read_b128 a[88:91], v228 offset:30720
    v_exp_f32 v62, v62
    v_add_f32 v226, v226, v61
    v_cvt_pk_bf16_f32 v58, v60, v61
    v_mfma_f32_32x32x16_bf16 v[144:159], a[68:71], v[48:51], v[144:159]
    s_waitcnt lgkmcnt(3)
    ds_read_b128 a[92:95], v228 offset:31744
    v_exp_f32 v63, v63
    v_add_f32 v226, v226, v62
    v_cndmask_b32 v32, v32, v229, s[84:85]
    v_exp_f32 v32, v32
    v_mfma_f32_32x32x16_bf16 v[160:175], a[72:75], v[48:51], v[160:175]
    s_cselect_b64 s[94:95], s[24:25], 0
    ds_read_b128 a[64:67], v228 offset:40960
    v_add_f32 v226, v226, v63
    v_cvt_pk_bf16_f32 v59, v62, v63
    v_cndmask_b32 v33, v33, v229, s[88:89]
    v_exp_f32 v33, v33
    v_add_f32 v226, v226, v32
    v_mfma_f32_32x32x16_bf16 v[176:191], a[76:79], v[48:51], v[176:191]
    s_waitcnt lgkmcnt(3)
    ds_read_b128 a[68:71], v228 offset:41984
    v_cndmask_b32 v34, v34, v229, s[90:91]
    v_exp_f32 v34, v34
    v_add_f32 v226, v226, v33
    v_cvt_pk_bf16_f32 v32, v32, v33
    v_mfma_f32_32x32x16_bf16 v[128:143], a[80:83], v[56:59], v[128:143]
    s_cselect_b64 s[100:101], s[26:27], 0
    ds_read_b128 a[72:75], v228 offset:43008
    v_cndmask_b32 v35, v35, v229, s[92:93]
    v_exp_f32 v35, v35
    v_add_f32 v226, v226, v34
    v_mfma_f32_32x32x16_bf16 v[144:159], a[84:87], v[56:59], v[144:159]
    s_waitcnt lgkmcnt(3)
    ds_read_b128 a[76:79], v228 offset:44032
    v_cndmask_b32 v36, v36, v229, s[94:95]
    v_exp_f32 v36, v36
    v_add_f32 v226, v226, v35
    v_cvt_pk_bf16_f32 v33, v34, v35
    v_mfma_f32_32x32x16_bf16 v[160:175], a[88:91], v[56:59], v[160:175]
    ds_read_b128 a[80:83], v228 offset:45056
    v_cndmask_b32 v37, v37, v229, s[100:101]
    v_exp_f32 v37, v37
    v_add_f32 v226, v226, v36
    v_add_u32 v234, 0x8000, v228
    v_mfma_f32_32x32x16_bf16 v[176:191], a[92:95], v[56:59], v[176:191]
    s_waitcnt lgkmcnt(3)
    s_cmp_eq_u32 s71, 2
    ds_read_b128 a[84:87], v228 offset:46080
    s_cbranch_scc1 L_dB0_sequential_preLN__compressed_kv_cla__geglu_ffn__prompt_kernel
    v_mfma_f32_32x32x16_bf16 v[48:63], a[64:67], a[32:35], v[208:223]
    ds_read_b128 a[88:91], v228 offset:47104
    v_exp_f32 v38, v38
    v_add_f32 v226, v226, v37
    v_cvt_pk_bf16_f32 v34, v36, v37
    v_mfma_f32_32x32x16_bf16 v[48:63], a[68:71], a[36:39], v[48:63]
    s_waitcnt lgkmcnt(3)
    ds_read_b128 a[92:95], v228 offset:48128
    v_exp_f32 v39, v39
    v_add_f32 v226, v226, v38
    v_mfma_f32_32x32x16_bf16 v[48:63], a[72:75], a[40:43], v[48:63]
    ds_read_b128 a[64:67], v228 offset:49152
    v_exp_f32 v40, v40
    v_add_f32 v226, v226, v39
    v_cvt_pk_bf16_f32 v35, v38, v39
    v_mfma_f32_32x32x16_bf16 v[48:63], a[76:79], a[44:47], v[48:63]
    s_waitcnt lgkmcnt(3)
    ds_read_b128 a[68:71], v228 offset:50176
    v_exp_f32 v41, v41
    v_add_f32 v226, v226, v40
    v_mfma_f32_32x32x16_bf16 v[48:63], a[80:83], a[48:51], v[48:63]
    ds_read_b128 a[72:75], v228 offset:51200
    v_exp_f32 v42, v42
    v_add_f32 v226, v226, v41
    v_cvt_pk_bf16_f32 v40, v40, v41
    v_mfma_f32_32x32x16_bf16 v[48:63], a[84:87], a[52:55], v[48:63]
    s_waitcnt lgkmcnt(3)
    ds_read_b128 a[76:79], v228 offset:52224
    v_exp_f32 v43, v43
    v_add_f32 v226, v226, v42
    v_mfma_f32_32x32x16_bf16 v[48:63], a[88:91], a[56:59], v[48:63]
    ds_read_b128 a[80:83], v228 offset:53248
    v_exp_f32 v44, v44
    v_add_f32 v226, v226, v43
    v_cvt_pk_bf16_f32 v41, v42, v43
    v_mfma_f32_32x32x16_bf16 v[48:63], a[92:95], a[60:63], v[48:63]
    s_waitcnt lgkmcnt(3)
    ds_read_b128 a[84:87], v228 offset:54272
    v_exp_f32 v45, v45
    v_add_f32 v226, v226, v44
    v_mfma_f32_32x32x16_bf16 v[128:143], a[64:67], v[32:35], v[128:143]
    ds_read_b128 a[88:91], v228 offset:55296
    v_exp_f32 v46, v46
    v_add_f32 v226, v226, v45
    v_cvt_pk_bf16_f32 v42, v44, v45
    v_mfma_f32_32x32x16_bf16 v[144:159], a[68:71], v[32:35], v[144:159]
    s_waitcnt lgkmcnt(3)
    ds_read_b128 a[92:95], v228 offset:56320
    v_exp_f32 v47, v47
    v_add_f32 v226, v226, v46
    v_cndmask_b32 v48, v48, v229, s[16:17]
    v_exp_f32 v48, v48
    v_mfma_f32_32x32x16_bf16 v[160:175], a[72:75], v[32:35], v[160:175]
    v_add_f32 v226, v226, v47
    v_cvt_pk_bf16_f32 v43, v46, v47
    v_cndmask_b32 v49, v49, v229, s[18:19]
    v_exp_f32 v49, v49
    v_add_f32 v226, v226, v48
    v_mfma_f32_32x32x16_bf16 v[176:191], a[76:79], v[32:35], v[176:191]
    s_waitcnt lgkmcnt(2)
    v_cndmask_b32 v50, v50, v229, s[20:21]
    v_exp_f32 v50, v50
    v_add_f32 v226, v226, v49
    v_cvt_pk_bf16_f32 v48, v48, v49
    v_mfma_f32_32x32x16_bf16 v[128:143], a[80:83], v[40:43], v[128:143]
    v_cndmask_b32 v51, v51, v229, s[22:23]
    v_exp_f32 v51, v51
    v_add_f32 v226, v226, v50
    v_mfma_f32_32x32x16_bf16 v[144:159], a[84:87], v[40:43], v[144:159]
    s_waitcnt lgkmcnt(0)
    v_cndmask_b32 v52, v52, v229, s[24:25]
    v_exp_f32 v52, v52
    v_add_f32 v226, v226, v51
    v_cvt_pk_bf16_f32 v49, v50, v51
    v_mfma_f32_32x32x16_bf16 v[160:175], a[88:91], v[40:43], v[160:175]
    v_cndmask_b32 v53, v53, v229, s[26:27]
    v_exp_f32 v53, v53
    v_add_f32 v226, v226, v52
    v_mfma_f32_32x32x16_bf16 v[176:191], a[92:95], v[40:43], v[176:191]
L_dB1_sequential_preLN__compressed_kv_cla__geglu_ffn__prompt_kernel:
    ds_read_b128 a[96:99], v234 offset:24576
    ds_read_b128 a[100:103], v234 offset:25600
    ds_read_b128 a[104:107], v234 offset:26624
    ds_read_b128 a[108:111], v234 offset:27648
    ds_read_b128 a[112:115], v234 offset:28672
    ds_read_b128 a[116:119], v234 offset:29696
    ds_read_b128 a[120:123], v234 offset:30720
    ds_read_b128 a[124:127], v234 offset:31744
    s_waitcnt vmcnt(17)
    buffer_store_dword v253, v251, s[8:11], s57 offen sc1
    v_cndmask_b32 v54, v54, v229, s[28:29]
    v_cndmask_b32 v55, v55, v229, s[30:31]
    v_cndmask_b32 v56, v56, v229, s[32:33]
    v_cndmask_b32 v57, v57, v229, s[34:35]
    v_cndmask_b32 v58, v58, v229, s[36:37]
    v_cndmask_b32 v59, v59, v229, s[38:39]
    v_cndmask_b32 v60, v60, v229, s[40:41]
    v_cndmask_b32 v61, v61, v229, s[42:43]
    v_cndmask_b32 v62, v62, v229, s[44:45]
    v_cndmask_b32 v63, v63, v229, s[46:47]
    v_exp_f32 v54, v54
    v_add_f32 v226, v226, v53
    v_cvt_pk_bf16_f32 v50, v52, v53
    v_exp_f32 v55, v55
    v_add_f32 v226, v226, v54
    v_exp_f32 v56, v56
    v_add_f32 v226, v226, v55
    v_cvt_pk_bf16_f32 v51, v54, v55
    s_nop 0
    s_waitcnt lgkmcnt(7)
    v_mfma_f32_32x32x16_bf16 v[128:143], a[96:99], v[48:51], v[128:143]
    v_exp_f32 v57, v57
    v_add_f32 v226, v226, v56
    v_exp_f32 v58, v58
    v_add_f32 v226, v226, v57
    v_cvt_pk_bf16_f32 v56, v56, v57
    s_waitcnt lgkmcnt(6)
    v_mfma_f32_32x32x16_bf16 v[144:159], a[100:103], v[48:51], v[144:159]
    v_exp_f32 v59, v59
    v_add_f32 v226, v226, v58
    v_exp_f32 v60, v60
    v_add_f32 v226, v226, v59
    v_cvt_pk_bf16_f32 v57, v58, v59
    s_waitcnt lgkmcnt(5)
    v_mfma_f32_32x32x16_bf16 v[160:175], a[104:107], v[48:51], v[160:175]
    v_exp_f32 v61, v61
    v_add_f32 v226, v226, v60
    v_exp_f32 v62, v62
    v_add_f32 v226, v226, v61
    v_cvt_pk_bf16_f32 v58, v60, v61
    s_waitcnt lgkmcnt(4)
    v_mfma_f32_32x32x16_bf16 v[176:191], a[108:111], v[48:51], v[176:191]
    v_exp_f32 v63, v63
    v_add_f32 v226, v226, v62
    s_nop 0
    v_add_f32 v226, v226, v63
    v_cvt_pk_bf16_f32 v59, v62, v63
    s_nop 1
    s_waitcnt lgkmcnt(3)
    v_mfma_f32_32x32x16_bf16 v[128:143], a[112:115], v[56:59], v[128:143]
    v_mov_b32 v232, v226
    s_nop 1
    v_permlane32_swap_b32 v232, v226
    s_waitcnt lgkmcnt(2)
    v_mfma_f32_32x32x16_bf16 v[144:159], a[116:119], v[56:59], v[144:159]
    v_add_f32 v226, v226, v232
    v_rcp_f32 v232, v226
    v_cmp_nge_f32 vcc, 0x53800000, v226
    s_waitcnt lgkmcnt(1)
    v_mfma_f32_32x32x16_bf16 v[160:175], a[120:123], v[56:59], v[160:175]
    s_waitcnt lgkmcnt(0)
    v_mfma_f32_32x32x16_bf16 v[176:191], a[124:127], v[56:59], v[176:191]
L_finB_sequential_preLN__compressed_kv_cla__geglu_ffn__prompt_kernel:
    s_cbranch_vccnz L_redoB_sequential_preLN__compressed_kv_cla__geglu_ffn__prompt_kernel
L_redoneB_sequential_preLN__compressed_kv_cla__geglu_ffn__prompt_kernel:
    v_pk_mul_f32 v[128:129], v[128:129], v[232:233] op_sel_hi:[1,0]
    v_pk_mul_f32 v[130:131], v[130:131], v[232:233] op_sel_hi:[1,0]
    v_pk_mul_f32 v[132:133], v[132:133], v[232:233] op_sel_hi:[1,0]
    v_pk_mul_f32 v[134:135], v[134:135], v[232:233] op_sel_hi:[1,0]
    v_cvt_pk_bf16_f32 v128, v128, v129
    v_cvt_pk_bf16_f32 v129, v130, v131
    v_cvt_pk_bf16_f32 v130, v132, v133
    v_cvt_pk_bf16_f32 v131, v134, v135
    buffer_store_dwordx4 v[128:131], v224, s[8:11], s65 offen offset:0 sc1
    v_pk_mul_f32 v[136:137], v[136:137], v[232:233] op_sel_hi:[1,0]
    v_pk_mul_f32 v[138:139], v[138:139], v[232:233] op_sel_hi:[1,0]
    v_pk_mul_f32 v[140:141], v[140:141], v[232:233] op_sel_hi:[1,0]
    v_pk_mul_f32 v[142:143], v[142:143], v[232:233] op_sel_hi:[1,0]
    v_cvt_pk_bf16_f32 v136, v136, v137
    v_cvt_pk_bf16_f32 v137, v138, v139
    v_cvt_pk_bf16_f32 v138, v140, v141
    v_cvt_pk_bf16_f32 v139, v142, v143
    buffer_store_dwordx4 v[136:139], v224, s[8:11], s65 offen offset:1024 sc1
    v_pk_mul_f32 v[144:145], v[144:145], v[232:233] op_sel_hi:[1,0]
    v_pk_mul_f32 v[146:147], v[146:147], v[232:233] op_sel_hi:[1,0]
    v_pk_mul_f32 v[148:149], v[148:149], v[232:233] op_sel_hi:[1,0]
    v_pk_mul_f32 v[150:151], v[150:151], v[232:233] op_sel_hi:[1,0]
    v_cvt_pk_bf16_f32 v144, v144, v145
    v_cvt_pk_bf16_f32 v145, v146, v147
    v_cvt_pk_bf16_f32 v146, v148, v149
    v_cvt_pk_bf16_f32 v147, v150, v151
    buffer_store_dwordx4 v[144:147], v224, s[8:11], s65 offen offset:2048 sc1
    v_pk_mul_f32 v[152:153], v[152:153], v[232:233] op_sel_hi:[1,0]
    v_pk_mul_f32 v[154:155], v[154:155], v[232:233] op_sel_hi:[1,0]
    v_pk_mul_f32 v[156:157], v[156:157], v[232:233] op_sel_hi:[1,0]
    v_pk_mul_f32 v[158:159], v[158:159], v[232:233] op_sel_hi:[1,0]
    v_cvt_pk_bf16_f32 v152, v152, v153
    v_cvt_pk_bf16_f32 v153, v154, v155
    v_cvt_pk_bf16_f32 v154, v156, v157
    v_cvt_pk_bf16_f32 v155, v158, v159
    buffer_store_dwordx4 v[152:155], v224, s[8:11], s65 offen offset:3072 sc1
    v_pk_mul_f32 v[160:161], v[160:161], v[232:233] op_sel_hi:[1,0]
    v_pk_mul_f32 v[162:163], v[162:163], v[232:233] op_sel_hi:[1,0]
    v_pk_mul_f32 v[164:165], v[164:165], v[232:233] op_sel_hi:[1,0]
    v_pk_mul_f32 v[166:167], v[166:167], v[232:233] op_sel_hi:[1,0]
    v_cvt_pk_bf16_f32 v160, v160, v161
    v_cvt_pk_bf16_f32 v161, v162, v163
    v_cvt_pk_bf16_f32 v162, v164, v165
    v_cvt_pk_bf16_f32 v163, v166, v167
    s_add_u32 s65, s65, 4096
    buffer_store_dwordx4 v[160:163], v224, s[8:11], s65 offen offset:0 sc1
    v_pk_mul_f32 v[168:169], v[168:169], v[232:233] op_sel_hi:[1,0]
    v_pk_mul_f32 v[170:171], v[170:171], v[232:233] op_sel_hi:[1,0]
    v_pk_mul_f32 v[172:173], v[172:173], v[232:233] op_sel_hi:[1,0]
    v_pk_mul_f32 v[174:175], v[174:175], v[232:233] op_sel_hi:[1,0]
    v_cvt_pk_bf16_f32 v168, v168, v169
    v_cvt_pk_bf16_f32 v169, v170, v171
    v_cvt_pk_bf16_f32 v170, v172, v173
    v_cvt_pk_bf16_f32 v171, v174, v175
    buffer_store_dwordx4 v[168:171], v224, s[8:11], s65 offen offset:1024 sc1
    v_pk_mul_f32 v[176:177], v[176:177], v[232:233] op_sel_hi:[1,0]
    v_pk_mul_f32 v[178:179], v[178:179], v[232:233] op_sel_hi:[1,0]
    v_pk_mul_f32 v[180:181], v[180:181], v[232:233] op_sel_hi:[1,0]
    v_pk_mul_f32 v[182:183], v[182:183], v[232:233] op_sel_hi:[1,0]
    v_cvt_pk_bf16_f32 v176, v176, v177
    v_cvt_pk_bf16_f32 v177, v178, v179
    v_cvt_pk_bf16_f32 v178, v180, v181
    v_cvt_pk_bf16_f32 v179, v182, v183
    buffer_store_dwordx4 v[176:179], v224, s[8:11], s65 offen offset:2048 sc1
    v_pk_mul_f32 v[184:185], v[184:185], v[232:233] op_sel_hi:[1,0]
    v_pk_mul_f32 v[186:187], v[186:187], v[232:233] op_sel_hi:[1,0]
    v_pk_mul_f32 v[188:189], v[188:189], v[232:233] op_sel_hi:[1,0]
    v_pk_mul_f32 v[190:191], v[190:191], v[232:233] op_sel_hi:[1,0]
    v_cvt_pk_bf16_f32 v184, v184, v185
    v_cvt_pk_bf16_f32 v185, v186, v187
    v_cvt_pk_bf16_f32 v186, v188, v189
    v_cvt_pk_bf16_f32 v187, v190, v191
    buffer_store_dwordx4 v[184:187], v224, s[8:11], s65 offen offset:3072 sc1
    s_cmp_lt_u32 s71, 3
    s_cbranch_scc1 L_cu_sequential_preLN__compressed_kv_cla__geglu_ffn__prompt_kernel
    s_sub_u32 s4, s59, 0x20000
    s_waitcnt vmcnt(0)
    buffer_store_dword v253, v251, s[8:11], s4 offen sc1
L_cur_sequential_preLN__compressed_kv_cla__geglu_ffn__prompt_kernel:
    v_add_u32 v205, s86, v224
    s_xor_b32 s38, s86, 0x10000
    s_sub_u32 s47, s59, 0x20000
    s_bitcmp0_b32 1, s71
    s_cbranch_scc1 L_cw0_sequential_preLN__compressed_kv_cla__geglu_ffn__prompt_kernel
    s_waitcnt vmcnt(21)
L_cw0_sequential_preLN__compressed_kv_cla__geglu_ffn__prompt_kernel:
    s_barrier
    ds_read_b128 a[64:67], v205 offset:0
    ds_read_b128 a[68:71], v205 offset:1024
    ds_read_b128 a[72:75], v205 offset:2048
    ds_read_b128 a[76:79], v205 offset:3072
    ds_read_b128 a[80:83], v205 offset:4096
    ds_read_b128 a[84:87], v205 offset:5120
    s_load_dwordx2 s[42:43], s[0:1], 80
    s_lshl_b32 s3, s71, 12
    s_add_u32 s40, s86, s3
    s_add_u32 s41, s38, s3
    v_add_u32 v206, s38, v224
    s_bfe_u32 s35, s2, 0x20001
    s_lshl_b32 s3, s35, 1
    s_lshr_b32 s4, 0xb9, s3
    s_and_b32 s4, s4, 3
    s_mul_i32 s4, s4, 278528
    s_add_u32 s36, s87, s4
    s_lshr_b32 s4, 0x5f, s3
    s_and_b32 s4, s4, 3
    s_mul_i32 s4, s4, 278528
    s_add_u32 s51, s87, s4
    s_mul_i32 s4, s35, 278528
    s_add_u32 s32, s87, s4
    s_sub_u32 s4, s56, 0x20000
    s_bitcmp1_b32 s35, 0
    s_cselect_b32 s33, s56, s4
    s_cselect_b32 s45, s4, s56
    v_bfe_u32 v238, v224, 7, 1
    v_lshl_add_u32 v238, v238, 12, v250
    s_lshl_b32 s3, s2, 2
    s_add_u32 s37, s3, 0x4e02c00
    s_waitcnt lgkmcnt(0)
    s_mov_b32 s16, s42
    s_and_b32 s17, s43, 0xffff
    s_mov_b32 s18, 0x200000
    s_mov_b32 s19, 0x20000
    v_mfma_f32_32x32x16_bf16 v[0:15], a[128:131], a[64:67], 0
    ds_read_b128 a[88:91], v205 offset:6144
    buffer_load_dwordx4 v[64:67], v224, s[8:11], s62 offen offset:0 sc1
    v_mfma_f32_32x32x16_bf16 v[0:15], a[132:135], a[68:71], v[0:15]
    s_lshl_b32 s3, s35, 21
    s_sub_u32 s4, s52, s3
    s_lshl_b32 s3, s35, 3
    ds_read_b128 a[92:95], v205 offset:7168
    buffer_load_dwordx4 v[68:71], v224, s[8:11], s62 offen offset:1024 sc1
    v_mfma_f32_32x32x16_bf16 v[0:15], a[136:139], a[72:75], v[0:15]
    s_lshr_b32 s92, 0x2000104, s3
    s_bfe_u32 s5, s92, 0x20002
    s_and_b32 s92, s92, 3
    ds_read_b128 a[64:67], v205 offset:8192
    buffer_load_dwordx4 v[72:75], v224, s[8:11], s62 offen offset:2048 sc1
    v_mfma_f32_32x32x16_bf16 v[0:15], a[140:143], a[76:79], v[0:15]
    s_lshl_b32 s92, s92, 11
    s_lshl_b32 s5, s5, 21
    s_add_u32 s92, s92, s5
    ds_read_b128 a[68:71], v205 offset:9216
    buffer_load_dwordx4 v[76:79], v224, s[8:11], s62 offen offset:3072 sc1
    v_mfma_f32_32x32x16_bf16 v[0:15], a[144:147], a[80:83], v[0:15]
    s_add_u32 s92, s92, s4
    s_lshr_b32 s93, 0x6050a08, s3
    s_bfe_u32 s5, s93, 0x20002
    ds_read_b128 a[72:75], v205 offset:10240
    v_mfma_f32_32x32x16_bf16 v[0:15], a[148:151], a[84:87], v[0:15]
    s_waitcnt lgkmcnt(3)
    s_and_b32 s93, s93, 3
    s_lshl_b32 s93, s93, 11
    s_lshl_b32 s5, s5, 21
    ds_read_b128 a[76:79], v205 offset:11264
    buffer_load_dwordx4 v[80:83], v252, s[8:11], s62 offen offset:0 sc1
    v_mfma_f32_32x32x16_bf16 v[0:15], a[152:155], a[88:91], v[0:15]
    s_add_u32 s93, s93, s5
    s_add_u32 s93, s93, s4
    s_lshr_b32 s94, 0x90d0e0c, s3
    ds_read_b128 a[80:83], v205 offset:12288
    buffer_load_dwordx4 v[84:87], v252, s[8:11], s62 offen offset:1024 sc1
    v_mfma_f32_32x32x16_bf16 v[0:15], a[156:159], a[92:95], v[0:15]
    s_waitcnt lgkmcnt(3)
    s_bfe_u32 s5, s94, 0x20002
    s_and_b32 s94, s94, 3
    s_lshl_b32 s94, s94, 11
    ds_read_b128 a[84:87], v205 offset:13312
    buffer_load_dwordx4 v[88:91], v252, s[8:11], s62 offen offset:2048 sc1
    v_mfma_f32_32x32x16_bf16 v[0:15], a[160:163], a[64:67], v[0:15]
    s_lshl_b32 s5, s5, 21
    s_add_u32 s94, s94, s5
    s_add_u32 s94, s94, s4
    ds_read_b128 a[88:91], v205 offset:14336
    v_mfma_f32_32x32x16_bf16 v[0:15], a[164:167], a[68:71], v[0:15]
    s_bitcmp0_b32 3, s71
    s_cbranch_scc1 L_cw1_sequential_preLN__compressed_kv_cla__geglu_ffn__prompt_kernel
    s_waitcnt vmcnt(20)
L_cw1_sequential_preLN__compressed_kv_cla__geglu_ffn__prompt_kernel:
    s_barrier
    s_waitcnt lgkmcnt(3)
    ds_read_b128 a[92:95], v205 offset:15360
    buffer_load_dwordx4 v[92:95], v252, s[8:11], s62 offen offset:3072 sc1
    s_add_u32 s62, s62, 8192
    v_mfma_f32_32x32x16_bf16 v[0:15], a[168:171], a[72:75], v[0:15]
    ds_read_b128 a[64:67], v205 offset:16384
    buffer_load_dwordx4 v[96:99], v224, s[8:11], s62 offen offset:0 sc1
    s_lshl_b32 s3, s35, 10
    s_sub_u32 s39, s47, s3
    v_bfe_u32 v207, v224, 4, 2
    v_mfma_f32_32x32x16_bf16 v[0:15], a[172:175], a[76:79], v[0:15]
    s_waitcnt lgkmcnt(3)
    ds_read_b128 a[68:71], v205 offset:17408
    buffer_load_dwordx4 v[100:103], v224, s[8:11], s62 offen offset:1024 sc1
    v_lshlrev_b32 v207, 10, v207
    s_and_b32 s3, s2, 1
    s_lshl_b32 s3, s3, 3
    v_mfma_f32_32x32x16_bf16 v[0:15], a[176:179], a[80:83], v[0:15]
    s_add_u32 s3, s3, s74
    s_lshl_b32 s3, s3, 2
    s_add_u32 s5, s3, s35
    ds_read_b128 a[72:75], v205 offset:18432
    v_mfma_f32_32x32x16_bf16 v[0:15], a[180:183], a[84:87], v[0:15]
    s_waitcnt lgkmcnt(3)
    s_bfe_u32 s7, s2, 0x20003
    s_lshl_b32 s95, s5, 2
    s_add_u32 s95, s95, s7
    ds_read_b128 a[76:79], v205 offset:19456
    buffer_load_dwordx4 v[104:107], v224, s[8:11], s62 offen offset:2048 sc1
    v_mfma_f32_32x32x16_bf16 v[0:15], a[184:187], a[88:91], v[0:15]
    ds_read_b128 a[80:83], v205 offset:20480
    buffer_load_dwordx4 v[108:111], v224, s[8:11], s62 offen offset:3072 sc1
    s_lshl_b32 s7, s7, 2
    s_add_u32 s7, s7, s71
    v_bfe_u32 v192, v224, 4, 5
    v_mfma_f32_32x32x16_bf16 v[0:15], a[188:191], a[92:95], v[0:15]
    s_waitcnt lgkmcnt(3)
    ds_read_b128 a[84:87], v205 offset:21504
    buffer_load_dwordx4 v[112:115], v252, s[8:11], s62 offen offset:0 sc1
    v_lshrrev_b32 v193, 9, v224
    s_mul_i32 s64, s5, 33792
    s_lshl_b32 s4, s7, 11
    v_mfma_f32_32x32x16_bf16 v[0:15], a[192:195], a[64:67], v[0:15]
    s_add_u32 s64, s64, s4
    s_add_u32 s64, s64, 0x3b00000
    s_lshl_b32 s3, s5, 12
    ds_read_b128 a[88:91], v205 offset:22528
    buffer_load_dwordx4 v[116:119], v252, s[8:11], s62 offen offset:1024 sc1
    v_mfma_f32_32x32x16_bf16 v[0:15], a[196:199], a[68:71], v[0:15]
    s_waitcnt lgkmcnt(3)
    s_lshl_b32 s4, s7, 8
    s_add_u32 s3, s3, s4
    s_add_u32 s3, s3, 0x3e00000
    ds_read_b128 a[92:95], v205 offset:23552
    v_mfma_f32_32x32x16_bf16 v[0:15], a[200:203], a[72:75], v[0:15]
    ds_read_b128 a[64:67], v205 offset:24576
    buffer_load_dwordx4 v[120:123], v252, s[8:11], s62 offen offset:2048 sc1
    v_lshlrev_b32 v195, 3, v192
    v_add_u32 v195, s3, v195
    v_mov_b32 v196, 0x7f000000
    v_mfma_f32_32x32x16_bf16 v[0:15], a[204:207], a[76:79], v[0:15]
    s_waitcnt lgkmcnt(3)
    ds_read_b128 a[68:71], v205 offset:25600
    buffer_load_dwordx4 v[124:127], v252, s[8:11], s62 offen offset:3072 sc1
    s_add_u32 s62, s62, 8192
    v_lshlrev_b32 v194, 7, v192
    v_cmp_eq_u32 vcc, 0, v193
    s_nop 1
    v_cndmask_b32 v237, v196, v195, vcc
    v_and_b32 v239, 2047, v194
    v_mfma_f32_32x32x16_bf16 v[0:15], a[208:211], a[80:83], v[0:15]
    ds_read_b128 a[72:75], v205 offset:26624
    buffer_load_dwordx4 a[32:35], v224, s[8:11], s62 offen offset:0 sc1
    buffer_load_dword v210, v238, s[8:11], s33 offen sc1
    v_and_b32 v248, 511, v194
    s_lshl_b32 s3, s71, 9
    v_add_u32 v248, s3, v248
    v_mfma_f32_32x32x16_bf16 v[0:15], a[212:215], a[84:87], v[0:15]
    s_waitcnt lgkmcnt(3)
    s_and_b32 s3, s71, 1
    s_lshl_b32 s5, s68, 1
    s_add_u32 s5, s5, s3
    ds_read_b128 a[76:79], v205 offset:27648
    v_mfma_f32_32x32x16_bf16 v[0:15], a[216:219], a[88:91], v[0:15]
    s_lshr_b32 s3, s71, 1
    s_lshl_b32 s7, s69, 1
    s_add_u32 s7, s7, s3
    ds_read_b128 a[80:83], v205 offset:28672
    buffer_load_dwordx4 a[36:39], v224, s[8:11], s62 offen offset:1024 sc1
    v_mfma_f32_32x32x16_bf16 v[0:15], a[220:223], a[92:95], v[0:15]
    s_waitcnt lgkmcnt(3)
    s_mul_i32 s65, s5, 33792
    s_lshl_b32 s4, s7, 11
    s_add_u32 s65, s65, s4
    ds_read_b128 a[84:87], v205 offset:29696
    buffer_load_dwordx4 a[40:43], v224, s[8:11], s62 offen offset:2048 sc1
    v_mfma_f32_32x32x16_bf16 v[0:15], a[224:227], a[64:67], v[0:15]
    s_add_u32 s65, s65, 0x3b00000
    s_xor_b32 s3, s71, 1
    s_lshl_b32 s3, s3, 14
    ds_read_b128 a[88:91], v205 offset:30720
    buffer_load_dwordx4 a[44:47], v224, s[8:11], s62 offen offset:3072 sc1
    v_mfma_f32_32x32x16_bf16 v[0:15], a[228:231], a[68:71], v[0:15]
    s_bitcmp0_b32 2, s71
    s_cbranch_scc1 L_cw2_sequential_preLN__compressed_kv_cla__geglu_ffn__prompt_kernel
    s_waitcnt vmcnt(22)
L_cw2_sequential_preLN__compressed_kv_cla__geglu_ffn__prompt_kernel:
    s_barrier
    s_waitcnt lgkmcnt(3)
    ds_read_b128 a[92:95], v205 offset:31744
    v_mfma_f32_32x32x16_bf16 v[0:15], a[232:235], a[72:75], v[0:15]
    ds_read_b128 a[64:67], v205 offset:32768
    buffer_load_dwordx4 a[48:51], v252, s[8:11], s62 offen offset:0 sc1
    s_add_u32 s3, s3, 4096
    v_add_u32 v232, s3, v224
    s_xor_b32 s3, s71, 2
    v_mfma_f32_32x32x16_bf16 v[0:15], a[236:239], a[76:79], v[0:15]
    s_waitcnt lgkmcnt(3)
    ds_read_b128 a[68:71], v205 offset:33792
    buffer_load_dwordx4 a[52:55], v252, s[8:11], s62 offen offset:1024 sc1
    s_lshl_b32 s3, s3, 14
    s_add_u32 s3, s3, 8192
    v_add_u32 v233, s3, v224
    v_mfma_f32_32x32x16_bf16 v[0:15], a[240:243], a[80:83], v[0:15]
    s_xor_b32 s3, s71, 3
    s_lshl_b32 s3, s3, 14
    s_add_u32 s3, s3, 12288
    ds_read_b128 a[72:75], v205 offset:34816
    buffer_load_dwordx4 a[56:59], v252, s[8:11], s62 offen offset:2048 sc1
    v_mfma_f32_32x32x16_bf16 v[0:15], a[244:247], a[84:87], v[0:15]
    s_waitcnt lgkmcnt(3)
    ds_read_b128 a[76:79], v205 offset:35840
    buffer_load_dwordx4 a[60:63], v252, s[8:11], s62 offen offset:3072 sc1
    s_add_u32 s62, s62, 8192
    v_add_u32 v234, s3, v224
    s_lshl_b32 s3, s71, 14
    v_add_u32 v235, s3, v224
    v_mfma_f32_32x32x16_bf16 v[0:15], a[248:251], a[88:91], v[0:15]
    s_and_b32 s49, s71, 1
    s_mul_i32 s49, s49, 15
    s_bfe_u32 s48, s2, 0x20001
    ds_read_b128 a[80:83], v205 offset:36864
    v_mfma_f32_32x32x16_bf16 v[0:15], a[252:255], a[92:95], v[0:15]
    s_waitcnt vmcnt(36) lgkmcnt(3)
    s_xor_b32 s48, s48, s49
    s_bfe_u32 s49, s2, 0x10006
    s_mul_i32 s49, s49, 7
    ds_read_b128 a[84:87], v205 offset:37888
    v_mfma_f32_32x32x16_bf16 v[0:15], a[0:3], a[64:67], v[0:15]
    s_xor_b32 s48, s48, s49
    s_lshl_b32 s48, s48, 1
    s_and_b32 s49, s2, 1
    ds_read_b128 a[88:91], v205 offset:38912
    v_mfma_f32_32x32x16_bf16 v[0:15], a[4:7], a[68:71], v[0:15]
    s_waitcnt vmcnt(34) lgkmcnt(3)
    s_add_u32 s48, s48, s49
    s_lshl_b32 s48, s48, 1
    s_lshr_b32 s49, s2, 7
    ds_read_b128 a[92:95], v205 offset:39936
    v_mfma_f32_32x32x16_bf16 v[0:15], a[8:11], a[72:75], v[0:15]
    s_add_u32 s48, s48, s49
    s_lshl_b32 s48, s48, 15
    s_bfe_u32 s49, s2, 0x30003
    ds_read_b128 a[64:67], v205 offset:40960
    v_mfma_f32_32x32x16_bf16 v[0:15], a[12:15], a[76:79], v[0:15]
    s_waitcnt vmcnt(32) lgkmcnt(3)
    s_lshl_b32 s49, s49, 7
    s_add_u32 s48, s48, s49
    s_lshr_b32 s49, s71, 1
    ds_read_b128 a[68:71], v205 offset:41984
    v_mfma_f32_32x32x16_bf16 v[0:15], a[16:19], a[80:83], v[0:15]
    ds_read_b128 a[72:75], v205 offset:43008
    s_waitcnt vmcnt(7)
    v_cmp_ne_u32 vcc, s73, v210
    s_nop 1
    s_cbranch_vccnz L_poll6_sequential_preLN__compressed_kv_cla__geglu_ffn__prompt_kernel
L_poll6_sequential_preLN__compressed_kv_cla__geglu_ffn__prompt_kernel_ok:
    v_mfma_f32_32x32x16_bf16 v[0:15], a[20:23], a[84:87], v[0:15]
    s_waitcnt lgkmcnt(3)
    ds_read_b128 a[76:79], v205 offset:44032
    s_add_u32 m0, s41, 0
    s_add_u32 s44, s36, 0
    buffer_load_dwordx4 v224, s[8:11], s44 offen offset:0 sc1 lds
    s_lshl_b32 s49, s49, 6
    s_add_u32 s48, s48, s49
    v_bfe_u32 v192, v224, 4, 4
    v_mfma_f32_32x32x16_bf16 v[0:15], a[24:27], a[88:91], v[0:15]
    ds_read_b128 a[80:83], v205 offset:45056
    buffer_load_dwordx4 v224, s[8:11], s44 offen offset:1024 sc1 lds
    v_lshrrev_b32 v193, 8, v224
    v_lshlrev_b32 v193, 4, v193
    v_lshl_add_u32 v193, v192, 10, v193
    v_mfma_f32_32x32x16_bf16 v[0:15], a[28:31], a[92:95], v[0:15]
    s_waitcnt lgkmcnt(3)
    ds_read_b128 a[84:87], v205 offset:46080
    buffer_load_dwordx4 v224, s[8:11], s44 offen offset:2048 sc1 lds
    v_add_u32 v249, s48, v193
    s_movk_i32 s49, 0x4000
    s_and_b32 s20, s2, 1
    v_mfma_f32_32x32x16_bf16 v[0:15], v[64:67], a[64:67], v[0:15]
    s_lshl_b32 s20, s20, 3
    s_bfe_u32 s3, s2, 0x30003
    s_add_u32 s28, s20, s3
    ds_read_b128 a[88:91], v205 offset:47104
    buffer_load_dword v211, v238, s[8:11], s45 offen sc1
    buffer_load_dwordx4 v224, s[8:11], s44 offen offset:3072 sc1 lds
    v_mfma_f32_32x32x16_bf16 v[0:15], v[68:71], a[68:71], v[0:15]
    s_bitcmp0_b32 5, s71
    s_cbranch_scc1 L_cw3_sequential_preLN__compressed_kv_cla__geglu_ffn__prompt_kernel
L_cw3_sequential_preLN__compressed_kv_cla__geglu_ffn__prompt_kernel:
    s_barrier
    s_waitcnt lgkmcnt(3)
    ds_read_b128 a[92:95], v205 offset:48128
    s_add_u32 m0, s41, 16384
    s_add_u32 s44, s36, 16384
    buffer_load_dwordx4 v224, s[8:11], s44 offen offset:0 sc1 lds
    v_mfma_f32_32x32x16_bf16 v[0:15], v[72:75], a[72:75], v[0:15]
    s_bfe_u32 s21, s2, 0x20001
    s_lshl_b32 s21, s21, 2
    s_lshr_b32 s3, s2, 6
    ds_read_b128 a[64:67], v205 offset:49152
    v_mfma_f32_32x32x16_bf16 v[0:15], v[76:79], a[76:79], v[0:15]
    s_waitcnt lgkmcnt(3)
    s_add_u32 s21, s21, s3
    s_lshl_b32 s20, s28, 2
    s_add_u32 s20, s20, s71
    ds_read_b128 a[68:71], v205 offset:50176
    buffer_load_dwordx4 v224, s[8:11], s44 offen offset:1024 sc1 lds
    v_mfma_f32_32x32x16_bf16 v[0:15], v[80:83], a[80:83], v[0:15]
    s_mul_i32 s22, s21, 229376
    s_lshl_b32 s23, s71, 13
    s_add_u32 s22, s22, s23
    ds_read_b128 a[72:75], v205 offset:51200
    buffer_load_dwordx4 v224, s[8:11], s44 offen offset:2048 sc1 lds
    v_mfma_f32_32x32x16_bf16 v[0:15], v[84:87], a[84:87], v[0:15]
    s_waitcnt lgkmcnt(3)
    s_add_u32 s22, s22, 0x3f00000
    s_add_u32 s30, s23, s38
    s_add_u32 s23, s23, s86
    ds_read_b128 a[76:79], v205 offset:52224
    buffer_load_dwordx4 v224, s[8:11], s44 offen offset:3072 sc1 lds
    v_mfma_f32_32x32x16_bf16 v[0:15], v[88:91], a[88:91], v[0:15]
    s_mul_i32 s31, s21, 7168
    s_add_u32 s31, s31, 0x4280000
    ds_read_b128 a[80:83], v205 offset:53248
    s_add_u32 m0, s41, 32768
    s_add_u32 s44, s36, 32768
    buffer_load_dwordx4 v224, s[8:11], s44 offen offset:0 sc1 lds
    v_mfma_f32_32x32x16_bf16 v[0:15], v[92:95], a[92:95], v[0:15]
    s_waitcnt lgkmcnt(3)
    ds_read_b128 a[84:87], v205 offset:54272
    buffer_load_dwordx4 v224, s[8:11], s44 offen offset:1024 sc1 lds
    v_mfma_f32_32x32x16_bf16 v[0:15], v[96:99], a[64:67], v[0:15]
    ds_read_b128 a[88:91], v205 offset:55296
    v_mfma_f32_32x32x16_bf16 v[0:15], v[100:103], a[68:71], v[0:15]
    s_waitcnt lgkmcnt(3)
    ds_read_b128 a[92:95], v205 offset:56320
    buffer_load_dwordx4 v224, s[8:11], s44 offen offset:2048 sc1 lds
    v_mfma_f32_32x32x16_bf16 v[0:15], v[104:107], a[72:75], v[0:15]
    ds_read_b128 a[64:67], v205 offset:57344
    buffer_load_dwordx4 v224, s[8:11], s44 offen offset:3072 sc1 lds
    v_mfma_f32_32x32x16_bf16 v[0:15], v[108:111], a[76:79], v[0:15]
    s_waitcnt lgkmcnt(3)
    ds_read_b128 a[68:71], v205 offset:58368
    s_add_u32 m0, s41, 49152
    s_add_u32 s44, s36, 49152
    buffer_load_dwordx4 v224, s[8:11], s44 offen offset:0 sc1 lds
    v_mfma_f32_32x32x16_bf16 v[0:15], v[112:115], a[80:83], v[0:15]
    ds_read_b128 a[72:75], v205 offset:59392
    buffer_load_dwordx4 v224, s[8:11], s44 offen offset:1024 sc1 lds
    v_mfma_f32_32x32x16_bf16 v[0:15], v[116:119], a[84:87], v[0:15]
    s_waitcnt lgkmcnt(3)
    ds_read_b128 a[76:79], v205 offset:60416
    buffer_load_dwordx4 v224, s[8:11], s44 offen offset:2048 sc1 lds
    v_mfma_f32_32x32x16_bf16 v[0:15], v[120:123], a[88:91], v[0:15]
    ds_read_b128 a[80:83], v205 offset:61440
    v_mfma_f32_32x32x16_bf16 v[0:15], v[124:127], a[92:95], v[0:15]
    s_waitcnt vmcnt(22) lgkmcnt(3)
    ds_read_b128 a[84:87], v205 offset:62464
    buffer_load_dwordx4 v224, s[8:11], s44 offen offset:3072 sc1 lds
    v_mfma_f32_32x32x16_bf16 v[0:15], a[32:35], a[64:67], v[0:15]
    ds_read_b128 a[88:91], v205 offset:63488
    v_mfma_f32_32x32x16_bf16 v[0:15], a[36:39], a[68:71], v[0:15]
    s_waitcnt vmcnt(12)
    s_barrier
    s_waitcnt lgkmcnt(3)
    ds_read_b128 a[92:95], v205 offset:64512
    v_mfma_f32_32x32x16_bf16 v[0:15], a[40:43], a[72:75], v[0:15]
    buffer_store_dword v253, v255, s[8:11], s37 offen sc1
    ds_read_b128 a[64:67], v206 offset:0
    v_mfma_f32_32x32x16_bf16 v[0:15], a[44:47], a[76:79], v[0:15]
    s_waitcnt lgkmcnt(3)
    s_add_u32 s46, s52, 0
    ds_read_b128 a[68:71], v206 offset:1024
    v_mfma_f32_32x32x16_bf16 v[0:15], a[48:51], a[80:83], v[0:15]
    ds_read_b128 a[72:75], v206 offset:2048
    v_permlane16_swap_b32 v240, v244
    v_permlane16_swap_b32 v241, v245
    v_permlane16_swap_b32 v242, v246
    v_permlane16_swap_b32 v243, v247
    v_mfma_f32_32x32x16_bf16 v[0:15], a[52:55], a[84:87], v[0:15]
    s_waitcnt lgkmcnt(3)
    ds_read_b128 a[76:79], v206 offset:3072
    v_mfma_f32_32x32x16_bf16 v[0:15], a[56:59], a[88:91], v[0:15]
    ds_read_b128 a[80:83], v206 offset:4096
    v_permlane32_swap_b32 v240, v242
    v_permlane32_swap_b32 v241, v243
    v_permlane32_swap_b32 v244, v246
    v_permlane32_swap_b32 v245, v247
    v_mfma_f32_32x32x16_bf16 v[0:15], a[60:63], a[92:95], v[0:15]
    s_waitcnt lgkmcnt(3)
    ds_read_b128 a[84:87], v206 offset:5120
    v_mfma_f32_32x32x16_bf16 v[16:31], a[128:131], a[64:67], 0
    ds_read_b128 a[88:91], v206 offset:6144
    v_mfma_f32_32x32x16_bf16 v[16:31], a[132:135], a[68:71], v[16:31]
    s_waitcnt lgkmcnt(3)
    ds_read_b128 a[92:95], v206 offset:7168
    v_mfma_f32_32x32x16_bf16 v[16:31], a[136:139], a[72:75], v[16:31]
    ds_read_b128 a[64:67], v206 offset:8192
    v_cvt_pk_bf16_f32 v152, v0, v1
    v_cvt_pk_bf16_f32 v153, v2, v3
    v_cvt_pk_bf16_f32 v154, v4, v5
    v_cvt_pk_bf16_f32 v155, v6, v7
    v_mfma_f32_32x32x16_bf16 v[16:31], a[140:143], a[76:79], v[16:31]
    s_waitcnt lgkmcnt(3)
    ds_read_b128 a[68:71], v206 offset:9216
    buffer_store_dwordx4 v[152:155], v224, s[8:11], s46 offen offset:0 sc1
    v_lshlrev_b32 v176, 16, v240
    v_mfma_f32_32x32x16_bf16 v[16:31], a[144:147], a[80:83], v[16:31]
    ds_read_b128 a[72:75], v206 offset:10240
    v_cvt_pk_bf16_f32 v156, v8, v9
    v_cvt_pk_bf16_f32 v157, v10, v11
    v_cvt_pk_bf16_f32 v158, v12, v13
    v_cvt_pk_bf16_f32 v159, v14, v15
    v_mfma_f32_32x32x16_bf16 v[16:31], a[148:151], a[84:87], v[16:31]
    s_waitcnt lgkmcnt(3)
    ds_read_b128 a[76:79], v206 offset:11264
    v_and_b32 v177, 0xffff0000, v240
    v_lshlrev_b32 v178, 16, v241
    v_and_b32 v179, 0xffff0000, v241
    v_mfma_f32_32x32x16_bf16 v[16:31], a[152:155], a[88:91], v[16:31]
    ds_read_b128 a[80:83], v206 offset:12288
    buffer_store_dwordx4 v[156:159], v224, s[8:11], s46 offen offset:1024 sc1
    v_lshlrev_b32 v180, 16, v244
    v_mfma_f32_32x32x16_bf16 v[16:31], a[156:159], a[92:95], v[16:31]
    s_waitcnt lgkmcnt(3)
    ds_read_b128 a[84:87], v206 offset:13312
    v_and_b32 v181, 0xffff0000, v244
    v_lshlrev_b32 v182, 16, v245
    v_and_b32 v183, 0xffff0000, v245
    v_mfma_f32_32x32x16_bf16 v[16:31], a[160:163], a[64:67], v[16:31]
    ds_read_b128 a[88:91], v206 offset:14336
    v_lshlrev_b32 v184, 16, v242
    v_and_b32 v185, 0xffff0000, v242
    v_lshlrev_b32 v186, 16, v243
    v_mfma_f32_32x32x16_bf16 v[16:31], a[164:167], a[68:71], v[16:31]
    s_waitcnt vmcnt(11)
    s_barrier
    s_waitcnt lgkmcnt(3)
    ds_read_b128 a[92:95], v206 offset:15360
    v_mfma_f32_32x32x16_bf16 v[16:31], a[168:171], a[72:75], v[16:31]
    ds_read_b128 a[64:67], v206 offset:16384
    v_and_b32 v187, 0xffff0000, v243
    v_lshlrev_b32 v188, 16, v246
    v_and_b32 v189, 0xffff0000, v246
    v_mfma_f32_32x32x16_bf16 v[16:31], a[172:175], a[76:79], v[16:31]
    s_waitcnt lgkmcnt(3)
    ds_read_b128 a[68:71], v206 offset:17408
    v_lshlrev_b32 v190, 16, v247
    v_and_b32 v191, 0xffff0000, v247
    v_mfma_f32_32x32x16_bf16 v[16:31], a[176:179], a[80:83], v[16:31]
    ds_read_b128 a[72:75], v206 offset:18432
    v_mfma_f32_32x32x16_bf16 v[16:31], a[180:183], a[84:87], v[16:31]
    s_waitcnt lgkmcnt(3)
    ds_read_b128 a[76:79], v206 offset:19456
    v_mfma_f32_32x32x16_bf16 v[16:31], a[184:187], a[88:91], v[16:31]
    ds_read_b128 a[80:83], v206 offset:20480
    v_mfma_f32_32x32x16_bf16 v[16:31], a[188:191], a[92:95], v[16:31]
    s_waitcnt lgkmcnt(3)
    ds_read_b128 a[84:87], v206 offset:21504
    v_mfma_f32_32x32x16_bf16 v[16:31], a[192:195], a[64:67], v[16:31]
    ds_read_b128 a[88:91], v206 offset:22528
    v_cmp_ne_u32 vcc, s73, v211
    s_nop 1
    s_cbranch_vccnz L_poll9_sequential_preLN__compressed_kv_cla__geglu_ffn__prompt_kernel
L_poll9_sequential_preLN__compressed_kv_cla__geglu_ffn__prompt_kernel_ok:
    v_mfma_f32_32x32x16_bf16 v[16:31], a[196:199], a[68:71], v[16:31]
    s_waitcnt lgkmcnt(3)
    ds_read_b128 a[92:95], v206 offset:23552
    s_add_u32 m0, s40, 0
    s_add_u32 s44, s51, 0
    buffer_load_dwordx4 v224, s[8:11], s44 offen offset:0 sc1 lds
    v_mfma_f32_32x32x16_bf16 v[16:31], a[200:203], a[72:75], v[16:31]
    ds_read_b128 a[64:67], v206 offset:24576
    v_mfma_f32_32x32x16_bf16 v[16:31], a[204:207], a[76:79], v[16:31]
    s_waitcnt lgkmcnt(3)
    ds_read_b128 a[68:71], v206 offset:25600
    buffer_load_dwordx4 v224, s[8:11], s44 offen offset:1024 sc1 lds
    v_mfma_f32_32x32x16_bf16 v[16:31], a[208:211], a[80:83], v[16:31]
    ds_read_b128 a[72:75], v206 offset:26624
    v_mfma_f32_32x32x16_bf16 v[16:31], a[212:215], a[84:87], v[16:31]
    s_waitcnt lgkmcnt(3)
    ds_read_b128 a[76:79], v206 offset:27648
    buffer_load_dwordx4 v224, s[8:11], s44 offen offset:2048 sc1 lds
    v_mfma_f32_32x32x16_bf16 v[16:31], a[216:219], a[88:91], v[16:31]
    ds_read_b128 a[80:83], v206 offset:28672
    v_mfma_f32_32x32x16_bf16 v[16:31], a[220:223], a[92:95], v[16:31]
    s_waitcnt lgkmcnt(3)
    ds_read_b128 a[84:87], v206 offset:29696
    buffer_load_dwordx4 v224, s[8:11], s44 offen offset:3072 sc1 lds
    v_mfma_f32_32x32x16_bf16 v[16:31], a[224:227], a[64:67], v[16:31]
    ds_read_b128 a[88:91], v206 offset:30720
    v_mfma_f32_32x32x16_bf16 v[16:31], a[228:231], a[68:71], v[16:31]
    s_waitcnt vmcnt(11)
    s_barrier
    s_waitcnt lgkmcnt(3)
    ds_read_b128 a[92:95], v206 offset:31744
    s_add_u32 m0, s40, 16384
    s_add_u32 s44, s51, 16384
    buffer_load_dwordx4 v224, s[8:11], s44 offen offset:0 sc1 lds
    v_mfma_f32_32x32x16_bf16 v[16:31], a[232:235], a[72:75], v[16:31]
    ds_read_b128 a[64:67], v206 offset:32768
    v_mfma_f32_32x32x16_bf16 v[16:31], a[236:239], a[76:79], v[16:31]
    s_waitcnt lgkmcnt(3)
    ds_read_b128 a[68:71], v206 offset:33792
    v_mfma_f32_32x32x16_bf16 v[16:31], a[240:243], a[80:83], v[16:31]
    ds_read_b128 a[72:75], v206 offset:34816
    buffer_load_dwordx4 v224, s[8:11], s44 offen offset:1024 sc1 lds
    v_mfma_f32_32x32x16_bf16 v[16:31], a[244:247], a[84:87], v[16:31]
    s_waitcnt lgkmcnt(3)
    ds_read_b128 a[76:79], v206 offset:35840
    v_mfma_f32_32x32x16_bf16 v[16:31], a[248:251], a[88:91], v[16:31]
    ds_read_b128 a[80:83], v206 offset:36864
    buffer_load_dwordx4 v224, s[8:11], s44 offen offset:2048 sc1 lds
    v_mfma_f32_32x32x16_bf16 v[16:31], a[252:255], a[92:95], v[16:31]
    s_waitcnt lgkmcnt(3)
    ds_read_b128 a[84:87], v206 offset:37888
    v_mfma_f32_32x32x16_bf16 v[16:31], a[0:3], a[64:67], v[16:31]
    ds_read_b128 a[88:91], v206 offset:38912
    buffer_load_dwordx4 v224, s[8:11], s44 offen offset:3072 sc1 lds
    v_mfma_f32_32x32x16_bf16 v[16:31], a[4:7], a[68:71], v[16:31]
    s_waitcnt lgkmcnt(3)
    ds_read_b128 a[92:95], v206 offset:39936
    v_mfma_f32_32x32x16_bf16 v[16:31], a[8:11], a[72:75], v[16:31]
    ds_read_b128 a[64:67], v206 offset:40960
    s_add_u32 m0, s40, 32768
    s_add_u32 s44, s51, 32768
    buffer_load_dwordx4 v224, s[8:11], s44 offen offset:0 sc1 lds
    v_mfma_f32_32x32x16_bf16 v[16:31], a[12:15], a[76:79], v[16:31]
    s_waitcnt lgkmcnt(3)
    ds_read_b128 a[68:71], v206 offset:41984
    v_mfma_f32_32x32x16_bf16 v[16:31], a[16:19], a[80:83], v[16:31]
    s_mul_i32 s3, s71, 28672
    s_mul_i32 s62, s69, 231424
    ds_read_b128 a[72:75], v206 offset:43008
    buffer_load_dwordx4 v224, s[8:11], s44 offen offset:1024 sc1 lds
    v_mfma_f32_32x32x16_bf16 v[16:31], a[20:23], a[84:87], v[16:31]
    s_waitcnt lgkmcnt(3)
    s_add_u32 s3, s3, s62
    s_add_u32 s3, s3, 0x4b00000
    s_lshr_b32 s4, s71, 1
    ds_read_b128 a[76:79], v206 offset:44032
    v_mfma_f32_32x32x16_bf16 v[16:31], a[24:27], a[88:91], v[16:31]
    s_mul_i32 s4, s4, 115712
    s_add_u32 s62, s3, s4
    s_sub_u32 s66, s3, s4
    s_add_u32 s66, s66, 115712
    ds_read_b128 a[80:83], v206 offset:45056
    v_mfma_f32_32x32x16_bf16 v[16:31], a[28:31], a[92:95], v[16:31]
    s_waitcnt lgkmcnt(3)
    ds_read_b128 a[84:87], v206 offset:46080
    buffer_load_dwordx4 v224, s[8:11], s44 offen offset:2048 sc1 lds
    v_mfma_f32_32x32x16_bf16 v[16:31], v[64:67], a[64:67], v[16:31]
    ds_read_b128 a[88:91], v206 offset:47104
    v_mfma_f32_32x32x16_bf16 v[16:31], v[68:71], a[68:71], v[16:31]
    s_waitcnt vmcnt(14)
    s_barrier
    s_waitcnt lgkmcnt(3)
    ds_read_b128 a[92:95], v206 offset:48128
    buffer_load_dwordx4 v224, s[8:11], s44 offen offset:3072 sc1 lds
    v_mfma_f32_32x32x16_bf16 v[16:31], v[72:75], a[72:75], v[16:31]
    ds_read_b128 a[64:67], v206 offset:49152
    v_mfma_f32_32x32x16_bf16 v[16:31], v[76:79], a[76:79], v[16:31]
    s_waitcnt lgkmcnt(3)
    ds_read_b128 a[68:71], v206 offset:50176
    s_add_u32 m0, s40, 49152
    s_add_u32 s44, s51, 49152
    buffer_load_dwordx4 v224, s[8:11], s44 offen offset:0 sc1 lds
    v_mfma_f32_32x32x16_bf16 v[16:31], v[80:83], a[80:83], v[16:31]
    ds_read_b128 a[72:75], v206 offset:51200
    v_mfma_f32_32x32x16_bf16 v[16:31], v[84:87], a[84:87], v[16:31]
    s_waitcnt lgkmcnt(3)
    ds_read_b128 a[76:79], v206 offset:52224
    buffer_load_dwordx4 v224, s[8:11], s44 offen offset:1024 sc1 lds
    v_mfma_f32_32x32x16_bf16 v[16:31], v[88:91], a[88:91], v[16:31]
    ds_read_b128 a[80:83], v206 offset:53248
    v_mfma_f32_32x32x16_bf16 v[16:31], v[92:95], a[92:95], v[16:31]
    s_waitcnt lgkmcnt(3)
    ds_read_b128 a[84:87], v206 offset:54272
    buffer_load_dwordx4 v224, s[8:11], s44 offen offset:2048 sc1 lds
    v_mfma_f32_32x32x16_bf16 v[16:31], v[96:99], a[64:67], v[16:31]
    ds_read_b128 a[88:91], v206 offset:55296
    v_mfma_f32_32x32x16_bf16 v[16:31], v[100:103], a[68:71], v[16:31]
    s_waitcnt lgkmcnt(3)
    ds_read_b128 a[92:95], v206 offset:56320
    v_mfma_f32_32x32x16_bf16 v[16:31], v[104:107], a[72:75], v[16:31]
    ds_read_b128 a[64:67], v206 offset:57344
    buffer_load_dwordx4 v224, s[8:11], s44 offen offset:3072 sc1 lds
    v_mfma_f32_32x32x16_bf16 v[16:31], v[108:111], a[76:79], v[16:31]
    s_waitcnt lgkmcnt(3)
    ds_read_b128 a[68:71], v206 offset:58368
    v_mfma_f32_32x32x16_bf16 v[16:31], v[112:115], a[80:83], v[16:31]
    ds_read_b128 a[72:75], v206 offset:59392
    v_mfma_f32_32x32x16_bf16 v[16:31], v[116:119], a[84:87], v[16:31]
    s_waitcnt lgkmcnt(3)
    ds_read_b128 a[76:79], v206 offset:60416
    s_add_u32 m0, s41, 0
    s_add_u32 s44, s32, 0
    buffer_load_dwordx4 v224, s[8:11], s44 offen offset:0 sc1 lds
    v_mfma_f32_32x32x16_bf16 v[16:31], v[120:123], a[88:91], v[16:31]
    ds_read_b128 a[80:83], v206 offset:61440
    v_mfma_f32_32x32x16_bf16 v[16:31], v[124:127], a[92:95], v[16:31]
    s_waitcnt lgkmcnt(3)
    ds_read_b128 a[84:87], v206 offset:62464
    buffer_load_dwordx4 v224, s[8:11], s44 offen offset:1024 sc1 lds
    v_mfma_f32_32x32x16_bf16 v[16:31], a[32:35], a[64:67], v[16:31]
    ds_read_b128 a[88:91], v206 offset:63488
    v_mfma_f32_32x32x16_bf16 v[16:31], a[36:39], a[68:71], v[16:31]
    s_waitcnt vmcnt(14)
    s_barrier
    s_waitcnt lgkmcnt(3)
    ds_read_b128 a[92:95], v206 offset:64512
    v_mfma_f32_32x32x16_bf16 v[16:31], a[40:43], a[72:75], v[16:31]
    ds_read_b128 a[64:67], v205 offset:0
    buffer_load_dwordx4 v224, s[8:11], s44 offen offset:2048 sc1 lds
    v_mfma_f32_32x32x16_bf16 v[16:31], a[44:47], a[76:79], v[16:31]
    s_waitcnt lgkmcnt(3)
    s_add_u32 s46, s52, 2048
    ds_read_b128 a[68:71], v205 offset:1024
    v_mfma_f32_32x32x16_bf16 v[16:31], a[48:51], a[80:83], v[16:31]
    ds_read_b128 a[72:75], v205 offset:2048
    buffer_load_dwordx4 v224, s[8:11], s44 offen offset:3072 sc1 lds
    v_mfma_f32_32x32x16_bf16 v[16:31], a[52:55], a[84:87], v[16:31]
    s_waitcnt lgkmcnt(3)
    ds_read_b128 a[76:79], v205 offset:3072
    v_mfma_f32_32x32x16_bf16 v[16:31], a[56:59], a[88:91], v[16:31]
    ds_read_b128 a[80:83], v205 offset:4096
    v_mfma_f32_32x32x16_bf16 v[16:31], a[60:63], a[92:95], v[16:31]
    s_waitcnt lgkmcnt(3)
    ds_read_b128 a[84:87], v205 offset:5120
    s_add_u32 m0, s41, 16384
    s_add_u32 s44, s32, 16384
    buffer_load_dwordx4 v224, s[8:11], s44 offen offset:0 sc1 lds
    v_mfma_f32_32x32x16_bf16 v[32:47], a[128:131], a[64:67], 0
    ds_read_b128 a[88:91], v205 offset:6144
    v_mfma_f32_32x32x16_bf16 v[32:47], a[132:135], a[68:71], v[32:47]
    s_waitcnt lgkmcnt(3)
    ds_read_b128 a[92:95], v205 offset:7168
    buffer_load_dwordx4 v224, s[8:11], s44 offen offset:1024 sc1 lds
    v_mfma_f32_32x32x16_bf16 v[32:47], a[136:139], a[72:75], v[32:47]
    ds_read_b128 a[64:67], v205 offset:8192
    v_cvt_pk_bf16_f32 v152, v16, v17
    v_cvt_pk_bf16_f32 v153, v18, v19
    v_cvt_pk_bf16_f32 v154, v20, v21
    v_cvt_pk_bf16_f32 v155, v22, v23
    v_mfma_f32_32x32x16_bf16 v[32:47], a[140:143], a[76:79], v[32:47]
    s_waitcnt lgkmcnt(3)
    ds_read_b128 a[68:71], v205 offset:9216
    buffer_store_dwordx4 v[152:155], v224, s[8:11], s46 offen offset:0 sc1
    v_mfma_f32_32x32x16_bf16 v[32:47], a[144:147], a[80:83], v[32:47]
    ds_read_b128 a[72:75], v205 offset:10240
    buffer_load_dwordx4 v224, s[8:11], s44 offen offset:2048 sc1 lds
    v_cvt_pk_bf16_f32 v156, v24, v25
    v_cvt_pk_bf16_f32 v157, v26, v27
    v_cvt_pk_bf16_f32 v158, v28, v29
    v_cvt_pk_bf16_f32 v159, v30, v31
    v_mfma_f32_32x32x16_bf16 v[32:47], a[148:151], a[84:87], v[32:47]
    s_waitcnt lgkmcnt(3)
    ds_read_b128 a[76:79], v205 offset:11264
    v_mfma_f32_32x32x16_bf16 v[32:47], a[152:155], a[88:91], v[32:47]
    ds_read_b128 a[80:83], v205 offset:12288
    buffer_store_dwordx4 v[156:159], v224, s[8:11], s46 offen offset:1024 sc1
    buffer_load_dwordx4 v224, s[8:11], s44 offen offset:3072 sc1 lds
    v_mfma_f32_32x32x16_bf16 v[32:47], a[156:159], a[92:95], v[32:47]
    s_waitcnt lgkmcnt(3)
    ds_read_b128 a[84:87], v205 offset:13312
    v_mfma_f32_32x32x16_bf16 v[32:47], a[160:163], a[64:67], v[32:47]
    ds_read_b128 a[88:91], v205 offset:14336
    v_mfma_f32_32x32x16_bf16 v[32:47], a[164:167], a[68:71], v[32:47]
    s_waitcnt vmcnt(18)
    s_barrier
    s_waitcnt lgkmcnt(3)
    ds_read_b128 a[92:95], v205 offset:15360
    s_add_u32 m0, s41, 32768
    s_add_u32 s44, s32, 32768
    buffer_load_dwordx4 v224, s[8:11], s44 offen offset:0 sc1 lds
    v_mfma_f32_32x32x16_bf16 v[32:47], a[168:171], a[72:75], v[32:47]
    ds_read_b128 a[64:67], v205 offset:16384
    v_mfma_f32_32x32x16_bf16 v[32:47], a[172:175], a[76:79], v[32:47]
    s_waitcnt lgkmcnt(3)
    ds_read_b128 a[68:71], v205 offset:17408
    buffer_load_dwordx4 v224, s[8:11], s44 offen offset:1024 sc1 lds
    v_mfma_f32_32x32x16_bf16 v[32:47], a[176:179], a[80:83], v[32:47]
    ds_read_b128 a[72:75], v205 offset:18432
    buffer_load_dword v212, v207, s[8:11], s39 offen sc1
    v_mfma_f32_32x32x16_bf16 v[32:47], a[180:183], a[84:87], v[32:47]
    s_waitcnt lgkmcnt(3)
    s_mov_b32 s37, 0x4e02c00
    ds_read_b128 a[76:79], v205 offset:19456
    v_mfma_f32_32x32x16_bf16 v[32:47], a[184:187], a[88:91], v[32:47]
    ds_read_b128 a[80:83], v205 offset:20480
    buffer_load_dwordx4 v224, s[8:11], s44 offen offset:2048 sc1 lds
    v_mfma_f32_32x32x16_bf16 v[32:47], a[188:191], a[92:95], v[32:47]
    s_waitcnt lgkmcnt(3)
    ds_read_b128 a[84:87], v205 offset:21504
    v_mfma_f32_32x32x16_bf16 v[32:47], a[192:195], a[64:67], v[32:47]
    ds_read_b128 a[88:91], v205 offset:22528
    buffer_load_dwordx4 v224, s[8:11], s44 offen offset:3072 sc1 lds
    v_mfma_f32_32x32x16_bf16 v[32:47], a[196:199], a[68:71], v[32:47]
    s_waitcnt lgkmcnt(3)
    ds_read_b128 a[92:95], v205 offset:23552
    v_mfma_f32_32x32x16_bf16 v[32:47], a[200:203], a[72:75], v[32:47]
    ds_read_b128 a[64:67], v205 offset:24576
    v_mfma_f32_32x32x16_bf16 v[32:47], a[204:207], a[76:79], v[32:47]
    s_waitcnt lgkmcnt(3)
    ds_read_b128 a[68:71], v205 offset:25600
    s_add_u32 m0, s41, 49152
    s_add_u32 s44, s32, 49152
    buffer_load_dwordx4 v224, s[8:11], s44 offen offset:0 sc1 lds
    v_mfma_f32_32x32x16_bf16 v[32:47], a[208:211], a[80:83], v[32:47]
    ds_read_b128 a[72:75], v205 offset:26624
    v_mfma_f32_32x32x16_bf16 v[32:47], a[212:215], a[84:87], v[32:47]
    s_waitcnt lgkmcnt(3)
    ds_read_b128 a[76:79], v205 offset:27648
    buffer_load_dwordx4 v224, s[8:11], s44 offen offset:1024 sc1 lds
    v_mfma_f32_32x32x16_bf16 v[32:47], a[216:219], a[88:91], v[32:47]
    ds_read_b128 a[80:83], v205 offset:28672
    v_mfma_f32_32x32x16_bf16 v[32:47], a[220:223], a[92:95], v[32:47]
    s_waitcnt lgkmcnt(3)
    ds_read_b128 a[84:87], v205 offset:29696
    v_mfma_f32_32x32x16_bf16 v[32:47], a[224:227], a[64:67], v[32:47]
    ds_read_b128 a[88:91], v205 offset:30720
    buffer_load_dwordx4 v224, s[8:11], s44 offen offset:2048 sc1 lds
    v_mfma_f32_32x32x16_bf16 v[32:47], a[228:231], a[68:71], v[32:47]
    s_waitcnt vmcnt(22)
    s_barrier
    s_waitcnt lgkmcnt(3)
    ds_read_b128 a[92:95], v205 offset:31744
    v_mfma_f32_32x32x16_bf16 v[32:47], a[232:235], a[72:75], v[32:47]
    ds_read_b128 a[64:67], v205 offset:32768
    buffer_load_dwordx4 v224, s[8:11], s44 offen offset:3072 sc1 lds
    v_mfma_f32_32x32x16_bf16 v[32:47], a[236:239], a[76:79], v[32:47]
    s_waitcnt lgkmcnt(3)
    ds_read_b128 a[68:71], v205 offset:33792
    v_mfma_f32_32x32x16_bf16 v[32:47], a[240:243], a[80:83], v[32:47]
    ds_read_b128 a[72:75], v205 offset:34816
    v_mfma_f32_32x32x16_bf16 v[32:47], a[244:247], a[84:87], v[32:47]
    s_waitcnt lgkmcnt(3)
    ds_read_b128 a[76:79], v205 offset:35840
    v_mfma_f32_32x32x16_bf16 v[32:47], a[248:251], a[88:91], v[32:47]
    ds_read_b128 a[80:83], v205 offset:36864
    v_mfma_f32_32x32x16_bf16 v[32:47], a[252:255], a[92:95], v[32:47]
    s_waitcnt lgkmcnt(3)
    ds_read_b128 a[84:87], v205 offset:37888
    v_mfma_f32_32x32x16_bf16 v[32:47], a[0:3], a[64:67], v[32:47]
    ds_read_b128 a[88:91], v205 offset:38912
    v_mfma_f32_32x32x16_bf16 v[32:47], a[4:7], a[68:71], v[32:47]
    s_waitcnt lgkmcnt(3)
    ds_read_b128 a[92:95], v205 offset:39936
    v_mfma_f32_32x32x16_bf16 v[32:47], a[8:11], a[72:75], v[32:47]
    ds_read_b128 a[64:67], v205 offset:40960
    v_mfma_f32_32x32x16_bf16 v[32:47], a[12:15], a[76:79], v[32:47]
    s_waitcnt lgkmcnt(3)
    ds_read_b128 a[68:71], v205 offset:41984
    v_mfma_f32_32x32x16_bf16 v[32:47], a[16:19], a[80:83], v[32:47]
    ds_read_b128 a[72:75], v205 offset:43008
    v_mfma_f32_32x32x16_bf16 v[32:47], a[20:23], a[84:87], v[32:47]
    s_waitcnt lgkmcnt(3)
    ds_read_b128 a[76:79], v205 offset:44032
    v_mfma_f32_32x32x16_bf16 v[32:47], a[24:27], a[88:91], v[32:47]
    ds_read_b128 a[80:83], v205 offset:45056
    v_mfma_f32_32x32x16_bf16 v[32:47], a[28:31], a[92:95], v[32:47]
    s_waitcnt lgkmcnt(3)
    ds_read_b128 a[84:87], v205 offset:46080
    v_mfma_f32_32x32x16_bf16 v[32:47], v[64:67], a[64:67], v[32:47]
    ds_read_b128 a[88:91], v205 offset:47104
    v_mfma_f32_32x32x16_bf16 v[32:47], v[68:71], a[68:71], v[32:47]
    s_waitcnt vmcnt(19)
    s_barrier
    s_waitcnt lgkmcnt(3)
    ds_read_b128 a[92:95], v205 offset:48128
    v_mfma_f32_32x32x16_bf16 v[32:47], v[72:75], a[72:75], v[32:47]
    ds_read_b128 a[64:67], v205 offset:49152
    s_waitcnt vmcnt(6)
    v_cmp_ne_u32 vcc, s73, v212
    s_nop 1
    s_cbranch_vccnz L_poll8_sequential_preLN__compressed_kv_cla__geglu_ffn__prompt_kernel
L_poll8_sequential_preLN__compressed_kv_cla__geglu_ffn__prompt_kernel_ok:
    v_mfma_f32_32x32x16_bf16 v[32:47], v[76:79], a[76:79], v[32:47]
    s_waitcnt lgkmcnt(3)
    ds_read_b128 a[68:71], v205 offset:50176
    v_mfma_f32_32x32x16_bf16 v[32:47], v[80:83], a[80:83], v[32:47]
    ds_read_b128 a[72:75], v205 offset:51200
    buffer_load_dwordx4 a[96:99], v224, s[8:11], s31 offen offset:0 sc1
    v_mfma_f32_32x32x16_bf16 v[32:47], v[84:87], a[84:87], v[32:47]
    s_waitcnt lgkmcnt(3)
    ds_read_b128 a[76:79], v205 offset:52224
    v_mfma_f32_32x32x16_bf16 v[32:47], v[88:91], a[88:91], v[32:47]
    ds_read_b128 a[80:83], v205 offset:53248
    buffer_load_dwordx4 a[100:103], v224, s[8:11], s31 offen offset:1024 sc1
    v_mfma_f32_32x32x16_bf16 v[32:47], v[92:95], a[92:95], v[32:47]
    s_waitcnt lgkmcnt(3)
    ds_read_b128 a[84:87], v205 offset:54272
    v_mfma_f32_32x32x16_bf16 v[32:47], v[96:99], a[64:67], v[32:47]
    ds_read_b128 a[88:91], v205 offset:55296
    buffer_load_dwordx4 a[104:107], v224, s[8:11], s31 offen offset:2048 sc1
    v_mfma_f32_32x32x16_bf16 v[32:47], v[100:103], a[68:71], v[32:47]
    s_waitcnt lgkmcnt(3)
    ds_read_b128 a[92:95], v205 offset:56320
    v_mfma_f32_32x32x16_bf16 v[32:47], v[104:107], a[72:75], v[32:47]
    ds_read_b128 a[64:67], v205 offset:57344
    buffer_load_dwordx4 a[108:111], v224, s[8:11], s31 offen offset:3072 sc1
    v_mfma_f32_32x32x16_bf16 v[32:47], v[108:111], a[76:79], v[32:47]
    s_waitcnt lgkmcnt(3)
    ds_read_b128 a[68:71], v205 offset:58368
    v_mfma_f32_32x32x16_bf16 v[32:47], v[112:115], a[80:83], v[32:47]
    ds_read_b128 a[72:75], v205 offset:59392
    buffer_load_dwordx4 a[112:115], v252, s[8:11], s31 offen offset:0 sc1
    v_mfma_f32_32x32x16_bf16 v[32:47], v[116:119], a[84:87], v[32:47]
    s_waitcnt lgkmcnt(3)
    ds_read_b128 a[76:79], v205 offset:60416
    v_mfma_f32_32x32x16_bf16 v[32:47], v[120:123], a[88:91], v[32:47]
    ds_read_b128 a[80:83], v205 offset:61440
    buffer_load_dwordx4 a[116:119], v252, s[8:11], s31 offen offset:1024 sc1
    v_mfma_f32_32x32x16_bf16 v[32:47], v[124:127], a[92:95], v[32:47]
    s_waitcnt lgkmcnt(3)
    ds_read_b128 a[84:87], v205 offset:62464
    v_mfma_f32_32x32x16_bf16 v[32:47], a[32:35], a[64:67], v[32:47]
    ds_read_b128 a[88:91], v205 offset:63488
    buffer_load_dwordx4 a[120:123], v252, s[8:11], s31 offen offset:2048 sc1
    v_mfma_f32_32x32x16_bf16 v[32:47], a[36:39], a[68:71], v[32:47]
    s_barrier
    s_waitcnt lgkmcnt(3)
    ds_read_b128 a[92:95], v205 offset:64512
    v_mfma_f32_32x32x16_bf16 v[32:47], a[40:43], a[72:75], v[32:47]
    ds_read_b128 a[64:67], v206 offset:0
    v_mfma_f32_32x32x16_bf16 v[32:47], a[44:47], a[76:79], v[32:47]
    s_waitcnt lgkmcnt(3)
    s_add_u32 s46, s52, 4096
    ds_read_b128 a[68:71], v206 offset:1024
    v_mfma_f32_32x32x16_bf16 v[32:47], a[48:51], a[80:83], v[32:47]
    ds_read_b128 a[72:75], v206 offset:2048
    s_add_u32 m0, s23, 0
    s_add_u32 s24, s22, 0
    buffer_load_dwordx4 v224, s[8:11], s24 offen offset:0 sc1 lds
    v_mfma_f32_32x32x16_bf16 v[32:47], a[52:55], a[84:87], v[32:47]
    s_waitcnt lgkmcnt(3)
    ds_read_b128 a[76:79], v206 offset:3072
    v_mfma_f32_32x32x16_bf16 v[32:47], a[56:59], a[88:91], v[32:47]
    ds_read_b128 a[80:83], v206 offset:4096
    buffer_load_dwordx4 v224, s[8:11], s24 offen offset:1024 sc1 lds
    v_mfma_f32_32x32x16_bf16 v[32:47], a[60:63], a[92:95], v[32:47]
    s_waitcnt lgkmcnt(3)
    ds_read_b128 a[84:87], v206 offset:5120
    v_mfma_f32_32x32x16_bf16 v[48:63], a[128:131], a[64:67], 0
    ds_read_b128 a[88:91], v206 offset:6144
    v_mfma_f32_32x32x16_bf16 v[48:63], a[132:135], a[68:71], v[48:63]
    s_waitcnt lgkmcnt(3)
    ds_read_b128 a[92:95], v206 offset:7168
    buffer_load_dwordx4 v224, s[8:11], s24 offen offset:2048 sc1 lds
    v_mfma_f32_32x32x16_bf16 v[48:63], a[136:139], a[72:75], v[48:63]
    ds_read_b128 a[64:67], v206 offset:8192
    v_cvt_pk_bf16_f32 v152, v32, v33
    v_cvt_pk_bf16_f32 v153, v34, v35
    v_cvt_pk_bf16_f32 v154, v36, v37
    v_cvt_pk_bf16_f32 v155, v38, v39
    v_mfma_f32_32x32x16_bf16 v[48:63], a[140:143], a[76:79], v[48:63]
    s_waitcnt lgkmcnt(3)
    ds_read_b128 a[68:71], v206 offset:9216
    buffer_store_dwordx4 v[152:155], v224, s[8:11], s46 offen offset:0 sc1
    buffer_load_dwordx4 v224, s[8:11], s24 offen offset:3072 sc1 lds
    v_mfma_f32_32x32x16_bf16 v[48:63], a[144:147], a[80:83], v[48:63]
    ds_read_b128 a[72:75], v206 offset:10240
    v_cvt_pk_bf16_f32 v156, v40, v41
    v_cvt_pk_bf16_f32 v157, v42, v43
    v_cvt_pk_bf16_f32 v158, v44, v45
    v_cvt_pk_bf16_f32 v159, v46, v47
    v_mfma_f32_32x32x16_bf16 v[48:63], a[148:151], a[84:87], v[48:63]
    s_waitcnt lgkmcnt(3)
    ds_read_b128 a[76:79], v206 offset:11264
    v_mfma_f32_32x32x16_bf16 v[48:63], a[152:155], a[88:91], v[48:63]
    ds_read_b128 a[80:83], v206 offset:12288
    buffer_store_dwordx4 v[156:159], v224, s[8:11], s46 offen offset:1024 sc1
    s_add_u32 m0, s23, 4096
    s_add_u32 s24, s22, 4096
    buffer_load_dwordx4 v224, s[8:11], s24 offen offset:0 sc1 lds
    v_mfma_f32_32x32x16_bf16 v[48:63], a[156:159], a[92:95], v[48:63]
    s_waitcnt lgkmcnt(3)
    ds_read_b128 a[84:87], v206 offset:13312
    v_mfma_f32_32x32x16_bf16 v[48:63], a[160:163], a[64:67], v[48:63]
    ds_read_b128 a[88:91], v206 offset:14336
    buffer_load_dwordx4 v224, s[8:11], s24 offen offset:1024 sc1 lds
    v_mfma_f32_32x32x16_bf16 v[48:63], a[164:167], a[68:71], v[48:63]
    s_barrier
    s_waitcnt lgkmcnt(3)
    ds_read_b128 a[92:95], v206 offset:15360
    v_mfma_f32_32x32x16_bf16 v[48:63], a[168:171], a[72:75], v[48:63]
    ds_read_b128 a[64:67], v206 offset:16384
    v_mfma_f32_32x32x16_bf16 v[48:63], a[172:175], a[76:79], v[48:63]
    s_waitcnt lgkmcnt(3)
    ds_read_b128 a[68:71], v206 offset:17408
    buffer_load_dwordx4 v224, s[8:11], s24 offen offset:2048 sc1 lds
    v_mfma_f32_32x32x16_bf16 v[48:63], a[176:179], a[80:83], v[48:63]
    ds_read_b128 a[72:75], v206 offset:18432
    v_mfma_f32_32x32x16_bf16 v[48:63], a[180:183], a[84:87], v[48:63]
    s_waitcnt lgkmcnt(3)
    ds_read_b128 a[76:79], v206 offset:19456
    buffer_load_dwordx4 v224, s[8:11], s24 offen offset:3072 sc1 lds
    v_mfma_f32_32x32x16_bf16 v[48:63], a[184:187], a[88:91], v[48:63]
    ds_read_b128 a[80:83], v206 offset:20480
    v_mfma_f32_32x32x16_bf16 v[48:63], a[188:191], a[92:95], v[48:63]
    s_waitcnt lgkmcnt(3)
    ds_read_b128 a[84:87], v206 offset:21504
    v_mfma_f32_32x32x16_bf16 v[48:63], a[192:195], a[64:67], v[48:63]
    ds_read_b128 a[88:91], v206 offset:22528
    s_add_u32 m0, s23, 32768
    s_add_u32 s24, s22, 32768
    buffer_load_dwordx4 v224, s[8:11], s24 offen offset:0 sc1 lds
    v_mfma_f32_32x32x16_bf16 v[48:63], a[196:199], a[68:71], v[48:63]
    s_waitcnt lgkmcnt(3)
    ds_read_b128 a[92:95], v206 offset:23552
    v_mfma_f32_32x32x16_bf16 v[48:63], a[200:203], a[72:75], v[48:63]
    ds_read_b128 a[64:67], v206 offset:24576
    buffer_load_dwordx4 v224, s[8:11], s24 offen offset:1024 sc1 lds
    v_mfma_f32_32x32x16_bf16 v[48:63], a[204:207], a[76:79], v[48:63]
    s_waitcnt lgkmcnt(3)
    ds_read_b128 a[68:71], v206 offset:25600
    v_mfma_f32_32x32x16_bf16 v[48:63], a[208:211], a[80:83], v[48:63]
    ds_read_b128 a[72:75], v206 offset:26624
    v_mfma_f32_32x32x16_bf16 v[48:63], a[212:215], a[84:87], v[48:63]
    s_waitcnt lgkmcnt(3)
    ds_read_b128 a[76:79], v206 offset:27648
    buffer_load_dwordx4 v224, s[8:11], s24 offen offset:2048 sc1 lds
    v_mfma_f32_32x32x16_bf16 v[48:63], a[216:219], a[88:91], v[48:63]
    ds_read_b128 a[80:83], v206 offset:28672
    v_mfma_f32_32x32x16_bf16 v[48:63], a[220:223], a[92:95], v[48:63]
    s_waitcnt lgkmcnt(3)
    ds_read_b128 a[84:87], v206 offset:29696
    buffer_load_dwordx4 v224, s[8:11], s24 offen offset:3072 sc1 lds
    v_mfma_f32_32x32x16_bf16 v[48:63], a[224:227], a[64:67], v[48:63]
    ds_read_b128 a[88:91], v206 offset:30720
    v_mfma_f32_32x32x16_bf16 v[48:63], a[228:231], a[68:71], v[48:63]
    s_waitcnt vmcnt(25)
    s_barrier
    s_waitcnt lgkmcnt(3)
    ds_read_b128 a[92:95], v206 offset:31744
    v_mfma_f32_32x32x16_bf16 v[48:63], a[232:235], a[72:75], v[48:63]
    ds_read_b128 a[64:67], v206 offset:32768
    s_add_u32 m0, s23, 36864
    s_add_u32 s24, s22, 36864
    buffer_load_dwordx4 v224, s[8:11], s24 offen offset:0 sc1 lds
    v_mfma_f32_32x32x16_bf16 v[48:63], a[236:239], a[76:79], v[48:63]
    s_waitcnt lgkmcnt(3)
    ds_read_b128 a[68:71], v206 offset:33792
    v_mfma_f32_32x32x16_bf16 v[48:63], a[240:243], a[80:83], v[48:63]
    ds_read_b128 a[72:75], v206 offset:34816
    buffer_load_dwordx4 v224, s[8:11], s24 offen offset:1024 sc1 lds
    v_mfma_f32_32x32x16_bf16 v[48:63], a[244:247], a[84:87], v[48:63]
    s_waitcnt lgkmcnt(3)
    ds_read_b128 a[76:79], v206 offset:35840
    v_mfma_f32_32x32x16_bf16 v[48:63], a[248:251], a[88:91], v[48:63]
    ds_read_b128 a[80:83], v206 offset:36864
    v_mfma_f32_32x32x16_bf16 v[48:63], a[252:255], a[92:95], v[48:63]
    s_waitcnt lgkmcnt(3)
    ds_read_b128 a[84:87], v206 offset:37888
    buffer_load_dwordx4 v224, s[8:11], s24 offen offset:2048 sc1 lds
    v_mfma_f32_32x32x16_bf16 v[48:63], a[0:3], a[64:67], v[48:63]
    ds_read_b128 a[88:91], v206 offset:38912
    v_mfma_f32_32x32x16_bf16 v[48:63], a[4:7], a[68:71], v[48:63]
    s_waitcnt lgkmcnt(3)
    ds_read_b128 a[92:95], v206 offset:39936
    buffer_load_dwordx4 v224, s[8:11], s24 offen offset:3072 sc1 lds
    v_mfma_f32_32x32x16_bf16 v[48:63], a[8:11], a[72:75], v[48:63]
    ds_read_b128 a[64:67], v206 offset:40960
    v_mfma_f32_32x32x16_bf16 v[48:63], a[12:15], a[76:79], v[48:63]
    s_waitcnt lgkmcnt(3)
    ds_read_b128 a[68:71], v206 offset:41984
    v_mfma_f32_32x32x16_bf16 v[48:63], a[16:19], a[80:83], v[48:63]
    ds_read_b128 a[72:75], v206 offset:43008
    v_mfma_f32_32x32x16_bf16 v[48:63], a[20:23], a[84:87], v[48:63]
    s_waitcnt lgkmcnt(3)
    ds_read_b128 a[76:79], v206 offset:44032
    v_mfma_f32_32x32x16_bf16 v[48:63], a[24:27], a[88:91], v[48:63]
    ds_read_b128 a[80:83], v206 offset:45056
    v_mfma_f32_32x32x16_bf16 v[48:63], a[28:31], a[92:95], v[48:63]
    s_waitcnt lgkmcnt(3)
    ds_read_b128 a[84:87], v206 offset:46080
    v_mfma_f32_32x32x16_bf16 v[48:63], v[64:67], a[64:67], v[48:63]
    ds_read_b128 a[88:91], v206 offset:47104
    v_mfma_f32_32x32x16_bf16 v[48:63], v[68:71], a[68:71], v[48:63]
    s_waitcnt vmcnt(25)
    s_barrier
    s_waitcnt lgkmcnt(3)
    ds_read_b128 a[92:95], v206 offset:48128
    v_mfma_f32_32x32x16_bf16 v[48:63], v[72:75], a[72:75], v[48:63]
    ds_read_b128 a[64:67], v206 offset:49152
    v_mfma_f32_32x32x16_bf16 v[48:63], v[76:79], a[76:79], v[48:63]
    s_waitcnt lgkmcnt(3)
    ds_read_b128 a[68:71], v206 offset:50176
    v_mfma_f32_32x32x16_bf16 v[48:63], v[80:83], a[80:83], v[48:63]
    ds_read_b128 a[72:75], v206 offset:51200
    buffer_load_dwordx4 v[128:131], v224, s[8:11], s92 offen offset:0 sc1
    v_mfma_f32_32x32x16_bf16 v[48:63], v[84:87], a[84:87], v[48:63]
    s_waitcnt lgkmcnt(3)
    ds_read_b128 a[76:79], v206 offset:52224
    v_mfma_f32_32x32x16_bf16 v[48:63], v[88:91], a[88:91], v[48:63]
    ds_read_b128 a[80:83], v206 offset:53248
    buffer_load_dwordx4 v[132:135], v224, s[8:11], s92 offen offset:1024 sc1
    v_mfma_f32_32x32x16_bf16 v[48:63], v[92:95], a[92:95], v[48:63]
    s_waitcnt lgkmcnt(3)
    ds_read_b128 a[84:87], v206 offset:54272
    v_mfma_f32_32x32x16_bf16 v[48:63], v[96:99], a[64:67], v[48:63]
    ds_read_b128 a[88:91], v206 offset:55296
    v_mfma_f32_32x32x16_bf16 v[48:63], v[100:103], a[68:71], v[48:63]
    s_waitcnt lgkmcnt(3)
    ds_read_b128 a[92:95], v206 offset:56320
    buffer_load_dwordx4 v[136:139], v224, s[8:11], s93 offen offset:0 sc1
    v_mfma_f32_32x32x16_bf16 v[48:63], v[104:107], a[72:75], v[48:63]
    ds_read_b128 a[64:67], v206 offset:57344
    v_mfma_f32_32x32x16_bf16 v[48:63], v[108:111], a[76:79], v[48:63]
    s_waitcnt lgkmcnt(3)
    ds_read_b128 a[68:71], v206 offset:58368
    buffer_load_dwordx4 v[140:143], v224, s[8:11], s93 offen offset:1024 sc1
    v_mfma_f32_32x32x16_bf16 v[48:63], v[112:115], a[80:83], v[48:63]
    ds_read_b128 a[72:75], v206 offset:59392
    v_mfma_f32_32x32x16_bf16 v[48:63], v[116:119], a[84:87], v[48:63]
    s_waitcnt lgkmcnt(3)
    ds_read_b128 a[76:79], v206 offset:60416
    v_mfma_f32_32x32x16_bf16 v[48:63], v[120:123], a[88:91], v[48:63]
    ds_read_b128 a[80:83], v206 offset:61440
    buffer_load_dwordx4 v[144:147], v224, s[8:11], s94 offen offset:0 sc1
    v_mfma_f32_32x32x16_bf16 v[48:63], v[124:127], a[92:95], v[48:63]
    s_waitcnt lgkmcnt(3)
    ds_read_b128 a[84:87], v206 offset:62464
    v_mfma_f32_32x32x16_bf16 v[48:63], a[32:35], a[64:67], v[48:63]
    ds_read_b128 a[88:91], v206 offset:63488
    buffer_load_dwordx4 v[148:151], v224, s[8:11], s94 offen offset:1024 sc1
    v_mfma_f32_32x32x16_bf16 v[48:63], a[36:39], a[68:71], v[48:63]
    s_waitcnt lgkmcnt(3)
    ds_read_b128 a[92:95], v206 offset:64512
    v_mfma_f32_32x32x16_bf16 v[48:63], a[40:43], a[72:75], v[48:63]
    v_mfma_f32_32x32x16_bf16 v[48:63], a[44:47], a[76:79], v[48:63]
    s_waitcnt lgkmcnt(2)
    v_mfma_f32_32x32x16_bf16 v[48:63], a[48:51], a[80:83], v[48:63]
    v_mfma_f32_32x32x16_bf16 v[48:63], a[52:55], a[84:87], v[48:63]
    s_waitcnt lgkmcnt(0)
    v_mfma_f32_32x32x16_bf16 v[48:63], a[56:59], a[88:91], v[48:63]
    v_mfma_f32_32x32x16_bf16 v[48:63], a[60:63], a[92:95], v[48:63]
    s_waitcnt vmcnt(0)
    v_max3_u32 v216, v128, v132, v136
    v_max3_u32 v217, v140, v144, v148
    v_max_u32 v216, v216, v217
    v_cmp_eq_u32 vcc, -1, v216
    s_nop 1
    s_cbranch_vccnz L_px0_sequential_preLN__compressed_kv_cla__geglu_ffn__prompt_kernel
L_px0_sequential_preLN__compressed_kv_cla__geglu_ffn__prompt_kernel_ok:
    v_lshlrev_b32 v160, 16, v128
    v_and_b32 v161, 0xffff0000, v128
    v_lshlrev_b32 v162, 16, v129
    v_and_b32 v163, 0xffff0000, v129
    v_lshlrev_b32 v164, 16, v130
    v_and_b32 v165, 0xffff0000, v130
    v_lshlrev_b32 v166, 16, v131
    v_and_b32 v167, 0xffff0000, v131
    v_lshlrev_b32 v168, 16, v132
    v_and_b32 v169, 0xffff0000, v132
    v_lshlrev_b32 v170, 16, v133
    v_and_b32 v171, 0xffff0000, v133
    v_lshlrev_b32 v172, 16, v134
    v_and_b32 v173, 0xffff0000, v134
    v_lshlrev_b32 v174, 16, v135
    v_and_b32 v175, 0xffff0000, v135
    v_pk_add_f32 v[176:177], v[176:177], v[160:161]
    v_pk_add_f32 v[178:179], v[178:179], v[162:163]
    v_pk_add_f32 v[180:181], v[180:181], v[164:165]
    v_pk_add_f32 v[182:183], v[182:183], v[166:167]
    v_pk_add_f32 v[184:185], v[184:185], v[168:169]
    v_pk_add_f32 v[186:187], v[186:187], v[170:171]
    v_pk_add_f32 v[188:189], v[188:189], v[172:173]
    v_pk_add_f32 v[190:191], v[190:191], v[174:175]
    v_lshlrev_b32 v160, 16, v136
    v_and_b32 v161, 0xffff0000, v136
    v_lshlrev_b32 v162, 16, v137
    v_and_b32 v163, 0xffff0000, v137
    v_lshlrev_b32 v164, 16, v138
    v_and_b32 v165, 0xffff0000, v138
    v_lshlrev_b32 v166, 16, v139
    v_and_b32 v167, 0xffff0000, v139
    v_lshlrev_b32 v168, 16, v140
    v_and_b32 v169, 0xffff0000, v140
    v_lshlrev_b32 v170, 16, v141
    v_and_b32 v171, 0xffff0000, v141
    v_lshlrev_b32 v172, 16, v142
    v_and_b32 v173, 0xffff0000, v142
    v_lshlrev_b32 v174, 16, v143
    v_and_b32 v175, 0xffff0000, v143
    v_pk_add_f32 v[176:177], v[176:177], v[160:161]
    v_pk_add_f32 v[178:179], v[178:179], v[162:163]
    v_pk_add_f32 v[180:181], v[180:181], v[164:165]
    v_pk_add_f32 v[182:183], v[182:183], v[166:167]
    v_pk_add_f32 v[184:185], v[184:185], v[168:169]
    v_pk_add_f32 v[186:187], v[186:187], v[170:171]
    v_pk_add_f32 v[188:189], v[188:189], v[172:173]
    v_pk_add_f32 v[190:191], v[190:191], v[174:175]
    v_pk_add_f32 v[0:1], v[48:49], v[176:177]
    v_pk_add_f32 v[2:3], v[50:51], v[178:179]
    v_pk_add_f32 v[4:5], v[52:53], v[180:181]
    v_pk_add_f32 v[6:7], v[54:55], v[182:183]
    v_pk_add_f32 v[8:9], v[56:57], v[184:185]
    v_pk_add_f32 v[10:11], v[58:59], v[186:187]
    v_pk_add_f32 v[12:13], v[60:61], v[188:189]
    v_pk_add_f32 v[14:15], v[62:63], v[190:191]
    v_lshlrev_b32 v160, 16, v144
    v_and_b32 v161, 0xffff0000, v144
    v_lshlrev_b32 v162, 16, v145
    v_and_b32 v163, 0xffff0000, v145
    v_lshlrev_b32 v164, 16, v146
    v_and_b32 v165, 0xffff0000, v146
    v_lshlrev_b32 v166, 16, v147
    v_and_b32 v167, 0xffff0000, v147
    v_lshlrev_b32 v168, 16, v148
    v_and_b32 v169, 0xffff0000, v148
    v_lshlrev_b32 v170, 16, v149
    v_and_b32 v171, 0xffff0000, v149
    v_lshlrev_b32 v172, 16, v150
    v_and_b32 v173, 0xffff0000, v150
    v_lshlrev_b32 v174, 16, v151
    v_and_b32 v175, 0xffff0000, v151
    v_pk_add_f32 v[0:1], v[0:1], v[160:161]
    v_pk_add_f32 v[2:3], v[2:3], v[162:163]
    v_pk_add_f32 v[4:5], v[4:5], v[164:165]
    v_pk_add_f32 v[6:7], v[6:7], v[166:167]
    v_pk_add_f32 v[8:9], v[8:9], v[168:169]
    v_pk_add_f32 v[10:11], v[10:11], v[170:171]
    v_pk_add_f32 v[12:13], v[12:13], v[172:173]
    v_pk_add_f32 v[14:15], v[14:15], v[174:175]
    v_cvt_pk_bf16_f32 v240, v0, v1
    v_cvt_pk_bf16_f32 v241, v2, v3
    v_cvt_pk_bf16_f32 v242, v4, v5
    v_cvt_pk_bf16_f32 v243, v6, v7
    buffer_store_dwordx4 v[240:243], v224, s[8:11], s64 offen offset:0 sc1
    v_cvt_pk_bf16_f32 v244, v8, v9
    v_cvt_pk_bf16_f32 v245, v10, v11
    v_cvt_pk_bf16_f32 v246, v12, v13
    v_cvt_pk_bf16_f32 v247, v14, v15
    buffer_store_dwordx4 v[244:247], v224, s[8:11], s64 offen offset:1024 sc1
    v_lshlrev_b32 v0, 16, v240
    v_and_b32 v1, 0xffff0000, v240
    v_lshlrev_b32 v2, 16, v241
    v_and_b32 v3, 0xffff0000, v241
    v_lshlrev_b32 v4, 16, v242
    v_and_b32 v5, 0xffff0000, v242
    v_lshlrev_b32 v6, 16, v243
    v_and_b32 v7, 0xffff0000, v243
    v_lshlrev_b32 v8, 16, v244
    v_and_b32 v9, 0xffff0000, v244
    v_lshlrev_b32 v10, 16, v245
    v_and_b32 v11, 0xffff0000, v245
    v_lshlrev_b32 v12, 16, v246
    v_and_b32 v13, 0xffff0000, v246
    v_lshlrev_b32 v14, 16, v247
    v_and_b32 v15, 0xffff0000, v247
    v_pk_add_f32 v[40:41], v[0:1], v[2:3]
    v_pk_add_f32 v[42:43], v[4:5], v[6:7]
    v_pk_add_f32 v[44:45], v[8:9], v[10:11]
    v_pk_add_f32 v[46:47], v[12:13], v[14:15]
    v_pk_add_f32 v[40:41], v[40:41], v[42:43]
    v_pk_add_f32 v[44:45], v[44:45], v[46:47]
    v_pk_add_f32 v[40:41], v[40:41], v[44:45]
    v_add_f32 v40, v40, v41
    v_mov_b32 v42, v40
    s_nop 1
    v_permlane32_swap_b32 v42, v40
    v_add_f32 v40, v40, v42
    v_mul_f32 v44, 0xbd000000, v40
    v_pk_add_f32 v[0:1], v[0:1], v[44:45] op_sel_hi:[1,0]
    v_pk_add_f32 v[2:3], v[2:3], v[44:45] op_sel_hi:[1,0]
    v_pk_add_f32 v[4:5], v[4:5], v[44:45] op_sel_hi:[1,0]
    v_pk_add_f32 v[6:7], v[6:7], v[44:45] op_sel_hi:[1,0]
    v_pk_add_f32 v[8:9], v[8:9], v[44:45] op_sel_hi:[1,0]
    v_pk_add_f32 v[10:11], v[10:11], v[44:45] op_sel_hi:[1,0]
    v_pk_add_f32 v[12:13], v[12:13], v[44:45] op_sel_hi:[1,0]
    v_pk_add_f32 v[14:15], v[14:15], v[44:45] op_sel_hi:[1,0]
    v_pk_mul_f32 v[42:43], v[0:1], v[0:1]
    v_pk_mul_f32 v[44:45], v[2:3], v[2:3]
    v_pk_fma_f32 v[42:43], v[4:5], v[4:5], v[42:43]
    v_pk_fma_f32 v[44:45], v[6:7], v[6:7], v[44:45]
    v_pk_fma_f32 v[42:43], v[8:9], v[8:9], v[42:43]
    v_pk_fma_f32 v[44:45], v[10:11], v[10:11], v[44:45]
    v_pk_fma_f32 v[42:43], v[12:13], v[12:13], v[42:43]
    v_pk_fma_f32 v[44:45], v[14:15], v[14:15], v[44:45]
    v_pk_add_f32 v[42:43], v[42:43], v[44:45]
    v_add_f32 v41, v42, v43
    v_mov_b32 v42, v41
    s_nop 1
    v_permlane32_swap_b32 v42, v41
    v_add_f32 v41, v41, v42
    buffer_store_dwordx2 v[40:41], v237, s[8:11], 0 offen sc1
    s_barrier
    s_add_u32 m0, s30, 0
    s_add_u32 s24, s22, 98304
    buffer_load_dwordx4 v224, s[8:11], s24 offen offset:0 sc1 lds
    buffer_load_dwordx4 v224, s[8:11], s24 offen offset:1024 sc1 lds
    buffer_load_dwordx4 v224, s[8:11], s24 offen offset:2048 sc1 lds
    buffer_load_dwordx4 v224, s[8:11], s24 offen offset:3072 sc1 lds
    s_add_u32 m0, s30, 4096
    s_add_u32 s24, s22, 102400
    buffer_load_dwordx4 v224, s[8:11], s24 offen offset:0 sc1 lds
    buffer_load_dwordx4 v224, s[8:11], s24 offen offset:1024 sc1 lds
    buffer_load_dwordx4 v224, s[8:11], s24 offen offset:2048 sc1 lds
    buffer_load_dwordx4 v224, s[8:11], s24 offen offset:3072 sc1 lds
    s_lshl_b32 s3, s95, 7
    s_add_u32 s3, s3, 0x4e20000
    s_waitcnt vmcnt(8)
    s_barrier
    s_cmp_eq_u32 s71, 0
    s_cselect_b32 s3, s3, 0x7f000000
    buffer_store_dword v253, v251, s[8:11], s3 offen sc1
    s_add_u32 m0, s30, 32768
    s_add_u32 s24, s22, 131072
    buffer_load_dwordx4 v224, s[8:11], s24 offen offset:0 sc1 lds
    buffer_load_dwordx4 v224, s[8:11], s24 offen offset:1024 sc1 lds
    buffer_load_dwordx4 v224, s[8:11], s24 offen offset:2048 sc1 lds
    buffer_load_dwordx4 v224, s[8:11], s24 offen offset:3072 sc1 lds
    s_add_u32 m0, s30, 36864
    s_add_u32 s24, s22, 135168
    buffer_load_dwordx4 v224, s[8:11], s24 offen offset:0 sc1 lds
    buffer_load_dwordx4 v224, s[8:11], s24 offen offset:1024 sc1 lds
    buffer_load_dwordx4 v224, s[8:11], s24 offen offset:2048 sc1 lds
    buffer_load_dwordx4 v224, s[8:11], s24 offen offset:3072 sc1 lds
    s_lshl_b32 s6, s28, 11
    s_add_u32 s6, s6, 0x4e20000
    buffer_load_dword v250, v248, s[8:11], s6 offen sc1
    v_add_u32 v225, s38, v224
    v_add_u32 v226, s86, v224
    v_add_u32 v227, 0x20000, v224
    s_mul_i32 s25, s20, 33792
    s_add_u32 s25, s25, 0x3b00000
    s_lshl_b32 s5, s20, 12
    s_add_u32 s5, s5, 0x3e00000
    v_lshrrev_b32 v231, 1, v224
    s_mul_i32 s26, s20, 113
    s_mul_i32 s3, s21, 7
    s_add_u32 s26, s26, s3
    s_lshl_b32 s26, s26, 10
    s_add_u32 s26, s26, 0x4300000
    s_mul_i32 s3, s71, 28672
    s_mul_i32 s60, s68, 231424
    s_add_u32 s3, s3, s60
    s_add_u32 s3, s3, 0x4300000
    s_and_b32 s4, s71, 1
    s_mul_i32 s4, s4, 115712
    s_add_u32 s60, s3, s4
    s_sub_u32 s61, s3, s4
    s_add_u32 s61, s61, 115712
    s_waitcnt vmcnt(1)
    s_barrier
    ds_read_b128 a[0:3], v226 offset:0
    ds_read_b128 a[4:7], v226 offset:1024
    ds_read_b128 a[8:11], v226 offset:2048
    ds_read_b128 a[12:15], v226 offset:3072
    ds_read_b128 a[16:19], v226 offset:4096
    ds_read_b128 a[20:23], v226 offset:5120
    s_waitcnt vmcnt(0)
    v_cmp_ne_u32 vcc, s73, v250
    s_nop 1
    s_cbranch_vccnz L_poll10_sequential_preLN__compressed_kv_cla__geglu_ffn__prompt_kernel
L_poll10_sequential_preLN__compressed_kv_cla__geglu_ffn__prompt_kernel_ok:
    buffer_load_dwordx4 v[0:3], v224, s[8:11], s25 offen offset:0 sc1
    buffer_load_dwordx4 v[4:7], v224, s[8:11], s25 offen offset:1024 sc1
    buffer_load_dwordx4 v[8:11], v224, s[8:11], s25 offen offset:2048 sc1
    buffer_load_dwordx4 v[12:15], v224, s[8:11], s25 offen offset:3072 sc1
    buffer_load_dwordx4 v[16:19], v252, s[8:11], s25 offen offset:0 sc1
    buffer_load_dwordx4 v[20:23], v252, s[8:11], s25 offen offset:1024 sc1
    buffer_load_dwordx4 v[24:27], v252, s[8:11], s25 offen offset:2048 sc1
    buffer_load_dwordx4 v[28:31], v252, s[8:11], s25 offen offset:3072 sc1
    s_add_u32 s25, s25, 8192
    buffer_load_dwordx4 v[32:35], v224, s[8:11], s25 offen offset:0 sc1
    buffer_load_dwordx4 v[36:39], v224, s[8:11], s25 offen offset:1024 sc1
    s_waitcnt vmcnt(9) lgkmcnt(4)
    v_mfma_f32_32x32x16_bf16 v[128:143], a[0:3], v[0:3], 0
    ds_read_b128 a[24:27], v226 offset:6144
    buffer_load_dwordx4 v[40:43], v224, s[8:11], s25 offen offset:2048 sc1
    v_mfma_f32_32x32x16_bf16 v[144:159], a[4:7], v[0:3], 0
    s_waitcnt vmcnt(9) lgkmcnt(3)
    ds_read_b128 a[28:31], v226 offset:7168
    v_mfma_f32_32x32x16_bf16 v[160:175], a[8:11], v[0:3], 0
    ds_read_b128 a[0:3], v226 offset:8192
    buffer_load_dwordx4 v[44:47], v224, s[8:11], s25 offen offset:3072 sc1
    v_mfma_f32_32x32x16_bf16 v[128:143], a[12:15], v[4:7], v[128:143]
    s_waitcnt lgkmcnt(3)
    ds_read_b128 a[4:7], v226 offset:9216
    v_mfma_f32_32x32x16_bf16 v[144:159], a[16:19], v[4:7], v[144:159]
    ds_read_b128 a[8:11], v226 offset:10240
    buffer_load_dwordx4 v[48:51], v252, s[8:11], s25 offen offset:0 sc1
    v_mfma_f32_32x32x16_bf16 v[160:175], a[20:23], v[4:7], v[160:175]
    s_waitcnt vmcnt(10) lgkmcnt(3)
    ds_read_b128 a[12:15], v226 offset:11264
    v_mfma_f32_32x32x16_bf16 v[128:143], a[24:27], v[8:11], v[128:143]
    ds_read_b128 a[16:19], v226 offset:12288
    buffer_load_dwordx4 v[52:55], v252, s[8:11], s25 offen offset:1024 sc1
    v_mfma_f32_32x32x16_bf16 v[144:159], a[28:31], v[8:11], v[144:159]
    s_waitcnt vmcnt(10) lgkmcnt(3)
    ds_read_b128 a[20:23], v226 offset:13312
    v_mfma_f32_32x32x16_bf16 v[160:175], a[0:3], v[8:11], v[160:175]
    ds_read_b128 a[24:27], v226 offset:14336
    buffer_load_dwordx4 v[56:59], v252, s[8:11], s25 offen offset:2048 sc1
    v_mfma_f32_32x32x16_bf16 v[128:143], a[4:7], v[12:15], v[128:143]
    s_waitcnt lgkmcnt(3)
    ds_read_b128 a[28:31], v226 offset:15360
    v_mfma_f32_32x32x16_bf16 v[144:159], a[8:11], v[12:15], v[144:159]
    ds_read_b128 a[0:3], v226 offset:16384
    buffer_load_dwordx4 v[60:63], v252, s[8:11], s25 offen offset:3072 sc1
    s_add_u32 s25, s25, 8192
    v_mfma_f32_32x32x16_bf16 v[160:175], a[12:15], v[12:15], v[160:175]
    s_waitcnt vmcnt(11) lgkmcnt(3)
    ds_read_b128 a[4:7], v226 offset:17408
    v_mfma_f32_32x32x16_bf16 v[128:143], a[16:19], v[16:19], v[128:143]
    ds_read_b128 a[8:11], v226 offset:18432
    buffer_load_dwordx4 v[64:67], v224, s[8:11], s25 offen offset:0 sc1
    v_mfma_f32_32x32x16_bf16 v[144:159], a[20:23], v[16:19], v[144:159]
    s_waitcnt vmcnt(11) lgkmcnt(3)
    ds_read_b128 a[12:15], v226 offset:19456
    v_mfma_f32_32x32x16_bf16 v[160:175], a[24:27], v[16:19], v[160:175]
    ds_read_b128 a[16:19], v226 offset:20480
    buffer_load_dwordx4 v[68:71], v224, s[8:11], s25 offen offset:1024 sc1
    v_mfma_f32_32x32x16_bf16 v[128:143], a[28:31], v[20:23], v[128:143]
    s_waitcnt lgkmcnt(3)
    ds_read_b128 a[20:23], v226 offset:21504
    v_mfma_f32_32x32x16_bf16 v[144:159], a[0:3], v[20:23], v[144:159]
    ds_read_b128 a[24:27], v226 offset:22528
    buffer_load_dwordx4 v[72:75], v224, s[8:11], s25 offen offset:2048 sc1
    v_mfma_f32_32x32x16_bf16 v[160:175], a[4:7], v[20:23], v[160:175]
    s_waitcnt vmcnt(12) lgkmcnt(3)
    ds_read_b128 a[28:31], v226 offset:23552
    v_mfma_f32_32x32x16_bf16 v[128:143], a[8:11], v[24:27], v[128:143]
    ds_read_b128 a[0:3], v226 offset:24576
    buffer_load_dwordx4 v[76:79], v224, s[8:11], s25 offen offset:3072 sc1
    v_mfma_f32_32x32x16_bf16 v[144:159], a[12:15], v[24:27], v[144:159]
    s_waitcnt vmcnt(12) lgkmcnt(3)
    ds_read_b128 a[4:7], v226 offset:25600
    v_mfma_f32_32x32x16_bf16 v[160:175], a[16:19], v[24:27], v[160:175]
    ds_read_b128 a[8:11], v226 offset:26624
    buffer_load_dwordx2 v[208:209], v231, s[8:11], s5 offen offset:0 sc1
    v_mfma_f32_32x32x16_bf16 v[128:143], a[20:23], v[28:31], v[128:143]
    s_waitcnt lgkmcnt(3)
    ds_read_b128 a[12:15], v226 offset:27648
    v_mfma_f32_32x32x16_bf16 v[144:159], a[24:27], v[28:31], v[144:159]
    ds_read_b128 a[16:19], v226 offset:28672
    buffer_load_dwordx2 v[210:211], v231, s[8:11], s5 offen offset:512 sc1
    v_mfma_f32_32x32x16_bf16 v[160:175], a[28:31], v[28:31], v[160:175]
    s_waitcnt vmcnt(13) lgkmcnt(3)
    ds_read_b128 a[20:23], v226 offset:29696
    v_mfma_f32_32x32x16_bf16 v[128:143], a[0:3], v[32:35], v[128:143]
    ds_read_b128 a[24:27], v226 offset:30720
    buffer_load_dwordx2 v[212:213], v231, s[8:11], s5 offen offset:1024 sc1
    v_mfma_f32_32x32x16_bf16 v[144:159], a[4:7], v[32:35], v[144:159]
    s_waitcnt vmcnt(13) lgkmcnt(3)
    ds_read_b128 a[28:31], v226 offset:31744
    v_mfma_f32_32x32x16_bf16 v[160:175], a[8:11], v[32:35], v[160:175]
    ds_read_b128 a[0:3], v226 offset:32768
    buffer_load_dwordx2 v[214:215], v231, s[8:11], s5 offen offset:1536 sc1
    v_mfma_f32_32x32x16_bf16 v[128:143], a[12:15], v[36:39], v[128:143]
    s_waitcnt lgkmcnt(3)
    ds_read_b128 a[4:7], v226 offset:33792
    v_mfma_f32_32x32x16_bf16 v[144:159], a[16:19], v[36:39], v[144:159]
    ds_read_b128 a[8:11], v226 offset:34816
    buffer_load_dwordx2 v[216:217], v231, s[8:11], s5 offen offset:2048 sc1
    v_mfma_f32_32x32x16_bf16 v[160:175], a[20:23], v[36:39], v[160:175]
    s_waitcnt vmcnt(14) lgkmcnt(3)
    ds_read_b128 a[12:15], v226 offset:35840
    v_mfma_f32_32x32x16_bf16 v[128:143], a[24:27], v[40:43], v[128:143]
    ds_read_b128 a[16:19], v226 offset:36864
    buffer_load_dwordx2 v[218:219], v231, s[8:11], s5 offen offset:2560 sc1
    v_mfma_f32_32x32x16_bf16 v[144:159], a[28:31], v[40:43], v[144:159]
    s_waitcnt vmcnt(14) lgkmcnt(3)
    ds_read_b128 a[20:23], v226 offset:37888
    v_mfma_f32_32x32x16_bf16 v[160:175], a[0:3], v[40:43], v[160:175]
    ds_read_b128 a[24:27], v226 offset:38912
    buffer_load_dwordx2 v[220:221], v231, s[8:11], s5 offen offset:3072 sc1
    v_mfma_f32_32x32x16_bf16 v[128:143], a[4:7], v[44:47], v[128:143]
    s_waitcnt lgkmcnt(3)
    ds_read_b128 a[28:31], v226 offset:39936
    v_mfma_f32_32x32x16_bf16 v[144:159], a[8:11], v[44:47], v[144:159]
    ds_read_b128 a[0:3], v226 offset:40960
    buffer_load_dwordx2 v[222:223], v231, s[8:11], s5 offen offset:3584 sc1
    v_mfma_f32_32x32x16_bf16 v[160:175], a[12:15], v[44:47], v[160:175]
    s_waitcnt vmcnt(15) lgkmcnt(3)
    ds_read_b128 a[4:7], v226 offset:41984
    v_mfma_f32_32x32x16_bf16 v[128:143], a[16:19], v[48:51], v[128:143]
    ds_read_b128 a[8:11], v226 offset:43008
    buffer_load_dwordx4 v[80:83], v252, s[8:11], s25 offen offset:0 sc1
    v_mfma_f32_32x32x16_bf16 v[144:159], a[20:23], v[48:51], v[144:159]
    s_waitcnt vmcnt(15) lgkmcnt(3)
    ds_read_b128 a[12:15], v226 offset:44032
    v_mfma_f32_32x32x16_bf16 v[160:175], a[24:27], v[48:51], v[160:175]
    ds_read_b128 a[16:19], v226 offset:45056
    buffer_load_dwordx4 v[84:87], v252, s[8:11], s25 offen offset:1024 sc1
    v_mfma_f32_32x32x16_bf16 v[128:143], a[28:31], v[52:55], v[128:143]
    s_waitcnt lgkmcnt(3)
    ds_read_b128 a[20:23], v226 offset:46080
    v_mfma_f32_32x32x16_bf16 v[144:159], a[0:3], v[52:55], v[144:159]
    ds_read_b128 a[24:27], v226 offset:47104
    buffer_load_dwordx4 v[88:91], v252, s[8:11], s25 offen offset:2048 sc1
    v_mfma_f32_32x32x16_bf16 v[160:175], a[4:7], v[52:55], v[160:175]
    s_waitcnt vmcnt(16) lgkmcnt(3)
    ds_read_b128 a[28:31], v226 offset:48128
    v_mfma_f32_32x32x16_bf16 v[128:143], a[8:11], v[56:59], v[128:143]
    ds_read_b128 a[0:3], v226 offset:49152
    buffer_load_dwordx4 v[92:95], v252, s[8:11], s25 offen offset:3072 sc1
    s_add_u32 s25, s25, 8192
    v_mfma_f32_32x32x16_bf16 v[144:159], a[12:15], v[56:59], v[144:159]
    s_waitcnt vmcnt(16) lgkmcnt(3)
    ds_read_b128 a[4:7], v226 offset:50176
    v_mfma_f32_32x32x16_bf16 v[160:175], a[16:19], v[56:59], v[160:175]
    ds_read_b128 a[8:11], v226 offset:51200
    buffer_load_dwordx4 v[96:99], v224, s[8:11], s25 offen offset:0 sc1
    v_mfma_f32_32x32x16_bf16 v[128:143], a[20:23], v[60:63], v[128:143]
    s_waitcnt lgkmcnt(3)
    ds_read_b128 a[12:15], v226 offset:52224
    v_mfma_f32_32x32x16_bf16 v[144:159], a[24:27], v[60:63], v[144:159]
    ds_read_b128 a[16:19], v226 offset:53248
    buffer_load_dwordx4 v[100:103], v224, s[8:11], s25 offen offset:1024 sc1
    v_mfma_f32_32x32x16_bf16 v[160:175], a[28:31], v[60:63], v[160:175]
    s_waitcnt vmcnt(17) lgkmcnt(3)
    ds_read_b128 a[20:23], v226 offset:54272
    v_mfma_f32_32x32x16_bf16 v[128:143], a[0:3], v[64:67], v[128:143]
    ds_read_b128 a[24:27], v226 offset:55296
    buffer_load_dwordx4 v[104:107], v224, s[8:11], s25 offen offset:2048 sc1
    v_mfma_f32_32x32x16_bf16 v[144:159], a[4:7], v[64:67], v[144:159]
    s_waitcnt vmcnt(17) lgkmcnt(3)
    ds_read_b128 a[28:31], v226 offset:56320
    v_mfma_f32_32x32x16_bf16 v[160:175], a[8:11], v[64:67], v[160:175]
    ds_read_b128 a[0:3], v226 offset:57344
    buffer_load_dwordx4 v[108:111], v224, s[8:11], s25 offen offset:3072 sc1
    v_mfma_f32_32x32x16_bf16 v[128:143], a[12:15], v[68:71], v[128:143]
    s_waitcnt lgkmcnt(3)
    ds_read_b128 a[4:7], v226 offset:58368
    v_mfma_f32_32x32x16_bf16 v[144:159], a[16:19], v[68:71], v[144:159]
    ds_read_b128 a[8:11], v226 offset:59392
    buffer_load_dwordx4 v[112:115], v252, s[8:11], s25 offen offset:0 sc1
    v_mfma_f32_32x32x16_bf16 v[160:175], a[20:23], v[68:71], v[160:175]
    s_waitcnt vmcnt(18) lgkmcnt(3)
    ds_read_b128 a[12:15], v226 offset:60416
    v_mfma_f32_32x32x16_bf16 v[128:143], a[24:27], v[72:75], v[128:143]
    ds_read_b128 a[16:19], v226 offset:61440
    buffer_load_dwordx4 v[116:119], v252, s[8:11], s25 offen offset:1024 sc1
    v_mfma_f32_32x32x16_bf16 v[144:159], a[28:31], v[72:75], v[144:159]
    s_waitcnt vmcnt(18) lgkmcnt(3)
    ds_read_b128 a[20:23], v226 offset:62464
    v_mfma_f32_32x32x16_bf16 v[160:175], a[0:3], v[72:75], v[160:175]
    ds_read_b128 a[24:27], v226 offset:63488
    buffer_load_dwordx4 v[120:123], v252, s[8:11], s25 offen offset:2048 sc1
    v_mfma_f32_32x32x16_bf16 v[128:143], a[4:7], v[76:79], v[128:143]
    s_waitcnt lgkmcnt(3)
    ds_read_b128 a[28:31], v226 offset:64512
    v_mfma_f32_32x32x16_bf16 v[144:159], a[8:11], v[76:79], v[144:159]
    ds_read_b128 a[0:3], v227 offset:0
    buffer_load_dwordx4 v[124:127], v252, s[8:11], s25 offen offset:3072 sc1
    s_add_u32 s25, s25, 8192
    v_mfma_f32_32x32x16_bf16 v[160:175], a[12:15], v[76:79], v[160:175]
    s_waitcnt vmcnt(11) lgkmcnt(3)
    ds_read_b128 a[4:7], v227 offset:1024
    v_mfma_f32_32x32x16_bf16 v[128:143], a[16:19], v[80:83], v[128:143]
    ds_read_b128 a[8:11], v227 offset:2048
    buffer_load_dwordx4 v[240:243], v224, s[8:11], s37 offen sc1
    v_mfma_f32_32x32x16_bf16 v[144:159], a[20:23], v[80:83], v[144:159]
    s_waitcnt vmcnt(11) lgkmcnt(3)
    ds_read_b128 a[12:15], v227 offset:3072
    v_mfma_f32_32x32x16_bf16 v[160:175], a[24:27], v[80:83], v[160:175]
    ds_read_b128 a[16:19], v227 offset:4096
    v_mfma_f32_32x32x16_bf16 v[128:143], a[28:31], v[84:87], v[128:143]
    s_waitcnt lgkmcnt(3)
    ds_read_b128 a[20:23], v227 offset:5120
    v_mfma_f32_32x32x16_bf16 v[144:159], a[0:3], v[84:87], v[144:159]
    s_barrier
    ds_read_b128 a[24:27], v227 offset:6144
    v_mfma_f32_32x32x16_bf16 v[160:175], a[4:7], v[84:87], v[160:175]
    s_waitcnt vmcnt(10) lgkmcnt(3)
    ds_read_b128 a[28:31], v227 offset:7168
    v_mfma_f32_32x32x16_bf16 v[128:143], a[8:11], v[88:91], v[128:143]
    ds_read_b128 a[0:3], v227 offset:8192
    s_add_u32 m0, s23, 0
    s_add_u32 s24, s22, 163840
    buffer_load_dwordx4 v224, s[8:11], s24 offen offset:0 sc1 lds
    v_mfma_f32_32x32x16_bf16 v[144:159], a[12:15], v[88:91], v[144:159]
    s_waitcnt vmcnt(10) lgkmcnt(3)
    ds_read_b128 a[4:7], v227 offset:9216
    v_add_f32 v236, v208, v210
    v_add_f32 v237, v209, v211
    v_add_f32 v236, v236, v212
    v_add_f32 v237, v237, v213
    v_mfma_f32_32x32x16_bf16 v[160:175], a[16:19], v[88:91], v[160:175]
    ds_read_b128 a[8:11], v227 offset:10240
    buffer_load_dwordx4 v224, s[8:11], s24 offen offset:1024 sc1 lds
    v_add_f32 v236, v236, v214
    v_add_f32 v237, v237, v215
    v_mfma_f32_32x32x16_bf16 v[128:143], a[20:23], v[92:95], v[128:143]
    s_waitcnt lgkmcnt(3)
    ds_read_b128 a[12:15], v227 offset:11264
    v_add_f32 v236, v236, v216
    v_add_f32 v237, v237, v217
    v_add_f32 v236, v236, v218
    v_add_f32 v237, v237, v219
    v_mfma_f32_32x32x16_bf16 v[144:159], a[24:27], v[92:95], v[144:159]
    ds_read_b128 a[16:19], v227 offset:12288
    buffer_load_dwordx4 v224, s[8:11], s24 offen offset:2048 sc1 lds
    v_add_f32 v236, v236, v220
    v_add_f32 v237, v237, v221
    v_mfma_f32_32x32x16_bf16 v[160:175], a[28:31], v[92:95], v[160:175]
    s_waitcnt vmcnt(11) lgkmcnt(3)
    ds_read_b128 a[20:23], v227 offset:13312
    v_add_f32 v236, v236, v222
    v_add_f32 v237, v237, v223
    v_mov_b32 v238, v236
    v_mov_b32 v239, 0x3d000000
    v_mfma_f32_32x32x16_bf16 v[128:143], a[0:3], v[96:99], v[128:143]
    ds_read_b128 a[24:27], v227 offset:14336
    buffer_load_dwordx4 v224, s[8:11], s24 offen offset:3072 sc1 lds
    v_mov_b32 v230, 0x3727c5ac
    v_permlane32_swap_b32 v238, v236
    v_mfma_f32_32x32x16_bf16 v[144:159], a[4:7], v[96:99], v[144:159]
    s_waitcnt vmcnt(11) lgkmcnt(3)
    ds_read_b128 a[28:31], v227 offset:15360
    v_add_f32 v236, v236, v238
    v_mul_f32 v236, 0xbb000000, v236
    v_fma_f32 v208, v208, v239, v236
    v_fma_f32 v210, v210, v239, v236
    v_mfma_f32_32x32x16_bf16 v[160:175], a[8:11], v[96:99], v[160:175]
    ds_read_b128 a[0:3], v227 offset:16384
    s_add_u32 m0, s23, 4096
    s_add_u32 s24, s22, 167936
    buffer_load_dwordx4 v224, s[8:11], s24 offen offset:0 sc1 lds
    v_mfma_f32_32x32x16_bf16 v[128:143], a[12:15], v[100:103], v[128:143]
    s_waitcnt lgkmcnt(3)
    ds_read_b128 a[4:7], v227 offset:17408
    v_fma_f32 v212, v212, v239, v236
    v_fma_f32 v214, v214, v239, v236
    v_fma_f32 v216, v216, v239, v236
    v_fma_f32 v218, v218, v239, v236
    v_mfma_f32_32x32x16_bf16 v[144:159], a[16:19], v[100:103], v[144:159]
    ds_read_b128 a[8:11], v227 offset:18432
    buffer_load_dwordx4 v224, s[8:11], s24 offen offset:1024 sc1 lds
    v_fma_f32 v220, v220, v239, v236
    v_fma_f32 v222, v222, v239, v236
    v_mfma_f32_32x32x16_bf16 v[160:175], a[20:23], v[100:103], v[160:175]
    s_waitcnt vmcnt(12) lgkmcnt(3)
    ds_read_b128 a[12:15], v227 offset:19456
    v_mul_f32 v238, v208, v208
    v_fmac_f32 v238, v210, v210
    v_fmac_f32 v238, v212, v212
    v_fmac_f32 v238, v214, v214
    v_mfma_f32_32x32x16_bf16 v[128:143], a[24:27], v[104:107], v[128:143]
    ds_read_b128 a[16:19], v227 offset:20480
    buffer_load_dwordx4 v224, s[8:11], s24 offen offset:2048 sc1 lds
    v_fmac_f32 v238, v216, v216
    v_fmac_f32 v238, v218, v218
    v_mfma_f32_32x32x16_bf16 v[144:159], a[28:31], v[104:107], v[144:159]
    s_waitcnt vmcnt(12) lgkmcnt(3)
    ds_read_b128 a[20:23], v227 offset:21504
    v_fmac_f32 v238, v220, v220
    v_fmac_f32 v238, v222, v222
    v_fmac_f32 v237, 0x42000000, v238
    v_mov_b32 v238, v237
    v_mfma_f32_32x32x16_bf16 v[160:175], a[0:3], v[104:107], v[160:175]
    ds_read_b128 a[24:27], v227 offset:22528
    buffer_load_dwordx4 v224, s[8:11], s24 offen offset:3072 sc1 lds
    v_cvt_pk_bf16_f32 v216, v236, v236
    v_lshlrev_b32 v239, 16, v216
    v_mfma_f32_32x32x16_bf16 v[128:143], a[4:7], v[108:111], v[128:143]
    s_waitcnt lgkmcnt(3)
    ds_read_b128 a[28:31], v227 offset:23552
    v_permlane32_swap_b32 v238, v237
    v_sub_f32 v236, v236, v239
    v_add_f32 v237, v237, v238
    v_cvt_pk_bf16_f32 v220, v236, v236
    v_mfma_f32_32x32x16_bf16 v[144:159], a[8:11], v[108:111], v[144:159]
    ds_read_b128 a[0:3], v227 offset:24576
    s_add_u32 m0, s23, 32768
    s_add_u32 s24, s22, 196608
    buffer_load_dwordx4 v224, s[8:11], s24 offen offset:0 sc1 lds
    v_mfma_f32_32x32x16_bf16 v[160:175], a[12:15], v[108:111], v[160:175]
    s_waitcnt vmcnt(13) lgkmcnt(3)
    ds_read_b128 a[4:7], v227 offset:25600
    v_fmac_f32 v230, 0x3b000000, v237
    v_rsq_f32 v237, v230
    v_mov_b32 v217, v216
    v_mfma_f32_32x32x16_bf16 v[128:143], a[16:19], v[112:115], v[128:143]
    ds_read_b128 a[8:11], v227 offset:26624
    buffer_load_dwordx4 v224, s[8:11], s24 offen offset:1024 sc1 lds
    v_mov_b32 v221, v220
    v_mov_b32 v218, v216
    v_mfma_f32_32x32x16_bf16 v[144:159], a[20:23], v[112:115], v[144:159]
    s_waitcnt vmcnt(13) lgkmcnt(3)
    ds_read_b128 a[12:15], v227 offset:27648
    v_mov_b32 v222, v220
    v_mov_b32 v219, v216
    v_mov_b32 v223, v220
    v_mul_f32 v229, 0xc0135761, v237
    v_mfma_f32_32x32x16_bf16 v[160:175], a[24:27], v[112:115], v[160:175]
    ds_read_b128 a[16:19], v227 offset:28672
    buffer_load_dwordx4 v224, s[8:11], s24 offen offset:2048 sc1 lds
    v_mul_f32 v238, v237, v237
    v_mul_f32 v238, 0x3d372713, v238
    v_mfma_f32_32x32x16_bf16 v[128:143], a[28:31], v[116:119], v[128:143]
    s_waitcnt lgkmcnt(3)
    ds_read_b128 a[20:23], v227 offset:29696
    v_mul_f32 v228, v229, v238
    v_mfma_f32_32x32x16_bf16 v[144:159], a[0:3], v[116:119], v[144:159]
    ds_read_b128 a[24:27], v227 offset:30720
    buffer_load_dwordx4 v224, s[8:11], s24 offen offset:3072 sc1 lds
    v_mfma_f32_32x32x16_bf16 v[160:175], a[4:7], v[116:119], v[160:175]
    ds_read_b128 a[28:31], v227 offset:31744
    v_mfma_f32_32x32x16_bf16 v[128:143], a[96:99], v[216:219], v[128:143]
    s_add_u32 m0, s23, 36864
    s_add_u32 s24, s22, 200704
    buffer_load_dwordx4 v224, s[8:11], s24 offen offset:0 sc1 lds
    v_mfma_f32_32x32x16_bf16 v[144:159], a[100:103], v[216:219], v[144:159]
    v_mfma_f32_32x32x16_bf16 v[160:175], a[104:107], v[216:219], v[160:175]
    buffer_load_dwordx4 v224, s[8:11], s24 offen offset:1024 sc1 lds
    v_mfma_f32_32x32x16_bf16 v[128:143], a[96:99], v[220:223], v[128:143]
    v_mfma_f32_32x32x16_bf16 v[144:159], a[100:103], v[220:223], v[144:159]
    buffer_load_dwordx4 v224, s[8:11], s24 offen offset:2048 sc1 lds
    v_mfma_f32_32x32x16_bf16 v[160:175], a[104:107], v[220:223], v[160:175]
    s_waitcnt vmcnt(17) lgkmcnt(4)
    v_mfma_f32_32x32x16_bf16 v[128:143], a[8:11], v[120:123], v[128:143]
    ds_read_b128 a[0:3], v225 offset:0
    buffer_load_dwordx4 v224, s[8:11], s24 offen offset:3072 sc1 lds
    v_mfma_f32_32x32x16_bf16 v[144:159], a[12:15], v[120:123], v[144:159]
    s_waitcnt vmcnt(17) lgkmcnt(3)
    ds_read_b128 a[4:7], v225 offset:1024
    v_mfma_f32_32x32x16_bf16 v[160:175], a[16:19], v[120:123], v[160:175]
    ds_read_b128 a[8:11], v225 offset:2048
    s_waitcnt vmcnt(16)
    v_bitop3_b32 v240, v240, v241, s73 bitop3:0x7e
    v_bitop3_b32 v242, v242, v243, s73 bitop3:0x7e
    v_or_b32 v240, v240, v242
    v_cmp_ne_u32 vcc, 0, v240
    s_nop 1
    s_cbranch_vccnz L_poll7_sequential_preLN__compressed_kv_cla__geglu_ffn__prompt_kernel
L_poll7_sequential_preLN__compressed_kv_cla__geglu_ffn__prompt_kernel_ok:
    buffer_load_dwordx4 a[128:131], v224, s[8:11], s62 offen offset:0 sc1
    v_mfma_f32_32x32x16_bf16 v[128:143], a[20:23], v[124:127], v[128:143]
    s_waitcnt lgkmcnt(3)
    ds_read_b128 a[12:15], v225 offset:3072
    v_mfma_f32_32x32x16_bf16 v[144:159], a[24:27], v[124:127], v[144:159]
    ds_read_b128 a[16:19], v225 offset:4096
    buffer_load_dwordx4 a[132:135], v224, s[8:11], s66 offen offset:0 sc1
    v_mfma_f32_32x32x16_bf16 v[160:175], a[28:31], v[124:127], v[160:175]
    ds_read_b128 a[20:23], v225 offset:5120
    v_mfma_f32_32x32x16_bf16 v[176:191], a[108:111], v[216:219], 0
    buffer_load_dwordx4 a[136:139], v224, s[8:11], s62 offen offset:1024 sc1
    v_mul_f32 v208, v128, v128
    v_mul_f32 v209, v129, v129
    v_mul_f32 v210, v130, v130
    v_mul_f32 v211, v131, v131
    v_mfma_f32_32x32x16_bf16 v[176:191], a[108:111], v[220:223], v[176:191]
    s_waitcnt lgkmcnt(4)
    v_mul_f32 v212, v132, v132
    v_mul_f32 v213, v133, v133
    v_mul_f32 v214, v134, v134
    v_mul_f32 v215, v135, v135
    v_fma_f32 v208, v208, v228, v229
    v_fma_f32 v209, v209, v228, v229
    v_mfma_f32_32x32x16_bf16 v[176:191], a[0:3], v[0:3], v[176:191]
    ds_read_b128 a[24:27], v225 offset:6144
    buffer_load_dwordx4 a[140:143], v224, s[8:11], s66 offen offset:1024 sc1
    v_fma_f32 v210, v210, v228, v229
    v_fma_f32 v211, v211, v228, v229
    v_fma_f32 v212, v212, v228, v229
    v_mfma_f32_32x32x16_bf16 v[176:191], a[4:7], v[4:7], v[176:191]
    s_waitcnt lgkmcnt(3)
    ds_read_b128 a[28:31], v225 offset:7168
    v_fma_f32 v213, v213, v228, v229
    v_fma_f32 v214, v214, v228, v229
    v_fma_f32 v215, v215, v228, v229
    v_mul_f32 v208, v208, v128
    v_mul_f32 v209, v209, v129
    v_mfma_f32_32x32x16_bf16 v[176:191], a[8:11], v[8:11], v[176:191]
    ds_read_b128 a[0:3], v225 offset:8192
    buffer_load_dwordx4 a[144:147], v224, s[8:11], s62 offen offset:2048 sc1
    v_mul_f32 v210, v210, v130
    v_mul_f32 v211, v211, v131
    v_mul_f32 v212, v212, v132
    v_mfma_f32_32x32x16_bf16 v[176:191], a[12:15], v[12:15], v[176:191]
    s_waitcnt lgkmcnt(3)
    ds_read_b128 a[4:7], v225 offset:9216
    v_mul_f32 v213, v213, v133
    v_mul_f32 v214, v214, v134
    v_mul_f32 v215, v215, v135
    v_exp_f32 v208, v208
    v_mfma_f32_32x32x16_bf16 v[176:191], a[16:19], v[16:19], v[176:191]
    ds_read_b128 a[8:11], v225 offset:10240
    buffer_load_dwordx4 a[148:151], v224, s[8:11], s66 offen offset:2048 sc1
    v_exp_f32 v209, v209
    v_mfma_f32_32x32x16_bf16 v[176:191], a[20:23], v[20:23], v[176:191]
    s_waitcnt lgkmcnt(3)
    ds_read_b128 a[12:15], v225 offset:11264
    v_exp_f32 v210, v210
    v_exp_f32 v211, v211
    v_mfma_f32_32x32x16_bf16 v[176:191], a[24:27], v[24:27], v[176:191]
    ds_read_b128 a[16:19], v225 offset:12288
    buffer_load_dwordx4 a[152:155], v224, s[8:11], s62 offen offset:3072 sc1
    s_add_u32 s62, s62, 0x1c00
    v_exp_f32 v212, v212
    v_mfma_f32_32x32x16_bf16 v[176:191], a[28:31], v[28:31], v[176:191]
    s_waitcnt lgkmcnt(3)
    ds_read_b128 a[20:23], v225 offset:13312
    v_exp_f32 v213, v213
    v_exp_f32 v214, v214
    v_mfma_f32_32x32x16_bf16 v[176:191], a[0:3], v[32:35], v[176:191]
    ds_read_b128 a[24:27], v225 offset:14336
    buffer_load_dwordx4 a[156:159], v224, s[8:11], s66 offen offset:3072 sc1
    s_add_u32 s66, s66, 0x1c00
    v_exp_f32 v215, v215
    v_mfma_f32_32x32x16_bf16 v[176:191], a[4:7], v[36:39], v[176:191]
    s_waitcnt lgkmcnt(3)
    ds_read_b128 a[28:31], v225 offset:15360
    v_mul_f32 v128, v128, v136
    v_mul_f32 v129, v129, v137
    v_mul_f32 v130, v130, v138
    v_mul_f32 v131, v131, v139
    v_mul_f32 v132, v132, v140
    v_mfma_f32_32x32x16_bf16 v[176:191], a[8:11], v[40:43], v[176:191]
    ds_read_b128 a[0:3], v225 offset:16384
    buffer_load_dwordx4 a[160:163], v224, s[8:11], s62 offen offset:0 sc1
    v_mul_f32 v133, v133, v141
    v_mul_f32 v134, v134, v142
    v_mul_f32 v135, v135, v143
    v_mfma_f32_32x32x16_bf16 v[176:191], a[12:15], v[44:47], v[176:191]
    s_waitcnt lgkmcnt(3)
    ds_read_b128 a[4:7], v225 offset:17408
    v_fma_f32 v208, v208, v230, v230
    v_fma_f32 v209, v209, v230, v230
    v_fma_f32 v210, v210, v230, v230
    v_fma_f32 v211, v211, v230, v230
    v_fma_f32 v212, v212, v230, v230
    v_mfma_f32_32x32x16_bf16 v[176:191], a[16:19], v[48:51], v[176:191]
    ds_read_b128 a[8:11], v225 offset:18432
    buffer_load_dwordx4 a[164:167], v224, s[8:11], s66 offen offset:0 sc1
    v_fma_f32 v213, v213, v230, v230
    v_fma_f32 v214, v214, v230, v230
    v_fma_f32 v215, v215, v230, v230
    v_mfma_f32_32x32x16_bf16 v[176:191], a[20:23], v[52:55], v[176:191]
    s_waitcnt lgkmcnt(3)
    ds_read_b128 a[12:15], v225 offset:19456
    v_rcp_f32 v208, v208
    v_rcp_f32 v209, v209
    v_mfma_f32_32x32x16_bf16 v[176:191], a[24:27], v[56:59], v[176:191]
    ds_read_b128 a[16:19], v225 offset:20480
    buffer_load_dwordx4 a[168:171], v224, s[8:11], s62 offen offset:1024 sc1
    v_rcp_f32 v210, v210
    v_mfma_f32_32x32x16_bf16 v[176:191], a[28:31], v[60:63], v[176:191]
    s_waitcnt lgkmcnt(3)
    ds_read_b128 a[20:23], v225 offset:21504
    v_rcp_f32 v211, v211
    v_rcp_f32 v212, v212
    v_mfma_f32_32x32x16_bf16 v[176:191], a[0:3], v[64:67], v[176:191]
    ds_read_b128 a[24:27], v225 offset:22528
    buffer_load_dwordx4 a[172:175], v224, s[8:11], s66 offen offset:1024 sc1
    v_rcp_f32 v213, v213
    v_mfma_f32_32x32x16_bf16 v[176:191], a[4:7], v[68:71], v[176:191]
    s_waitcnt lgkmcnt(3)
    ds_read_b128 a[28:31], v225 offset:23552
    v_rcp_f32 v214, v214
    v_rcp_f32 v215, v215
    v_mul_f32 v128, v128, v208
    v_mfma_f32_32x32x16_bf16 v[176:191], a[8:11], v[72:75], v[176:191]
    ds_read_b128 a[0:3], v225 offset:24576
    buffer_load_dwordx4 a[176:179], v224, s[8:11], s62 offen offset:2048 sc1
    v_mul_f32 v129, v129, v209
    v_mul_f32 v130, v130, v210
    v_mul_f32 v131, v131, v211
    v_mfma_f32_32x32x16_bf16 v[176:191], a[12:15], v[76:79], v[176:191]
    s_waitcnt lgkmcnt(3)
    ds_read_b128 a[4:7], v225 offset:25600
    v_mul_f32 v132, v132, v212
    v_mul_f32 v133, v133, v213
    v_mul_f32 v134, v134, v214
    v_mul_f32 v135, v135, v215
    v_cvt_pk_bf16_f32 v136, v128, v129
    v_mfma_f32_32x32x16_bf16 v[176:191], a[16:19], v[80:83], v[176:191]
    ds_read_b128 a[8:11], v225 offset:26624
    buffer_load_dwordx4 a[180:183], v224, s[8:11], s66 offen offset:2048 sc1
    v_cvt_pk_bf16_f32 v137, v130, v131
    v_cvt_pk_bf16_f32 v138, v132, v133
    v_cvt_pk_bf16_f32 v139, v134, v135
    v_mfma_f32_32x32x16_bf16 v[176:191], a[20:23], v[84:87], v[176:191]
    s_waitcnt lgkmcnt(3)
    ds_read_b128 a[12:15], v225 offset:27648
    buffer_store_dwordx4 v[136:139], v224, s[8:11], s26 offen offset:0 sc1
    v_mul_f32 v208, v144, v144
    v_mul_f32 v209, v145, v145
    v_mul_f32 v210, v146, v146
    v_mfma_f32_32x32x16_bf16 v[176:191], a[24:27], v[88:91], v[176:191]
    ds_read_b128 a[16:19], v225 offset:28672
    buffer_load_dwordx4 a[184:187], v224, s[8:11], s62 offen offset:3072 sc1
    s_add_u32 s62, s62, 0x1c00
    v_mul_f32 v211, v147, v147
    v_mul_f32 v212, v148, v148
    v_mfma_f32_32x32x16_bf16 v[176:191], a[28:31], v[92:95], v[176:191]
    s_waitcnt lgkmcnt(3)
    ds_read_b128 a[20:23], v225 offset:29696
    v_mul_f32 v213, v149, v149
    v_mul_f32 v214, v150, v150
    v_mul_f32 v215, v151, v151
    v_fma_f32 v208, v208, v228, v229
    v_fma_f32 v209, v209, v228, v229
    v_mfma_f32_32x32x16_bf16 v[176:191], a[0:3], v[96:99], v[176:191]
    ds_read_b128 a[24:27], v225 offset:30720
    buffer_load_dwordx4 a[188:191], v224, s[8:11], s66 offen offset:3072 sc1
    s_add_u32 s66, s66, 0x1c00
    v_fma_f32 v210, v210, v228, v229
    v_fma_f32 v211, v211, v228, v229
    v_mfma_f32_32x32x16_bf16 v[176:191], a[4:7], v[100:103], v[176:191]
    s_waitcnt lgkmcnt(3)
    ds_read_b128 a[28:31], v225 offset:31744
    v_fma_f32 v212, v212, v228, v229
    v_fma_f32 v213, v213, v228, v229
    v_fma_f32 v214, v214, v228, v229
    v_fma_f32 v215, v215, v228, v229
    v_mul_f32 v208, v208, v144
    v_mfma_f32_32x32x16_bf16 v[176:191], a[8:11], v[104:107], v[176:191]
    ds_read_b128 a[0:3], v225 offset:32768
    buffer_load_dwordx4 a[192:195], v224, s[8:11], s62 offen offset:0 sc1
    v_mul_f32 v209, v209, v145
    v_mul_f32 v210, v210, v146
    v_mul_f32 v211, v211, v147
    v_mfma_f32_32x32x16_bf16 v[176:191], a[12:15], v[108:111], v[176:191]
    s_waitcnt lgkmcnt(3)
    ds_read_b128 a[4:7], v225 offset:33792
    v_mul_f32 v212, v212, v148
    v_mul_f32 v213, v213, v149
    v_mul_f32 v214, v214, v150
    v_mul_f32 v215, v215, v151
    v_mfma_f32_32x32x16_bf16 v[176:191], a[16:19], v[112:115], v[176:191]
    ds_read_b128 a[8:11], v225 offset:34816
    buffer_load_dwordx4 a[196:199], v224, s[8:11], s66 offen offset:0 sc1
    v_exp_f32 v208, v208
    v_mfma_f32_32x32x16_bf16 v[176:191], a[20:23], v[116:119], v[176:191]
    s_waitcnt lgkmcnt(3)
    ds_read_b128 a[12:15], v225 offset:35840
    v_exp_f32 v209, v209
    v_exp_f32 v210, v210
    v_mfma_f32_32x32x16_bf16 v[176:191], a[24:27], v[120:123], v[176:191]
    ds_read_b128 a[16:19], v225 offset:36864
    buffer_load_dwordx4 a[200:203], v224, s[8:11], s62 offen offset:1024 sc1
    v_exp_f32 v211, v211
    v_mfma_f32_32x32x16_bf16 v[176:191], a[28:31], v[124:127], v[176:191]
    ds_read_b128 a[20:23], v225 offset:37888
    v_exp_f32 v212, v212
    v_exp_f32 v213, v213
    v_mfma_f32_32x32x16_bf16 v[192:207], a[112:115], v[216:219], 0
    buffer_load_dwordx4 a[204:207], v224, s[8:11], s66 offen offset:1024 sc1
    v_exp_f32 v214, v214
    v_exp_f32 v215, v215
    v_mfma_f32_32x32x16_bf16 v[192:207], a[112:115], v[220:223], v[192:207]
    s_waitcnt lgkmcnt(4)
    v_mul_f32 v144, v144, v152
    v_mul_f32 v145, v145, v153
    v_mul_f32 v146, v146, v154
    v_mul_f32 v147, v147, v155
    v_mul_f32 v148, v148, v156
    v_mul_f32 v149, v149, v157
    v_mfma_f32_32x32x16_bf16 v[192:207], a[0:3], v[0:3], v[192:207]
    ds_read_b128 a[24:27], v225 offset:38912
    buffer_load_dwordx4 a[208:211], v224, s[8:11], s62 offen offset:2048 sc1
    v_mul_f32 v150, v150, v158
    v_mul_f32 v151, v151, v159
    v_fma_f32 v208, v208, v230, v230
    v_mfma_f32_32x32x16_bf16 v[192:207], a[4:7], v[4:7], v[192:207]
    s_waitcnt lgkmcnt(3)
    ds_read_b128 a[28:31], v225 offset:39936
    v_fma_f32 v209, v209, v230, v230
    v_fma_f32 v210, v210, v230, v230
    v_fma_f32 v211, v211, v230, v230
    v_fma_f32 v212, v212, v230, v230
    v_fma_f32 v213, v213, v230, v230
    v_mfma_f32_32x32x16_bf16 v[192:207], a[8:11], v[8:11], v[192:207]
    s_lshl_b32 s3, s28, 5
    ds_read_b128 a[0:3], v225 offset:40960
    buffer_load_dwordx4 a[212:215], v224, s[8:11], s66 offen offset:2048 sc1
    v_fma_f32 v214, v214, v230, v230
    v_fma_f32 v215, v215, v230, v230
    v_mfma_f32_32x32x16_bf16 v[192:207], a[12:15], v[12:15], v[192:207]
    s_waitcnt lgkmcnt(3)
    ds_read_b128 a[4:7], v225 offset:41984
    v_rcp_f32 v208, v208
    v_rcp_f32 v209, v209
    v_mfma_f32_32x32x16_bf16 v[192:207], a[16:19], v[16:19], v[192:207]
    s_add_u32 s3, s3, s21
    ds_read_b128 a[8:11], v225 offset:43008
    buffer_load_dwordx4 a[216:219], v224, s[8:11], s62 offen offset:3072 sc1
    s_add_u32 s62, s62, 0x1c00
    v_rcp_f32 v210, v210
    v_mfma_f32_32x32x16_bf16 v[192:207], a[20:23], v[20:23], v[192:207]
    s_waitcnt lgkmcnt(3)
    ds_read_b128 a[12:15], v225 offset:44032
    v_rcp_f32 v211, v211
    v_rcp_f32 v212, v212
    v_mfma_f32_32x32x16_bf16 v[192:207], a[24:27], v[24:27], v[192:207]
    s_lshl_b32 s3, s3, 7
    ds_read_b128 a[16:19], v225 offset:45056
    buffer_load_dwordx4 a[220:223], v224, s[8:11], s66 offen offset:3072 sc1
    s_add_u32 s66, s66, 0x1c00
    v_rcp_f32 v213, v213
    v_mfma_f32_32x32x16_bf16 v[192:207], a[28:31], v[28:31], v[192:207]
    s_waitcnt lgkmcnt(3)
    ds_read_b128 a[20:23], v225 offset:46080
    v_rcp_f32 v214, v214
    v_rcp_f32 v215, v215
    v_mul_f32 v144, v144, v208
    v_mfma_f32_32x32x16_bf16 v[192:207], a[0:3], v[32:35], v[192:207]
    s_add_u32 s3, s3, 0x4e30000
    ds_read_b128 a[24:27], v225 offset:47104
    buffer_load_dwordx4 a[224:227], v224, s[8:11], s62 offen offset:0 sc1
    v_mul_f32 v145, v145, v209
    v_mul_f32 v146, v146, v210
    v_mul_f32 v147, v147, v211
    v_mfma_f32_32x32x16_bf16 v[192:207], a[4:7], v[36:39], v[192:207]
    s_waitcnt lgkmcnt(3)
    ds_read_b128 a[28:31], v225 offset:48128
    v_mul_f32 v148, v148, v212
    v_mul_f32 v149, v149, v213
    v_mul_f32 v150, v150, v214
    v_mul_f32 v151, v151, v215
    v_cvt_pk_bf16_f32 v152, v144, v145
    v_mfma_f32_32x32x16_bf16 v[192:207], a[8:11], v[40:43], v[192:207]
    s_add_u32 s4, s3, 2048
    ds_read_b128 a[0:3], v225 offset:49152
    buffer_load_dwordx4 a[228:231], v224, s[8:11], s66 offen offset:0 sc1
    v_cvt_pk_bf16_f32 v153, v146, v147
    v_cvt_pk_bf16_f32 v154, v148, v149
    v_cvt_pk_bf16_f32 v155, v150, v151
    v_mfma_f32_32x32x16_bf16 v[192:207], a[12:15], v[44:47], v[192:207]
    s_waitcnt lgkmcnt(3)
    ds_read_b128 a[4:7], v225 offset:50176
    buffer_store_dwordx4 v[152:155], v224, s[8:11], s26 offen offset:1024 sc1
    v_mul_f32 v208, v160, v160
    v_mul_f32 v209, v161, v161
    v_mul_f32 v210, v162, v162
    v_mfma_f32_32x32x16_bf16 v[192:207], a[16:19], v[48:51], v[192:207]
    s_lshr_b32 s6, s68, 1
    ds_read_b128 a[8:11], v225 offset:51200
    buffer_load_dwordx4 a[232:235], v224, s[8:11], s62 offen offset:1024 sc1
    v_mul_f32 v211, v163, v163
    v_mul_f32 v212, v164, v164
    v_mul_f32 v213, v165, v165
    v_mfma_f32_32x32x16_bf16 v[192:207], a[20:23], v[52:55], v[192:207]
    s_waitcnt lgkmcnt(3)
    ds_read_b128 a[12:15], v225 offset:52224
    v_mul_f32 v214, v166, v166
    v_mul_f32 v215, v167, v167
    v_fma_f32 v208, v208, v228, v229
    v_fma_f32 v209, v209, v228, v229
    v_fma_f32 v210, v210, v228, v229
    v_mfma_f32_32x32x16_bf16 v[192:207], a[24:27], v[56:59], v[192:207]
    ds_read_b128 a[16:19], v225 offset:53248
    buffer_load_dwordx4 a[236:239], v224, s[8:11], s66 offen offset:1024 sc1
    v_fma_f32 v211, v211, v228, v229
    v_fma_f32 v212, v212, v228, v229
    v_fma_f32 v213, v213, v228, v229
    v_mfma_f32_32x32x16_bf16 v[192:207], a[28:31], v[60:63], v[192:207]
    s_waitcnt lgkmcnt(3)
    s_lshl_b32 s6, s6, 12
    ds_read_b128 a[20:23], v225 offset:54272
    v_fma_f32 v214, v214, v228, v229
    v_fma_f32 v215, v215, v228, v229
    v_mul_f32 v208, v208, v160
    v_mul_f32 v209, v209, v161
    v_mul_f32 v210, v210, v162
    v_mfma_f32_32x32x16_bf16 v[192:207], a[0:3], v[64:67], v[192:207]
    s_add_u32 s6, s6, 0x4e30000
    ds_read_b128 a[24:27], v225 offset:55296
    buffer_load_dwordx4 a[240:243], v224, s[8:11], s62 offen offset:2048 sc1
    v_mul_f32 v211, v211, v163
    v_mul_f32 v212, v212, v164
    v_mul_f32 v213, v213, v165
    v_mfma_f32_32x32x16_bf16 v[192:207], a[4:7], v[68:71], v[192:207]
    s_waitcnt lgkmcnt(3)
    ds_read_b128 a[28:31], v225 offset:56320
    v_mul_f32 v214, v214, v166
    v_mul_f32 v215, v215, v167
    v_exp_f32 v208, v208
    v_mfma_f32_32x32x16_bf16 v[192:207], a[8:11], v[72:75], v[192:207]
    s_add_u32 s7, s6, 2048
    ds_read_b128 a[0:3], v225 offset:57344
    buffer_load_dwordx4 a[244:247], v224, s[8:11], s66 offen offset:2048 sc1
    v_exp_f32 v209, v209
    v_mfma_f32_32x32x16_bf16 v[192:207], a[12:15], v[76:79], v[192:207]
    s_waitcnt lgkmcnt(3)
    ds_read_b128 a[4:7], v225 offset:58368
    v_exp_f32 v210, v210
    v_exp_f32 v211, v211
    v_mfma_f32_32x32x16_bf16 v[192:207], a[16:19], v[80:83], v[192:207]
    s_add_u32 s5, s3, 131072
    ds_read_b128 a[8:11], v225 offset:59392
    buffer_load_dwordx4 a[248:251], v224, s[8:11], s62 offen offset:3072 sc1
    s_add_u32 s62, s62, 0xffffac00
    v_exp_f32 v212, v212
    v_mfma_f32_32x32x16_bf16 v[192:207], a[20:23], v[84:87], v[192:207]
    s_waitcnt lgkmcnt(3)
    ds_read_b128 a[12:15], v225 offset:60416
    v_exp_f32 v213, v213
    v_exp_f32 v214, v214
    v_mfma_f32_32x32x16_bf16 v[192:207], a[24:27], v[88:91], v[192:207]
    s_add_u32 s31, s6, 131072
    ds_read_b128 a[16:19], v225 offset:61440
    buffer_load_dwordx4 a[252:255], v224, s[8:11], s66 offen offset:3072 sc1
    s_add_u32 s66, s66, 0xffffac00
    v_exp_f32 v215, v215
    v_mfma_f32_32x32x16_bf16 v[192:207], a[28:31], v[92:95], v[192:207]
    s_waitcnt lgkmcnt(3)
    ds_read_b128 a[20:23], v225 offset:62464
    v_mul_f32 v160, v160, v168
    v_mul_f32 v161, v161, v169
    v_mul_f32 v162, v162, v170
    v_mul_f32 v163, v163, v171
    v_mul_f32 v164, v164, v172
    v_mfma_f32_32x32x16_bf16 v[192:207], a[0:3], v[96:99], v[192:207]
    s_waitcnt vmcnt(34)
    s_barrier
    ds_read_b128 a[24:27], v225 offset:63488
    buffer_load_dwordx4 a[32:35], v252, s[8:11], s62 offen offset:0 sc1
    v_mfma_f32_32x32x16_bf16 v[192:207], a[4:7], v[100:103], v[192:207]
    s_waitcnt lgkmcnt(3)
    ds_read_b128 a[28:31], v225 offset:64512
    v_mul_f32 v165, v165, v173
    v_mul_f32 v166, v166, v174
    v_mul_f32 v167, v167, v175
    v_fma_f32 v208, v208, v230, v230
    v_fma_f32 v209, v209, v230, v230
    v_mfma_f32_32x32x16_bf16 v[192:207], a[8:11], v[104:107], v[192:207]
    ds_read_b128 a[0:3], v226 offset:0
    buffer_load_dwordx4 a[36:39], v252, s[8:11], s66 offen offset:0 sc1
    v_fma_f32 v210, v210, v230, v230
    v_fma_f32 v211, v211, v230, v230
    v_fma_f32 v212, v212, v230, v230
    v_mfma_f32_32x32x16_bf16 v[192:207], a[12:15], v[108:111], v[192:207]
    s_waitcnt lgkmcnt(3)
    ds_read_b128 a[4:7], v226 offset:1024
    v_fma_f32 v213, v213, v230, v230
    v_fma_f32 v214, v214, v230, v230
    v_fma_f32 v215, v215, v230, v230
    v_rcp_f32 v208, v208
    v_mfma_f32_32x32x16_bf16 v[192:207], a[16:19], v[112:115], v[192:207]
    ds_read_b128 a[8:11], v226 offset:2048
    buffer_load_dwordx4 a[40:43], v252, s[8:11], s62 offen offset:1024 sc1
    v_rcp_f32 v209, v209
    v_mfma_f32_32x32x16_bf16 v[192:207], a[20:23], v[116:119], v[192:207]
    s_waitcnt lgkmcnt(3)
    ds_read_b128 a[12:15], v226 offset:3072
    v_rcp_f32 v210, v210
    v_rcp_f32 v211, v211
    v_mfma_f32_32x32x16_bf16 v[192:207], a[24:27], v[120:123], v[192:207]
    ds_read_b128 a[16:19], v226 offset:4096
    buffer_load_dwordx4 a[44:47], v252, s[8:11], s66 offen offset:1024 sc1
    v_rcp_f32 v212, v212
    v_mfma_f32_32x32x16_bf16 v[192:207], a[28:31], v[124:127], v[192:207]
    ds_read_b128 a[20:23], v226 offset:5120
    v_rcp_f32 v213, v213
    v_rcp_f32 v214, v214
    v_mfma_f32_32x32x16_bf16 v[128:143], a[116:119], v[216:219], 0
    buffer_load_dwordx4 a[48:51], v252, s[8:11], s62 offen offset:2048 sc1
    s_add_u32 s62, s62, 0x1c00
    v_rcp_f32 v215, v215
    v_mul_f32 v160, v160, v208
    v_mfma_f32_32x32x16_bf16 v[128:143], a[116:119], v[220:223], v[128:143]
    s_waitcnt lgkmcnt(4)
    v_mul_f32 v161, v161, v209
    v_mul_f32 v162, v162, v210
    v_mul_f32 v163, v163, v211
    v_mul_f32 v164, v164, v212
    v_mul_f32 v165, v165, v213
    v_mul_f32 v166, v166, v214
    v_mfma_f32_32x32x16_bf16 v[128:143], a[0:3], v[0:3], v[128:143]
    ds_read_b128 a[24:27], v226 offset:6144
    buffer_load_dwordx4 a[52:55], v252, s[8:11], s66 offen offset:2048 sc1
    s_add_u32 s66, s66, 0x1c00
    v_mul_f32 v167, v167, v215
    v_cvt_pk_bf16_f32 v168, v160, v161
    v_mfma_f32_32x32x16_bf16 v[128:143], a[4:7], v[4:7], v[128:143]
    s_waitcnt lgkmcnt(3)
    ds_read_b128 a[28:31], v226 offset:7168
    v_cvt_pk_bf16_f32 v169, v162, v163
    v_cvt_pk_bf16_f32 v170, v164, v165
    v_cvt_pk_bf16_f32 v171, v166, v167
    v_mfma_f32_32x32x16_bf16 v[128:143], a[8:11], v[8:11], v[128:143]
    ds_read_b128 a[0:3], v226 offset:8192
    buffer_load_dwordx4 a[56:59], v252, s[8:11], s62 offen offset:0 sc1
    buffer_store_dwordx4 v[168:171], v224, s[8:11], s26 offen offset:2048 sc1
    v_mul_f32 v208, v176, v176
    v_mfma_f32_32x32x16_bf16 v[128:143], a[12:15], v[12:15], v[128:143]
    s_waitcnt lgkmcnt(3)
    ds_read_b128 a[4:7], v226 offset:9216
    v_mul_f32 v209, v177, v177
    v_mul_f32 v210, v178, v178
    v_mul_f32 v211, v179, v179
    v_mul_f32 v212, v180, v180
    v_mul_f32 v213, v181, v181
    v_mfma_f32_32x32x16_bf16 v[128:143], a[16:19], v[16:19], v[128:143]
    ds_read_b128 a[8:11], v226 offset:10240
    buffer_load_dwordx4 a[60:63], v252, s[8:11], s66 offen offset:0 sc1
    v_mul_f32 v214, v182, v182
    v_mul_f32 v215, v183, v183
    v_fma_f32 v208, v208, v228, v229
    v_mfma_f32_32x32x16_bf16 v[128:143], a[20:23], v[20:23], v[128:143]
    s_waitcnt lgkmcnt(3)
    ds_read_b128 a[12:15], v226 offset:11264
    v_fma_f32 v209, v209, v228, v229
    v_fma_f32 v210, v210, v228, v229
    v_fma_f32 v211, v211, v228, v229
    v_fma_f32 v212, v212, v228, v229
    v_fma_f32 v213, v213, v228, v229
    v_mfma_f32_32x32x16_bf16 v[128:143], a[24:27], v[24:27], v[128:143]
    ds_read_b128 a[16:19], v226 offset:12288
    buffer_load_dwordx4 a[64:67], v252, s[8:11], s62 offen offset:1024 sc1
    v_fma_f32 v214, v214, v228, v229
    v_fma_f32 v215, v215, v228, v229
    v_mul_f32 v208, v208, v176
    v_mfma_f32_32x32x16_bf16 v[128:143], a[28:31], v[28:31], v[128:143]
    s_waitcnt lgkmcnt(3)
    ds_read_b128 a[20:23], v226 offset:13312
    v_mul_f32 v209, v209, v177
    v_mul_f32 v210, v210, v178
    v_mul_f32 v211, v211, v179
    v_mul_f32 v212, v212, v180
    v_mul_f32 v213, v213, v181
    v_mfma_f32_32x32x16_bf16 v[128:143], a[0:3], v[32:35], v[128:143]
    ds_read_b128 a[24:27], v226 offset:14336
    buffer_load_dwordx4 a[68:71], v252, s[8:11], s66 offen offset:1024 sc1
    v_mul_f32 v214, v214, v182
    v_mul_f32 v215, v215, v183
    v_mfma_f32_32x32x16_bf16 v[128:143], a[4:7], v[36:39], v[128:143]
    s_waitcnt lgkmcnt(3)
    ds_read_b128 a[28:31], v226 offset:15360
    v_exp_f32 v208, v208
    v_exp_f32 v209, v209
    v_mfma_f32_32x32x16_bf16 v[128:143], a[8:11], v[40:43], v[128:143]
    ds_read_b128 a[0:3], v226 offset:16384
    buffer_load_dwordx4 a[72:75], v252, s[8:11], s62 offen offset:2048 sc1
    s_add_u32 s62, s62, 0x1c00
    v_exp_f32 v210, v210
    v_mfma_f32_32x32x16_bf16 v[128:143], a[12:15], v[44:47], v[128:143]
    s_waitcnt lgkmcnt(3)
    ds_read_b128 a[4:7], v226 offset:17408
    v_exp_f32 v211, v211
    v_exp_f32 v212, v212
    v_mfma_f32_32x32x16_bf16 v[128:143], a[16:19], v[48:51], v[128:143]
    ds_read_b128 a[8:11], v226 offset:18432
    buffer_load_dwordx4 a[76:79], v252, s[8:11], s66 offen offset:2048 sc1
    s_add_u32 s66, s66, 0x1c00
    v_exp_f32 v213, v213
    v_mfma_f32_32x32x16_bf16 v[128:143], a[20:23], v[52:55], v[128:143]
    s_waitcnt lgkmcnt(3)
    ds_read_b128 a[12:15], v226 offset:19456
    v_exp_f32 v214, v214
    v_exp_f32 v215, v215
    v_mul_f32 v176, v176, v184
    v_mfma_f32_32x32x16_bf16 v[128:143], a[24:27], v[56:59], v[128:143]
    ds_read_b128 a[16:19], v226 offset:20480
    buffer_load_dwordx4 a[80:83], v252, s[8:11], s62 offen offset:0 sc1
    v_mul_f32 v177, v177, v185
    v_mul_f32 v178, v178, v186
    v_mul_f32 v179, v179, v187
    v_mfma_f32_32x32x16_bf16 v[128:143], a[28:31], v[60:63], v[128:143]
    s_waitcnt lgkmcnt(3)
    ds_read_b128 a[20:23], v226 offset:21504
    v_mul_f32 v180, v180, v188
    v_mul_f32 v181, v181, v189
    v_mul_f32 v182, v182, v190
    v_mul_f32 v183, v183, v191
    v_fma_f32 v208, v208, v230, v230
    v_mfma_f32_32x32x16_bf16 v[128:143], a[0:3], v[64:67], v[128:143]
    ds_read_b128 a[24:27], v226 offset:22528
    buffer_load_dwordx4 a[84:87], v252, s[8:11], s66 offen offset:0 sc1
    v_fma_f32 v209, v209, v230, v230
    v_fma_f32 v210, v210, v230, v230
    v_fma_f32 v211, v211, v230, v230
    v_mfma_f32_32x32x16_bf16 v[128:143], a[4:7], v[68:71], v[128:143]
    s_waitcnt lgkmcnt(3)
    ds_read_b128 a[28:31], v226 offset:23552
    v_fma_f32 v212, v212, v230, v230
    v_fma_f32 v213, v213, v230, v230
    v_fma_f32 v214, v214, v230, v230
    v_fma_f32 v215, v215, v230, v230
    v_mfma_f32_32x32x16_bf16 v[128:143], a[8:11], v[72:75], v[128:143]
    ds_read_b128 a[0:3], v226 offset:24576
    buffer_load_dwordx4 a[88:91], v252, s[8:11], s62 offen offset:1024 sc1
    v_rcp_f32 v208, v208
    v_mfma_f32_32x32x16_bf16 v[128:143], a[12:15], v[76:79], v[128:143]
    s_waitcnt lgkmcnt(3)
    ds_read_b128 a[4:7], v226 offset:25600
    v_rcp_f32 v209, v209
    v_rcp_f32 v210, v210
    v_mfma_f32_32x32x16_bf16 v[128:143], a[16:19], v[80:83], v[128:143]
    ds_read_b128 a[8:11], v226 offset:26624
    buffer_load_dwordx4 a[92:95], v252, s[8:11], s66 offen offset:1024 sc1
    v_rcp_f32 v211, v211
    v_mfma_f32_32x32x16_bf16 v[128:143], a[20:23], v[84:87], v[128:143]
    s_waitcnt lgkmcnt(3)
    ds_read_b128 a[12:15], v226 offset:27648
    v_rcp_f32 v212, v212
    v_rcp_f32 v213, v213
    v_mfma_f32_32x32x16_bf16 v[128:143], a[24:27], v[88:91], v[128:143]
    ds_read_b128 a[16:19], v226 offset:28672
    v_rcp_f32 v214, v214
    v_rcp_f32 v215, v215
    v_mul_f32 v176, v176, v208
    v_mfma_f32_32x32x16_bf16 v[128:143], a[28:31], v[92:95], v[128:143]
    s_waitcnt lgkmcnt(3)
    ds_read_b128 a[20:23], v226 offset:29696
    v_mul_f32 v177, v177, v209
    v_mul_f32 v178, v178, v210
    v_mul_f32 v179, v179, v211
    v_mul_f32 v180, v180, v212
    v_mul_f32 v181, v181, v213
    v_mfma_f32_32x32x16_bf16 v[128:143], a[0:3], v[96:99], v[128:143]
    ds_read_b128 a[24:27], v226 offset:30720
    v_mul_f32 v182, v182, v214
    v_mul_f32 v183, v183, v215
    v_cvt_pk_bf16_f32 v184, v176, v177
    v_cvt_pk_bf16_f32 v185, v178, v179
    v_cvt_pk_bf16_f32 v186, v180, v181
    v_mfma_f32_32x32x16_bf16 v[128:143], a[4:7], v[100:103], v[128:143]
    s_waitcnt lgkmcnt(3)
    ds_read_b128 a[28:31], v226 offset:31744
    v_cvt_pk_bf16_f32 v187, v182, v183
    v_mfma_f32_32x32x16_bf16 v[128:143], a[8:11], v[104:107], v[128:143]
    ds_read_b128 a[0:3], v226 offset:32768
    buffer_store_dwordx4 v[184:187], v224, s[8:11], s26 offen offset:3072 sc1
    v_mul_f32 v208, v192, v192
    v_mul_f32 v209, v193, v193
    v_mul_f32 v210, v194, v194
    v_mfma_f32_32x32x16_bf16 v[128:143], a[12:15], v[108:111], v[128:143]
    s_waitcnt lgkmcnt(3)
    ds_read_b128 a[4:7], v226 offset:33792
    v_mul_f32 v211, v195, v195
    v_mul_f32 v212, v196, v196
    v_mul_f32 v213, v197, v197
    v_mul_f32 v214, v198, v198
    v_mul_f32 v215, v199, v199
    v_mfma_f32_32x32x16_bf16 v[128:143], a[16:19], v[112:115], v[128:143]
    ds_read_b128 a[8:11], v226 offset:34816
    v_fma_f32 v208, v208, v228, v229
    v_fma_f32 v209, v209, v228, v229
    v_fma_f32 v210, v210, v228, v229
    v_fma_f32 v211, v211, v228, v229
    v_fma_f32 v212, v212, v228, v229
    v_mfma_f32_32x32x16_bf16 v[128:143], a[20:23], v[116:119], v[128:143]
    s_waitcnt lgkmcnt(3)
    ds_read_b128 a[12:15], v226 offset:35840
    v_fma_f32 v213, v213, v228, v229
    v_fma_f32 v214, v214, v228, v229
    v_fma_f32 v215, v215, v228, v229
    v_mul_f32 v208, v208, v192
    v_mul_f32 v209, v209, v193
    v_mfma_f32_32x32x16_bf16 v[128:143], a[24:27], v[120:123], v[128:143]
    ds_read_b128 a[16:19], v226 offset:36864
    v_mul_f32 v210, v210, v194
    v_mul_f32 v211, v211, v195
    v_mul_f32 v212, v212, v196
    v_mul_f32 v213, v213, v197
    v_mul_f32 v214, v214, v198
    v_mfma_f32_32x32x16_bf16 v[128:143], a[28:31], v[124:127], v[128:143]
    ds_read_b128 a[20:23], v226 offset:37888
    v_mul_f32 v215, v215, v199
    v_exp_f32 v208, v208
    v_exp_f32 v209, v209
    v_mfma_f32_32x32x16_bf16 v[144:159], a[120:123], v[216:219], 0
    v_exp_f32 v210, v210
    v_exp_f32 v211, v211
    v_exp_f32 v212, v212
    v_mfma_f32_32x32x16_bf16 v[144:159], a[120:123], v[220:223], v[144:159]
    s_waitcnt lgkmcnt(4)
    v_exp_f32 v213, v213
    v_exp_f32 v214, v214
    v_exp_f32 v215, v215
    v_mfma_f32_32x32x16_bf16 v[144:159], a[0:3], v[0:3], v[144:159]
    ds_read_b128 a[24:27], v226 offset:38912
    v_mul_f32 v192, v192, v200
    v_mul_f32 v193, v193, v201
    v_mul_f32 v194, v194, v202
    v_mul_f32 v195, v195, v203
    v_mul_f32 v196, v196, v204
    v_mfma_f32_32x32x16_bf16 v[144:159], a[4:7], v[4:7], v[144:159]
    s_waitcnt lgkmcnt(3)
    ds_read_b128 a[28:31], v226 offset:39936
    v_mul_f32 v197, v197, v205
    v_mul_f32 v198, v198, v206
    v_mul_f32 v199, v199, v207
    v_fma_f32 v208, v208, v230, v230
    v_fma_f32 v209, v209, v230, v230
    v_mfma_f32_32x32x16_bf16 v[144:159], a[8:11], v[8:11], v[144:159]
    ds_read_b128 a[0:3], v226 offset:40960
    v_fma_f32 v210, v210, v230, v230
    v_fma_f32 v211, v211, v230, v230
    v_fma_f32 v212, v212, v230, v230
    v_fma_f32 v213, v213, v230, v230
    v_fma_f32 v214, v214, v230, v230
    v_mfma_f32_32x32x16_bf16 v[144:159], a[12:15], v[12:15], v[144:159]
    s_waitcnt lgkmcnt(3)
    ds_read_b128 a[4:7], v226 offset:41984
    v_fma_f32 v215, v215, v230, v230
    v_rcp_f32 v208, v208
    v_rcp_f32 v209, v209
    v_mfma_f32_32x32x16_bf16 v[144:159], a[16:19], v[16:19], v[144:159]
    ds_read_b128 a[8:11], v226 offset:43008
    v_rcp_f32 v210, v210
    v_rcp_f32 v211, v211
    v_mfma_f32_32x32x16_bf16 v[144:159], a[20:23], v[20:23], v[144:159]
    s_waitcnt lgkmcnt(3)
    ds_read_b128 a[12:15], v226 offset:44032
    v_rcp_f32 v212, v212
    v_rcp_f32 v213, v213
    v_mfma_f32_32x32x16_bf16 v[144:159], a[24:27], v[24:27], v[144:159]
    ds_read_b128 a[16:19], v226 offset:45056
    v_rcp_f32 v214, v214
    v_rcp_f32 v215, v215
    v_mul_f32 v192, v192, v208
    v_mfma_f32_32x32x16_bf16 v[144:159], a[28:31], v[28:31], v[144:159]
    s_waitcnt lgkmcnt(3)
    ds_read_b128 a[20:23], v226 offset:46080
    v_mul_f32 v193, v193, v209
    v_mul_f32 v194, v194, v210
    v_mul_f32 v195, v195, v211
    v_mul_f32 v196, v196, v212
    v_mul_f32 v197, v197, v213
    v_mfma_f32_32x32x16_bf16 v[144:159], a[0:3], v[32:35], v[144:159]
    ds_read_b128 a[24:27], v226 offset:47104
    v_mul_f32 v198, v198, v214
    v_mul_f32 v199, v199, v215
    v_cvt_pk_bf16_f32 v200, v192, v193
    v_cvt_pk_bf16_f32 v201, v194, v195
    v_cvt_pk_bf16_f32 v202, v196, v197
    v_mfma_f32_32x32x16_bf16 v[144:159], a[4:7], v[36:39], v[144:159]
    s_waitcnt lgkmcnt(3)
    ds_read_b128 a[28:31], v226 offset:48128
    v_cvt_pk_bf16_f32 v203, v198, v199
    v_mfma_f32_32x32x16_bf16 v[144:159], a[8:11], v[40:43], v[144:159]
    ds_read_b128 a[0:3], v226 offset:49152
    buffer_store_dwordx4 v[200:203], v252, s[8:11], s26 offen offset:0 sc1
    v_mul_f32 v208, v128, v128
    v_mul_f32 v209, v129, v129
    v_mul_f32 v210, v130, v130
    v_mfma_f32_32x32x16_bf16 v[144:159], a[12:15], v[44:47], v[144:159]
    s_waitcnt lgkmcnt(3)
    ds_read_b128 a[4:7], v226 offset:50176
    v_mul_f32 v211, v131, v131
    v_mul_f32 v212, v132, v132
    v_mul_f32 v213, v133, v133
    v_mul_f32 v214, v134, v134
    v_mul_f32 v215, v135, v135
    v_mfma_f32_32x32x16_bf16 v[144:159], a[16:19], v[48:51], v[144:159]
    ds_read_b128 a[8:11], v226 offset:51200
    v_fma_f32 v208, v208, v228, v229
    v_fma_f32 v209, v209, v228, v229
    v_fma_f32 v210, v210, v228, v229
    v_fma_f32 v211, v211, v228, v229
    v_fma_f32 v212, v212, v228, v229
    v_mfma_f32_32x32x16_bf16 v[144:159], a[20:23], v[52:55], v[144:159]
    s_waitcnt lgkmcnt(3)
    ds_read_b128 a[12:15], v226 offset:52224
    v_fma_f32 v213, v213, v228, v229
    v_fma_f32 v214, v214, v228, v229
    v_fma_f32 v215, v215, v228, v229
    v_mul_f32 v208, v208, v128
    v_mul_f32 v209, v209, v129
    v_mfma_f32_32x32x16_bf16 v[144:159], a[24:27], v[56:59], v[144:159]
    ds_read_b128 a[16:19], v226 offset:53248
    v_mul_f32 v210, v210, v130
    v_mul_f32 v211, v211, v131
    v_mul_f32 v212, v212, v132
    v_mul_f32 v213, v213, v133
    v_mul_f32 v214, v214, v134
    v_mfma_f32_32x32x16_bf16 v[144:159], a[28:31], v[60:63], v[144:159]
    s_waitcnt lgkmcnt(3)
    ds_read_b128 a[20:23], v226 offset:54272
    v_mul_f32 v215, v215, v135
    v_exp_f32 v208, v208
    v_exp_f32 v209, v209
    v_mfma_f32_32x32x16_bf16 v[144:159], a[0:3], v[64:67], v[144:159]
    s_waitcnt vmcnt(1)
    s_barrier
    ds_read_b128 a[24:27], v226 offset:55296
    v_exp_f32 v210, v210
    v_exp_f32 v211, v211
    v_mfma_f32_32x32x16_bf16 v[144:159], a[4:7], v[68:71], v[144:159]
    s_waitcnt lgkmcnt(3)
    ds_read_b128 a[28:31], v226 offset:56320
    s_cmp_eq_u32 s71, 0
    s_cselect_b32 s4, s4, 0x7f000000
    buffer_store_dword v253, v251, s[8:11], s4 offen sc1
    v_exp_f32 v212, v212
    v_exp_f32 v213, v213
    v_mfma_f32_32x32x16_bf16 v[144:159], a[8:11], v[72:75], v[144:159]
    ds_read_b128 a[0:3], v226 offset:57344
    v_exp_f32 v214, v214
    v_exp_f32 v215, v215
    v_mul_f32 v128, v128, v136
    v_mfma_f32_32x32x16_bf16 v[144:159], a[12:15], v[76:79], v[144:159]
    s_waitcnt lgkmcnt(3)
    ds_read_b128 a[4:7], v226 offset:58368
    v_mul_f32 v129, v129, v137
    v_mul_f32 v130, v130, v138
    v_mul_f32 v131, v131, v139
    v_mul_f32 v132, v132, v140
    v_mul_f32 v133, v133, v141
    v_mfma_f32_32x32x16_bf16 v[144:159], a[16:19], v[80:83], v[144:159]
    ds_read_b128 a[8:11], v226 offset:59392
    v_mul_f32 v134, v134, v142
    v_mul_f32 v135, v135, v143
    v_fma_f32 v208, v208, v230, v230
    v_fma_f32 v209, v209, v230, v230
    v_fma_f32 v210, v210, v230, v230
    v_mfma_f32_32x32x16_bf16 v[144:159], a[20:23], v[84:87], v[144:159]
    s_waitcnt lgkmcnt(3)
    ds_read_b128 a[12:15], v226 offset:60416
    v_fma_f32 v211, v211, v230, v230
    v_fma_f32 v212, v212, v230, v230
    v_fma_f32 v213, v213, v230, v230
    v_fma_f32 v214, v214, v230, v230
    v_fma_f32 v215, v215, v230, v230
    v_mfma_f32_32x32x16_bf16 v[144:159], a[24:27], v[88:91], v[144:159]
    ds_read_b128 a[16:19], v226 offset:61440
    v_rcp_f32 v208, v208
    v_rcp_f32 v209, v209
    v_mfma_f32_32x32x16_bf16 v[144:159], a[28:31], v[92:95], v[144:159]
    s_waitcnt lgkmcnt(3)
    ds_read_b128 a[20:23], v226 offset:62464
    v_rcp_f32 v210, v210
    v_rcp_f32 v211, v211
    v_mfma_f32_32x32x16_bf16 v[144:159], a[0:3], v[96:99], v[144:159]
    ds_read_b128 a[24:27], v226 offset:63488
    v_rcp_f32 v212, v212
    v_rcp_f32 v213, v213
    v_mfma_f32_32x32x16_bf16 v[144:159], a[4:7], v[100:103], v[144:159]
    s_waitcnt lgkmcnt(3)
    ds_read_b128 a[28:31], v226 offset:64512
    v_rcp_f32 v214, v214
    v_rcp_f32 v215, v215
    v_mul_f32 v128, v128, v208
    v_mfma_f32_32x32x16_bf16 v[144:159], a[8:11], v[104:107], v[144:159]
    v_mul_f32 v129, v129, v209
    v_mul_f32 v130, v130, v210
    v_mul_f32 v131, v131, v211
    v_mul_f32 v132, v132, v212
    v_mul_f32 v133, v133, v213
    v_mul_f32 v134, v134, v214
    v_mfma_f32_32x32x16_bf16 v[144:159], a[12:15], v[108:111], v[144:159]
    s_waitcnt lgkmcnt(2)
    v_mul_f32 v135, v135, v215
    v_cvt_pk_bf16_f32 v136, v128, v129
    v_cvt_pk_bf16_f32 v137, v130, v131
    v_cvt_pk_bf16_f32 v138, v132, v133
    v_cvt_pk_bf16_f32 v139, v134, v135
    v_mfma_f32_32x32x16_bf16 v[144:159], a[16:19], v[112:115], v[144:159]
    buffer_store_dwordx4 v[136:139], v252, s[8:11], s26 offen offset:1024 sc1
    v_mfma_f32_32x32x16_bf16 v[144:159], a[20:23], v[116:119], v[144:159]
    s_waitcnt lgkmcnt(0)
    v_mfma_f32_32x32x16_bf16 v[144:159], a[24:27], v[120:123], v[144:159]
    v_mfma_f32_32x32x16_bf16 v[144:159], a[28:31], v[124:127], v[144:159]
    s_nop 7
    s_nop 3
    v_pk_mul_f32 v[208:209], v[144:145], v[144:145]
    v_pk_mul_f32 v[210:211], v[146:147], v[146:147]
    v_pk_mul_f32 v[212:213], v[148:149], v[148:149]
    v_pk_mul_f32 v[214:215], v[150:151], v[150:151]
    v_pk_fma_f32 v[208:209], v[208:209], v[228:229], v[228:229] op_sel:[0,0,1] op_sel_hi:[1,0,1]
    v_pk_fma_f32 v[210:211], v[210:211], v[228:229], v[228:229] op_sel:[0,0,1] op_sel_hi:[1,0,1]
    v_pk_fma_f32 v[212:213], v[212:213], v[228:229], v[228:229] op_sel:[0,0,1] op_sel_hi:[1,0,1]
    v_pk_fma_f32 v[214:215], v[214:215], v[228:229], v[228:229] op_sel:[0,0,1] op_sel_hi:[1,0,1]
    v_pk_mul_f32 v[208:209], v[208:209], v[144:145]
    v_pk_mul_f32 v[210:211], v[210:211], v[146:147]
    v_pk_mul_f32 v[212:213], v[212:213], v[148:149]
    v_pk_mul_f32 v[214:215], v[214:215], v[150:151]
    v_exp_f32 v208, v208
    v_exp_f32 v209, v209
    v_exp_f32 v210, v210
    v_exp_f32 v211, v211
    v_exp_f32 v212, v212
    v_exp_f32 v213, v213
    v_exp_f32 v214, v214
    v_exp_f32 v215, v215
    v_pk_mul_f32 v[144:145], v[144:145], v[152:153]
    v_pk_mul_f32 v[146:147], v[146:147], v[154:155]
    v_pk_mul_f32 v[148:149], v[148:149], v[156:157]
    v_pk_mul_f32 v[150:151], v[150:151], v[158:159]
    v_pk_fma_f32 v[208:209], v[208:209], v[230:231], v[230:231] op_sel_hi:[1,0,0]
    v_pk_fma_f32 v[210:211], v[210:211], v[230:231], v[230:231] op_sel_hi:[1,0,0]
    v_pk_fma_f32 v[212:213], v[212:213], v[230:231], v[230:231] op_sel_hi:[1,0,0]
    v_pk_fma_f32 v[214:215], v[214:215], v[230:231], v[230:231] op_sel_hi:[1,0,0]
    v_rcp_f32 v208, v208
    v_rcp_f32 v209, v209
    v_rcp_f32 v210, v210
    v_rcp_f32 v211, v211
    v_rcp_f32 v212, v212
    v_rcp_f32 v213, v213
    v_rcp_f32 v214, v214
    v_rcp_f32 v215, v215
    s_nop 0
    v_pk_mul_f32 v[144:145], v[144:145], v[208:209]
    v_pk_mul_f32 v[146:147], v[146:147], v[210:211]
    v_pk_mul_f32 v[148:149], v[148:149], v[212:213]
    v_pk_mul_f32 v[150:151], v[150:151], v[214:215]
    v_cvt_pk_bf16_f32 v152, v144, v145
    v_cvt_pk_bf16_f32 v153, v146, v147
    v_cvt_pk_bf16_f32 v154, v148, v149
    v_cvt_pk_bf16_f32 v155, v150, v151
    buffer_store_dwordx4 v[152:155], v252, s[8:11], s26 offen offset:2048 sc1
    buffer_load_dwordx4 a[96:99], v252, s[8:11], s62 offen offset:2048 sc1
    s_add_u32 s62, s62, 0x1c00
    buffer_load_dwordx4 a[100:103], v252, s[8:11], s66 offen offset:2048 sc1
    s_add_u32 s66, s66, 0x1c00
    buffer_load_dwordx4 a[104:107], v252, s[8:11], s62 offen offset:0 sc1
    buffer_load_dwordx4 a[108:111], v252, s[8:11], s66 offen offset:0 sc1
    buffer_load_dword v250, v248, s[8:11], s7 offen sc1
    buffer_load_dwordx4 a[112:115], v252, s[8:11], s62 offen offset:1024 sc1
    buffer_load_dwordx4 a[116:119], v252, s[8:11], s66 offen offset:1024 sc1
    buffer_load_dwordx4 a[120:123], v252, s[8:11], s62 offen offset:2048 sc1
    buffer_load_dwordx4 a[124:127], v252, s[8:11], s66 offen offset:2048 sc1
    s_waitcnt vmcnt(9)
    s_barrier
    s_cmp_eq_u32 s71, 0
    s_cselect_b32 s3, s3, 0x7f000000
    buffer_store_dword v253, v251, s[8:11], s3 offen sc1
L_fjoin_sequential_preLN__compressed_kv_cla__geglu_ffn__prompt_kernel:
    s_waitcnt vmcnt(5)
    v_cmp_ne_u32 vcc, s73, v250
    s_nop 1
    s_cbranch_vccnz L_poll11_sequential_preLN__compressed_kv_cla__geglu_ffn__prompt_kernel
L_poll11_sequential_preLN__compressed_kv_cla__geglu_ffn__prompt_kernel_ok:
    buffer_load_dwordx4 v[68:71], v224, s[8:11], s61 offen offset:0 sc1
    buffer_load_dwordx4 v[64:67], v224, s[8:11], s60 offen offset:0 sc1
    buffer_load_dwordx4 v[76:79], v224, s[8:11], s61 offen offset:1024 sc1
    buffer_load_dwordx4 v[72:75], v224, s[8:11], s60 offen offset:1024 sc1
    buffer_load_dwordx4 v[84:87], v224, s[8:11], s61 offen offset:2048 sc1
    buffer_load_dwordx4 v[80:83], v224, s[8:11], s60 offen offset:2048 sc1
    buffer_load_dwordx4 v[92:95], v224, s[8:11], s61 offen offset:3072 sc1
    s_add_u32 s61, s61, 0x1c00
    buffer_load_dwordx4 v[88:91], v224, s[8:11], s60 offen offset:3072 sc1
    s_add_u32 s60, s60, 0x1c00
    buffer_load_dwordx4 v[100:103], v224, s[8:11], s61 offen offset:0 sc1
    buffer_load_dwordx4 v[96:99], v224, s[8:11], s60 offen offset:0 sc1
    buffer_load_dwordx4 v[108:111], v224, s[8:11], s61 offen offset:1024 sc1
    buffer_load_dwordx4 v[104:107], v224, s[8:11], s60 offen offset:1024 sc1
    s_waitcnt vmcnt(10)
    v_mfma_f32_32x32x16_bf16 v[0:15], a[128:131], v[64:67], 0
    v_mfma_f32_32x32x16_bf16 v[16:31], a[128:131], v[68:71], 0
    v_mfma_f32_32x32x16_bf16 v[48:63], a[132:135], v[68:71], 0
    v_mfma_f32_32x32x16_bf16 v[32:47], a[132:135], v[64:67], 0
    buffer_load_dwordx4 v[68:71], v224, s[8:11], s61 offen offset:2048 sc1
    buffer_load_dwordx4 v[64:67], v224, s[8:11], s60 offen offset:2048 sc1
    s_waitcnt vmcnt(10)
    v_mfma_f32_32x32x16_bf16 v[0:15], a[136:139], v[72:75], v[0:15]
    v_mfma_f32_32x32x16_bf16 v[16:31], a[136:139], v[76:79], v[16:31]
    v_mfma_f32_32x32x16_bf16 v[48:63], a[140:143], v[76:79], v[48:63]
    v_mfma_f32_32x32x16_bf16 v[32:47], a[140:143], v[72:75], v[32:47]
    buffer_load_dwordx4 v[76:79], v224, s[8:11], s61 offen offset:3072 sc1
    s_add_u32 s61, s61, 0x1c00
    buffer_load_dwordx4 v[72:75], v224, s[8:11], s60 offen offset:3072 sc1
    s_add_u32 s60, s60, 0x1c00
    s_waitcnt vmcnt(10)
    v_mfma_f32_32x32x16_bf16 v[0:15], a[144:147], v[80:83], v[0:15]
    v_mfma_f32_32x32x16_bf16 v[16:31], a[144:147], v[84:87], v[16:31]
    v_mfma_f32_32x32x16_bf16 v[48:63], a[148:151], v[84:87], v[48:63]
    v_mfma_f32_32x32x16_bf16 v[32:47], a[148:151], v[80:83], v[32:47]
    buffer_load_dwordx4 v[84:87], v224, s[8:11], s61 offen offset:0 sc1
    buffer_load_dwordx4 v[80:83], v224, s[8:11], s60 offen offset:0 sc1
    s_waitcnt vmcnt(10)
    v_mfma_f32_32x32x16_bf16 v[0:15], a[152:155], v[88:91], v[0:15]
    v_mfma_f32_32x32x16_bf16 v[16:31], a[152:155], v[92:95], v[16:31]
    v_mfma_f32_32x32x16_bf16 v[48:63], a[156:159], v[92:95], v[48:63]
    v_mfma_f32_32x32x16_bf16 v[32:47], a[156:159], v[88:91], v[32:47]
    buffer_load_dwordx4 v[92:95], v224, s[8:11], s61 offen offset:1024 sc1
    buffer_load_dwordx4 v[88:91], v224, s[8:11], s60 offen offset:1024 sc1
    s_waitcnt vmcnt(10)
    v_mfma_f32_32x32x16_bf16 v[0:15], a[160:163], v[96:99], v[0:15]
    v_mfma_f32_32x32x16_bf16 v[16:31], a[160:163], v[100:103], v[16:31]
    v_mfma_f32_32x32x16_bf16 v[48:63], a[164:167], v[100:103], v[48:63]
    v_mfma_f32_32x32x16_bf16 v[32:47], a[164:167], v[96:99], v[32:47]
    buffer_load_dwordx4 v[100:103], v224, s[8:11], s61 offen offset:2048 sc1
    buffer_load_dwordx4 v[96:99], v224, s[8:11], s60 offen offset:2048 sc1
    s_waitcnt vmcnt(10)
    v_mfma_f32_32x32x16_bf16 v[0:15], a[168:171], v[104:107], v[0:15]
    v_mfma_f32_32x32x16_bf16 v[16:31], a[168:171], v[108:111], v[16:31]
    v_mfma_f32_32x32x16_bf16 v[48:63], a[172:175], v[108:111], v[48:63]
    v_mfma_f32_32x32x16_bf16 v[32:47], a[172:175], v[104:107], v[32:47]
    buffer_load_dwordx4 v[108:111], v224, s[8:11], s61 offen offset:3072 sc1
    s_add_u32 s61, s61, 0x1c00
    buffer_load_dwordx4 v[104:107], v224, s[8:11], s60 offen offset:3072 sc1
    s_add_u32 s60, s60, 0x1c00
    buffer_load_dword v238, v248, s[8:11], s6 offen sc1
    s_waitcnt vmcnt(11)
    v_mfma_f32_32x32x16_bf16 v[0:15], a[176:179], v[64:67], v[0:15]
    v_mfma_f32_32x32x16_bf16 v[16:31], a[176:179], v[68:71], v[16:31]
    v_mfma_f32_32x32x16_bf16 v[48:63], a[180:183], v[68:71], v[48:63]
    v_mfma_f32_32x32x16_bf16 v[32:47], a[180:183], v[64:67], v[32:47]
    buffer_load_dwordx4 v[68:71], v224, s[8:11], s61 offen offset:0 sc1
    buffer_load_dwordx4 v[64:67], v224, s[8:11], s60 offen offset:0 sc1
    s_waitcnt vmcnt(11)
    v_mfma_f32_32x32x16_bf16 v[0:15], a[184:187], v[72:75], v[0:15]
    v_mfma_f32_32x32x16_bf16 v[16:31], a[184:187], v[76:79], v[16:31]
    v_mfma_f32_32x32x16_bf16 v[48:63], a[188:191], v[76:79], v[48:63]
    v_mfma_f32_32x32x16_bf16 v[32:47], a[188:191], v[72:75], v[32:47]
    buffer_load_dwordx4 v[76:79], v224, s[8:11], s61 offen offset:1024 sc1
    buffer_load_dwordx4 v[72:75], v224, s[8:11], s60 offen offset:1024 sc1
    s_waitcnt vmcnt(11)
    v_mfma_f32_32x32x16_bf16 v[0:15], a[192:195], v[80:83], v[0:15]
    v_mfma_f32_32x32x16_bf16 v[16:31], a[192:195], v[84:87], v[16:31]
    v_mfma_f32_32x32x16_bf16 v[48:63], a[196:199], v[84:87], v[48:63]
    v_mfma_f32_32x32x16_bf16 v[32:47], a[196:199], v[80:83], v[32:47]
    buffer_load_dwordx4 v[84:87], v224, s[8:11], s61 offen offset:2048 sc1
    buffer_load_dwordx4 v[80:83], v224, s[8:11], s60 offen offset:2048 sc1
    buffer_load_dwordx4 v[240:243], v224, s[8:11], s65 offen offset:0 sc1
    buffer_load_dwordx4 v[244:247], v224, s[8:11], s65 offen offset:1024 sc1
    s_waitcnt vmcnt(13)
    v_mfma_f32_32x32x16_bf16 v[0:15], a[200:203], v[88:91], v[0:15]
    v_mfma_f32_32x32x16_bf16 v[16:31], a[200:203], v[92:95], v[16:31]
    v_mfma_f32_32x32x16_bf16 v[48:63], a[204:207], v[92:95], v[48:63]
    v_mfma_f32_32x32x16_bf16 v[32:47], a[204:207], v[88:91], v[32:47]
    buffer_load_dwordx4 v[92:95], v224, s[8:11], s61 offen offset:3072 sc1
    s_add_u32 s61, s61, 0xffffac00
    buffer_load_dwordx4 v[88:91], v224, s[8:11], s60 offen offset:3072 sc1
    s_add_u32 s60, s60, 0xffffac00
    s_waitcnt vmcnt(13)
    v_mfma_f32_32x32x16_bf16 v[0:15], a[208:211], v[96:99], v[0:15]
    v_mfma_f32_32x32x16_bf16 v[16:31], a[208:211], v[100:103], v[16:31]
    v_mfma_f32_32x32x16_bf16 v[48:63], a[212:215], v[100:103], v[48:63]
    v_mfma_f32_32x32x16_bf16 v[32:47], a[212:215], v[96:99], v[32:47]
    s_waitcnt vmcnt(10)
    v_cmp_ne_u32 vcc, s73, v238
    s_nop 1
    s_cbranch_vccnz L_poll12_sequential_preLN__compressed_kv_cla__geglu_ffn__prompt_kernel
L_poll12_sequential_preLN__compressed_kv_cla__geglu_ffn__prompt_kernel_ok:
    buffer_load_dwordx4 v[100:103], v252, s[8:11], s61 offen offset:0 sc1
    buffer_load_dwordx4 v[96:99], v252, s[8:11], s60 offen offset:0 sc1
    v_mfma_f32_32x32x16_bf16 v[0:15], a[216:219], v[104:107], v[0:15]
    v_mfma_f32_32x32x16_bf16 v[16:31], a[216:219], v[108:111], v[16:31]
    v_mfma_f32_32x32x16_bf16 v[48:63], a[220:223], v[108:111], v[48:63]
    v_mfma_f32_32x32x16_bf16 v[32:47], a[220:223], v[104:107], v[32:47]
    buffer_load_dwordx4 v[108:111], v252, s[8:11], s61 offen offset:1024 sc1
    buffer_load_dwordx4 v[104:107], v252, s[8:11], s60 offen offset:1024 sc1
    s_waitcnt vmcnt(12)
    v_mfma_f32_32x32x16_bf16 v[0:15], a[224:227], v[64:67], v[0:15]
    v_mfma_f32_32x32x16_bf16 v[16:31], a[224:227], v[68:71], v[16:31]
    v_mfma_f32_32x32x16_bf16 v[48:63], a[228:231], v[68:71], v[48:63]
    v_mfma_f32_32x32x16_bf16 v[32:47], a[228:231], v[64:67], v[32:47]
    buffer_load_dwordx4 v[68:71], v252, s[8:11], s61 offen offset:2048 sc1
    s_add_u32 s61, s61, 0x1c00
    buffer_load_dwordx4 v[64:67], v252, s[8:11], s60 offen offset:2048 sc1
    s_add_u32 s60, s60, 0x1c00
    s_waitcnt vmcnt(12)
    v_mfma_f32_32x32x16_bf16 v[0:15], a[232:235], v[72:75], v[0:15]
    v_mfma_f32_32x32x16_bf16 v[16:31], a[232:235], v[76:79], v[16:31]
    v_mfma_f32_32x32x16_bf16 v[48:63], a[236:239], v[76:79], v[48:63]
    v_mfma_f32_32x32x16_bf16 v[32:47], a[236:239], v[72:75], v[32:47]
    buffer_load_dwordx4 v[76:79], v252, s[8:11], s61 offen offset:0 sc1
    buffer_load_dwordx4 v[72:75], v252, s[8:11], s60 offen offset:0 sc1
    s_waitcnt vmcnt(12)
    v_mfma_f32_32x32x16_bf16 v[0:15], a[240:243], v[80:83], v[0:15]
    v_mfma_f32_32x32x16_bf16 v[16:31], a[240:243], v[84:87], v[16:31]
    v_mfma_f32_32x32x16_bf16 v[48:63], a[244:247], v[84:87], v[48:63]
    v_mfma_f32_32x32x16_bf16 v[32:47], a[244:247], v[80:83], v[32:47]
    buffer_load_dwordx4 v[84:87], v252, s[8:11], s61 offen offset:1024 sc1
    buffer_load_dwordx4 v[80:83], v252, s[8:11], s60 offen offset:1024 sc1
    s_waitcnt vmcnt(10)
    v_mfma_f32_32x32x16_bf16 v[0:15], a[248:251], v[88:91], v[0:15]
    v_mfma_f32_32x32x16_bf16 v[16:31], a[248:251], v[92:95], v[16:31]
    v_mfma_f32_32x32x16_bf16 v[48:63], a[252:255], v[92:95], v[48:63]
    v_mfma_f32_32x32x16_bf16 v[32:47], a[252:255], v[88:91], v[32:47]
    buffer_load_dwordx4 v[92:95], v252, s[8:11], s61 offen offset:2048 sc1
    s_add_u32 s61, s61, 0x1c00
    buffer_load_dwordx4 v[88:91], v252, s[8:11], s60 offen offset:2048 sc1
    s_add_u32 s60, s60, 0x1c00
    s_waitcnt vmcnt(10)
    v_mfma_f32_32x32x16_bf16 v[0:15], a[32:35], v[96:99], v[0:15]
    v_mfma_f32_32x32x16_bf16 v[16:31], a[32:35], v[100:103], v[16:31]
    v_mfma_f32_32x32x16_bf16 v[48:63], a[36:39], v[100:103], v[48:63]
    v_mfma_f32_32x32x16_bf16 v[32:47], a[36:39], v[96:99], v[32:47]
    buffer_load_dwordx4 v[100:103], v252, s[8:11], s61 offen offset:0 sc1
    buffer_load_dwordx4 v[96:99], v252, s[8:11], s60 offen offset:0 sc1
    s_waitcnt vmcnt(10)
    v_mfma_f32_32x32x16_bf16 v[0:15], a[40:43], v[104:107], v[0:15]
    v_mfma_f32_32x32x16_bf16 v[16:31], a[40:43], v[108:111], v[16:31]
    v_mfma_f32_32x32x16_bf16 v[48:63], a[44:47], v[108:111], v[48:63]
    v_mfma_f32_32x32x16_bf16 v[32:47], a[44:47], v[104:107], v[32:47]
    buffer_load_dwordx4 v[108:111], v252, s[8:11], s61 offen offset:1024 sc1
    buffer_load_dwordx4 v[104:107], v252, s[8:11], s60 offen offset:1024 sc1
    s_waitcnt vmcnt(10)
    v_mfma_f32_32x32x16_bf16 v[0:15], a[48:51], v[64:67], v[0:15]
    v_mfma_f32_32x32x16_bf16 v[16:31], a[48:51], v[68:71], v[16:31]
    v_mfma_f32_32x32x16_bf16 v[48:63], a[52:55], v[68:71], v[48:63]
    v_mfma_f32_32x32x16_bf16 v[32:47], a[52:55], v[64:67], v[32:47]
    buffer_load_dwordx4 v[68:71], v252, s[8:11], s61 offen offset:2048 sc1
    s_add_u32 s61, s61, 0x1c00
    buffer_load_dwordx4 v[64:67], v252, s[8:11], s60 offen offset:2048 sc1
    s_add_u32 s60, s60, 0x1c00
    s_waitcnt vmcnt(10)
    v_mfma_f32_32x32x16_bf16 v[0:15], a[56:59], v[72:75], v[0:15]
    v_mfma_f32_32x32x16_bf16 v[16:31], a[56:59], v[76:79], v[16:31]
    v_mfma_f32_32x32x16_bf16 v[48:63], a[60:63], v[76:79], v[48:63]
    v_mfma_f32_32x32x16_bf16 v[32:47], a[60:63], v[72:75], v[32:47]
    buffer_load_dwordx4 v[76:79], v252, s[8:11], s61 offen offset:0 sc1
    buffer_load_dwordx4 v[72:75], v252, s[8:11], s60 offen offset:0 sc1
    s_waitcnt vmcnt(10)
    v_mfma_f32_32x32x16_bf16 v[0:15], a[64:67], v[80:83], v[0:15]
    v_mfma_f32_32x32x16_bf16 v[16:31], a[64:67], v[84:87], v[16:31]
    v_mfma_f32_32x32x16_bf16 v[48:63], a[68:71], v[84:87], v[48:63]
    v_mfma_f32_32x32x16_bf16 v[32:47], a[68:71], v[80:83], v[32:47]
    buffer_load_dwordx4 v[84:87], v252, s[8:11], s61 offen offset:1024 sc1
    buffer_load_dwordx4 v[80:83], v252, s[8:11], s60 offen offset:1024 sc1
    s_waitcnt vmcnt(10)
    v_mfma_f32_32x32x16_bf16 v[0:15], a[72:75], v[88:91], v[0:15]
    v_mfma_f32_32x32x16_bf16 v[16:31], a[72:75], v[92:95], v[16:31]
    v_mfma_f32_32x32x16_bf16 v[48:63], a[76:79], v[92:95], v[48:63]
    v_mfma_f32_32x32x16_bf16 v[32:47], a[76:79], v[88:91], v[32:47]
    buffer_load_dwordx4 v[92:95], v252, s[8:11], s61 offen offset:2048 sc1
    buffer_load_dwordx4 v[88:91], v252, s[8:11], s60 offen offset:2048 sc1
    s_waitcnt vmcnt(10)
    v_mfma_f32_32x32x16_bf16 v[0:15], a[80:83], v[96:99], v[0:15]
    v_mfma_f32_32x32x16_bf16 v[16:31], a[80:83], v[100:103], v[16:31]
    v_mfma_f32_32x32x16_bf16 v[48:63], a[84:87], v[100:103], v[48:63]
    v_mfma_f32_32x32x16_bf16 v[32:47], a[84:87], v[96:99], v[32:47]
    s_waitcnt vmcnt(8)
    v_mfma_f32_32x32x16_bf16 v[0:15], a[88:91], v[104:107], v[0:15]
    v_mfma_f32_32x32x16_bf16 v[16:31], a[88:91], v[108:111], v[16:31]
    v_mfma_f32_32x32x16_bf16 v[48:63], a[92:95], v[108:111], v[48:63]
    v_mfma_f32_32x32x16_bf16 v[32:47], a[92:95], v[104:107], v[32:47]
    s_waitcnt vmcnt(6)
    v_mfma_f32_32x32x16_bf16 v[0:15], a[96:99], v[64:67], v[0:15]
    v_mfma_f32_32x32x16_bf16 v[16:31], a[96:99], v[68:71], v[16:31]
    v_mfma_f32_32x32x16_bf16 v[48:63], a[100:103], v[68:71], v[48:63]
    v_mfma_f32_32x32x16_bf16 v[32:47], a[100:103], v[64:67], v[32:47]
    s_waitcnt vmcnt(4)
    v_mfma_f32_32x32x16_bf16 v[0:15], a[104:107], v[72:75], v[0:15]
    v_mfma_f32_32x32x16_bf16 v[16:31], a[104:107], v[76:79], v[16:31]
    v_mfma_f32_32x32x16_bf16 v[48:63], a[108:111], v[76:79], v[48:63]
    v_mfma_f32_32x32x16_bf16 v[32:47], a[108:111], v[72:75], v[32:47]
    s_waitcnt vmcnt(2)
    v_mfma_f32_32x32x16_bf16 v[0:15], a[112:115], v[80:83], v[0:15]
    v_lshlrev_b32 v128, 16, v240
    v_and_b32 v129, 0xffff0000, v240
    v_lshlrev_b32 v130, 16, v241
    v_and_b32 v131, 0xffff0000, v241
    v_mfma_f32_32x32x16_bf16 v[16:31], a[112:115], v[84:87], v[16:31]
    v_lshlrev_b32 v132, 16, v242
    v_and_b32 v133, 0xffff0000, v242
    v_lshlrev_b32 v134, 16, v243
    v_and_b32 v135, 0xffff0000, v243
    v_mfma_f32_32x32x16_bf16 v[48:63], a[116:119], v[84:87], v[48:63]
    v_lshlrev_b32 v140, 16, v246
    v_and_b32 v141, 0xffff0000, v246
    v_lshlrev_b32 v142, 16, v247
    v_and_b32 v143, 0xffff0000, v247
    v_mfma_f32_32x32x16_bf16 v[32:47], a[116:119], v[80:83], v[32:47]
    v_lshlrev_b32 v136, 16, v244
    v_and_b32 v137, 0xffff0000, v244
    v_lshlrev_b32 v138, 16, v245
    v_and_b32 v139, 0xffff0000, v245
    s_waitcnt vmcnt(1)
    v_mfma_f32_32x32x16_bf16 v[16:31], a[120:123], v[92:95], v[16:31]
    v_mfma_f32_32x32x16_bf16 v[48:63], a[124:127], v[92:95], v[48:63]
    s_waitcnt vmcnt(0)
    v_mfma_f32_32x32x16_bf16 v[32:47], a[124:127], v[88:91], v[32:47]
    ds_write_b128 v232, v[16:19] offset:0
    ds_write_b128 v232, v[20:23] offset:1024
    ds_write_b128 v232, v[24:27] offset:2048
    ds_write_b128 v232, v[28:31] offset:3072
    v_mfma_f32_32x32x16_bf16 v[0:15], a[120:123], v[88:91], v[0:15]
    ds_write_b128 v234, v[48:51] offset:0
    ds_write_b128 v234, v[52:55] offset:1024
    ds_write_b128 v234, v[56:59] offset:2048
    ds_write_b128 v234, v[60:63] offset:3072
    ds_write_b128 v233, v[32:35] offset:0
    ds_write_b128 v233, v[36:39] offset:1024
    ds_write_b128 v233, v[40:43] offset:2048
    ds_write_b128 v233, v[44:47] offset:3072
    s_nop 3
    v_pk_add_f32 v[0:1], v[0:1], v[128:129]
    v_pk_add_f32 v[2:3], v[2:3], v[130:131]
    v_pk_add_f32 v[4:5], v[4:5], v[132:133]
    v_pk_add_f32 v[6:7], v[6:7], v[134:135]
    v_pk_add_f32 v[8:9], v[8:9], v[136:137]
    v_pk_add_f32 v[10:11], v[10:11], v[138:139]
    v_pk_add_f32 v[12:13], v[12:13], v[140:141]
    v_pk_add_f32 v[14:15], v[14:15], v[142:143]
    s_waitcnt lgkmcnt(0)
    s_barrier
    ds_read_b128 v[64:67], v235 offset:4096
    ds_read_b128 v[80:83], v235 offset:8192
    ds_read_b128 v[96:99], v235 offset:12288
    ds_read_b128 v[68:71], v235 offset:5120
    ds_read_b128 v[84:87], v235 offset:9216
    ds_read_b128 v[100:103], v235 offset:13312
    ds_read_b128 v[72:75], v235 offset:6144
    ds_read_b128 v[88:91], v235 offset:10240
    ds_read_b128 v[104:107], v235 offset:14336
    ds_read_b128 v[76:79], v235 offset:7168
    ds_read_b128 v[92:95], v235 offset:11264
    ds_read_b128 v[108:111], v235 offset:15360
    s_waitcnt lgkmcnt(10)
    v_pk_add_f32 v[64:65], v[64:65], v[80:81]
    s_waitcnt lgkmcnt(9)
    v_pk_add_f32 v[0:1], v[0:1], v[96:97]
    v_pk_add_f32 v[66:67], v[66:67], v[82:83]
    v_pk_add_f32 v[2:3], v[2:3], v[98:99]
    v_pk_add_f32 v[0:1], v[0:1], v[64:65]
    v_pk_add_f32 v[2:3], v[2:3], v[66:67]
    s_waitcnt lgkmcnt(7)
    v_pk_add_f32 v[68:69], v[68:69], v[84:85]
    s_waitcnt lgkmcnt(6)
    v_pk_add_f32 v[4:5], v[4:5], v[100:101]
    v_pk_add_f32 v[70:71], v[70:71], v[86:87]
    v_pk_add_f32 v[6:7], v[6:7], v[102:103]
    v_pk_add_f32 v[4:5], v[4:5], v[68:69]
    v_pk_add_f32 v[6:7], v[6:7], v[70:71]
    s_waitcnt lgkmcnt(4)
    v_pk_add_f32 v[72:73], v[72:73], v[88:89]
    s_waitcnt lgkmcnt(3)
    v_pk_add_f32 v[8:9], v[8:9], v[104:105]
    v_pk_add_f32 v[74:75], v[74:75], v[90:91]
    v_pk_add_f32 v[10:11], v[10:11], v[106:107]
    v_pk_add_f32 v[8:9], v[8:9], v[72:73]
    v_pk_add_f32 v[10:11], v[10:11], v[74:75]
    s_waitcnt lgkmcnt(1)
    v_pk_add_f32 v[76:77], v[76:77], v[92:93]
    s_waitcnt lgkmcnt(0)
    v_pk_add_f32 v[12:13], v[12:13], v[108:109]
    v_pk_add_f32 v[78:79], v[78:79], v[94:95]
    v_pk_add_f32 v[14:15], v[14:15], v[110:111]
    v_pk_add_f32 v[12:13], v[12:13], v[76:77]
    v_pk_add_f32 v[14:15], v[14:15], v[78:79]
    v_cvt_pk_bf16_f32 v16, v0, v1
    v_cvt_pk_bf16_f32 v17, v2, v3
    v_cvt_pk_bf16_f32 v20, v4, v5
    v_cvt_pk_bf16_f32 v21, v6, v7
    v_cvt_pk_bf16_f32 v18, v8, v9
    v_cvt_pk_bf16_f32 v19, v10, v11
    v_cvt_pk_bf16_f32 v22, v12, v13
    v_cvt_pk_bf16_f32 v23, v14, v15
    s_nop 0
    v_permlane32_swap_b32 v16, v18
    v_permlane32_swap_b32 v17, v19
    v_permlane32_swap_b32 v20, v22
    v_permlane32_swap_b32 v21, v23
    s_movk_i32 s3, 0x4000
    v_permlane16_swap_b32 v16, v20
    v_permlane16_swap_b32 v17, v21
    v_permlane16_swap_b32 v18, v22
    v_permlane16_swap_b32 v19, v23
    buffer_store_dwordx4 v[16:19], v249, s[16:19], 0 offen
    buffer_store_dwordx4 v[20:23], v249, s[16:19], s3 offen
L_end_sequential_preLN__compressed_kv_cla__geglu_ffn__prompt_kernel:
    s_endpgm
L_dB0_sequential_preLN__compressed_kv_cla__geglu_ffn__prompt_kernel:
    ds_read_b128 a[96:99], v234 offset:16384
    ds_read_b128 a[100:103], v234 offset:17408
    ds_read_b128 a[104:107], v234 offset:18432
    ds_read_b128 a[108:111], v234 offset:19456
    ds_read_b128 a[112:115], v234 offset:20480
    ds_read_b128 a[116:119], v234 offset:21504
    ds_read_b128 a[120:123], v234 offset:22528
    ds_read_b128 a[124:127], v234 offset:23552
    s_waitcnt vmcnt(9)
    buffer_store_dword v253, v251, s[8:11], s57 offen sc1
    v_cndmask_b32 v38, v38, v229, s[28:29]
    v_cndmask_b32 v39, v39, v229, s[30:31]
    v_cndmask_b32 v40, v40, v229, s[32:33]
    v_cndmask_b32 v41, v41, v229, s[34:35]
    v_cndmask_b32 v42, v42, v229, s[36:37]
    v_cndmask_b32 v43, v43, v229, s[38:39]
    v_cndmask_b32 v44, v44, v229, s[40:41]
    v_cndmask_b32 v45, v45, v229, s[42:43]
    v_cndmask_b32 v46, v46, v229, s[44:45]
    v_cndmask_b32 v47, v47, v229, s[46:47]
    v_exp_f32 v38, v38
    v_add_f32 v226, v226, v37
    v_cvt_pk_bf16_f32 v34, v36, v37
    v_exp_f32 v39, v39
    v_add_f32 v226, v226, v38
    v_exp_f32 v40, v40
    v_add_f32 v226, v226, v39
    v_cvt_pk_bf16_f32 v35, v38, v39
    s_nop 0
    s_waitcnt lgkmcnt(7)
    v_mfma_f32_32x32x16_bf16 v[128:143], a[96:99], v[32:35], v[128:143]
    v_exp_f32 v41, v41
    v_add_f32 v226, v226, v40
    v_exp_f32 v42, v42
    v_add_f32 v226, v226, v41
    v_cvt_pk_bf16_f32 v40, v40, v41
    s_waitcnt lgkmcnt(6)
    v_mfma_f32_32x32x16_bf16 v[144:159], a[100:103], v[32:35], v[144:159]
    v_exp_f32 v43, v43
    v_add_f32 v226, v226, v42
    v_exp_f32 v44, v44
    v_add_f32 v226, v226, v43
    v_cvt_pk_bf16_f32 v41, v42, v43
    s_waitcnt lgkmcnt(5)
    v_mfma_f32_32x32x16_bf16 v[160:175], a[104:107], v[32:35], v[160:175]
    v_exp_f32 v45, v45
    v_add_f32 v226, v226, v44
    v_exp_f32 v46, v46
    v_add_f32 v226, v226, v45
    v_cvt_pk_bf16_f32 v42, v44, v45
    s_waitcnt lgkmcnt(4)
    v_mfma_f32_32x32x16_bf16 v[176:191], a[108:111], v[32:35], v[176:191]
    v_exp_f32 v47, v47
    v_add_f32 v226, v226, v46
    s_nop 0
    v_add_f32 v226, v226, v47
    v_cvt_pk_bf16_f32 v43, v46, v47
    s_nop 1
    s_waitcnt lgkmcnt(3)
    v_mfma_f32_32x32x16_bf16 v[128:143], a[112:115], v[40:43], v[128:143]
    v_mov_b32 v232, v226
    s_nop 1
    v_permlane32_swap_b32 v232, v226
    s_waitcnt lgkmcnt(2)
    v_mfma_f32_32x32x16_bf16 v[144:159], a[116:119], v[40:43], v[144:159]
    v_add_f32 v226, v226, v232
    v_rcp_f32 v232, v226
    v_cmp_nge_f32 vcc, 0x53800000, v226
    s_waitcnt lgkmcnt(1)
    v_mfma_f32_32x32x16_bf16 v[160:175], a[120:123], v[40:43], v[160:175]
    s_waitcnt lgkmcnt(0)
    v_mfma_f32_32x32x16_bf16 v[176:191], a[124:127], v[40:43], v[176:191]
    s_branch L_finB_sequential_preLN__compressed_kv_cla__geglu_ffn__prompt_kernel
L_cu_sequential_preLN__compressed_kv_cla__geglu_ffn__prompt_kernel:
    s_waitcnt vmcnt(17)
    v_cmp_ne_u32 vcc, s73, v236
    s_nop 1
    s_cbranch_vccnz L_poll5_sequential_preLN__compressed_kv_cla__geglu_ffn__prompt_kernel
L_poll5_sequential_preLN__compressed_kv_cla__geglu_ffn__prompt_kernel_ok:
    s_cmp_eq_u32 s71, 2
    s_cbranch_scc1 L_cu2_sequential_preLN__compressed_kv_cla__geglu_ffn__prompt_kernel
    s_cmp_eq_u32 s71, 1
    s_cbranch_scc1 L_cu1_sequential_preLN__compressed_kv_cla__geglu_ffn__prompt_kernel
L_cu0_sequential_preLN__compressed_kv_cla__geglu_ffn__prompt_kernel:
    s_add_u32 m0, s86, 0
    s_add_u32 s70, s48, 0x0
    buffer_load_dwordx4 v224, s[8:11], s70 offen offset:0 sc1 lds
    buffer_load_dwordx4 v224, s[8:11], s70 offen offset:1024 sc1 lds
    buffer_load_dwordx4 v224, s[8:11], s70 offen offset:2048 sc1 lds
    buffer_load_dwordx4 v224, s[8:11], s70 offen offset:3072 sc1 lds
    s_add_u32 m0, s86, 4096
    s_add_u32 s70, s48, 0x1000
    buffer_load_dwordx4 v224, s[8:11], s70 offen offset:0 sc1 lds
    buffer_load_dwordx4 v224, s[8:11], s70 offen offset:1024 sc1 lds
    buffer_load_dwordx4 v224, s[8:11], s70 offen offset:2048 sc1 lds
    buffer_load_dwordx4 v224, s[8:11], s70 offen offset:3072 sc1 lds
    s_add_u32 m0, s86, 8192
    s_add_u32 s70, s48, 0x2000
    buffer_load_dwordx4 v224, s[8:11], s70 offen offset:0 sc1 lds
    buffer_load_dwordx4 v224, s[8:11], s70 offen offset:1024 sc1 lds
    buffer_load_dwordx4 v224, s[8:11], s70 offen offset:2048 sc1 lds
    buffer_load_dwordx4 v224, s[8:11], s70 offen offset:3072 sc1 lds
    s_add_u32 m0, s86, 12288
    s_add_u32 s70, s48, 0x3000
    buffer_load_dwordx4 v224, s[8:11], s70 offen offset:0 sc1 lds
    buffer_load_dwordx4 v224, s[8:11], s70 offen offset:1024 sc1 lds
    buffer_load_dwordx4 v224, s[8:11], s70 offen offset:2048 sc1 lds
    buffer_load_dwordx4 v224, s[8:11], s70 offen offset:3072 sc1 lds
    s_add_u32 m0, s86, 16384
    s_add_u32 s70, s48, 0x4000
    buffer_load_dwordx4 v224, s[8:11], s70 offen offset:0 sc1 lds
    buffer_load_dwordx4 v224, s[8:11], s70 offen offset:1024 sc1 lds
    buffer_load_dwordx4 v224, s[8:11], s70 offen offset:2048 sc1 lds
    buffer_load_dwordx4 v224, s[8:11], s70 offen offset:3072 sc1 lds
    s_add_u32 m0, s86, 20480
    s_add_u32 s70, s48, 0x5000
    buffer_load_dwordx4 v224, s[8:11], s70 offen offset:0 sc1 lds
    buffer_load_dwordx4 v224, s[8:11], s70 offen offset:1024 sc1 lds
    buffer_load_dwordx4 v224, s[8:11], s70 offen offset:2048 sc1 lds
    buffer_load_dwordx4 v224, s[8:11], s70 offen offset:3072 sc1 lds
    s_waitcnt vmcnt(33)
    buffer_load_dwordx4 a[0:3], v224, s[8:11], s62 offen offset:0 sc1
    buffer_load_dwordx4 a[4:7], v224, s[8:11], s62 offen offset:1024 sc1
    buffer_load_dwordx4 a[8:11], v224, s[8:11], s62 offen offset:2048 sc1
    buffer_load_dwordx4 a[12:15], v224, s[8:11], s62 offen offset:3072 sc1
    buffer_load_dwordx4 a[16:19], v252, s[8:11], s62 offen offset:0 sc1
    buffer_load_dwordx4 a[20:23], v252, s[8:11], s62 offen offset:1024 sc1
    buffer_load_dwordx4 a[24:27], v252, s[8:11], s62 offen offset:2048 sc1
    buffer_load_dwordx4 a[28:31], v252, s[8:11], s62 offen offset:3072 sc1
    s_add_u32 s62, s62, 8192
    s_add_u32 m0, s86, 49152
    s_add_u32 s70, s48, 0xc000
    buffer_load_dwordx4 v224, s[8:11], s70 offen offset:0 sc1 lds
    buffer_load_dwordx4 v224, s[8:11], s70 offen offset:1024 sc1 lds
    buffer_load_dwordx4 v224, s[8:11], s70 offen offset:2048 sc1 lds
    buffer_load_dwordx4 v224, s[8:11], s70 offen offset:3072 sc1 lds
    s_sub_u32 s4, s59, 0x20000
    s_waitcnt vmcnt(36)
    buffer_store_dword v253, v251, s[8:11], s4 offen sc1
    s_branch L_cur_sequential_preLN__compressed_kv_cla__geglu_ffn__prompt_kernel
L_cu1_sequential_preLN__compressed_kv_cla__geglu_ffn__prompt_kernel:
    s_add_u32 m0, s86, 24576
    s_add_u32 s70, s48, 0x5000
    buffer_load_dwordx4 v224, s[8:11], s70 offen offset:0 sc1 lds
    buffer_load_dwordx4 v224, s[8:11], s70 offen offset:1024 sc1 lds
    buffer_load_dwordx4 v224, s[8:11], s70 offen offset:2048 sc1 lds
    buffer_load_dwordx4 v224, s[8:11], s70 offen offset:3072 sc1 lds
    s_add_u32 m0, s86, 28672
    s_add_u32 s70, s48, 0x6000
    buffer_load_dwordx4 v224, s[8:11], s70 offen offset:0 sc1 lds
    buffer_load_dwordx4 v224, s[8:11], s70 offen offset:1024 sc1 lds
    buffer_load_dwordx4 v224, s[8:11], s70 offen offset:2048 sc1 lds
    buffer_load_dwordx4 v224, s[8:11], s70 offen offset:3072 sc1 lds
    s_add_u32 m0, s86, 32768
    s_add_u32 s70, s48, 0x7000
    buffer_load_dwordx4 v224, s[8:11], s70 offen offset:0 sc1 lds
    buffer_load_dwordx4 v224, s[8:11], s70 offen offset:1024 sc1 lds
    buffer_load_dwordx4 v224, s[8:11], s70 offen offset:2048 sc1 lds
    buffer_load_dwordx4 v224, s[8:11], s70 offen offset:3072 sc1 lds
    s_add_u32 m0, s86, 36864
    s_add_u32 s70, s48, 0x8000
    buffer_load_dwordx4 v224, s[8:11], s70 offen offset:0 sc1 lds
    buffer_load_dwordx4 v224, s[8:11], s70 offen offset:1024 sc1 lds
    buffer_load_dwordx4 v224, s[8:11], s70 offen offset:2048 sc1 lds
    buffer_load_dwordx4 v224, s[8:11], s70 offen offset:3072 sc1 lds
    s_add_u32 m0, s86, 40960
    s_add_u32 s70, s48, 0x9000
    buffer_load_dwordx4 v224, s[8:11], s70 offen offset:0 sc1 lds
    buffer_load_dwordx4 v224, s[8:11], s70 offen offset:1024 sc1 lds
    buffer_load_dwordx4 v224, s[8:11], s70 offen offset:2048 sc1 lds
    buffer_load_dwordx4 v224, s[8:11], s70 offen offset:3072 sc1 lds
    s_add_u32 m0, s86, 45056
    s_add_u32 s70, s48, 0xa000
    buffer_load_dwordx4 v224, s[8:11], s70 offen offset:0 sc1 lds
    buffer_load_dwordx4 v224, s[8:11], s70 offen offset:1024 sc1 lds
    buffer_load_dwordx4 v224, s[8:11], s70 offen offset:2048 sc1 lds
    buffer_load_dwordx4 v224, s[8:11], s70 offen offset:3072 sc1 lds
    s_sub_u32 s4, s59, 0x20000
    s_waitcnt vmcnt(24)
    buffer_store_dword v253, v251, s[8:11], s4 offen sc1
    s_branch L_cur_sequential_preLN__compressed_kv_cla__geglu_ffn__prompt_kernel
L_cu2_sequential_preLN__compressed_kv_cla__geglu_ffn__prompt_kernel:
    s_add_u32 m0, s86, 53248
    s_add_u32 s70, s48, 0xb000
    buffer_load_dwordx4 v224, s[8:11], s70 offen offset:0 sc1 lds
    buffer_load_dwordx4 v224, s[8:11], s70 offen offset:1024 sc1 lds
    buffer_load_dwordx4 v224, s[8:11], s70 offen offset:2048 sc1 lds
    buffer_load_dwordx4 v224, s[8:11], s70 offen offset:3072 sc1 lds
    s_add_u32 m0, s86, 57344
    s_add_u32 s70, s48, 0xc000
    buffer_load_dwordx4 v224, s[8:11], s70 offen offset:0 sc1 lds
    buffer_load_dwordx4 v224, s[8:11], s70 offen offset:1024 sc1 lds
    buffer_load_dwordx4 v224, s[8:11], s70 offen offset:2048 sc1 lds
    buffer_load_dwordx4 v224, s[8:11], s70 offen offset:3072 sc1 lds
    s_add_u32 m0, s86, 61440
    s_add_u32 s70, s48, 0xd000
    buffer_load_dwordx4 v224, s[8:11], s70 offen offset:0 sc1 lds
    buffer_load_dwordx4 v224, s[8:11], s70 offen offset:1024 sc1 lds
    buffer_load_dwordx4 v224, s[8:11], s70 offen offset:2048 sc1 lds
    buffer_load_dwordx4 v224, s[8:11], s70 offen offset:3072 sc1 lds
    s_sub_u32 s4, s59, 0x20000
    s_waitcnt vmcnt(12)
    buffer_store_dword v253, v251, s[8:11], s4 offen sc1
    s_branch L_cur_sequential_preLN__compressed_kv_cla__geglu_ffn__prompt_kernel
L_S1x_sequential_preLN__compressed_kv_cla__geglu_ffn__prompt_kernel:
    buffer_load_dword v236, v250, s[8:11], s53 offen sc1
    s_branch L_S1_sequential_preLN__compressed_kv_cla__geglu_ffn__prompt_kernel
L_mk0_sequential_preLN__compressed_kv_cla__geglu_ffn__prompt_kernel:
    v_mov_b32 v0, -1
    v_mov_b32 v1, -1
    v_mov_b32 v2, -1
    v_mov_b32 v3, -1
    buffer_store_dwordx4 v[0:3], v224, s[8:11], s52 offen offset:0 sc1
    buffer_store_dwordx4 v[0:3], v224, s[8:11], s52 offen offset:1024 sc1
    buffer_store_dwordx4 v[0:3], v224, s[8:11], s52 offen offset:2048 sc1
    buffer_store_dwordx4 v[0:3], v224, s[8:11], s52 offen offset:3072 sc1
    buffer_store_dwordx4 v[0:3], v252, s[8:11], s52 offen offset:0 sc1
    buffer_store_dwordx4 v[0:3], v252, s[8:11], s52 offen offset:1024 sc1
    s_branch L_single_sequential_preLN__compressed_kv_cla__geglu_ffn__prompt_kernel
L_tagsp_sequential_preLN__compressed_kv_cla__geglu_ffn__prompt_kernel:
    s_mov_b32 s58, 0
L_tagsp2_sequential_preLN__compressed_kv_cla__geglu_ffn__prompt_kernel:
    s_sleep 1
    buffer_load_dwordx2 v[218:219], v221, s[36:39], 0 offen sc1
    s_waitcnt vmcnt(0)
    v_cmp_ne_u32 vcc, 1, v219
    s_add_u32 s58, s58, 1
    s_cmp_lt_u32 s58, 50000
    s_cbranch_scc0 L_tagok_sequential_preLN__compressed_kv_cla__geglu_ffn__prompt_kernel
    s_cbranch_vccnz L_tagsp2_sequential_preLN__compressed_kv_cla__geglu_ffn__prompt_kernel
    s_branch L_tagok_sequential_preLN__compressed_kv_cla__geglu_ffn__prompt_kernel
L_poll1_sequential_preLN__compressed_kv_cla__geglu_ffn__prompt_kernel:
    s_mov_b32 s58, 0
L_poll1_sequential_preLN__compressed_kv_cla__geglu_ffn__prompt_kernel_sp:
    s_sleep 1
    buffer_load_dword v218, v217, s[8:11], s6 offen sc1
    s_waitcnt vmcnt(0)
    v_cmp_ne_u32 vcc, s73, v218
    s_add_u32 s58, s58, 1
    s_cmp_lt_u32 s58, 50000
    s_cbranch_scc0 L_poll1_sequential_preLN__compressed_kv_cla__geglu_ffn__prompt_kernel_ok
    s_cbranch_vccnz L_poll1_sequential_preLN__compressed_kv_cla__geglu_ffn__prompt_kernel_sp
    s_branch L_poll1_sequential_preLN__compressed_kv_cla__geglu_ffn__prompt_kernel_ok
L_poll2_sequential_preLN__compressed_kv_cla__geglu_ffn__prompt_kernel:
    s_mov_b32 s58, 0
L_poll2_sequential_preLN__compressed_kv_cla__geglu_ffn__prompt_kernel_sp:
    s_sleep 1
    buffer_load_dword v218, v220, s[8:11], s6 offen sc1
    s_waitcnt vmcnt(0)
    v_cmp_ne_u32 vcc, s73, v218
    s_add_u32 s58, s58, 1
    s_cmp_lt_u32 s58, 50000
    s_cbranch_scc0 L_poll2_sequential_preLN__compressed_kv_cla__geglu_ffn__prompt_kernel_ok
    s_cbranch_vccnz L_poll2_sequential_preLN__compressed_kv_cla__geglu_ffn__prompt_kernel_sp
    s_branch L_poll2_sequential_preLN__compressed_kv_cla__geglu_ffn__prompt_kernel_ok
L_poll3_sequential_preLN__compressed_kv_cla__geglu_ffn__prompt_kernel:
    s_mov_b32 s58, 0
L_poll3_sequential_preLN__compressed_kv_cla__geglu_ffn__prompt_kernel_sp:
    s_sleep 1
    buffer_load_dwordx4 v[236:239], v224, s[8:11], s72 offen sc1
    s_waitcnt vmcnt(0)
    v_bitop3_b32 v236, v236, v237, s73 bitop3:0x7e
    v_bitop3_b32 v238, v238, v239, s73 bitop3:0x7e
    v_or_b32 v236, v236, v238
    v_cmp_ne_u32 vcc, 0, v236
    s_add_u32 s58, s58, 1
    s_cmp_lt_u32 s58, 50000
    s_cbranch_scc0 L_poll3_sequential_preLN__compressed_kv_cla__geglu_ffn__prompt_kernel_ok
    s_cbranch_vccnz L_poll3_sequential_preLN__compressed_kv_cla__geglu_ffn__prompt_kernel_sp
    s_branch L_poll3_sequential_preLN__compressed_kv_cla__geglu_ffn__prompt_kernel_ok
L_poll4_sequential_preLN__compressed_kv_cla__geglu_ffn__prompt_kernel:
    s_mov_b32 s58, 0
L_poll4_sequential_preLN__compressed_kv_cla__geglu_ffn__prompt_kernel_sp:
    s_sleep 1
    buffer_load_dwordx4 v[236:239], v224, s[8:11], s72 offen sc1
    s_waitcnt vmcnt(0)
    v_bitop3_b32 v236, v236, v237, s73 bitop3:0x7e
    v_bitop3_b32 v238, v238, v239, s73 bitop3:0x7e
    v_or_b32 v236, v236, v238
    v_cmp_ne_u32 vcc, 0, v236
    s_add_u32 s58, s58, 1
    s_cmp_lt_u32 s58, 50000
    s_cbranch_scc0 L_poll4_sequential_preLN__compressed_kv_cla__geglu_ffn__prompt_kernel_ok
    s_cbranch_vccnz L_poll4_sequential_preLN__compressed_kv_cla__geglu_ffn__prompt_kernel_sp
    s_branch L_poll4_sequential_preLN__compressed_kv_cla__geglu_ffn__prompt_kernel_ok
L_poll5_sequential_preLN__compressed_kv_cla__geglu_ffn__prompt_kernel:
    s_mov_b32 s58, 0
L_poll5_sequential_preLN__compressed_kv_cla__geglu_ffn__prompt_kernel_sp:
    s_sleep 1
    buffer_load_dword v236, v250, s[8:11], s53 offen sc1
    s_waitcnt vmcnt(0)
    v_cmp_ne_u32 vcc, s73, v236
    s_add_u32 s58, s58, 1
    s_cmp_lt_u32 s58, 50000
    s_cbranch_scc0 L_poll5_sequential_preLN__compressed_kv_cla__geglu_ffn__prompt_kernel_ok
    s_cbranch_vccnz L_poll5_sequential_preLN__compressed_kv_cla__geglu_ffn__prompt_kernel_sp
    s_branch L_poll5_sequential_preLN__compressed_kv_cla__geglu_ffn__prompt_kernel_ok
L_poll6_sequential_preLN__compressed_kv_cla__geglu_ffn__prompt_kernel:
    s_mov_b32 s58, 0
L_poll6_sequential_preLN__compressed_kv_cla__geglu_ffn__prompt_kernel_sp:
    s_sleep 1
    buffer_load_dword v210, v238, s[8:11], s33 offen sc1
    s_waitcnt vmcnt(0)
    v_cmp_ne_u32 vcc, s73, v210
    s_add_u32 s58, s58, 1
    s_cmp_lt_u32 s58, 50000
    s_cbranch_scc0 L_poll6_sequential_preLN__compressed_kv_cla__geglu_ffn__prompt_kernel_ok
    s_cbranch_vccnz L_poll6_sequential_preLN__compressed_kv_cla__geglu_ffn__prompt_kernel_sp
    s_branch L_poll6_sequential_preLN__compressed_kv_cla__geglu_ffn__prompt_kernel_ok
L_poll7_sequential_preLN__compressed_kv_cla__geglu_ffn__prompt_kernel:
    s_mov_b32 s58, 0
L_poll7_sequential_preLN__compressed_kv_cla__geglu_ffn__prompt_kernel_sp:
    s_sleep 1
    buffer_load_dwordx4 v[240:243], v224, s[8:11], s37 offen sc1
    s_waitcnt vmcnt(0)
    v_bitop3_b32 v240, v240, v241, s73 bitop3:0x7e
    v_bitop3_b32 v242, v242, v243, s73 bitop3:0x7e
    v_or_b32 v240, v240, v242
    v_cmp_ne_u32 vcc, 0, v240
    s_add_u32 s58, s58, 1
    s_cmp_lt_u32 s58, 50000
    s_cbranch_scc0 L_poll7_sequential_preLN__compressed_kv_cla__geglu_ffn__prompt_kernel_ok
    s_cbranch_vccnz L_poll7_sequential_preLN__compressed_kv_cla__geglu_ffn__prompt_kernel_sp
    s_branch L_poll7_sequential_preLN__compressed_kv_cla__geglu_ffn__prompt_kernel_ok
L_poll8_sequential_preLN__compressed_kv_cla__geglu_ffn__prompt_kernel:
    s_mov_b32 s58, 0
L_poll8_sequential_preLN__compressed_kv_cla__geglu_ffn__prompt_kernel_sp:
    s_sleep 1
    buffer_load_dword v212, v207, s[8:11], s39 offen sc1
    s_waitcnt vmcnt(0)
    v_cmp_ne_u32 vcc, s73, v212
    s_add_u32 s58, s58, 1
    s_cmp_lt_u32 s58, 50000
    s_cbranch_scc0 L_poll8_sequential_preLN__compressed_kv_cla__geglu_ffn__prompt_kernel_ok
    s_cbranch_vccnz L_poll8_sequential_preLN__compressed_kv_cla__geglu_ffn__prompt_kernel_sp
    s_branch L_poll8_sequential_preLN__compressed_kv_cla__geglu_ffn__prompt_kernel_ok
L_poll9_sequential_preLN__compressed_kv_cla__geglu_ffn__prompt_kernel:
    s_mov_b32 s58, 0
L_poll9_sequential_preLN__compressed_kv_cla__geglu_ffn__prompt_kernel_sp:
    s_sleep 1
    buffer_load_dword v211, v238, s[8:11], s45 offen sc1
    s_waitcnt vmcnt(0)
    v_cmp_ne_u32 vcc, s73, v211
    s_add_u32 s58, s58, 1
    s_cmp_lt_u32 s58, 50000
    s_cbranch_scc0 L_poll9_sequential_preLN__compressed_kv_cla__geglu_ffn__prompt_kernel_ok
    s_cbranch_vccnz L_poll9_sequential_preLN__compressed_kv_cla__geglu_ffn__prompt_kernel_sp
    s_branch L_poll9_sequential_preLN__compressed_kv_cla__geglu_ffn__prompt_kernel_ok
L_px0_sequential_preLN__compressed_kv_cla__geglu_ffn__prompt_kernel:
    s_mov_b32 s58, 0
L_px0_sequential_preLN__compressed_kv_cla__geglu_ffn__prompt_kernel_sp:
    buffer_load_dwordx4 v[128:131], v224, s[8:11], s92 offen offset:0 sc1
    buffer_load_dwordx4 v[132:135], v224, s[8:11], s92 offen offset:1024 sc1
    buffer_load_dwordx4 v[136:139], v224, s[8:11], s93 offen offset:0 sc1
    buffer_load_dwordx4 v[140:143], v224, s[8:11], s93 offen offset:1024 sc1
    buffer_load_dwordx4 v[144:147], v224, s[8:11], s94 offen offset:0 sc1
    buffer_load_dwordx4 v[148:151], v224, s[8:11], s94 offen offset:1024 sc1
    s_waitcnt vmcnt(0)
    v_max3_u32 v216, v128, v132, v136
    v_max3_u32 v217, v140, v144, v148
    v_max_u32 v216, v216, v217
    v_cmp_eq_u32 vcc, -1, v216
    s_add_u32 s58, s58, 1
    s_cmp_lt_u32 s58, 50000
    s_cbranch_scc0 L_px0_sequential_preLN__compressed_kv_cla__geglu_ffn__prompt_kernel_ok
    s_cbranch_vccnz L_px0_sequential_preLN__compressed_kv_cla__geglu_ffn__prompt_kernel_sp
    s_branch L_px0_sequential_preLN__compressed_kv_cla__geglu_ffn__prompt_kernel_ok
L_poll10_sequential_preLN__compressed_kv_cla__geglu_ffn__prompt_kernel:
    s_mov_b32 s58, 0
L_poll10_sequential_preLN__compressed_kv_cla__geglu_ffn__prompt_kernel_sp:
    s_sleep 1
    buffer_load_dword v250, v248, s[8:11], s6 offen sc1
    s_waitcnt vmcnt(0)
    v_cmp_ne_u32 vcc, s73, v250
    s_add_u32 s58, s58, 1
    s_cmp_lt_u32 s58, 50000
    s_cbranch_scc0 L_poll10_sequential_preLN__compressed_kv_cla__geglu_ffn__prompt_kernel_ok
    s_cbranch_vccnz L_poll10_sequential_preLN__compressed_kv_cla__geglu_ffn__prompt_kernel_sp
    s_branch L_poll10_sequential_preLN__compressed_kv_cla__geglu_ffn__prompt_kernel_ok
L_poll12_sequential_preLN__compressed_kv_cla__geglu_ffn__prompt_kernel:
    s_mov_b32 s58, 0
L_poll12_sequential_preLN__compressed_kv_cla__geglu_ffn__prompt_kernel_sp:
    s_sleep 1
    buffer_load_dword v238, v248, s[8:11], s6 offen sc1
    s_waitcnt vmcnt(0)
    v_cmp_ne_u32 vcc, s73, v238
    s_add_u32 s58, s58, 1
    s_cmp_lt_u32 s58, 50000
    s_cbranch_scc0 L_poll12_sequential_preLN__compressed_kv_cla__geglu_ffn__prompt_kernel_ok
    s_cbranch_vccnz L_poll12_sequential_preLN__compressed_kv_cla__geglu_ffn__prompt_kernel_sp
    s_branch L_poll12_sequential_preLN__compressed_kv_cla__geglu_ffn__prompt_kernel_ok
L_poll11_sequential_preLN__compressed_kv_cla__geglu_ffn__prompt_kernel:
    s_mov_b32 s58, 0
L_poll11_sequential_preLN__compressed_kv_cla__geglu_ffn__prompt_kernel_sp:
    s_sleep 1
    buffer_load_dword v250, v248, s[8:11], s7 offen sc1
    s_waitcnt vmcnt(0)
    v_cmp_ne_u32 vcc, s73, v250
    s_add_u32 s58, s58, 1
    s_cmp_lt_u32 s58, 50000
    s_cbranch_scc0 L_poll11_sequential_preLN__compressed_kv_cla__geglu_ffn__prompt_kernel_ok
    s_cbranch_vccnz L_poll11_sequential_preLN__compressed_kv_cla__geglu_ffn__prompt_kernel_sp
    s_branch L_poll11_sequential_preLN__compressed_kv_cla__geglu_ffn__prompt_kernel_ok
L_redoA_sequential_preLN__compressed_kv_cla__geglu_ffn__prompt_kernel:
    s_nop 7
    s_nop 7
    v_mov_b32 v230, v229
    v_mov_b32 v225, 0
    s_mov_b32 s82, 0
    v_mov_b32 v64, 0
    v_mov_b32 v65, 0
    v_mov_b32 v66, 0
    v_mov_b32 v67, 0
    v_mov_b32 v68, 0
    v_mov_b32 v69, 0
    v_mov_b32 v70, 0
    v_mov_b32 v71, 0
    v_mov_b32 v72, 0
    v_mov_b32 v73, 0
    v_mov_b32 v74, 0
    v_mov_b32 v75, 0
    v_mov_b32 v76, 0
    v_mov_b32 v77, 0
    v_mov_b32 v78, 0
    v_mov_b32 v79, 0
    v_mov_b32 v80, 0
    v_mov_b32 v81, 0
    v_mov_b32 v82, 0
    v_mov_b32 v83, 0
    v_mov_b32 v84, 0
    v_mov_b32 v85, 0
    v_mov_b32 v86, 0
    v_mov_b32 v87, 0
    v_mov_b32 v88, 0
    v_mov_b32 v89, 0
    v_mov_b32 v90, 0
    v_mov_b32 v91, 0
    v_mov_b32 v92, 0
    v_mov_b32 v93, 0
    v_mov_b32 v94, 0
    v_mov_b32 v95, 0
    v_mov_b32 v96, 0
    v_mov_b32 v97, 0
    v_mov_b32 v98, 0
    v_mov_b32 v99, 0
    v_mov_b32 v100, 0
    v_mov_b32 v101, 0
    v_mov_b32 v102, 0
    v_mov_b32 v103, 0
    v_mov_b32 v104, 0
    v_mov_b32 v105, 0
    v_mov_b32 v106, 0
    v_mov_b32 v107, 0
    v_mov_b32 v108, 0
    v_mov_b32 v109, 0
    v_mov_b32 v110, 0
    v_mov_b32 v111, 0
    v_mov_b32 v112, 0
    v_mov_b32 v113, 0
    v_mov_b32 v114, 0
    v_mov_b32 v115, 0
    v_mov_b32 v116, 0
    v_mov_b32 v117, 0
    v_mov_b32 v118, 0
    v_mov_b32 v119, 0
    v_mov_b32 v120, 0
    v_mov_b32 v121, 0
    v_mov_b32 v122, 0
    v_mov_b32 v123, 0
    v_mov_b32 v124, 0
    v_mov_b32 v125, 0
    v_mov_b32 v126, 0
    v_mov_b32 v127, 0
L_redo1A_sequential_preLN__compressed_kv_cla__geglu_ffn__prompt_kernel:
    s_lshr_b32 s83, s82, 1
    s_mul_i32 s83, s83, 33792
    s_and_b32 s84, s82, 1
    s_lshl_b32 s84, s84, 13
    s_add_u32 s83, s83, s84
    s_add_u32 s83, s83, 0
    s_add_u32 s84, s83, 4096
    buffer_load_dwordx4 a[96:99], v224, s[12:15], s83 offen offset:0 sc1
    buffer_load_dwordx4 a[100:103], v224, s[12:15], s83 offen offset:1024 sc1
    buffer_load_dwordx4 a[104:107], v224, s[12:15], s83 offen offset:2048 sc1
    buffer_load_dwordx4 a[108:111], v224, s[12:15], s83 offen offset:3072 sc1
    buffer_load_dwordx4 a[112:115], v224, s[12:15], s84 offen offset:0 sc1
    buffer_load_dwordx4 a[116:119], v224, s[12:15], s84 offen offset:1024 sc1
    buffer_load_dwordx4 a[120:123], v224, s[12:15], s84 offen offset:2048 sc1
    buffer_load_dwordx4 a[124:127], v224, s[12:15], s84 offen offset:3072 sc1
    s_waitcnt vmcnt(0)
    v_mfma_f32_32x32x16_bf16 v[0:15], a[96:99], a[0:3], 0
    v_mfma_f32_32x32x16_bf16 v[0:15], a[100:103], a[4:7], v[0:15]
    v_mfma_f32_32x32x16_bf16 v[0:15], a[104:107], a[8:11], v[0:15]
    v_mfma_f32_32x32x16_bf16 v[0:15], a[108:111], a[12:15], v[0:15]
    v_mfma_f32_32x32x16_bf16 v[0:15], a[112:115], a[16:19], v[0:15]
    v_mfma_f32_32x32x16_bf16 v[0:15], a[116:119], a[20:23], v[0:15]
    v_mfma_f32_32x32x16_bf16 v[0:15], a[120:123], a[24:27], v[0:15]
    v_mfma_f32_32x32x16_bf16 v[0:15], a[124:127], a[28:31], v[0:15]
    s_nop 7
    s_nop 7
    s_cmp_lg_u32 s82, s80
    s_cbranch_scc1 L_redo1mA_sequential_preLN__compressed_kv_cla__geglu_ffn__prompt_kernel
    v_cndmask_b32 v0, v0, v229, s[16:17]
    v_cndmask_b32 v1, v1, v229, s[18:19]
    v_cndmask_b32 v2, v2, v229, s[20:21]
    v_cndmask_b32 v3, v3, v229, s[22:23]
    v_cndmask_b32 v4, v4, v229, s[24:25]
    v_cndmask_b32 v5, v5, v229, s[26:27]
    v_cndmask_b32 v6, v6, v229, s[28:29]
    v_cndmask_b32 v7, v7, v229, s[30:31]
    v_cndmask_b32 v8, v8, v229, s[32:33]
    v_cndmask_b32 v9, v9, v229, s[34:35]
    v_cndmask_b32 v10, v10, v229, s[36:37]
    v_cndmask_b32 v11, v11, v229, s[38:39]
    v_cndmask_b32 v12, v12, v229, s[40:41]
    v_cndmask_b32 v13, v13, v229, s[42:43]
    v_cndmask_b32 v14, v14, v229, s[44:45]
    v_cndmask_b32 v15, v15, v229, s[46:47]
L_redo1mA_sequential_preLN__compressed_kv_cla__geglu_ffn__prompt_kernel:
    v_max3_f32 v230, v230, v0, v1
    v_max3_f32 v230, v230, v2, v3
    v_max3_f32 v230, v230, v4, v5
    v_max3_f32 v230, v230, v6, v7
    v_max3_f32 v230, v230, v8, v9
    v_max3_f32 v230, v230, v10, v11
    v_max3_f32 v230, v230, v12, v13
    v_max3_f32 v230, v230, v14, v15
    s_add_u32 s82, s82, 1
    s_cmp_le_u32 s82, s80
    s_cbranch_scc1 L_redo1A_sequential_preLN__compressed_kv_cla__geglu_ffn__prompt_kernel
    v_mov_b32 v232, v230
    s_nop 1
    v_permlane32_swap_b32 v232, v230
    s_nop 1
    v_max_f32 v230, v230, v232
    v_sub_f32 v230, 0, v230
    s_mov_b32 s82, 0
    v_mov_b32 v192, v230
    v_mov_b32 v193, v230
    v_mov_b32 v194, v230
    v_mov_b32 v195, v230
    v_mov_b32 v196, v230
    v_mov_b32 v197, v230
    v_mov_b32 v198, v230
    v_mov_b32 v199, v230
    v_mov_b32 v200, v230
    v_mov_b32 v201, v230
    v_mov_b32 v202, v230
    v_mov_b32 v203, v230
    v_mov_b32 v204, v230
    v_mov_b32 v205, v230
    v_mov_b32 v206, v230
    v_mov_b32 v207, v230
L_redo2A_sequential_preLN__compressed_kv_cla__geglu_ffn__prompt_kernel:
    s_lshr_b32 s83, s82, 1
    s_mul_i32 s83, s83, 33792
    s_and_b32 s84, s82, 1
    s_lshl_b32 s84, s84, 13
    s_add_u32 s83, s83, s84
    s_add_u32 s83, s83, 0
    s_add_u32 s84, s83, 4096
    buffer_load_dwordx4 a[96:99], v224, s[12:15], s83 offen offset:0 sc1
    buffer_load_dwordx4 a[100:103], v224, s[12:15], s83 offen offset:1024 sc1
    buffer_load_dwordx4 a[104:107], v224, s[12:15], s83 offen offset:2048 sc1
    buffer_load_dwordx4 a[108:111], v224, s[12:15], s83 offen offset:3072 sc1
    buffer_load_dwordx4 a[112:115], v224, s[12:15], s84 offen offset:0 sc1
    buffer_load_dwordx4 a[116:119], v224, s[12:15], s84 offen offset:1024 sc1
    buffer_load_dwordx4 a[120:123], v224, s[12:15], s84 offen offset:2048 sc1
    buffer_load_dwordx4 a[124:127], v224, s[12:15], s84 offen offset:3072 sc1
    s_waitcnt vmcnt(0)
    v_mfma_f32_32x32x16_bf16 v[0:15], a[96:99], a[0:3], v[192:207]
    v_mfma_f32_32x32x16_bf16 v[0:15], a[100:103], a[4:7], v[0:15]
    v_mfma_f32_32x32x16_bf16 v[0:15], a[104:107], a[8:11], v[0:15]
    v_mfma_f32_32x32x16_bf16 v[0:15], a[108:111], a[12:15], v[0:15]
    v_mfma_f32_32x32x16_bf16 v[0:15], a[112:115], a[16:19], v[0:15]
    v_mfma_f32_32x32x16_bf16 v[0:15], a[116:119], a[20:23], v[0:15]
    v_mfma_f32_32x32x16_bf16 v[0:15], a[120:123], a[24:27], v[0:15]
    v_mfma_f32_32x32x16_bf16 v[0:15], a[124:127], a[28:31], v[0:15]
    s_nop 7
    s_nop 7
    s_cmp_lg_u32 s82, s80
    s_cbranch_scc1 L_redo2mA_sequential_preLN__compressed_kv_cla__geglu_ffn__prompt_kernel
    v_cndmask_b32 v0, v0, v229, s[16:17]
    v_cndmask_b32 v1, v1, v229, s[18:19]
    v_cndmask_b32 v2, v2, v229, s[20:21]
    v_cndmask_b32 v3, v3, v229, s[22:23]
    v_cndmask_b32 v4, v4, v229, s[24:25]
    v_cndmask_b32 v5, v5, v229, s[26:27]
    v_cndmask_b32 v6, v6, v229, s[28:29]
    v_cndmask_b32 v7, v7, v229, s[30:31]
    v_cndmask_b32 v8, v8, v229, s[32:33]
    v_cndmask_b32 v9, v9, v229, s[34:35]
    v_cndmask_b32 v10, v10, v229, s[36:37]
    v_cndmask_b32 v11, v11, v229, s[38:39]
    v_cndmask_b32 v12, v12, v229, s[40:41]
    v_cndmask_b32 v13, v13, v229, s[42:43]
    v_cndmask_b32 v14, v14, v229, s[44:45]
    v_cndmask_b32 v15, v15, v229, s[46:47]
L_redo2mA_sequential_preLN__compressed_kv_cla__geglu_ffn__prompt_kernel:
    v_exp_f32 v0, v0
    v_exp_f32 v1, v1
    v_exp_f32 v2, v2
    v_exp_f32 v3, v3
    v_exp_f32 v4, v4
    v_exp_f32 v5, v5
    v_exp_f32 v6, v6
    v_exp_f32 v7, v7
    v_exp_f32 v8, v8
    v_exp_f32 v9, v9
    v_exp_f32 v10, v10
    v_exp_f32 v11, v11
    v_exp_f32 v12, v12
    v_exp_f32 v13, v13
    v_exp_f32 v14, v14
    v_exp_f32 v15, v15
    s_nop 1
    v_add_f32 v225, v225, v0
    v_add_f32 v225, v225, v1
    v_add_f32 v225, v225, v2
    v_add_f32 v225, v225, v3
    v_add_f32 v225, v225, v4
    v_add_f32 v225, v225, v5
    v_add_f32 v225, v225, v6
    v_add_f32 v225, v225, v7
    v_add_f32 v225, v225, v8
    v_add_f32 v225, v225, v9
    v_add_f32 v225, v225, v10
    v_add_f32 v225, v225, v11
    v_add_f32 v225, v225, v12
    v_add_f32 v225, v225, v13
    v_add_f32 v225, v225, v14
    v_add_f32 v225, v225, v15
    v_cvt_pk_bf16_f32 v0, v0, v1
    v_cvt_pk_bf16_f32 v1, v2, v3
    v_cvt_pk_bf16_f32 v2, v4, v5
    v_cvt_pk_bf16_f32 v3, v6, v7
    v_cvt_pk_bf16_f32 v8, v8, v9
    v_cvt_pk_bf16_f32 v9, v10, v11
    v_cvt_pk_bf16_f32 v10, v12, v13
    v_cvt_pk_bf16_f32 v11, v14, v15
    s_lshr_b32 s83, s82, 1
    s_mul_i32 s83, s83, 33792
    s_and_b32 s84, s82, 1
    s_lshl_b32 s84, s84, 13
    s_add_u32 s83, s83, s84
    s_add_u32 s83, s83, 16384
    s_add_u32 s84, s83, 4096
    buffer_load_dwordx4 a[96:99], v224, s[12:15], s83 offen offset:0 sc1
    buffer_load_dwordx4 a[100:103], v224, s[12:15], s83 offen offset:1024 sc1
    buffer_load_dwordx4 a[104:107], v224, s[12:15], s83 offen offset:2048 sc1
    buffer_load_dwordx4 a[108:111], v224, s[12:15], s83 offen offset:3072 sc1
    buffer_load_dwordx4 a[112:115], v224, s[12:15], s84 offen offset:0 sc1
    buffer_load_dwordx4 a[116:119], v224, s[12:15], s84 offen offset:1024 sc1
    buffer_load_dwordx4 a[120:123], v224, s[12:15], s84 offen offset:2048 sc1
    buffer_load_dwordx4 a[124:127], v224, s[12:15], s84 offen offset:3072 sc1
    s_waitcnt vmcnt(0)
    v_mfma_f32_32x32x16_bf16 v[64:79], a[96:99], v[0:3], v[64:79]
    v_mfma_f32_32x32x16_bf16 v[80:95], a[100:103], v[0:3], v[80:95]
    v_mfma_f32_32x32x16_bf16 v[96:111], a[104:107], v[0:3], v[96:111]
    v_mfma_f32_32x32x16_bf16 v[112:127], a[108:111], v[0:3], v[112:127]
    v_mfma_f32_32x32x16_bf16 v[64:79], a[112:115], v[8:11], v[64:79]
    v_mfma_f32_32x32x16_bf16 v[80:95], a[116:119], v[8:11], v[80:95]
    v_mfma_f32_32x32x16_bf16 v[96:111], a[120:123], v[8:11], v[96:111]
    v_mfma_f32_32x32x16_bf16 v[112:127], a[124:127], v[8:11], v[112:127]
    s_nop 7
    s_nop 7
    s_add_u32 s82, s82, 1
    s_cmp_le_u32 s82, s80
    s_cbranch_scc1 L_redo2A_sequential_preLN__compressed_kv_cla__geglu_ffn__prompt_kernel
    v_mov_b32 v232, v225
    s_nop 1
    v_permlane32_swap_b32 v232, v225
    s_nop 1
    v_add_f32 v225, v225, v232
    v_rcp_f32 v232, v225
    s_nop 1
    s_branch L_redoneA_sequential_preLN__compressed_kv_cla__geglu_ffn__prompt_kernel
L_redoB_sequential_preLN__compressed_kv_cla__geglu_ffn__prompt_kernel:
    s_nop 7
    s_nop 7
    v_mov_b32 v231, v229
    v_mov_b32 v226, 0
    s_mov_b32 s82, 0
    v_mov_b32 v128, 0
    v_mov_b32 v129, 0
    v_mov_b32 v130, 0
    v_mov_b32 v131, 0
    v_mov_b32 v132, 0
    v_mov_b32 v133, 0
    v_mov_b32 v134, 0
    v_mov_b32 v135, 0
    v_mov_b32 v136, 0
    v_mov_b32 v137, 0
    v_mov_b32 v138, 0
    v_mov_b32 v139, 0
    v_mov_b32 v140, 0
    v_mov_b32 v141, 0
    v_mov_b32 v142, 0
    v_mov_b32 v143, 0
    v_mov_b32 v144, 0
    v_mov_b32 v145, 0
    v_mov_b32 v146, 0
    v_mov_b32 v147, 0
    v_mov_b32 v148, 0
    v_mov_b32 v149, 0
    v_mov_b32 v150, 0
    v_mov_b32 v151, 0
    v_mov_b32 v152, 0
    v_mov_b32 v153, 0
    v_mov_b32 v154, 0
    v_mov_b32 v155, 0
    v_mov_b32 v156, 0
    v_mov_b32 v157, 0
    v_mov_b32 v158, 0
    v_mov_b32 v159, 0
    v_mov_b32 v160, 0
    v_mov_b32 v161, 0
    v_mov_b32 v162, 0
    v_mov_b32 v163, 0
    v_mov_b32 v164, 0
    v_mov_b32 v165, 0
    v_mov_b32 v166, 0
    v_mov_b32 v167, 0
    v_mov_b32 v168, 0
    v_mov_b32 v169, 0
    v_mov_b32 v170, 0
    v_mov_b32 v171, 0
    v_mov_b32 v172, 0
    v_mov_b32 v173, 0
    v_mov_b32 v174, 0
    v_mov_b32 v175, 0
    v_mov_b32 v176, 0
    v_mov_b32 v177, 0
    v_mov_b32 v178, 0
    v_mov_b32 v179, 0
    v_mov_b32 v180, 0
    v_mov_b32 v181, 0
    v_mov_b32 v182, 0
    v_mov_b32 v183, 0
    v_mov_b32 v184, 0
    v_mov_b32 v185, 0
    v_mov_b32 v186, 0
    v_mov_b32 v187, 0
    v_mov_b32 v188, 0
    v_mov_b32 v189, 0
    v_mov_b32 v190, 0
    v_mov_b32 v191, 0
L_redo1B_sequential_preLN__compressed_kv_cla__geglu_ffn__prompt_kernel:
    s_lshr_b32 s83, s82, 1
    s_mul_i32 s83, s83, 33792
    s_and_b32 s84, s82, 1
    s_lshl_b32 s84, s84, 13
    s_add_u32 s83, s83, s84
    s_add_u32 s83, s83, 0
    s_add_u32 s84, s83, 4096
    buffer_load_dwordx4 a[96:99], v224, s[12:15], s83 offen offset:0 sc1
    buffer_load_dwordx4 a[100:103], v224, s[12:15], s83 offen offset:1024 sc1
    buffer_load_dwordx4 a[104:107], v224, s[12:15], s83 offen offset:2048 sc1
    buffer_load_dwordx4 a[108:111], v224, s[12:15], s83 offen offset:3072 sc1
    buffer_load_dwordx4 a[112:115], v224, s[12:15], s84 offen offset:0 sc1
    buffer_load_dwordx4 a[116:119], v224, s[12:15], s84 offen offset:1024 sc1
    buffer_load_dwordx4 a[120:123], v224, s[12:15], s84 offen offset:2048 sc1
    buffer_load_dwordx4 a[124:127], v224, s[12:15], s84 offen offset:3072 sc1
    s_waitcnt vmcnt(0)
    v_mfma_f32_32x32x16_bf16 v[32:47], a[96:99], a[32:35], 0
    v_mfma_f32_32x32x16_bf16 v[32:47], a[100:103], a[36:39], v[32:47]
    v_mfma_f32_32x32x16_bf16 v[32:47], a[104:107], a[40:43], v[32:47]
    v_mfma_f32_32x32x16_bf16 v[32:47], a[108:111], a[44:47], v[32:47]
    v_mfma_f32_32x32x16_bf16 v[32:47], a[112:115], a[48:51], v[32:47]
    v_mfma_f32_32x32x16_bf16 v[32:47], a[116:119], a[52:55], v[32:47]
    v_mfma_f32_32x32x16_bf16 v[32:47], a[120:123], a[56:59], v[32:47]
    v_mfma_f32_32x32x16_bf16 v[32:47], a[124:127], a[60:63], v[32:47]
    s_nop 7
    s_nop 7
    s_cmp_lg_u32 s82, s81
    s_cbranch_scc1 L_redo1mB_sequential_preLN__compressed_kv_cla__geglu_ffn__prompt_kernel
    v_cndmask_b32 v32, v32, v229, s[16:17]
    v_cndmask_b32 v33, v33, v229, s[18:19]
    v_cndmask_b32 v34, v34, v229, s[20:21]
    v_cndmask_b32 v35, v35, v229, s[22:23]
    v_cndmask_b32 v36, v36, v229, s[24:25]
    v_cndmask_b32 v37, v37, v229, s[26:27]
    v_cndmask_b32 v38, v38, v229, s[28:29]
    v_cndmask_b32 v39, v39, v229, s[30:31]
    v_cndmask_b32 v40, v40, v229, s[32:33]
    v_cndmask_b32 v41, v41, v229, s[34:35]
    v_cndmask_b32 v42, v42, v229, s[36:37]
    v_cndmask_b32 v43, v43, v229, s[38:39]
    v_cndmask_b32 v44, v44, v229, s[40:41]
    v_cndmask_b32 v45, v45, v229, s[42:43]
    v_cndmask_b32 v46, v46, v229, s[44:45]
    v_cndmask_b32 v47, v47, v229, s[46:47]
L_redo1mB_sequential_preLN__compressed_kv_cla__geglu_ffn__prompt_kernel:
    v_max3_f32 v231, v231, v32, v33
    v_max3_f32 v231, v231, v34, v35
    v_max3_f32 v231, v231, v36, v37
    v_max3_f32 v231, v231, v38, v39
    v_max3_f32 v231, v231, v40, v41
    v_max3_f32 v231, v231, v42, v43
    v_max3_f32 v231, v231, v44, v45
    v_max3_f32 v231, v231, v46, v47
    s_add_u32 s82, s82, 1
    s_cmp_le_u32 s82, s81
    s_cbranch_scc1 L_redo1B_sequential_preLN__compressed_kv_cla__geglu_ffn__prompt_kernel
    v_mov_b32 v232, v231
    s_nop 1
    v_permlane32_swap_b32 v232, v231
    s_nop 1
    v_max_f32 v231, v231, v232
    v_sub_f32 v231, 0, v231
    s_mov_b32 s82, 0
    v_mov_b32 v208, v231
    v_mov_b32 v209, v231
    v_mov_b32 v210, v231
    v_mov_b32 v211, v231
    v_mov_b32 v212, v231
    v_mov_b32 v213, v231
    v_mov_b32 v214, v231
    v_mov_b32 v215, v231
    v_mov_b32 v216, v231
    v_mov_b32 v217, v231
    v_mov_b32 v218, v231
    v_mov_b32 v219, v231
    v_mov_b32 v220, v231
    v_mov_b32 v221, v231
    v_mov_b32 v222, v231
    v_mov_b32 v223, v231
L_redo2B_sequential_preLN__compressed_kv_cla__geglu_ffn__prompt_kernel:
    s_lshr_b32 s83, s82, 1
    s_mul_i32 s83, s83, 33792
    s_and_b32 s84, s82, 1
    s_lshl_b32 s84, s84, 13
    s_add_u32 s83, s83, s84
    s_add_u32 s83, s83, 0
    s_add_u32 s84, s83, 4096
    buffer_load_dwordx4 a[96:99], v224, s[12:15], s83 offen offset:0 sc1
    buffer_load_dwordx4 a[100:103], v224, s[12:15], s83 offen offset:1024 sc1
    buffer_load_dwordx4 a[104:107], v224, s[12:15], s83 offen offset:2048 sc1
    buffer_load_dwordx4 a[108:111], v224, s[12:15], s83 offen offset:3072 sc1
    buffer_load_dwordx4 a[112:115], v224, s[12:15], s84 offen offset:0 sc1
    buffer_load_dwordx4 a[116:119], v224, s[12:15], s84 offen offset:1024 sc1
    buffer_load_dwordx4 a[120:123], v224, s[12:15], s84 offen offset:2048 sc1
    buffer_load_dwordx4 a[124:127], v224, s[12:15], s84 offen offset:3072 sc1
    s_waitcnt vmcnt(0)
    v_mfma_f32_32x32x16_bf16 v[32:47], a[96:99], a[32:35], v[208:223]
    v_mfma_f32_32x32x16_bf16 v[32:47], a[100:103], a[36:39], v[32:47]
    v_mfma_f32_32x32x16_bf16 v[32:47], a[104:107], a[40:43], v[32:47]
    v_mfma_f32_32x32x16_bf16 v[32:47], a[108:111], a[44:47], v[32:47]
    v_mfma_f32_32x32x16_bf16 v[32:47], a[112:115], a[48:51], v[32:47]
    v_mfma_f32_32x32x16_bf16 v[32:47], a[116:119], a[52:55], v[32:47]
    v_mfma_f32_32x32x16_bf16 v[32:47], a[120:123], a[56:59], v[32:47]
    v_mfma_f32_32x32x16_bf16 v[32:47], a[124:127], a[60:63], v[32:47]
    s_nop 7
    s_nop 7
    s_cmp_lg_u32 s82, s81
    s_cbranch_scc1 L_redo2mB_sequential_preLN__compressed_kv_cla__geglu_ffn__prompt_kernel
    v_cndmask_b32 v32, v32, v229, s[16:17]
    v_cndmask_b32 v33, v33, v229, s[18:19]
    v_cndmask_b32 v34, v34, v229, s[20:21]
    v_cndmask_b32 v35, v35, v229, s[22:23]
    v_cndmask_b32 v36, v36, v229, s[24:25]
    v_cndmask_b32 v37, v37, v229, s[26:27]
    v_cndmask_b32 v38, v38, v229, s[28:29]
    v_cndmask_b32 v39, v39, v229, s[30:31]
    v_cndmask_b32 v40, v40, v229, s[32:33]
    v_cndmask_b32 v41, v41, v229, s[34:35]
    v_cndmask_b32 v42, v42, v229, s[36:37]
    v_cndmask_b32 v43, v43, v229, s[38:39]
    v_cndmask_b32 v44, v44, v229, s[40:41]
    v_cndmask_b32 v45, v45, v229, s[42:43]
    v_cndmask_b32 v46, v46, v229, s[44:45]
    v_cndmask_b32 v47, v47, v229, s[46:47]
L_redo2mB_sequential_preLN__compressed_kv_cla__geglu_ffn__prompt_kernel:
    v_exp_f32 v32, v32
    v_exp_f32 v33, v33
    v_exp_f32 v34, v34
    v_exp_f32 v35, v35
    v_exp_f32 v36, v36
    v_exp_f32 v37, v37
    v_exp_f32 v38, v38
    v_exp_f32 v39, v39
    v_exp_f32 v40, v40
    v_exp_f32 v41, v41
    v_exp_f32 v42, v42
    v_exp_f32 v43, v43
    v_exp_f32 v44, v44
    v_exp_f32 v45, v45
    v_exp_f32 v46, v46
    v_exp_f32 v47, v47
    s_nop 1
    v_add_f32 v226, v226, v32
    v_add_f32 v226, v226, v33
    v_add_f32 v226, v226, v34
    v_add_f32 v226, v226, v35
    v_add_f32 v226, v226, v36
    v_add_f32 v226, v226, v37
    v_add_f32 v226, v226, v38
    v_add_f32 v226, v226, v39
    v_add_f32 v226, v226, v40
    v_add_f32 v226, v226, v41
    v_add_f32 v226, v226, v42
    v_add_f32 v226, v226, v43
    v_add_f32 v226, v226, v44
    v_add_f32 v226, v226, v45
    v_add_f32 v226, v226, v46
    v_add_f32 v226, v226, v47
    v_cvt_pk_bf16_f32 v32, v32, v33
    v_cvt_pk_bf16_f32 v33, v34, v35
    v_cvt_pk_bf16_f32 v34, v36, v37
    v_cvt_pk_bf16_f32 v35, v38, v39
    v_cvt_pk_bf16_f32 v40, v40, v41
    v_cvt_pk_bf16_f32 v41, v42, v43
    v_cvt_pk_bf16_f32 v42, v44, v45
    v_cvt_pk_bf16_f32 v43, v46, v47
    s_lshr_b32 s83, s82, 1
    s_mul_i32 s83, s83, 33792
    s_and_b32 s84, s82, 1
    s_lshl_b32 s84, s84, 13
    s_add_u32 s83, s83, s84
    s_add_u32 s83, s83, 16384
    s_add_u32 s84, s83, 4096
    buffer_load_dwordx4 a[96:99], v224, s[12:15], s83 offen offset:0 sc1
    buffer_load_dwordx4 a[100:103], v224, s[12:15], s83 offen offset:1024 sc1
    buffer_load_dwordx4 a[104:107], v224, s[12:15], s83 offen offset:2048 sc1
    buffer_load_dwordx4 a[108:111], v224, s[12:15], s83 offen offset:3072 sc1
    buffer_load_dwordx4 a[112:115], v224, s[12:15], s84 offen offset:0 sc1
    buffer_load_dwordx4 a[116:119], v224, s[12:15], s84 offen offset:1024 sc1
    buffer_load_dwordx4 a[120:123], v224, s[12:15], s84 offen offset:2048 sc1
    buffer_load_dwordx4 a[124:127], v224, s[12:15], s84 offen offset:3072 sc1
    s_waitcnt vmcnt(0)
    v_mfma_f32_32x32x16_bf16 v[128:143], a[96:99], v[32:35], v[128:143]
    v_mfma_f32_32x32x16_bf16 v[144:159], a[100:103], v[32:35], v[144:159]
    v_mfma_f32_32x32x16_bf16 v[160:175], a[104:107], v[32:35], v[160:175]
    v_mfma_f32_32x32x16_bf16 v[176:191], a[108:111], v[32:35], v[176:191]
    v_mfma_f32_32x32x16_bf16 v[128:143], a[112:115], v[40:43], v[128:143]
    v_mfma_f32_32x32x16_bf16 v[144:159], a[116:119], v[40:43], v[144:159]
    v_mfma_f32_32x32x16_bf16 v[160:175], a[120:123], v[40:43], v[160:175]
    v_mfma_f32_32x32x16_bf16 v[176:191], a[124:127], v[40:43], v[176:191]
    s_nop 7
    s_nop 7
    s_add_u32 s82, s82, 1
    s_cmp_le_u32 s82, s81
    s_cbranch_scc1 L_redo2B_sequential_preLN__compressed_kv_cla__geglu_ffn__prompt_kernel
    v_mov_b32 v232, v226
    s_nop 1
    v_permlane32_swap_b32 v232, v226
    s_nop 1
    v_add_f32 v226, v226, v232
    v_rcp_f32 v232, v226
    s_nop 1
    s_branch L_redoneB_sequential_preLN__compressed_kv_cla__geglu_ffn__prompt_kernel
L_codeend_sequential_preLN__compressed_kv_cla__geglu_ffn__prompt_kernel:

.section .rodata,"a"
.p2align 6
.amdhsa_kernel sequential_preLN__compressed_kv_cla__geglu_ffn__prompt_kernel
  .amdhsa_next_free_vgpr 512
  .amdhsa_next_free_sgpr 102
  .amdhsa_accum_offset 256
  .amdhsa_group_segment_fixed_size 0
  .amdhsa_kernarg_size 104
  .amdhsa_user_sgpr_count 2
  .amdhsa_user_sgpr_kernarg_segment_ptr 1
  .amdhsa_system_sgpr_workgroup_id_x 1
  .amdhsa_float_denorm_mode_32 3
.end_amdhsa_kernel
.text
```
